```python
import torch

def _softmax(x, axis=-1):
    return torch.softmax(x, dim=axis)
def _gelu(x):
    return torch.nn.functional.gelu(x, approximate="tanh")
def _silu(x):
    return torch.nn.functional.silu(x)
def _sigmoid(x):
    return torch.sigmoid(x)
def _layernorm(x, axis=-1, eps=1e-5):
    m = x.mean(dim=axis, keepdim=True)
    v = x.var(dim=axis, keepdim=True, unbiased=False)
    return (x - m) / torch.sqrt(v + eps)
def _scatter_add(tgt, idx, src, axis=0):
    return tgt.clone().index_add_(axis, idx, src)
def _segment_sum(src, seg, n):
    out = torch.zeros((n,) + src.shape[1:], dtype=src.dtype)
    return out.index_add_(0, seg, src)
def _pad(x, pw):
    flat = tuple(v for pair in reversed(pw) for v in pair)
    return torch.nn.functional.pad(x, flat)

kernel_name = 'sequential_preLN__linear_attn_block__mixer_s_mlp__prompt'

def setup_inputs():

    _w = (lambda a: (lambda t: t.to(torch.bfloat16) if t.is_floating_point() else t)(torch.as_tensor(a)))
    def _A_setup():
        B, S, D = 1, 2048, 640
        return {
            "x": _w((lambda *s: torch.randn(*s, dtype=torch.bfloat16) * 0.05)(B, S, D)),
            "wqkv": _w((lambda *s: torch.randn(*s, dtype=torch.bfloat16) * 0.05)(D, 3 * D)),
            "wo": _w((lambda *s: torch.randn(*s, dtype=torch.bfloat16) * 0.05)(D, D)),
        }
    _A_in = _A_setup()

    def _B_setup():
        B, S, D, F = 1, 2048, 640, 1728
        return {
            "x":  _w((lambda *s: torch.randn(*s, dtype=torch.bfloat16) * 0.05)(B, S, D)),
            "w1": _w((lambda *s: torch.randn(*s, dtype=torch.bfloat16) * 3.2)(D, D) * (D ** -0.5)),
            "w2": _w((lambda *s: torch.randn(*s, dtype=torch.bfloat16) * 3.2)(D, D) * (D ** -0.5)),
            "w3": _w((lambda *s: torch.randn(*s, dtype=torch.bfloat16) * 3.2)(D, F) * (D ** -0.5)),
            "w4": _w((lambda *s: torch.randn(*s, dtype=torch.bfloat16) * 3.2)(F, D) * (F ** -0.5)),
        }
    _B_in = _B_setup()

    return {
        "A_x": _A_in["x"],
        "A_wqkv": _A_in["wqkv"],
        "A_wo": _A_in["wo"],
        "B_x": _B_in["x"],
        "B_w1": _B_in["w1"],
        "B_w2": _B_in["w2"],
        "B_w3": _B_in["w3"],
        "B_w4": _B_in["w4"],
    }

def reference(A_x, A_wqkv, A_wo, B_x, B_w1, B_w2, B_w3, B_w4):
    def _A_ref(x, wqkv, wo):
        B, S, D = x.shape
        H = 32; Dh = D // H
        qkv = (lambda x, *d: x.permute(*d))((x @ wqkv).reshape(B, S, 3, H, Dh), 2, 0, 3, 1, 4)
        q, k, v = qkv[0], qkv[1], qkv[2]
        phi = lambda t: torch.where(t > 0, t + 1, torch.exp(t)) + 1e-6
        pq, pk = phi(q), phi(k)
        kv = torch.einsum("bhsd,bhse->bhde", pk, v)
        z = torch.einsum("bhsd->bhd", pk)
        num = torch.einsum("bhqd,bhde->bhqe", pq, kv)
        den = torch.einsum("bhqd,bhd->bhq", pq, z)[..., None] + 1e-6
        o = num / den
        return (lambda x, *d: x.permute(*d))(o, 0, 2, 1, 3).reshape(B, S, D) @ wo

    def _B_ref(x, w1, w2, w3, w4):
        B, S, D = x.shape
        h = _gelu(_layernorm(x, axis=-1) @ w1)
        c = D // 4
        g0 = _pad(h[:, :, 0*c:1*c], ((0, 0), (1, 0), (0, 0)))[:, :S, :]
        g1 = _pad(h[:, :, 1*c:2*c], ((0, 0), (0, 1), (0, 0)))[:, 1:, :]
        g2 = _pad(h[:, :, 2*c:3*c], ((0, 0), (2, 0), (0, 0)))[:, :S, :]
        g3 = _pad(h[:, :, 3*c:   ], ((0, 0), (0, 2), (0, 0)))[:, 2:, :]
        hs = torch.concatenate([g0, g1, g2, g3], axis=-1) @ w2
        x1 = x + hs
        h2 = _gelu(_layernorm(x1, axis=-1) @ w3) @ w4
        return x1 + h2

    x = A_x
    h = x + _A_ref(_layernorm(x, axis=-1), A_wqkv, A_wo)
    h2 = h + _B_ref(_layernorm(h, axis=-1), B_w1, B_w2, B_w3, B_w4)
    return h2
```

```asm
; @launch grid=(256,1,1) block=(512,1,1) lds=163840
.amdgcn_target "amdgcn-amd-amdhsa--gfx950"
.text
.globl sequential_preLN__linear_attn_block__mixer_s_mlp__prompt_kernel
.p2align 8
.type sequential_preLN__linear_attn_block__mixer_s_mlp__prompt_kernel,@function
sequential_preLN__linear_attn_block__mixer_s_mlp__prompt_kernel:
  s_cmp_ge_u32 s2, 256
  s_cbranch_scc1 L_end
  s_load_dwordx4 s[32:35], s[0:1], 0
  s_load_dwordx2 s[36:37], s[0:1], 16
  s_load_dwordx8 s[40:47], s[0:1], 32
  s_load_dwordx4 s[48:51], s[0:1], 64
  s_load_dwordx2 s[52:53], s[0:1], 80
  v_and_b32 v1, 63, v0
  v_lshrrev_b32 v4, 6, v0
  v_and_b32 v2, 15, v0
  v_bfe_u32 v3, v0, 4, 2
  v_readfirstlane_b32 s6, v4
  v_mov_b32 v8, 163584
  v_mov_b32 v9, 0
  v_lshlrev_b32 v10, 2, v1
  v_add_u32 v10, 163584, v10
  ds_write_b32 v10, v9
  s_and_b32 s4, s2, 7
  s_lshr_b32 s5, s2, 3
  s_mov_b32 s61, 0x3f803f80
  s_lshr_b32 s88, s5, 3
  s_lshl_b32 s56, s4, 2
  s_add_u32 s88, s88, s56
  s_and_b32 s89, s5, 7
  s_lshr_b32 s91, s88, 1
  s_and_b32 s92, s5, 15
  s_and_b32 s7, s6, 3
  s_lshl_b32 s90, s88, 2
  s_add_u32 s90, s90, s7
  s_lshl_b32 s77, s91, 2
  s_add_u32 s77, s77, s7
  s_lshl_b32 s74, s77, 1
  s_xor_b32 s76, s92, 1
  s_lshl_b32 s56, s7, 2
  v_add_u32 v11, s56, v8
  s_waitcnt lgkmcnt(0)
  s_mov_b32 s80, s50
  s_mov_b32 s81, s51
  s_mov_b32 s82, 256
  s_mov_b32 s83, 0x00020000
  s_add_u32 s24, s52, 18874368
  s_addc_u32 s25, s53, 0
  s_mov_b32 s26, 917504
  s_mov_b32 s27, 0x00020000
  s_barrier
  s_cmp_ge_u32 s6, 4
  s_cbranch_scc1 L_helper
  s_or_b32 s56, s2, s6
  s_cmp_lg_u32 s56, 0
  s_cbranch_scc1 L_1
  v_mov_b32 v10, 0
  s_memrealtime s[56:57]
  s_waitcnt lgkmcnt(0)
  s_or_b32 s56, s56, 1
  s_or_b32 s57, s57, 0x40000000
  v_mov_b32 v12, s56
  v_mov_b32 v13, s57
  s_mov_b64 s[58:59], exec
  s_mov_b64 exec, 1
  buffer_store_dwordx2 v[12:13], v10, s[80:83], 0 offen sc1
  s_mov_b64 exec, s[58:59]
L_1:
  s_mul_i32 s68, s74, 20480
  s_add_u32 s69, s68, 20480
  v_xor_b32 v30, v3, v2
  v_lshlrev_b32 v30, 4, v30
  v_lshl_add_u32 v30, v2, 8, v30
  s_lshl_b32 s56, s7, 13
  v_add_u32 v30, s56, v30
  s_lshl_b32 s56, s2, 2
  s_add_u32 s56, s56, s7
  s_mul_i32 s60, s56, 2400
  s_mov_b32 s84, s34
  s_mov_b32 s85, s35
  s_mov_b32 s86, 2457600
  s_mov_b32 s87, 0x00020000
  s_lshl_b32 s57, s7, 12
  v_lshlrev_b32 v12, 4, v1
  s_add_u32 m0, s57, 122880
  s_nop 0
  buffer_load_dwordx4 v12, s[84:87], s60 offen lds
  s_add_u32 s60, s60, 1024
  v_lshlrev_b32 v12, 4, v1
  s_add_u32 m0, s57, 123904
  s_nop 0
  buffer_load_dwordx4 v12, s[84:87], s60 offen lds
  s_add_u32 s60, s60, 1024
  v_lshlrev_b32 v12, 4, v1
  v_cmp_gt_u32 vcc, 352, v12
  v_bfrev_b32 v13, 1
  s_nop 0
  v_cndmask_b32 v12, v13, v12, vcc
  s_add_u32 m0, s57, 124928
  s_nop 0
  buffer_load_dwordx4 v12, s[84:87], s60 offen lds
  s_lshl_b32 s56, s2, 2
  s_add_u32 s56, s56, s7
  s_mul_i32 s60, s56, 2560
  s_mov_b32 s84, s32
  s_mov_b32 s85, s33
  s_mov_b32 s86, 2621440
  s_mov_b32 s87, 0x00020000
  s_lshl_b32 s57, s7, 12
  v_lshlrev_b32 v12, 4, v1
  s_add_u32 m0, s57, 122880
  s_nop 0
  buffer_load_dwordx4 v12, s[84:87], s60 offen lds
  s_add_u32 s60, s60, 1024
  v_lshlrev_b32 v12, 4, v1
  s_add_u32 m0, s57, 123904
  s_nop 0
  buffer_load_dwordx4 v12, s[84:87], s60 offen lds
  s_add_u32 s60, s60, 1024
  v_lshlrev_b32 v12, 4, v1
  v_cmp_gt_u32 vcc, 512, v12
  v_bfrev_b32 v13, 1
  s_nop 0
  v_cndmask_b32 v12, v13, v12, vcc
  s_add_u32 m0, s57, 124928
  s_nop 0
  buffer_load_dwordx4 v12, s[84:87], s60 offen lds
  s_mul_i32 s56, s7, 3456
  s_add_u32 s56, s56, 139264
  s_add_u32 s57, s56, 3360
  s_mul_i32 s58, s7, 3456
  s_add_u32 s58, s58, 139264
  v_lshl_add_u32 v31, v1, 2, s58
  v_lshl_add_u32 v32, v3, 2, 0
  v_cmp_lt_u32 vcc, 19, v32
  s_nop 1
  v_cndmask_b32 v34, 0, 1, vcc
  v_mul_u32_u24 v33, 20, v34
  v_sub_u32 v36, v32, v33
  v_add_u32 v35, -8, v2
  v_sub_u32 v35, v35, v33
  v_cmp_gt_u32 s[72:73], 20, v35
  v_cmp_gt_u32 vcc, 40, v32
  s_nop 3
  s_and_b64 s[72:73], s[72:73], vcc
  v_mul_u32_u24 v34, 420, v34
  v_mad_u32_u24 v35, v35, 20, v34
  v_add_u32 v36, v36, v35
  v_lshl_add_u32 v36, v36, 2, s56
  v_mov_b32 v35, s57
  v_cndmask_b32 v36, v35, v36, s[72:73]
  ds_write_b32 v31, v36
  v_lshl_add_u32 v32, v3, 2, 0
  v_cmp_lt_u32 vcc, 19, v32
  s_nop 1
  v_cndmask_b32 v34, 0, 1, vcc
  v_mul_u32_u24 v33, 20, v34
  v_sub_u32 v36, v32, v33
  v_add_u32 v35, 8, v2
  v_sub_u32 v35, v35, v33
  v_cmp_gt_u32 s[72:73], 20, v35
  v_cmp_gt_u32 vcc, 40, v32
  s_nop 3
  s_and_b64 s[72:73], s[72:73], vcc
  v_mul_u32_u24 v34, 420, v34
  v_mad_u32_u24 v35, v35, 20, v34
  v_add_u32 v36, v36, v35
  v_lshl_add_u32 v36, v36, 2, s56
  v_mov_b32 v35, s57
  v_cndmask_b32 v36, v35, v36, s[72:73]
  ds_write_b32 v31, v36 offset:256
  v_lshl_add_u32 v32, v3, 2, 16
  v_cmp_lt_u32 vcc, 19, v32
  s_nop 1
  v_cndmask_b32 v34, 0, 1, vcc
  v_mul_u32_u24 v33, 20, v34
  v_sub_u32 v36, v32, v33
  v_add_u32 v35, -8, v2
  v_sub_u32 v35, v35, v33
  v_cmp_gt_u32 s[72:73], 20, v35
  v_cmp_gt_u32 vcc, 40, v32
  s_nop 3
  s_and_b64 s[72:73], s[72:73], vcc
  v_mul_u32_u24 v34, 420, v34
  v_mad_u32_u24 v35, v35, 20, v34
  v_add_u32 v36, v36, v35
  v_lshl_add_u32 v36, v36, 2, s56
  v_mov_b32 v35, s57
  v_cndmask_b32 v36, v35, v36, s[72:73]
  ds_write_b32 v31, v36 offset:512
  v_lshl_add_u32 v32, v3, 2, 16
  v_cmp_lt_u32 vcc, 19, v32
  s_nop 1
  v_cndmask_b32 v34, 0, 1, vcc
  v_mul_u32_u24 v33, 20, v34
  v_sub_u32 v36, v32, v33
  v_add_u32 v35, 8, v2
  v_sub_u32 v35, v35, v33
  v_cmp_gt_u32 s[72:73], 20, v35
  v_cmp_gt_u32 vcc, 40, v32
  s_nop 3
  s_and_b64 s[72:73], s[72:73], vcc
  v_mul_u32_u24 v34, 420, v34
  v_mad_u32_u24 v35, v35, 20, v34
  v_add_u32 v36, v36, v35
  v_lshl_add_u32 v36, v36, 2, s56
  v_mov_b32 v35, s57
  v_cndmask_b32 v36, v35, v36, s[72:73]
  ds_write_b32 v31, v36 offset:768
  v_lshl_add_u32 v32, v3, 2, 16
  v_cmp_lt_u32 vcc, 19, v32
  s_nop 1
  v_cndmask_b32 v34, 0, 1, vcc
  v_mul_u32_u24 v33, 20, v34
  v_sub_u32 v36, v32, v33
  v_add_u32 v35, 24, v2
  v_sub_u32 v35, v35, v33
  v_cmp_gt_u32 s[72:73], 20, v35
  v_cmp_gt_u32 vcc, 40, v32
  s_nop 3
  s_and_b64 s[72:73], s[72:73], vcc
  v_mul_u32_u24 v34, 420, v34
  v_mad_u32_u24 v35, v35, 20, v34
  v_add_u32 v36, v36, v35
  v_lshl_add_u32 v36, v36, 2, s56
  v_mov_b32 v35, s57
  v_cndmask_b32 v36, v35, v36, s[72:73]
  ds_write_b32 v31, v36 offset:1024
  v_lshl_add_u32 v32, v3, 2, 32
  v_cmp_lt_u32 vcc, 19, v32
  s_nop 1
  v_cndmask_b32 v34, 0, 1, vcc
  v_mul_u32_u24 v33, 20, v34
  v_sub_u32 v36, v32, v33
  v_add_u32 v35, 8, v2
  v_sub_u32 v35, v35, v33
  v_cmp_gt_u32 s[72:73], 20, v35
  v_cmp_gt_u32 vcc, 40, v32
  s_nop 3
  s_and_b64 s[72:73], s[72:73], vcc
  v_mul_u32_u24 v34, 420, v34
  v_mad_u32_u24 v35, v35, 20, v34
  v_add_u32 v36, v36, v35
  v_lshl_add_u32 v36, v36, 2, s56
  v_mov_b32 v35, s57
  v_cndmask_b32 v36, v35, v36, s[72:73]
  ds_write_b32 v31, v36 offset:1280
  v_lshl_add_u32 v32, v3, 2, 32
  v_cmp_lt_u32 vcc, 19, v32
  s_nop 1
  v_cndmask_b32 v34, 0, 1, vcc
  v_mul_u32_u24 v33, 20, v34
  v_sub_u32 v36, v32, v33
  v_add_u32 v35, 24, v2
  v_sub_u32 v35, v35, v33
  v_cmp_gt_u32 s[72:73], 20, v35
  v_cmp_gt_u32 vcc, 40, v32
  s_nop 3
  s_and_b64 s[72:73], s[72:73], vcc
  v_mul_u32_u24 v34, 420, v34
  v_mad_u32_u24 v35, v35, 20, v34
  v_add_u32 v36, v36, v35
  v_lshl_add_u32 v36, v36, 2, s56
  v_mov_b32 v35, s57
  v_cndmask_b32 v36, v35, v36, s[72:73]
  ds_write_b32 v31, v36 offset:1536
  v_lshl_add_u32 v32, v3, 2, 0
  v_cmp_lt_u32 vcc, 19, v32
  s_nop 1
  v_cndmask_b32 v34, 0, 1, vcc
  v_mul_u32_u24 v33, 20, v34
  v_sub_u32 v36, v32, v33
  v_mov_b32 v35, 20
  v_cmp_eq_u32 s[72:73], 0, v2
  v_cmp_gt_u32 vcc, 40, v32
  s_nop 3
  s_and_b64 s[72:73], s[72:73], vcc
  v_mul_u32_u24 v34, 420, v34
  v_mad_u32_u24 v35, v35, 20, v34
  v_add_u32 v36, v36, v35
  v_lshl_add_u32 v36, v36, 2, s56
  v_mov_b32 v35, s57
  v_cndmask_b32 v36, v35, v36, s[72:73]
  ds_write_b32 v31, v36 offset:1792
  v_lshl_add_u32 v32, v3, 2, 16
  v_cmp_lt_u32 vcc, 19, v32
  s_nop 1
  v_cndmask_b32 v34, 0, 1, vcc
  v_mul_u32_u24 v33, 20, v34
  v_sub_u32 v36, v32, v33
  v_mov_b32 v35, 20
  v_cmp_eq_u32 s[72:73], 0, v2
  v_cmp_gt_u32 vcc, 40, v32
  s_nop 3
  s_and_b64 s[72:73], s[72:73], vcc
  v_mul_u32_u24 v34, 420, v34
  v_mad_u32_u24 v35, v35, 20, v34
  v_add_u32 v36, v36, v35
  v_lshl_add_u32 v36, v36, 2, s56
  v_mov_b32 v35, s57
  v_cndmask_b32 v36, v35, v36, s[72:73]
  ds_write_b32 v31, v36 offset:2048
  v_lshl_add_u32 v32, v3, 2, 32
  v_cmp_lt_u32 vcc, 19, v32
  s_nop 1
  v_cndmask_b32 v34, 0, 1, vcc
  v_mul_u32_u24 v33, 20, v34
  v_sub_u32 v36, v32, v33
  v_mov_b32 v35, 20
  v_cmp_eq_u32 s[72:73], 0, v2
  v_cmp_gt_u32 vcc, 40, v32
  s_nop 3
  s_and_b64 s[72:73], s[72:73], vcc
  v_mul_u32_u24 v34, 420, v34
  v_mad_u32_u24 v35, v35, 20, v34
  v_add_u32 v36, v36, v35
  v_lshl_add_u32 v36, v36, 2, s56
  v_mov_b32 v35, s57
  v_cndmask_b32 v36, v35, v36, s[72:73]
  ds_write_b32 v31, v36 offset:2304
  v_bfe_u32 v32, v0, 2, 2
  v_bfe_u32 v33, v0, 4, 1
  v_lshl_or_b32 v32, v33, 2, v32
  v_lshl_or_b32 v33, v3, 3, v32
  v_mul_u32_u24 v16, 160, v33
  v_xor_b32 v33, 4, v33
  v_mul_u32_u24 v17, 160, v33
  v_and_b32 v32, 3, v0
  v_lshl_add_u32 v16, v32, 3, v16
  v_lshl_add_u32 v17, v32, 3, v17
  s_lshl_b32 s56, s7, 5
  v_add_u32 v18, s56, v16
  v_add_u32 v19, s56, v17
  v_mov_b32 v24, 0
  v_mov_b32 v25, 0
  v_mov_b32 v26, 0
  v_mov_b32 v27, 0
  v_mov_b32 v28, 0
  v_mov_b32 v29, 0
  s_waitcnt lgkmcnt(0)
  s_mov_b32 s57, 0
L_2:
  ds_read_b128 v[12:15], v8 offset:0
  s_waitcnt lgkmcnt(0)
  v_min3_u32 v12, v12, v13, v14
  v_min_u32 v12, v12, v15
  s_nop 0
  v_readfirstlane_b32 s56, v12
  s_nop 3
  s_cmp_ge_u32 s56, 1
  s_cbranch_scc1 L_3
  s_add_u32 s57, s57, 1
  s_sleep 1
  s_cmp_lt_u32 s57, 0x400000
  s_cbranch_scc1 L_2
L_3:
  v_xor_b32 v12, 0, v30
  ds_read_b128 v[96:99], v12
  ds_read_b128 v[176:179], v12 offset:4096
  v_xor_b32 v13, 64, v30
  ds_read_b128 v[100:103], v13
  ds_read_b128 v[180:183], v13 offset:4096
  v_xor_b32 v14, 128, v30
  ds_read_b128 v[104:107], v14
  ds_read_b128 v[184:187], v14 offset:4096
  v_xor_b32 v15, 192, v30
  ds_read_b128 v[108:111], v15
  ds_read_b128 v[188:191], v15 offset:4096
  s_waitcnt lgkmcnt(0)
  v_mov_b32 v10, 1
  ds_write_b32 v11, v10 offset:16
  s_waitcnt lgkmcnt(0)
  s_mov_b32 s57, 0
L_4:
  ds_read_b128 v[12:15], v8 offset:0
  s_waitcnt lgkmcnt(0)
  v_min3_u32 v12, v12, v13, v14
  v_min_u32 v12, v12, v15
  s_nop 0
  v_readfirstlane_b32 s56, v12
  s_nop 3
  s_cmp_ge_u32 s56, 2
  s_cbranch_scc1 L_5
  s_add_u32 s57, s57, 1
  s_sleep 1
  s_cmp_lt_u32 s57, 0x400000
  s_cbranch_scc1 L_4
L_5:
  v_xor_b32 v12, 0, v30
  ds_read_b128 v[112:115], v12 offset:32768
  ds_read_b128 v[192:195], v12 offset:36864
  v_xor_b32 v13, 64, v30
  ds_read_b128 v[116:119], v13 offset:32768
  ds_read_b128 v[196:199], v13 offset:36864
  v_xor_b32 v14, 128, v30
  ds_read_b128 v[120:123], v14 offset:32768
  ds_read_b128 v[200:203], v14 offset:36864
  v_xor_b32 v15, 192, v30
  ds_read_b128 v[124:127], v15 offset:32768
  ds_read_b128 v[204:207], v15 offset:36864
  s_waitcnt lgkmcnt(0)
  v_mov_b32 v10, 2
  ds_write_b32 v11, v10 offset:16
  s_waitcnt lgkmcnt(0)
  s_mov_b32 s57, 0
L_6:
  ds_read_b128 v[12:15], v8 offset:0
  s_waitcnt lgkmcnt(0)
  v_min3_u32 v12, v12, v13, v14
  v_min_u32 v12, v12, v15
  s_nop 0
  v_readfirstlane_b32 s56, v12
  s_nop 3
  s_cmp_ge_u32 s56, 3
  s_cbranch_scc1 L_7
  s_add_u32 s57, s57, 1
  s_sleep 1
  s_cmp_lt_u32 s57, 0x400000
  s_cbranch_scc1 L_6
L_7:
  v_add_u32 v16, 65536, v16
  v_add_u32 v17, 65536, v17
  v_add_u32 v18, 65536, v18
  v_add_u32 v19, 65536, v19
  ds_read_b64_tr_b16 v[4:5], v16
  ds_read_b64_tr_b16 v[6:7], v17
  ds_read_b64_tr_b16 v[20:21], v16 offset:32
  ds_read_b64_tr_b16 v[22:23], v17 offset:32
  ds_read_b64_tr_b16 v[44:45], v16 offset:64
  ds_read_b64_tr_b16 v[46:47], v17 offset:64
  ds_read_b64_tr_b16 v[88:89], v16 offset:96
  ds_read_b64_tr_b16 v[90:91], v17 offset:96
  ds_read_b64_tr_b16 v[92:93], v16 offset:128
  ds_read_b64_tr_b16 v[94:95], v17 offset:128
  ds_read_b64_tr_b16 v[32:33], v18
  ds_read_b64_tr_b16 v[34:35], v19
  ds_read_b64_tr_b16 v[36:37], v18 offset:128
  ds_read_b64_tr_b16 v[38:39], v19 offset:128
  s_waitcnt lgkmcnt(12)
  v_mfma_f32_16x16x32_bf16 v[48:51], v[96:99], v[4:7], 0
  v_mfma_f32_16x16x32_bf16 v[68:71], v[176:179], v[4:7], 0
  ds_read_b64_tr_b16 v[4:5], v16 offset:5120
  ds_read_b64_tr_b16 v[6:7], v17 offset:5120
  s_waitcnt lgkmcnt(12)
  v_mfma_f32_16x16x32_bf16 v[52:55], v[96:99], v[20:23], 0
  v_mfma_f32_16x16x32_bf16 v[72:75], v[176:179], v[20:23], 0
  ds_read_b64_tr_b16 v[20:21], v16 offset:5152
  ds_read_b64_tr_b16 v[22:23], v17 offset:5152
  s_waitcnt lgkmcnt(12)
  v_mfma_f32_16x16x32_bf16 v[56:59], v[96:99], v[44:47], 0
  v_mfma_f32_16x16x32_bf16 v[76:79], v[176:179], v[44:47], 0
  ds_read_b64_tr_b16 v[44:45], v16 offset:5184
  ds_read_b64_tr_b16 v[46:47], v17 offset:5184
  s_waitcnt lgkmcnt(12)
  v_mfma_f32_16x16x32_bf16 v[60:63], v[96:99], v[88:91], 0
  v_mfma_f32_16x16x32_bf16 v[80:83], v[176:179], v[88:91], 0
  ds_read_b64_tr_b16 v[88:89], v16 offset:5216
  ds_read_b64_tr_b16 v[90:91], v17 offset:5216
  s_waitcnt lgkmcnt(12)
  v_mfma_f32_16x16x32_bf16 v[64:67], v[96:99], v[92:95], 0
  v_mfma_f32_16x16x32_bf16 v[84:87], v[176:179], v[92:95], 0
  ds_read_b64_tr_b16 v[92:93], v16 offset:5248
  ds_read_b64_tr_b16 v[94:95], v17 offset:5248
  v_dot2c_f32_bf16 v24, s61, v96
  v_dot2c_f32_bf16 v25, v96, v96
  v_dot2c_f32_bf16 v26, s61, v176
  v_dot2c_f32_bf16 v27, v176, v176
  v_dot2c_f32_bf16 v24, s61, v97
  v_dot2c_f32_bf16 v25, v97, v97
  v_dot2c_f32_bf16 v26, s61, v177
  v_dot2c_f32_bf16 v27, v177, v177
  v_dot2c_f32_bf16 v24, s61, v98
  v_dot2c_f32_bf16 v25, v98, v98
  v_dot2c_f32_bf16 v26, s61, v178
  v_dot2c_f32_bf16 v27, v178, v178
  v_dot2c_f32_bf16 v24, s61, v99
  v_dot2c_f32_bf16 v25, v99, v99
  v_dot2c_f32_bf16 v26, s61, v179
  v_dot2c_f32_bf16 v27, v179, v179
  s_waitcnt lgkmcnt(13)
  v_dot2c_f32_bf16 v28, s61, v32
  s_waitcnt lgkmcnt(11)
  v_dot2c_f32_bf16 v29, s61, v36
  v_dot2c_f32_bf16 v28, s61, v33
  v_dot2c_f32_bf16 v29, s61, v37
  v_dot2c_f32_bf16 v28, s61, v34
  s_waitcnt lgkmcnt(10)
  v_dot2c_f32_bf16 v29, s61, v38
  v_dot2c_f32_bf16 v28, s61, v35
  v_dot2c_f32_bf16 v29, s61, v39
  ds_read_b64_tr_b16 v[32:33], v18 offset:5120
  ds_read_b64_tr_b16 v[34:35], v19 offset:5120
  ds_read_b64_tr_b16 v[36:37], v18 offset:5248
  ds_read_b64_tr_b16 v[38:39], v19 offset:5248
  s_waitcnt lgkmcnt(12)
  v_mfma_f32_16x16x32_bf16 v[48:51], v[100:103], v[4:7], v[48:51]
  v_mfma_f32_16x16x32_bf16 v[68:71], v[180:183], v[4:7], v[68:71]
  ds_read_b64_tr_b16 v[4:5], v16 offset:10240
  ds_read_b64_tr_b16 v[6:7], v17 offset:10240
  s_waitcnt lgkmcnt(12)
  v_mfma_f32_16x16x32_bf16 v[52:55], v[100:103], v[20:23], v[52:55]
  v_mfma_f32_16x16x32_bf16 v[72:75], v[180:183], v[20:23], v[72:75]
  ds_read_b64_tr_b16 v[20:21], v16 offset:10272
  ds_read_b64_tr_b16 v[22:23], v17 offset:10272
  s_waitcnt lgkmcnt(12)
  v_mfma_f32_16x16x32_bf16 v[56:59], v[100:103], v[44:47], v[56:59]
  v_mfma_f32_16x16x32_bf16 v[76:79], v[180:183], v[44:47], v[76:79]
  ds_read_b64_tr_b16 v[44:45], v16 offset:10304
  ds_read_b64_tr_b16 v[46:47], v17 offset:10304
  s_waitcnt lgkmcnt(12)
  v_mfma_f32_16x16x32_bf16 v[60:63], v[100:103], v[88:91], v[60:63]
  v_mfma_f32_16x16x32_bf16 v[80:83], v[180:183], v[88:91], v[80:83]
  ds_read_b64_tr_b16 v[88:89], v16 offset:10336
  ds_read_b64_tr_b16 v[90:91], v17 offset:10336
  s_waitcnt lgkmcnt(12)
  v_mfma_f32_16x16x32_bf16 v[64:67], v[100:103], v[92:95], v[64:67]
  v_mfma_f32_16x16x32_bf16 v[84:87], v[180:183], v[92:95], v[84:87]
  ds_read_b64_tr_b16 v[92:93], v16 offset:10368
  ds_read_b64_tr_b16 v[94:95], v17 offset:10368
  v_dot2c_f32_bf16 v24, s61, v100
  v_dot2c_f32_bf16 v25, v100, v100
  v_dot2c_f32_bf16 v26, s61, v180
  v_dot2c_f32_bf16 v27, v180, v180
  v_dot2c_f32_bf16 v24, s61, v101
  v_dot2c_f32_bf16 v25, v101, v101
  v_dot2c_f32_bf16 v26, s61, v181
  v_dot2c_f32_bf16 v27, v181, v181
  v_dot2c_f32_bf16 v24, s61, v102
  v_dot2c_f32_bf16 v25, v102, v102
  v_dot2c_f32_bf16 v26, s61, v182
  v_dot2c_f32_bf16 v27, v182, v182
  v_dot2c_f32_bf16 v24, s61, v103
  v_dot2c_f32_bf16 v25, v103, v103
  v_dot2c_f32_bf16 v26, s61, v183
  v_dot2c_f32_bf16 v27, v183, v183
  s_waitcnt lgkmcnt(13)
  v_dot2c_f32_bf16 v28, s61, v32
  s_waitcnt lgkmcnt(11)
  v_dot2c_f32_bf16 v29, s61, v36
  v_dot2c_f32_bf16 v28, s61, v33
  v_dot2c_f32_bf16 v29, s61, v37
  v_dot2c_f32_bf16 v28, s61, v34
  s_waitcnt lgkmcnt(10)
  v_dot2c_f32_bf16 v29, s61, v38
  v_dot2c_f32_bf16 v28, s61, v35
  v_dot2c_f32_bf16 v29, s61, v39
  ds_read_b64_tr_b16 v[32:33], v18 offset:10240
  ds_read_b64_tr_b16 v[34:35], v19 offset:10240
  ds_read_b64_tr_b16 v[36:37], v18 offset:10368
  ds_read_b64_tr_b16 v[38:39], v19 offset:10368
  s_waitcnt lgkmcnt(12)
  v_mfma_f32_16x16x32_bf16 v[48:51], v[104:107], v[4:7], v[48:51]
  v_mfma_f32_16x16x32_bf16 v[68:71], v[184:187], v[4:7], v[68:71]
  ds_read_b64_tr_b16 v[4:5], v16 offset:15360
  ds_read_b64_tr_b16 v[6:7], v17 offset:15360
  s_waitcnt lgkmcnt(12)
  v_mfma_f32_16x16x32_bf16 v[52:55], v[104:107], v[20:23], v[52:55]
  v_mfma_f32_16x16x32_bf16 v[72:75], v[184:187], v[20:23], v[72:75]
  ds_read_b64_tr_b16 v[20:21], v16 offset:15392
  ds_read_b64_tr_b16 v[22:23], v17 offset:15392
  s_waitcnt lgkmcnt(12)
  v_mfma_f32_16x16x32_bf16 v[56:59], v[104:107], v[44:47], v[56:59]
  v_mfma_f32_16x16x32_bf16 v[76:79], v[184:187], v[44:47], v[76:79]
  ds_read_b64_tr_b16 v[44:45], v16 offset:15424
  ds_read_b64_tr_b16 v[46:47], v17 offset:15424
  s_waitcnt lgkmcnt(12)
  v_mfma_f32_16x16x32_bf16 v[60:63], v[104:107], v[88:91], v[60:63]
  v_mfma_f32_16x16x32_bf16 v[80:83], v[184:187], v[88:91], v[80:83]
  ds_read_b64_tr_b16 v[88:89], v16 offset:15456
  ds_read_b64_tr_b16 v[90:91], v17 offset:15456
  s_waitcnt lgkmcnt(12)
  v_mfma_f32_16x16x32_bf16 v[64:67], v[104:107], v[92:95], v[64:67]
  v_mfma_f32_16x16x32_bf16 v[84:87], v[184:187], v[92:95], v[84:87]
  ds_read_b64_tr_b16 v[92:93], v16 offset:15488
  ds_read_b64_tr_b16 v[94:95], v17 offset:15488
  v_dot2c_f32_bf16 v24, s61, v104
  v_dot2c_f32_bf16 v25, v104, v104
  v_dot2c_f32_bf16 v26, s61, v184
  v_dot2c_f32_bf16 v27, v184, v184
  v_dot2c_f32_bf16 v24, s61, v105
  v_dot2c_f32_bf16 v25, v105, v105
  v_dot2c_f32_bf16 v26, s61, v185
  v_dot2c_f32_bf16 v27, v185, v185
  v_dot2c_f32_bf16 v24, s61, v106
  v_dot2c_f32_bf16 v25, v106, v106
  v_dot2c_f32_bf16 v26, s61, v186
  v_dot2c_f32_bf16 v27, v186, v186
  v_dot2c_f32_bf16 v24, s61, v107
  v_dot2c_f32_bf16 v25, v107, v107
  v_dot2c_f32_bf16 v26, s61, v187
  v_dot2c_f32_bf16 v27, v187, v187
  s_waitcnt lgkmcnt(13)
  v_dot2c_f32_bf16 v28, s61, v32
  s_waitcnt lgkmcnt(11)
  v_dot2c_f32_bf16 v29, s61, v36
  v_dot2c_f32_bf16 v28, s61, v33
  v_dot2c_f32_bf16 v29, s61, v37
  v_dot2c_f32_bf16 v28, s61, v34
  s_waitcnt lgkmcnt(10)
  v_dot2c_f32_bf16 v29, s61, v38
  v_dot2c_f32_bf16 v28, s61, v35
  v_dot2c_f32_bf16 v29, s61, v39
  ds_read_b64_tr_b16 v[32:33], v18 offset:15360
  ds_read_b64_tr_b16 v[34:35], v19 offset:15360
  ds_read_b64_tr_b16 v[36:37], v18 offset:15488
  ds_read_b64_tr_b16 v[38:39], v19 offset:15488
  s_waitcnt lgkmcnt(12)
  v_mfma_f32_16x16x32_bf16 v[48:51], v[108:111], v[4:7], v[48:51]
  v_mfma_f32_16x16x32_bf16 v[68:71], v[188:191], v[4:7], v[68:71]
  s_waitcnt lgkmcnt(10)
  v_mfma_f32_16x16x32_bf16 v[52:55], v[108:111], v[20:23], v[52:55]
  v_mfma_f32_16x16x32_bf16 v[72:75], v[188:191], v[20:23], v[72:75]
  s_waitcnt lgkmcnt(8)
  v_mfma_f32_16x16x32_bf16 v[56:59], v[108:111], v[44:47], v[56:59]
  v_mfma_f32_16x16x32_bf16 v[76:79], v[188:191], v[44:47], v[76:79]
  s_waitcnt lgkmcnt(6)
  v_mfma_f32_16x16x32_bf16 v[60:63], v[108:111], v[88:91], v[60:63]
  v_mfma_f32_16x16x32_bf16 v[80:83], v[188:191], v[88:91], v[80:83]
  s_waitcnt lgkmcnt(4)
  v_mfma_f32_16x16x32_bf16 v[64:67], v[108:111], v[92:95], v[64:67]
  v_mfma_f32_16x16x32_bf16 v[84:87], v[188:191], v[92:95], v[84:87]
  v_dot2c_f32_bf16 v24, s61, v108
  v_dot2c_f32_bf16 v25, v108, v108
  v_dot2c_f32_bf16 v26, s61, v188
  v_dot2c_f32_bf16 v27, v188, v188
  v_dot2c_f32_bf16 v24, s61, v109
  v_dot2c_f32_bf16 v25, v109, v109
  v_dot2c_f32_bf16 v26, s61, v189
  v_dot2c_f32_bf16 v27, v189, v189
  v_dot2c_f32_bf16 v24, s61, v110
  v_dot2c_f32_bf16 v25, v110, v110
  v_dot2c_f32_bf16 v26, s61, v190
  v_dot2c_f32_bf16 v27, v190, v190
  v_dot2c_f32_bf16 v24, s61, v111
  v_dot2c_f32_bf16 v25, v111, v111
  v_dot2c_f32_bf16 v26, s61, v191
  v_dot2c_f32_bf16 v27, v191, v191
  s_waitcnt lgkmcnt(3)
  v_dot2c_f32_bf16 v28, s61, v32
  s_waitcnt lgkmcnt(1)
  v_dot2c_f32_bf16 v29, s61, v36
  v_dot2c_f32_bf16 v28, s61, v33
  v_dot2c_f32_bf16 v29, s61, v37
  v_dot2c_f32_bf16 v28, s61, v34
  s_waitcnt lgkmcnt(0)
  v_dot2c_f32_bf16 v29, s61, v38
  v_dot2c_f32_bf16 v28, s61, v35
  v_dot2c_f32_bf16 v29, s61, v39
  s_waitcnt lgkmcnt(0)
  v_mov_b32 v10, 3
  ds_write_b32 v11, v10 offset:16
  s_lshl_b32 s56, s2, 2
  s_add_u32 s56, s56, s7
  s_mul_i32 s60, s56, 2160
  s_mov_b32 s84, s44
  s_mov_b32 s85, s45
  s_mov_b32 s86, 2211840
  s_mov_b32 s87, 0x00020000
  s_lshl_b32 s57, s7, 12
  v_lshlrev_b32 v12, 4, v1
  s_add_u32 m0, s57, 122880
  s_nop 0
  buffer_load_dwordx4 v12, s[84:87], s60 offen lds
  s_add_u32 s60, s60, 1024
  v_lshlrev_b32 v12, 4, v1
  s_add_u32 m0, s57, 123904
  s_nop 0
  buffer_load_dwordx4 v12, s[84:87], s60 offen lds
  s_add_u32 s60, s60, 1024
  v_lshlrev_b32 v12, 4, v1
  v_cmp_gt_u32 vcc, 112, v12
  v_bfrev_b32 v13, 1
  s_nop 0
  v_cndmask_b32 v12, v13, v12, vcc
  s_add_u32 m0, s57, 124928
  s_nop 0
  buffer_load_dwordx4 v12, s[84:87], s60 offen lds
  s_lshl_b32 s56, s2, 2
  s_add_u32 s56, s56, s7
  s_mul_i32 s60, s56, 2160
  s_mov_b32 s84, s46
  s_mov_b32 s85, s47
  s_mov_b32 s86, 2211840
  s_mov_b32 s87, 0x00020000
  s_lshl_b32 s57, s7, 12
  v_lshlrev_b32 v12, 4, v1
  s_add_u32 m0, s57, 122880
  s_nop 0
  buffer_load_dwordx4 v12, s[84:87], s60 offen lds
  s_add_u32 s60, s60, 1024
  v_lshlrev_b32 v12, 4, v1
  s_add_u32 m0, s57, 123904
  s_nop 0
  buffer_load_dwordx4 v12, s[84:87], s60 offen lds
  s_add_u32 s60, s60, 1024
  v_lshlrev_b32 v12, 4, v1
  v_cmp_gt_u32 vcc, 112, v12
  v_bfrev_b32 v13, 1
  s_nop 0
  v_cndmask_b32 v12, v13, v12, vcc
  s_add_u32 m0, s57, 124928
  s_nop 0
  buffer_load_dwordx4 v12, s[84:87], s60 offen lds
  s_lshl_b32 s56, s2, 2
  s_add_u32 s56, s56, s7
  s_mul_i32 s60, s56, 800
  s_mov_b32 s84, s42
  s_mov_b32 s85, s43
  s_mov_b32 s86, 819200
  s_mov_b32 s87, 0x00020000
  s_lshl_b32 s57, s7, 12
  v_lshlrev_b32 v12, 4, v1
  v_cmp_gt_u32 vcc, 800, v12
  v_bfrev_b32 v13, 1
  s_nop 0
  v_cndmask_b32 v12, v13, v12, vcc
  s_add_u32 m0, s57, 122880
  s_nop 0
  buffer_load_dwordx4 v12, s[84:87], s60 offen lds
  s_waitcnt lgkmcnt(0)
  s_mov_b32 s57, 0
L_8:
  ds_read_b128 v[12:15], v8 offset:0
  s_waitcnt lgkmcnt(0)
  v_min3_u32 v12, v12, v13, v14
  v_min_u32 v12, v12, v15
  s_nop 0
  v_readfirstlane_b32 s56, v12
  s_nop 3
  s_cmp_ge_u32 s56, 4
  s_cbranch_scc1 L_9
  s_add_u32 s57, s57, 1
  s_sleep 1
  s_cmp_lt_u32 s57, 0x400000
  s_cbranch_scc1 L_8
L_9:
  v_xor_b32 v12, 0, v30
  ds_read_b128 v[128:131], v12
  ds_read_b128 v[208:211], v12 offset:4096
  v_xor_b32 v13, 64, v30
  ds_read_b128 v[132:135], v13
  ds_read_b128 v[212:215], v13 offset:4096
  v_xor_b32 v14, 128, v30
  ds_read_b128 v[136:139], v14
  ds_read_b128 v[216:219], v14 offset:4096
  v_xor_b32 v15, 192, v30
  ds_read_b128 v[140:143], v15
  ds_read_b128 v[220:223], v15 offset:4096
  s_waitcnt lgkmcnt(0)
  v_mov_b32 v10, 4
  ds_write_b32 v11, v10 offset:16
  s_waitcnt lgkmcnt(0)
  s_mov_b32 s57, 0
L_10:
  ds_read_b128 v[12:15], v8 offset:0
  s_waitcnt lgkmcnt(0)
  v_min3_u32 v12, v12, v13, v14
  v_min_u32 v12, v12, v15
  s_nop 0
  v_readfirstlane_b32 s56, v12
  s_nop 3
  s_cmp_ge_u32 s56, 5
  s_cbranch_scc1 L_11
  s_add_u32 s57, s57, 1
  s_sleep 1
  s_cmp_lt_u32 s57, 0x400000
  s_cbranch_scc1 L_10
L_11:
  ds_read_b64_tr_b16 v[4:5], v16 offset:20480
  ds_read_b64_tr_b16 v[6:7], v17 offset:20480
  ds_read_b64_tr_b16 v[20:21], v16 offset:20512
  ds_read_b64_tr_b16 v[22:23], v17 offset:20512
  ds_read_b64_tr_b16 v[44:45], v16 offset:20544
  ds_read_b64_tr_b16 v[46:47], v17 offset:20544
  ds_read_b64_tr_b16 v[88:89], v16 offset:20576
  ds_read_b64_tr_b16 v[90:91], v17 offset:20576
  ds_read_b64_tr_b16 v[92:93], v16 offset:20608
  ds_read_b64_tr_b16 v[94:95], v17 offset:20608
  ds_read_b64_tr_b16 v[32:33], v18 offset:20480
  ds_read_b64_tr_b16 v[34:35], v19 offset:20480
  ds_read_b64_tr_b16 v[36:37], v18 offset:20608
  ds_read_b64_tr_b16 v[38:39], v19 offset:20608
  s_waitcnt lgkmcnt(12)
  v_mfma_f32_16x16x32_bf16 v[48:51], v[112:115], v[4:7], v[48:51]
  v_mfma_f32_16x16x32_bf16 v[68:71], v[192:195], v[4:7], v[68:71]
  ds_read_b64_tr_b16 v[4:5], v16 offset:25600
  ds_read_b64_tr_b16 v[6:7], v17 offset:25600
  s_waitcnt lgkmcnt(12)
  v_mfma_f32_16x16x32_bf16 v[52:55], v[112:115], v[20:23], v[52:55]
  v_mfma_f32_16x16x32_bf16 v[72:75], v[192:195], v[20:23], v[72:75]
  ds_read_b64_tr_b16 v[20:21], v16 offset:25632
  ds_read_b64_tr_b16 v[22:23], v17 offset:25632
  s_waitcnt lgkmcnt(12)
  v_mfma_f32_16x16x32_bf16 v[56:59], v[112:115], v[44:47], v[56:59]
  v_mfma_f32_16x16x32_bf16 v[76:79], v[192:195], v[44:47], v[76:79]
  ds_read_b64_tr_b16 v[44:45], v16 offset:25664
  ds_read_b64_tr_b16 v[46:47], v17 offset:25664
  s_waitcnt lgkmcnt(12)
  v_mfma_f32_16x16x32_bf16 v[60:63], v[112:115], v[88:91], v[60:63]
  v_mfma_f32_16x16x32_bf16 v[80:83], v[192:195], v[88:91], v[80:83]
  ds_read_b64_tr_b16 v[88:89], v16 offset:25696
  ds_read_b64_tr_b16 v[90:91], v17 offset:25696
  s_waitcnt lgkmcnt(12)
  v_mfma_f32_16x16x32_bf16 v[64:67], v[112:115], v[92:95], v[64:67]
  v_mfma_f32_16x16x32_bf16 v[84:87], v[192:195], v[92:95], v[84:87]
  ds_read_b64_tr_b16 v[92:93], v16 offset:25728
  ds_read_b64_tr_b16 v[94:95], v17 offset:25728
  v_dot2c_f32_bf16 v24, s61, v112
  v_dot2c_f32_bf16 v25, v112, v112
  v_dot2c_f32_bf16 v26, s61, v192
  v_dot2c_f32_bf16 v27, v192, v192
  v_dot2c_f32_bf16 v24, s61, v113
  v_dot2c_f32_bf16 v25, v113, v113
  v_dot2c_f32_bf16 v26, s61, v193
  v_dot2c_f32_bf16 v27, v193, v193
  v_dot2c_f32_bf16 v24, s61, v114
  v_dot2c_f32_bf16 v25, v114, v114
  v_dot2c_f32_bf16 v26, s61, v194
  v_dot2c_f32_bf16 v27, v194, v194
  v_dot2c_f32_bf16 v24, s61, v115
  v_dot2c_f32_bf16 v25, v115, v115
  v_dot2c_f32_bf16 v26, s61, v195
  v_dot2c_f32_bf16 v27, v195, v195
  s_waitcnt lgkmcnt(13)
  v_dot2c_f32_bf16 v28, s61, v32
  s_waitcnt lgkmcnt(11)
  v_dot2c_f32_bf16 v29, s61, v36
  v_dot2c_f32_bf16 v28, s61, v33
  v_dot2c_f32_bf16 v29, s61, v37
  v_dot2c_f32_bf16 v28, s61, v34
  s_waitcnt lgkmcnt(10)
  v_dot2c_f32_bf16 v29, s61, v38
  v_dot2c_f32_bf16 v28, s61, v35
  v_dot2c_f32_bf16 v29, s61, v39
  ds_read_b64_tr_b16 v[32:33], v18 offset:25600
  ds_read_b64_tr_b16 v[34:35], v19 offset:25600
  ds_read_b64_tr_b16 v[36:37], v18 offset:25728
  ds_read_b64_tr_b16 v[38:39], v19 offset:25728
  s_waitcnt lgkmcnt(12)
  v_mfma_f32_16x16x32_bf16 v[48:51], v[116:119], v[4:7], v[48:51]
  v_mfma_f32_16x16x32_bf16 v[68:71], v[196:199], v[4:7], v[68:71]
  ds_read_b64_tr_b16 v[4:5], v16 offset:30720
  ds_read_b64_tr_b16 v[6:7], v17 offset:30720
  s_waitcnt lgkmcnt(12)
  v_mfma_f32_16x16x32_bf16 v[52:55], v[116:119], v[20:23], v[52:55]
  v_mfma_f32_16x16x32_bf16 v[72:75], v[196:199], v[20:23], v[72:75]
  ds_read_b64_tr_b16 v[20:21], v16 offset:30752
  ds_read_b64_tr_b16 v[22:23], v17 offset:30752
  s_waitcnt lgkmcnt(12)
  v_mfma_f32_16x16x32_bf16 v[56:59], v[116:119], v[44:47], v[56:59]
  v_mfma_f32_16x16x32_bf16 v[76:79], v[196:199], v[44:47], v[76:79]
  ds_read_b64_tr_b16 v[44:45], v16 offset:30784
  ds_read_b64_tr_b16 v[46:47], v17 offset:30784
  s_waitcnt lgkmcnt(12)
  v_mfma_f32_16x16x32_bf16 v[60:63], v[116:119], v[88:91], v[60:63]
  v_mfma_f32_16x16x32_bf16 v[80:83], v[196:199], v[88:91], v[80:83]
  ds_read_b64_tr_b16 v[88:89], v16 offset:30816
  ds_read_b64_tr_b16 v[90:91], v17 offset:30816
  s_waitcnt lgkmcnt(12)
  v_mfma_f32_16x16x32_bf16 v[64:67], v[116:119], v[92:95], v[64:67]
  v_mfma_f32_16x16x32_bf16 v[84:87], v[196:199], v[92:95], v[84:87]
  ds_read_b64_tr_b16 v[92:93], v16 offset:30848
  ds_read_b64_tr_b16 v[94:95], v17 offset:30848
  v_dot2c_f32_bf16 v24, s61, v116
  v_dot2c_f32_bf16 v25, v116, v116
  v_dot2c_f32_bf16 v26, s61, v196
  v_dot2c_f32_bf16 v27, v196, v196
  v_dot2c_f32_bf16 v24, s61, v117
  v_dot2c_f32_bf16 v25, v117, v117
  v_dot2c_f32_bf16 v26, s61, v197
  v_dot2c_f32_bf16 v27, v197, v197
  v_dot2c_f32_bf16 v24, s61, v118
  v_dot2c_f32_bf16 v25, v118, v118
  v_dot2c_f32_bf16 v26, s61, v198
  v_dot2c_f32_bf16 v27, v198, v198
  v_dot2c_f32_bf16 v24, s61, v119
  v_dot2c_f32_bf16 v25, v119, v119
  v_dot2c_f32_bf16 v26, s61, v199
  v_dot2c_f32_bf16 v27, v199, v199
  s_waitcnt lgkmcnt(13)
  v_dot2c_f32_bf16 v28, s61, v32
  s_waitcnt lgkmcnt(11)
  v_dot2c_f32_bf16 v29, s61, v36
  v_dot2c_f32_bf16 v28, s61, v33
  v_dot2c_f32_bf16 v29, s61, v37
  v_dot2c_f32_bf16 v28, s61, v34
  s_waitcnt lgkmcnt(10)
  v_dot2c_f32_bf16 v29, s61, v38
  v_dot2c_f32_bf16 v28, s61, v35
  v_dot2c_f32_bf16 v29, s61, v39
  ds_read_b64_tr_b16 v[32:33], v18 offset:30720
  ds_read_b64_tr_b16 v[34:35], v19 offset:30720
  ds_read_b64_tr_b16 v[36:37], v18 offset:30848
  ds_read_b64_tr_b16 v[38:39], v19 offset:30848
  s_waitcnt lgkmcnt(12)
  v_mfma_f32_16x16x32_bf16 v[48:51], v[120:123], v[4:7], v[48:51]
  v_mfma_f32_16x16x32_bf16 v[68:71], v[200:203], v[4:7], v[68:71]
  ds_read_b64_tr_b16 v[4:5], v16 offset:35840
  ds_read_b64_tr_b16 v[6:7], v17 offset:35840
  s_waitcnt lgkmcnt(12)
  v_mfma_f32_16x16x32_bf16 v[52:55], v[120:123], v[20:23], v[52:55]
  v_mfma_f32_16x16x32_bf16 v[72:75], v[200:203], v[20:23], v[72:75]
  ds_read_b64_tr_b16 v[20:21], v16 offset:35872
  ds_read_b64_tr_b16 v[22:23], v17 offset:35872
  s_waitcnt lgkmcnt(12)
  v_mfma_f32_16x16x32_bf16 v[56:59], v[120:123], v[44:47], v[56:59]
  v_mfma_f32_16x16x32_bf16 v[76:79], v[200:203], v[44:47], v[76:79]
  ds_read_b64_tr_b16 v[44:45], v16 offset:35904
  ds_read_b64_tr_b16 v[46:47], v17 offset:35904
  s_waitcnt lgkmcnt(12)
  v_mfma_f32_16x16x32_bf16 v[60:63], v[120:123], v[88:91], v[60:63]
  v_mfma_f32_16x16x32_bf16 v[80:83], v[200:203], v[88:91], v[80:83]
  ds_read_b64_tr_b16 v[88:89], v16 offset:35936
  ds_read_b64_tr_b16 v[90:91], v17 offset:35936
  s_waitcnt lgkmcnt(12)
  v_mfma_f32_16x16x32_bf16 v[64:67], v[120:123], v[92:95], v[64:67]
  v_mfma_f32_16x16x32_bf16 v[84:87], v[200:203], v[92:95], v[84:87]
  ds_read_b64_tr_b16 v[92:93], v16 offset:35968
  ds_read_b64_tr_b16 v[94:95], v17 offset:35968
  v_dot2c_f32_bf16 v24, s61, v120
  v_dot2c_f32_bf16 v25, v120, v120
  v_dot2c_f32_bf16 v26, s61, v200
  v_dot2c_f32_bf16 v27, v200, v200
  v_dot2c_f32_bf16 v24, s61, v121
  v_dot2c_f32_bf16 v25, v121, v121
  v_dot2c_f32_bf16 v26, s61, v201
  v_dot2c_f32_bf16 v27, v201, v201
  v_dot2c_f32_bf16 v24, s61, v122
  v_dot2c_f32_bf16 v25, v122, v122
  v_dot2c_f32_bf16 v26, s61, v202
  v_dot2c_f32_bf16 v27, v202, v202
  v_dot2c_f32_bf16 v24, s61, v123
  v_dot2c_f32_bf16 v25, v123, v123
  v_dot2c_f32_bf16 v26, s61, v203
  v_dot2c_f32_bf16 v27, v203, v203
  s_waitcnt lgkmcnt(13)
  v_dot2c_f32_bf16 v28, s61, v32
  s_waitcnt lgkmcnt(11)
  v_dot2c_f32_bf16 v29, s61, v36
  v_dot2c_f32_bf16 v28, s61, v33
  v_dot2c_f32_bf16 v29, s61, v37
  v_dot2c_f32_bf16 v28, s61, v34
  s_waitcnt lgkmcnt(10)
  v_dot2c_f32_bf16 v29, s61, v38
  v_dot2c_f32_bf16 v28, s61, v35
  v_dot2c_f32_bf16 v29, s61, v39
  ds_read_b64_tr_b16 v[32:33], v18 offset:35840
  ds_read_b64_tr_b16 v[34:35], v19 offset:35840
  ds_read_b64_tr_b16 v[36:37], v18 offset:35968
  ds_read_b64_tr_b16 v[38:39], v19 offset:35968
  s_waitcnt lgkmcnt(12)
  v_mfma_f32_16x16x32_bf16 v[48:51], v[124:127], v[4:7], v[48:51]
  v_mfma_f32_16x16x32_bf16 v[68:71], v[204:207], v[4:7], v[68:71]
  s_waitcnt lgkmcnt(10)
  v_mfma_f32_16x16x32_bf16 v[52:55], v[124:127], v[20:23], v[52:55]
  v_mfma_f32_16x16x32_bf16 v[72:75], v[204:207], v[20:23], v[72:75]
  s_waitcnt lgkmcnt(8)
  v_mfma_f32_16x16x32_bf16 v[56:59], v[124:127], v[44:47], v[56:59]
  v_mfma_f32_16x16x32_bf16 v[76:79], v[204:207], v[44:47], v[76:79]
  s_waitcnt lgkmcnt(6)
  v_mfma_f32_16x16x32_bf16 v[60:63], v[124:127], v[88:91], v[60:63]
  v_mfma_f32_16x16x32_bf16 v[80:83], v[204:207], v[88:91], v[80:83]
  s_waitcnt lgkmcnt(4)
  v_mfma_f32_16x16x32_bf16 v[64:67], v[124:127], v[92:95], v[64:67]
  v_mfma_f32_16x16x32_bf16 v[84:87], v[204:207], v[92:95], v[84:87]
  v_dot2c_f32_bf16 v24, s61, v124
  v_dot2c_f32_bf16 v25, v124, v124
  v_dot2c_f32_bf16 v26, s61, v204
  v_dot2c_f32_bf16 v27, v204, v204
  v_dot2c_f32_bf16 v24, s61, v125
  v_dot2c_f32_bf16 v25, v125, v125
  v_dot2c_f32_bf16 v26, s61, v205
  v_dot2c_f32_bf16 v27, v205, v205
  v_dot2c_f32_bf16 v24, s61, v126
  v_dot2c_f32_bf16 v25, v126, v126
  v_dot2c_f32_bf16 v26, s61, v206
  v_dot2c_f32_bf16 v27, v206, v206
  v_dot2c_f32_bf16 v24, s61, v127
  v_dot2c_f32_bf16 v25, v127, v127
  v_dot2c_f32_bf16 v26, s61, v207
  v_dot2c_f32_bf16 v27, v207, v207
  s_waitcnt lgkmcnt(3)
  v_dot2c_f32_bf16 v28, s61, v32
  s_waitcnt lgkmcnt(1)
  v_dot2c_f32_bf16 v29, s61, v36
  v_dot2c_f32_bf16 v28, s61, v33
  v_dot2c_f32_bf16 v29, s61, v37
  v_dot2c_f32_bf16 v28, s61, v34
  s_waitcnt lgkmcnt(0)
  v_dot2c_f32_bf16 v29, s61, v38
  v_dot2c_f32_bf16 v28, s61, v35
  v_dot2c_f32_bf16 v29, s61, v39
  s_waitcnt lgkmcnt(0)
  v_mov_b32 v10, 5
  ds_write_b32 v11, v10 offset:16
  s_waitcnt lgkmcnt(0)
  s_mov_b32 s57, 0
L_12:
  ds_read_b128 v[12:15], v8 offset:0
  s_waitcnt lgkmcnt(0)
  v_min3_u32 v12, v12, v13, v14
  v_min_u32 v12, v12, v15
  s_nop 0
  v_readfirstlane_b32 s56, v12
  s_nop 3
  s_cmp_ge_u32 s56, 6
  s_cbranch_scc1 L_13
  s_add_u32 s57, s57, 1
  s_sleep 1
  s_cmp_lt_u32 s57, 0x400000
  s_cbranch_scc1 L_12
L_13:
  v_xor_b32 v12, 0, v30
  ds_read_b128 v[144:147], v12 offset:32768
  ds_read_b128 v[224:227], v12 offset:36864
  v_xor_b32 v13, 64, v30
  ds_read_b128 v[148:151], v13 offset:32768
  ds_read_b128 v[228:231], v13 offset:36864
  v_xor_b32 v14, 128, v30
  ds_read_b128 v[152:155], v14 offset:32768
  ds_read_b128 v[232:235], v14 offset:36864
  v_xor_b32 v15, 192, v30
  ds_read_b128 v[156:159], v15 offset:32768
  ds_read_b128 v[236:239], v15 offset:36864
  s_waitcnt lgkmcnt(0)
  v_mov_b32 v10, 6
  ds_write_b32 v11, v10 offset:16
  s_waitcnt lgkmcnt(0)
  s_mov_b32 s57, 0
L_14:
  ds_read_b128 v[12:15], v8 offset:0
  s_waitcnt lgkmcnt(0)
  v_min3_u32 v12, v12, v13, v14
  v_min_u32 v12, v12, v15
  s_nop 0
  v_readfirstlane_b32 s56, v12
  s_nop 3
  s_cmp_ge_u32 s56, 7
  s_cbranch_scc1 L_15
  s_add_u32 s57, s57, 1
  s_sleep 1
  s_cmp_lt_u32 s57, 0x400000
  s_cbranch_scc1 L_14
L_15:
  ds_read_b64_tr_b16 v[4:5], v16
  ds_read_b64_tr_b16 v[6:7], v17
  ds_read_b64_tr_b16 v[20:21], v16 offset:32
  ds_read_b64_tr_b16 v[22:23], v17 offset:32
  ds_read_b64_tr_b16 v[44:45], v16 offset:64
  ds_read_b64_tr_b16 v[46:47], v17 offset:64
  ds_read_b64_tr_b16 v[88:89], v16 offset:96
  ds_read_b64_tr_b16 v[90:91], v17 offset:96
  ds_read_b64_tr_b16 v[92:93], v16 offset:128
  ds_read_b64_tr_b16 v[94:95], v17 offset:128
  ds_read_b64_tr_b16 v[32:33], v18
  ds_read_b64_tr_b16 v[34:35], v19
  ds_read_b64_tr_b16 v[36:37], v18 offset:128
  ds_read_b64_tr_b16 v[38:39], v19 offset:128
  s_waitcnt lgkmcnt(12)
  v_mfma_f32_16x16x32_bf16 v[48:51], v[128:131], v[4:7], v[48:51]
  v_mfma_f32_16x16x32_bf16 v[68:71], v[208:211], v[4:7], v[68:71]
  ds_read_b64_tr_b16 v[4:5], v16 offset:5120
  ds_read_b64_tr_b16 v[6:7], v17 offset:5120
  s_waitcnt lgkmcnt(12)
  v_mfma_f32_16x16x32_bf16 v[52:55], v[128:131], v[20:23], v[52:55]
  v_mfma_f32_16x16x32_bf16 v[72:75], v[208:211], v[20:23], v[72:75]
  ds_read_b64_tr_b16 v[20:21], v16 offset:5152
  ds_read_b64_tr_b16 v[22:23], v17 offset:5152
  s_waitcnt lgkmcnt(12)
  v_mfma_f32_16x16x32_bf16 v[56:59], v[128:131], v[44:47], v[56:59]
  v_mfma_f32_16x16x32_bf16 v[76:79], v[208:211], v[44:47], v[76:79]
  ds_read_b64_tr_b16 v[44:45], v16 offset:5184
  ds_read_b64_tr_b16 v[46:47], v17 offset:5184
  s_waitcnt lgkmcnt(12)
  v_mfma_f32_16x16x32_bf16 v[60:63], v[128:131], v[88:91], v[60:63]
  v_mfma_f32_16x16x32_bf16 v[80:83], v[208:211], v[88:91], v[80:83]
  ds_read_b64_tr_b16 v[88:89], v16 offset:5216
  ds_read_b64_tr_b16 v[90:91], v17 offset:5216
  s_waitcnt lgkmcnt(12)
  v_mfma_f32_16x16x32_bf16 v[64:67], v[128:131], v[92:95], v[64:67]
  v_mfma_f32_16x16x32_bf16 v[84:87], v[208:211], v[92:95], v[84:87]
  ds_read_b64_tr_b16 v[92:93], v16 offset:5248
  ds_read_b64_tr_b16 v[94:95], v17 offset:5248
  v_dot2c_f32_bf16 v24, s61, v128
  v_dot2c_f32_bf16 v25, v128, v128
  v_dot2c_f32_bf16 v26, s61, v208
  v_dot2c_f32_bf16 v27, v208, v208
  v_dot2c_f32_bf16 v24, s61, v129
  v_dot2c_f32_bf16 v25, v129, v129
  v_dot2c_f32_bf16 v26, s61, v209
  v_dot2c_f32_bf16 v27, v209, v209
  v_dot2c_f32_bf16 v24, s61, v130
  v_dot2c_f32_bf16 v25, v130, v130
  v_dot2c_f32_bf16 v26, s61, v210
  v_dot2c_f32_bf16 v27, v210, v210
  v_dot2c_f32_bf16 v24, s61, v131
  v_dot2c_f32_bf16 v25, v131, v131
  v_dot2c_f32_bf16 v26, s61, v211
  v_dot2c_f32_bf16 v27, v211, v211
  s_waitcnt lgkmcnt(13)
  v_dot2c_f32_bf16 v28, s61, v32
  s_waitcnt lgkmcnt(11)
  v_dot2c_f32_bf16 v29, s61, v36
  v_dot2c_f32_bf16 v28, s61, v33
  v_dot2c_f32_bf16 v29, s61, v37
  v_dot2c_f32_bf16 v28, s61, v34
  s_waitcnt lgkmcnt(10)
  v_dot2c_f32_bf16 v29, s61, v38
  v_dot2c_f32_bf16 v28, s61, v35
  v_dot2c_f32_bf16 v29, s61, v39
  ds_read_b64_tr_b16 v[32:33], v18 offset:5120
  ds_read_b64_tr_b16 v[34:35], v19 offset:5120
  ds_read_b64_tr_b16 v[36:37], v18 offset:5248
  ds_read_b64_tr_b16 v[38:39], v19 offset:5248
  s_waitcnt lgkmcnt(12)
  v_mfma_f32_16x16x32_bf16 v[48:51], v[132:135], v[4:7], v[48:51]
  v_mfma_f32_16x16x32_bf16 v[68:71], v[212:215], v[4:7], v[68:71]
  ds_read_b64_tr_b16 v[4:5], v16 offset:10240
  ds_read_b64_tr_b16 v[6:7], v17 offset:10240
  s_waitcnt lgkmcnt(12)
  v_mfma_f32_16x16x32_bf16 v[52:55], v[132:135], v[20:23], v[52:55]
  v_mfma_f32_16x16x32_bf16 v[72:75], v[212:215], v[20:23], v[72:75]
  ds_read_b64_tr_b16 v[20:21], v16 offset:10272
  ds_read_b64_tr_b16 v[22:23], v17 offset:10272
  s_waitcnt lgkmcnt(12)
  v_mfma_f32_16x16x32_bf16 v[56:59], v[132:135], v[44:47], v[56:59]
  v_mfma_f32_16x16x32_bf16 v[76:79], v[212:215], v[44:47], v[76:79]
  ds_read_b64_tr_b16 v[44:45], v16 offset:10304
  ds_read_b64_tr_b16 v[46:47], v17 offset:10304
  s_waitcnt lgkmcnt(12)
  v_mfma_f32_16x16x32_bf16 v[60:63], v[132:135], v[88:91], v[60:63]
  v_mfma_f32_16x16x32_bf16 v[80:83], v[212:215], v[88:91], v[80:83]
  ds_read_b64_tr_b16 v[88:89], v16 offset:10336
  ds_read_b64_tr_b16 v[90:91], v17 offset:10336
  s_waitcnt lgkmcnt(12)
  v_mfma_f32_16x16x32_bf16 v[64:67], v[132:135], v[92:95], v[64:67]
  v_mfma_f32_16x16x32_bf16 v[84:87], v[212:215], v[92:95], v[84:87]
  ds_read_b64_tr_b16 v[92:93], v16 offset:10368
  ds_read_b64_tr_b16 v[94:95], v17 offset:10368
  v_dot2c_f32_bf16 v24, s61, v132
  v_dot2c_f32_bf16 v25, v132, v132
  v_dot2c_f32_bf16 v26, s61, v212
  v_dot2c_f32_bf16 v27, v212, v212
  v_dot2c_f32_bf16 v24, s61, v133
  v_dot2c_f32_bf16 v25, v133, v133
  v_dot2c_f32_bf16 v26, s61, v213
  v_dot2c_f32_bf16 v27, v213, v213
  v_dot2c_f32_bf16 v24, s61, v134
  v_dot2c_f32_bf16 v25, v134, v134
  v_dot2c_f32_bf16 v26, s61, v214
  v_dot2c_f32_bf16 v27, v214, v214
  v_dot2c_f32_bf16 v24, s61, v135
  v_dot2c_f32_bf16 v25, v135, v135
  v_dot2c_f32_bf16 v26, s61, v215
  v_dot2c_f32_bf16 v27, v215, v215
  s_waitcnt lgkmcnt(13)
  v_dot2c_f32_bf16 v28, s61, v32
  s_waitcnt lgkmcnt(11)
  v_dot2c_f32_bf16 v29, s61, v36
  v_dot2c_f32_bf16 v28, s61, v33
  v_dot2c_f32_bf16 v29, s61, v37
  v_dot2c_f32_bf16 v28, s61, v34
  s_waitcnt lgkmcnt(10)
  v_dot2c_f32_bf16 v29, s61, v38
  v_dot2c_f32_bf16 v28, s61, v35
  v_dot2c_f32_bf16 v29, s61, v39
  ds_read_b64_tr_b16 v[32:33], v18 offset:10240
  ds_read_b64_tr_b16 v[34:35], v19 offset:10240
  ds_read_b64_tr_b16 v[36:37], v18 offset:10368
  ds_read_b64_tr_b16 v[38:39], v19 offset:10368
  s_waitcnt lgkmcnt(12)
  v_mfma_f32_16x16x32_bf16 v[48:51], v[136:139], v[4:7], v[48:51]
  v_mfma_f32_16x16x32_bf16 v[68:71], v[216:219], v[4:7], v[68:71]
  ds_read_b64_tr_b16 v[4:5], v16 offset:15360
  ds_read_b64_tr_b16 v[6:7], v17 offset:15360
  s_waitcnt lgkmcnt(12)
  v_mfma_f32_16x16x32_bf16 v[52:55], v[136:139], v[20:23], v[52:55]
  v_mfma_f32_16x16x32_bf16 v[72:75], v[216:219], v[20:23], v[72:75]
  ds_read_b64_tr_b16 v[20:21], v16 offset:15392
  ds_read_b64_tr_b16 v[22:23], v17 offset:15392
  s_waitcnt lgkmcnt(12)
  v_mfma_f32_16x16x32_bf16 v[56:59], v[136:139], v[44:47], v[56:59]
  v_mfma_f32_16x16x32_bf16 v[76:79], v[216:219], v[44:47], v[76:79]
  ds_read_b64_tr_b16 v[44:45], v16 offset:15424
  ds_read_b64_tr_b16 v[46:47], v17 offset:15424
  s_waitcnt lgkmcnt(12)
  v_mfma_f32_16x16x32_bf16 v[60:63], v[136:139], v[88:91], v[60:63]
  v_mfma_f32_16x16x32_bf16 v[80:83], v[216:219], v[88:91], v[80:83]
  ds_read_b64_tr_b16 v[88:89], v16 offset:15456
  ds_read_b64_tr_b16 v[90:91], v17 offset:15456
  s_waitcnt lgkmcnt(12)
  v_mfma_f32_16x16x32_bf16 v[64:67], v[136:139], v[92:95], v[64:67]
  v_mfma_f32_16x16x32_bf16 v[84:87], v[216:219], v[92:95], v[84:87]
  ds_read_b64_tr_b16 v[92:93], v16 offset:15488
  ds_read_b64_tr_b16 v[94:95], v17 offset:15488
  v_dot2c_f32_bf16 v24, s61, v136
  v_dot2c_f32_bf16 v25, v136, v136
  v_dot2c_f32_bf16 v26, s61, v216
  v_dot2c_f32_bf16 v27, v216, v216
  v_dot2c_f32_bf16 v24, s61, v137
  v_dot2c_f32_bf16 v25, v137, v137
  v_dot2c_f32_bf16 v26, s61, v217
  v_dot2c_f32_bf16 v27, v217, v217
  v_dot2c_f32_bf16 v24, s61, v138
  v_dot2c_f32_bf16 v25, v138, v138
  v_dot2c_f32_bf16 v26, s61, v218
  v_dot2c_f32_bf16 v27, v218, v218
  v_dot2c_f32_bf16 v24, s61, v139
  v_dot2c_f32_bf16 v25, v139, v139
  v_dot2c_f32_bf16 v26, s61, v219
  v_dot2c_f32_bf16 v27, v219, v219
  s_waitcnt lgkmcnt(13)
  v_dot2c_f32_bf16 v28, s61, v32
  s_waitcnt lgkmcnt(11)
  v_dot2c_f32_bf16 v29, s61, v36
  v_dot2c_f32_bf16 v28, s61, v33
  v_dot2c_f32_bf16 v29, s61, v37
  v_dot2c_f32_bf16 v28, s61, v34
  s_waitcnt lgkmcnt(10)
  v_dot2c_f32_bf16 v29, s61, v38
  v_dot2c_f32_bf16 v28, s61, v35
  v_dot2c_f32_bf16 v29, s61, v39
  ds_read_b64_tr_b16 v[32:33], v18 offset:15360
  ds_read_b64_tr_b16 v[34:35], v19 offset:15360
  ds_read_b64_tr_b16 v[36:37], v18 offset:15488
  ds_read_b64_tr_b16 v[38:39], v19 offset:15488
  s_waitcnt lgkmcnt(12)
  v_mfma_f32_16x16x32_bf16 v[48:51], v[140:143], v[4:7], v[48:51]
  v_mfma_f32_16x16x32_bf16 v[68:71], v[220:223], v[4:7], v[68:71]
  s_waitcnt lgkmcnt(10)
  v_mfma_f32_16x16x32_bf16 v[52:55], v[140:143], v[20:23], v[52:55]
  v_mfma_f32_16x16x32_bf16 v[72:75], v[220:223], v[20:23], v[72:75]
  s_waitcnt lgkmcnt(8)
  v_mfma_f32_16x16x32_bf16 v[56:59], v[140:143], v[44:47], v[56:59]
  v_mfma_f32_16x16x32_bf16 v[76:79], v[220:223], v[44:47], v[76:79]
  s_waitcnt lgkmcnt(6)
  v_mfma_f32_16x16x32_bf16 v[60:63], v[140:143], v[88:91], v[60:63]
  v_mfma_f32_16x16x32_bf16 v[80:83], v[220:223], v[88:91], v[80:83]
  s_waitcnt lgkmcnt(4)
  v_mfma_f32_16x16x32_bf16 v[64:67], v[140:143], v[92:95], v[64:67]
  v_mfma_f32_16x16x32_bf16 v[84:87], v[220:223], v[92:95], v[84:87]
  v_dot2c_f32_bf16 v24, s61, v140
  v_dot2c_f32_bf16 v25, v140, v140
  v_dot2c_f32_bf16 v26, s61, v220
  v_dot2c_f32_bf16 v27, v220, v220
  v_dot2c_f32_bf16 v24, s61, v141
  v_dot2c_f32_bf16 v25, v141, v141
  v_dot2c_f32_bf16 v26, s61, v221
  v_dot2c_f32_bf16 v27, v221, v221
  v_dot2c_f32_bf16 v24, s61, v142
  v_dot2c_f32_bf16 v25, v142, v142
  v_dot2c_f32_bf16 v26, s61, v222
  v_dot2c_f32_bf16 v27, v222, v222
  v_dot2c_f32_bf16 v24, s61, v143
  v_dot2c_f32_bf16 v25, v143, v143
  v_dot2c_f32_bf16 v26, s61, v223
  v_dot2c_f32_bf16 v27, v223, v223
  s_waitcnt lgkmcnt(3)
  v_dot2c_f32_bf16 v28, s61, v32
  s_waitcnt lgkmcnt(1)
  v_dot2c_f32_bf16 v29, s61, v36
  v_dot2c_f32_bf16 v28, s61, v33
  v_dot2c_f32_bf16 v29, s61, v37
  v_dot2c_f32_bf16 v28, s61, v34
  s_waitcnt lgkmcnt(0)
  v_dot2c_f32_bf16 v29, s61, v38
  v_dot2c_f32_bf16 v28, s61, v35
  v_dot2c_f32_bf16 v29, s61, v39
  s_waitcnt lgkmcnt(0)
  v_mov_b32 v10, 7
  ds_write_b32 v11, v10 offset:16
  s_lshl_b32 s56, s2, 2
  s_add_u32 s56, s56, s7
  s_mul_i32 s60, s56, 800
  v_lshlrev_b32 v12, 4, v1
  v_cmp_gt_u32 vcc, 800, v12
  v_bfrev_b32 v13, 1
  s_nop 0
  v_cndmask_b32 v12, v13, v12, vcc
  s_lshl_b32 s57, s7, 12
  s_mov_b32 s84, s36
  s_mov_b32 s85, s37
  s_mov_b32 s86, 819200
  s_mov_b32 s87, 0x00020000
  s_add_u32 m0, s57, 122880
  s_nop 0
  buffer_load_dwordx4 v12, s[84:87], s60 offen lds
  s_mov_b32 s84, s40
  s_mov_b32 s85, s41
  s_mov_b32 s86, 819200
  s_mov_b32 s87, 0x00020000
  s_add_u32 m0, s57, 123904
  s_nop 0
  buffer_load_dwordx4 v12, s[84:87], s60 offen lds
  s_waitcnt lgkmcnt(0)
  s_mov_b32 s57, 0
L_16:
  ds_read_b128 v[12:15], v8 offset:0
  s_waitcnt lgkmcnt(0)
  v_min3_u32 v12, v12, v13, v14
  v_min_u32 v12, v12, v15
  s_nop 0
  v_readfirstlane_b32 s56, v12
  s_nop 3
  s_cmp_ge_u32 s56, 8
  s_cbranch_scc1 L_17
  s_add_u32 s57, s57, 1
  s_sleep 1
  s_cmp_lt_u32 s57, 0x400000
  s_cbranch_scc1 L_16
L_17:
  v_xor_b32 v12, 0, v30
  ds_read_b128 v[160:163], v12
  ds_read_b128 v[240:243], v12 offset:4096
  v_xor_b32 v13, 64, v30
  ds_read_b128 v[164:167], v13
  ds_read_b128 v[244:247], v13 offset:4096
  v_xor_b32 v14, 128, v30
  ds_read_b128 v[168:171], v14
  ds_read_b128 v[248:251], v14 offset:4096
  v_xor_b32 v15, 192, v30
  ds_read_b128 v[172:175], v15
  ds_read_b128 v[252:255], v15 offset:4096
  s_waitcnt lgkmcnt(0)
  v_mov_b32 v10, 8
  ds_write_b32 v11, v10 offset:16
  s_waitcnt lgkmcnt(0)
  s_mov_b32 s57, 0
L_18:
  ds_read_b128 v[12:15], v8 offset:0
  s_waitcnt lgkmcnt(0)
  v_min3_u32 v12, v12, v13, v14
  v_min_u32 v12, v12, v15
  s_nop 0
  v_readfirstlane_b32 s56, v12
  s_nop 3
  s_cmp_ge_u32 s56, 9
  s_cbranch_scc1 L_19
  s_add_u32 s57, s57, 1
  s_sleep 1
  s_cmp_lt_u32 s57, 0x400000
  s_cbranch_scc1 L_18
L_19:
  ds_read_b64_tr_b16 v[4:5], v16 offset:20480
  ds_read_b64_tr_b16 v[6:7], v17 offset:20480
  ds_read_b64_tr_b16 v[20:21], v16 offset:20512
  ds_read_b64_tr_b16 v[22:23], v17 offset:20512
  ds_read_b64_tr_b16 v[44:45], v16 offset:20544
  ds_read_b64_tr_b16 v[46:47], v17 offset:20544
  ds_read_b64_tr_b16 v[88:89], v16 offset:20576
  ds_read_b64_tr_b16 v[90:91], v17 offset:20576
  ds_read_b64_tr_b16 v[92:93], v16 offset:20608
  ds_read_b64_tr_b16 v[94:95], v17 offset:20608
  ds_read_b64_tr_b16 v[32:33], v18 offset:20480
  ds_read_b64_tr_b16 v[34:35], v19 offset:20480
  ds_read_b64_tr_b16 v[36:37], v18 offset:20608
  ds_read_b64_tr_b16 v[38:39], v19 offset:20608
  s_waitcnt lgkmcnt(12)
  v_mfma_f32_16x16x32_bf16 v[48:51], v[144:147], v[4:7], v[48:51]
  v_mfma_f32_16x16x32_bf16 v[68:71], v[224:227], v[4:7], v[68:71]
  ds_read_b64_tr_b16 v[4:5], v16 offset:25600
  ds_read_b64_tr_b16 v[6:7], v17 offset:25600
  s_waitcnt lgkmcnt(12)
  v_mfma_f32_16x16x32_bf16 v[52:55], v[144:147], v[20:23], v[52:55]
  v_mfma_f32_16x16x32_bf16 v[72:75], v[224:227], v[20:23], v[72:75]
  ds_read_b64_tr_b16 v[20:21], v16 offset:25632
  ds_read_b64_tr_b16 v[22:23], v17 offset:25632
  s_waitcnt lgkmcnt(12)
  v_mfma_f32_16x16x32_bf16 v[56:59], v[144:147], v[44:47], v[56:59]
  v_mfma_f32_16x16x32_bf16 v[76:79], v[224:227], v[44:47], v[76:79]
  ds_read_b64_tr_b16 v[44:45], v16 offset:25664
  ds_read_b64_tr_b16 v[46:47], v17 offset:25664
  s_waitcnt lgkmcnt(12)
  v_mfma_f32_16x16x32_bf16 v[60:63], v[144:147], v[88:91], v[60:63]
  v_mfma_f32_16x16x32_bf16 v[80:83], v[224:227], v[88:91], v[80:83]
  ds_read_b64_tr_b16 v[88:89], v16 offset:25696
  ds_read_b64_tr_b16 v[90:91], v17 offset:25696
  s_waitcnt lgkmcnt(12)
  v_mfma_f32_16x16x32_bf16 v[64:67], v[144:147], v[92:95], v[64:67]
  v_mfma_f32_16x16x32_bf16 v[84:87], v[224:227], v[92:95], v[84:87]
  ds_read_b64_tr_b16 v[92:93], v16 offset:25728
  ds_read_b64_tr_b16 v[94:95], v17 offset:25728
  v_dot2c_f32_bf16 v24, s61, v144
  v_dot2c_f32_bf16 v25, v144, v144
  v_dot2c_f32_bf16 v26, s61, v224
  v_dot2c_f32_bf16 v27, v224, v224
  v_dot2c_f32_bf16 v24, s61, v145
  v_dot2c_f32_bf16 v25, v145, v145
  v_dot2c_f32_bf16 v26, s61, v225
  v_dot2c_f32_bf16 v27, v225, v225
  v_dot2c_f32_bf16 v24, s61, v146
  v_dot2c_f32_bf16 v25, v146, v146
  v_dot2c_f32_bf16 v26, s61, v226
  v_dot2c_f32_bf16 v27, v226, v226
  v_dot2c_f32_bf16 v24, s61, v147
  v_dot2c_f32_bf16 v25, v147, v147
  v_dot2c_f32_bf16 v26, s61, v227
  v_dot2c_f32_bf16 v27, v227, v227
  s_waitcnt lgkmcnt(13)
  v_dot2c_f32_bf16 v28, s61, v32
  s_waitcnt lgkmcnt(11)
  v_dot2c_f32_bf16 v29, s61, v36
  v_dot2c_f32_bf16 v28, s61, v33
  v_dot2c_f32_bf16 v29, s61, v37
  v_dot2c_f32_bf16 v28, s61, v34
  s_waitcnt lgkmcnt(10)
  v_dot2c_f32_bf16 v29, s61, v38
  v_dot2c_f32_bf16 v28, s61, v35
  v_dot2c_f32_bf16 v29, s61, v39
  ds_read_b64_tr_b16 v[32:33], v18 offset:25600
  ds_read_b64_tr_b16 v[34:35], v19 offset:25600
  ds_read_b64_tr_b16 v[36:37], v18 offset:25728
  ds_read_b64_tr_b16 v[38:39], v19 offset:25728
  s_waitcnt lgkmcnt(12)
  v_mfma_f32_16x16x32_bf16 v[48:51], v[148:151], v[4:7], v[48:51]
  v_mfma_f32_16x16x32_bf16 v[68:71], v[228:231], v[4:7], v[68:71]
  ds_read_b64_tr_b16 v[4:5], v16 offset:30720
  ds_read_b64_tr_b16 v[6:7], v17 offset:30720
  s_waitcnt lgkmcnt(12)
  v_mfma_f32_16x16x32_bf16 v[52:55], v[148:151], v[20:23], v[52:55]
  v_mfma_f32_16x16x32_bf16 v[72:75], v[228:231], v[20:23], v[72:75]
  ds_read_b64_tr_b16 v[20:21], v16 offset:30752
  ds_read_b64_tr_b16 v[22:23], v17 offset:30752
  s_waitcnt lgkmcnt(12)
  v_mfma_f32_16x16x32_bf16 v[56:59], v[148:151], v[44:47], v[56:59]
  v_mfma_f32_16x16x32_bf16 v[76:79], v[228:231], v[44:47], v[76:79]
  ds_read_b64_tr_b16 v[44:45], v16 offset:30784
  ds_read_b64_tr_b16 v[46:47], v17 offset:30784
  s_waitcnt lgkmcnt(12)
  v_mfma_f32_16x16x32_bf16 v[60:63], v[148:151], v[88:91], v[60:63]
  v_mfma_f32_16x16x32_bf16 v[80:83], v[228:231], v[88:91], v[80:83]
  ds_read_b64_tr_b16 v[88:89], v16 offset:30816
  ds_read_b64_tr_b16 v[90:91], v17 offset:30816
  s_waitcnt lgkmcnt(12)
  v_mfma_f32_16x16x32_bf16 v[64:67], v[148:151], v[92:95], v[64:67]
  v_mfma_f32_16x16x32_bf16 v[84:87], v[228:231], v[92:95], v[84:87]
  ds_read_b64_tr_b16 v[92:93], v16 offset:30848
  ds_read_b64_tr_b16 v[94:95], v17 offset:30848
  v_dot2c_f32_bf16 v24, s61, v148
  v_dot2c_f32_bf16 v25, v148, v148
  v_dot2c_f32_bf16 v26, s61, v228
  v_dot2c_f32_bf16 v27, v228, v228
  v_dot2c_f32_bf16 v24, s61, v149
  v_dot2c_f32_bf16 v25, v149, v149
  v_dot2c_f32_bf16 v26, s61, v229
  v_dot2c_f32_bf16 v27, v229, v229
  v_dot2c_f32_bf16 v24, s61, v150
  v_dot2c_f32_bf16 v25, v150, v150
  v_dot2c_f32_bf16 v26, s61, v230
  v_dot2c_f32_bf16 v27, v230, v230
  v_dot2c_f32_bf16 v24, s61, v151
  v_dot2c_f32_bf16 v25, v151, v151
  v_dot2c_f32_bf16 v26, s61, v231
  v_dot2c_f32_bf16 v27, v231, v231
  s_waitcnt lgkmcnt(13)
  v_dot2c_f32_bf16 v28, s61, v32
  s_waitcnt lgkmcnt(11)
  v_dot2c_f32_bf16 v29, s61, v36
  v_dot2c_f32_bf16 v28, s61, v33
  v_dot2c_f32_bf16 v29, s61, v37
  v_dot2c_f32_bf16 v28, s61, v34
  s_waitcnt lgkmcnt(10)
  v_dot2c_f32_bf16 v29, s61, v38
  v_dot2c_f32_bf16 v28, s61, v35
  v_dot2c_f32_bf16 v29, s61, v39
  ds_read_b64_tr_b16 v[32:33], v18 offset:30720
  ds_read_b64_tr_b16 v[34:35], v19 offset:30720
  ds_read_b64_tr_b16 v[36:37], v18 offset:30848
  ds_read_b64_tr_b16 v[38:39], v19 offset:30848
  s_waitcnt lgkmcnt(12)
  v_mfma_f32_16x16x32_bf16 v[48:51], v[152:155], v[4:7], v[48:51]
  v_mfma_f32_16x16x32_bf16 v[68:71], v[232:235], v[4:7], v[68:71]
  ds_read_b64_tr_b16 v[4:5], v16 offset:35840
  ds_read_b64_tr_b16 v[6:7], v17 offset:35840
  s_waitcnt lgkmcnt(12)
  v_mfma_f32_16x16x32_bf16 v[52:55], v[152:155], v[20:23], v[52:55]
  v_mfma_f32_16x16x32_bf16 v[72:75], v[232:235], v[20:23], v[72:75]
  ds_read_b64_tr_b16 v[20:21], v16 offset:35872
  ds_read_b64_tr_b16 v[22:23], v17 offset:35872
  s_waitcnt lgkmcnt(12)
  v_mfma_f32_16x16x32_bf16 v[56:59], v[152:155], v[44:47], v[56:59]
  v_mfma_f32_16x16x32_bf16 v[76:79], v[232:235], v[44:47], v[76:79]
  ds_read_b64_tr_b16 v[44:45], v16 offset:35904
  ds_read_b64_tr_b16 v[46:47], v17 offset:35904
  s_waitcnt lgkmcnt(12)
  v_mfma_f32_16x16x32_bf16 v[60:63], v[152:155], v[88:91], v[60:63]
  v_mfma_f32_16x16x32_bf16 v[80:83], v[232:235], v[88:91], v[80:83]
  ds_read_b64_tr_b16 v[88:89], v16 offset:35936
  ds_read_b64_tr_b16 v[90:91], v17 offset:35936
  s_waitcnt lgkmcnt(12)
  v_mfma_f32_16x16x32_bf16 v[64:67], v[152:155], v[92:95], v[64:67]
  v_mfma_f32_16x16x32_bf16 v[84:87], v[232:235], v[92:95], v[84:87]
  ds_read_b64_tr_b16 v[92:93], v16 offset:35968
  ds_read_b64_tr_b16 v[94:95], v17 offset:35968
  v_dot2c_f32_bf16 v24, s61, v152
  v_dot2c_f32_bf16 v25, v152, v152
  v_dot2c_f32_bf16 v26, s61, v232
  v_dot2c_f32_bf16 v27, v232, v232
  v_dot2c_f32_bf16 v24, s61, v153
  v_dot2c_f32_bf16 v25, v153, v153
  v_dot2c_f32_bf16 v26, s61, v233
  v_dot2c_f32_bf16 v27, v233, v233
  v_dot2c_f32_bf16 v24, s61, v154
  v_dot2c_f32_bf16 v25, v154, v154
  v_dot2c_f32_bf16 v26, s61, v234
  v_dot2c_f32_bf16 v27, v234, v234
  v_dot2c_f32_bf16 v24, s61, v155
  v_dot2c_f32_bf16 v25, v155, v155
  v_dot2c_f32_bf16 v26, s61, v235
  v_dot2c_f32_bf16 v27, v235, v235
  s_waitcnt lgkmcnt(13)
  v_dot2c_f32_bf16 v28, s61, v32
  s_waitcnt lgkmcnt(11)
  v_dot2c_f32_bf16 v29, s61, v36
  v_dot2c_f32_bf16 v28, s61, v33
  v_dot2c_f32_bf16 v29, s61, v37
  v_dot2c_f32_bf16 v28, s61, v34
  s_waitcnt lgkmcnt(10)
  v_dot2c_f32_bf16 v29, s61, v38
  v_dot2c_f32_bf16 v28, s61, v35
  v_dot2c_f32_bf16 v29, s61, v39
  ds_read_b64_tr_b16 v[32:33], v18 offset:35840
  ds_read_b64_tr_b16 v[34:35], v19 offset:35840
  ds_read_b64_tr_b16 v[36:37], v18 offset:35968
  ds_read_b64_tr_b16 v[38:39], v19 offset:35968
  s_waitcnt lgkmcnt(12)
  v_mfma_f32_16x16x32_bf16 v[48:51], v[156:159], v[4:7], v[48:51]
  v_mfma_f32_16x16x32_bf16 v[68:71], v[236:239], v[4:7], v[68:71]
  s_waitcnt lgkmcnt(10)
  v_mfma_f32_16x16x32_bf16 v[52:55], v[156:159], v[20:23], v[52:55]
  v_mfma_f32_16x16x32_bf16 v[72:75], v[236:239], v[20:23], v[72:75]
  s_waitcnt lgkmcnt(8)
  v_mfma_f32_16x16x32_bf16 v[56:59], v[156:159], v[44:47], v[56:59]
  v_mfma_f32_16x16x32_bf16 v[76:79], v[236:239], v[44:47], v[76:79]
  s_waitcnt lgkmcnt(6)
  v_mfma_f32_16x16x32_bf16 v[60:63], v[156:159], v[88:91], v[60:63]
  v_mfma_f32_16x16x32_bf16 v[80:83], v[236:239], v[88:91], v[80:83]
  s_waitcnt lgkmcnt(4)
  v_mfma_f32_16x16x32_bf16 v[64:67], v[156:159], v[92:95], v[64:67]
  v_mfma_f32_16x16x32_bf16 v[84:87], v[236:239], v[92:95], v[84:87]
  v_dot2c_f32_bf16 v24, s61, v156
  v_dot2c_f32_bf16 v25, v156, v156
  v_dot2c_f32_bf16 v26, s61, v236
  v_dot2c_f32_bf16 v27, v236, v236
  v_dot2c_f32_bf16 v24, s61, v157
  v_dot2c_f32_bf16 v25, v157, v157
  v_dot2c_f32_bf16 v26, s61, v237
  v_dot2c_f32_bf16 v27, v237, v237
  v_dot2c_f32_bf16 v24, s61, v158
  v_dot2c_f32_bf16 v25, v158, v158
  v_dot2c_f32_bf16 v26, s61, v238
  v_dot2c_f32_bf16 v27, v238, v238
  v_dot2c_f32_bf16 v24, s61, v159
  v_dot2c_f32_bf16 v25, v159, v159
  v_dot2c_f32_bf16 v26, s61, v239
  v_dot2c_f32_bf16 v27, v239, v239
  s_waitcnt lgkmcnt(3)
  v_dot2c_f32_bf16 v28, s61, v32
  s_waitcnt lgkmcnt(1)
  v_dot2c_f32_bf16 v29, s61, v36
  v_dot2c_f32_bf16 v28, s61, v33
  v_dot2c_f32_bf16 v29, s61, v37
  v_dot2c_f32_bf16 v28, s61, v34
  s_waitcnt lgkmcnt(0)
  v_dot2c_f32_bf16 v29, s61, v38
  v_dot2c_f32_bf16 v28, s61, v35
  v_dot2c_f32_bf16 v29, s61, v39
  s_waitcnt lgkmcnt(0)
  v_mov_b32 v10, 9
  ds_write_b32 v11, v10 offset:16
  s_waitcnt lgkmcnt(0)
  s_mov_b32 s57, 0
L_20:
  ds_read_b128 v[12:15], v8 offset:0
  s_waitcnt lgkmcnt(0)
  v_min3_u32 v12, v12, v13, v14
  v_min_u32 v12, v12, v15
  s_nop 0
  v_readfirstlane_b32 s56, v12
  s_nop 3
  s_cmp_ge_u32 s56, 10
  s_cbranch_scc1 L_21
  s_add_u32 s57, s57, 1
  s_sleep 1
  s_cmp_lt_u32 s57, 0x400000
  s_cbranch_scc1 L_20
L_21:
  ds_read_b64_tr_b16 v[4:5], v16
  ds_read_b64_tr_b16 v[6:7], v17
  ds_read_b64_tr_b16 v[20:21], v16 offset:32
  ds_read_b64_tr_b16 v[22:23], v17 offset:32
  ds_read_b64_tr_b16 v[44:45], v16 offset:64
  ds_read_b64_tr_b16 v[46:47], v17 offset:64
  ds_read_b64_tr_b16 v[88:89], v16 offset:96
  ds_read_b64_tr_b16 v[90:91], v17 offset:96
  ds_read_b64_tr_b16 v[92:93], v16 offset:128
  ds_read_b64_tr_b16 v[94:95], v17 offset:128
  ds_read_b64_tr_b16 v[32:33], v18
  ds_read_b64_tr_b16 v[34:35], v19
  ds_read_b64_tr_b16 v[36:37], v18 offset:128
  ds_read_b64_tr_b16 v[38:39], v19 offset:128
  s_waitcnt lgkmcnt(12)
  v_mfma_f32_16x16x32_bf16 v[48:51], v[160:163], v[4:7], v[48:51]
  v_mfma_f32_16x16x32_bf16 v[68:71], v[240:243], v[4:7], v[68:71]
  ds_read_b64_tr_b16 v[4:5], v16 offset:5120
  ds_read_b64_tr_b16 v[6:7], v17 offset:5120
  s_waitcnt lgkmcnt(12)
  v_mfma_f32_16x16x32_bf16 v[52:55], v[160:163], v[20:23], v[52:55]
  v_mfma_f32_16x16x32_bf16 v[72:75], v[240:243], v[20:23], v[72:75]
  ds_read_b64_tr_b16 v[20:21], v16 offset:5152
  ds_read_b64_tr_b16 v[22:23], v17 offset:5152
  s_waitcnt lgkmcnt(12)
  v_mfma_f32_16x16x32_bf16 v[56:59], v[160:163], v[44:47], v[56:59]
  v_mfma_f32_16x16x32_bf16 v[76:79], v[240:243], v[44:47], v[76:79]
  ds_read_b64_tr_b16 v[44:45], v16 offset:5184
  ds_read_b64_tr_b16 v[46:47], v17 offset:5184
  s_waitcnt lgkmcnt(12)
  v_mfma_f32_16x16x32_bf16 v[60:63], v[160:163], v[88:91], v[60:63]
  v_mfma_f32_16x16x32_bf16 v[80:83], v[240:243], v[88:91], v[80:83]
  ds_read_b64_tr_b16 v[88:89], v16 offset:5216
  ds_read_b64_tr_b16 v[90:91], v17 offset:5216
  s_waitcnt lgkmcnt(12)
  v_mfma_f32_16x16x32_bf16 v[64:67], v[160:163], v[92:95], v[64:67]
  v_mfma_f32_16x16x32_bf16 v[84:87], v[240:243], v[92:95], v[84:87]
  ds_read_b64_tr_b16 v[92:93], v16 offset:5248
  ds_read_b64_tr_b16 v[94:95], v17 offset:5248
  v_dot2c_f32_bf16 v24, s61, v160
  v_dot2c_f32_bf16 v25, v160, v160
  v_dot2c_f32_bf16 v26, s61, v240
  v_dot2c_f32_bf16 v27, v240, v240
  v_dot2c_f32_bf16 v24, s61, v161
  v_dot2c_f32_bf16 v25, v161, v161
  v_dot2c_f32_bf16 v26, s61, v241
  v_dot2c_f32_bf16 v27, v241, v241
  v_dot2c_f32_bf16 v24, s61, v162
  v_dot2c_f32_bf16 v25, v162, v162
  v_dot2c_f32_bf16 v26, s61, v242
  v_dot2c_f32_bf16 v27, v242, v242
  v_dot2c_f32_bf16 v24, s61, v163
  v_dot2c_f32_bf16 v25, v163, v163
  v_dot2c_f32_bf16 v26, s61, v243
  v_dot2c_f32_bf16 v27, v243, v243
  s_waitcnt lgkmcnt(13)
  v_dot2c_f32_bf16 v28, s61, v32
  s_waitcnt lgkmcnt(11)
  v_dot2c_f32_bf16 v29, s61, v36
  v_dot2c_f32_bf16 v28, s61, v33
  v_dot2c_f32_bf16 v29, s61, v37
  v_dot2c_f32_bf16 v28, s61, v34
  s_waitcnt lgkmcnt(10)
  v_dot2c_f32_bf16 v29, s61, v38
  v_dot2c_f32_bf16 v28, s61, v35
  v_dot2c_f32_bf16 v29, s61, v39
  ds_read_b64_tr_b16 v[32:33], v18 offset:5120
  ds_read_b64_tr_b16 v[34:35], v19 offset:5120
  ds_read_b64_tr_b16 v[36:37], v18 offset:5248
  ds_read_b64_tr_b16 v[38:39], v19 offset:5248
  s_waitcnt lgkmcnt(12)
  v_mfma_f32_16x16x32_bf16 v[48:51], v[164:167], v[4:7], v[48:51]
  v_mfma_f32_16x16x32_bf16 v[68:71], v[244:247], v[4:7], v[68:71]
  ds_read_b64_tr_b16 v[4:5], v16 offset:10240
  ds_read_b64_tr_b16 v[6:7], v17 offset:10240
  s_waitcnt lgkmcnt(12)
  v_mfma_f32_16x16x32_bf16 v[52:55], v[164:167], v[20:23], v[52:55]
  v_mfma_f32_16x16x32_bf16 v[72:75], v[244:247], v[20:23], v[72:75]
  ds_read_b64_tr_b16 v[20:21], v16 offset:10272
  ds_read_b64_tr_b16 v[22:23], v17 offset:10272
  s_waitcnt lgkmcnt(12)
  v_mfma_f32_16x16x32_bf16 v[56:59], v[164:167], v[44:47], v[56:59]
  v_mfma_f32_16x16x32_bf16 v[76:79], v[244:247], v[44:47], v[76:79]
  ds_read_b64_tr_b16 v[44:45], v16 offset:10304
  ds_read_b64_tr_b16 v[46:47], v17 offset:10304
  s_waitcnt lgkmcnt(12)
  v_mfma_f32_16x16x32_bf16 v[60:63], v[164:167], v[88:91], v[60:63]
  v_mfma_f32_16x16x32_bf16 v[80:83], v[244:247], v[88:91], v[80:83]
  ds_read_b64_tr_b16 v[88:89], v16 offset:10336
  ds_read_b64_tr_b16 v[90:91], v17 offset:10336
  s_waitcnt lgkmcnt(12)
  v_mfma_f32_16x16x32_bf16 v[64:67], v[164:167], v[92:95], v[64:67]
  v_mfma_f32_16x16x32_bf16 v[84:87], v[244:247], v[92:95], v[84:87]
  ds_read_b64_tr_b16 v[92:93], v16 offset:10368
  ds_read_b64_tr_b16 v[94:95], v17 offset:10368
  v_dot2c_f32_bf16 v24, s61, v164
  v_dot2c_f32_bf16 v25, v164, v164
  v_dot2c_f32_bf16 v26, s61, v244
  v_dot2c_f32_bf16 v27, v244, v244
  v_dot2c_f32_bf16 v24, s61, v165
  v_dot2c_f32_bf16 v25, v165, v165
  v_dot2c_f32_bf16 v26, s61, v245
  v_dot2c_f32_bf16 v27, v245, v245
  v_dot2c_f32_bf16 v24, s61, v166
  v_dot2c_f32_bf16 v25, v166, v166
  v_dot2c_f32_bf16 v26, s61, v246
  v_dot2c_f32_bf16 v27, v246, v246
  v_dot2c_f32_bf16 v24, s61, v167
  v_dot2c_f32_bf16 v25, v167, v167
  v_dot2c_f32_bf16 v26, s61, v247
  v_dot2c_f32_bf16 v27, v247, v247
  s_waitcnt lgkmcnt(13)
  v_dot2c_f32_bf16 v28, s61, v32
  s_waitcnt lgkmcnt(11)
  v_dot2c_f32_bf16 v29, s61, v36
  v_dot2c_f32_bf16 v28, s61, v33
  v_dot2c_f32_bf16 v29, s61, v37
  v_dot2c_f32_bf16 v28, s61, v34
  s_waitcnt lgkmcnt(10)
  v_dot2c_f32_bf16 v29, s61, v38
  v_dot2c_f32_bf16 v28, s61, v35
  v_dot2c_f32_bf16 v29, s61, v39
  ds_read_b64_tr_b16 v[32:33], v18 offset:10240
  ds_read_b64_tr_b16 v[34:35], v19 offset:10240
  ds_read_b64_tr_b16 v[36:37], v18 offset:10368
  ds_read_b64_tr_b16 v[38:39], v19 offset:10368
  s_waitcnt lgkmcnt(12)
  v_mfma_f32_16x16x32_bf16 v[48:51], v[168:171], v[4:7], v[48:51]
  v_mfma_f32_16x16x32_bf16 v[68:71], v[248:251], v[4:7], v[68:71]
  ds_read_b64_tr_b16 v[4:5], v16 offset:15360
  ds_read_b64_tr_b16 v[6:7], v17 offset:15360
  s_waitcnt lgkmcnt(12)
  v_mfma_f32_16x16x32_bf16 v[52:55], v[168:171], v[20:23], v[52:55]
  v_mfma_f32_16x16x32_bf16 v[72:75], v[248:251], v[20:23], v[72:75]
  ds_read_b64_tr_b16 v[20:21], v16 offset:15392
  ds_read_b64_tr_b16 v[22:23], v17 offset:15392
  s_waitcnt lgkmcnt(12)
  v_mfma_f32_16x16x32_bf16 v[56:59], v[168:171], v[44:47], v[56:59]
  v_mfma_f32_16x16x32_bf16 v[76:79], v[248:251], v[44:47], v[76:79]
  ds_read_b64_tr_b16 v[44:45], v16 offset:15424
  ds_read_b64_tr_b16 v[46:47], v17 offset:15424
  s_waitcnt lgkmcnt(12)
  v_mfma_f32_16x16x32_bf16 v[60:63], v[168:171], v[88:91], v[60:63]
  v_mfma_f32_16x16x32_bf16 v[80:83], v[248:251], v[88:91], v[80:83]
  ds_read_b64_tr_b16 v[88:89], v16 offset:15456
  ds_read_b64_tr_b16 v[90:91], v17 offset:15456
  s_waitcnt lgkmcnt(12)
  v_mfma_f32_16x16x32_bf16 v[64:67], v[168:171], v[92:95], v[64:67]
  v_mfma_f32_16x16x32_bf16 v[84:87], v[248:251], v[92:95], v[84:87]
  ds_read_b64_tr_b16 v[92:93], v16 offset:15488
  ds_read_b64_tr_b16 v[94:95], v17 offset:15488
  v_dot2c_f32_bf16 v24, s61, v168
  v_dot2c_f32_bf16 v25, v168, v168
  v_dot2c_f32_bf16 v26, s61, v248
  v_dot2c_f32_bf16 v27, v248, v248
  v_dot2c_f32_bf16 v24, s61, v169
  v_dot2c_f32_bf16 v25, v169, v169
  v_dot2c_f32_bf16 v26, s61, v249
  v_dot2c_f32_bf16 v27, v249, v249
  v_dot2c_f32_bf16 v24, s61, v170
  v_dot2c_f32_bf16 v25, v170, v170
  v_dot2c_f32_bf16 v26, s61, v250
  v_dot2c_f32_bf16 v27, v250, v250
  v_dot2c_f32_bf16 v24, s61, v171
  v_dot2c_f32_bf16 v25, v171, v171
  v_dot2c_f32_bf16 v26, s61, v251
  v_dot2c_f32_bf16 v27, v251, v251
  s_waitcnt lgkmcnt(13)
  v_dot2c_f32_bf16 v28, s61, v32
  s_waitcnt lgkmcnt(11)
  v_dot2c_f32_bf16 v29, s61, v36
  v_dot2c_f32_bf16 v28, s61, v33
  v_dot2c_f32_bf16 v29, s61, v37
  v_dot2c_f32_bf16 v28, s61, v34
  s_waitcnt lgkmcnt(10)
  v_dot2c_f32_bf16 v29, s61, v38
  v_dot2c_f32_bf16 v28, s61, v35
  v_dot2c_f32_bf16 v29, s61, v39
  ds_read_b64_tr_b16 v[32:33], v18 offset:15360
  ds_read_b64_tr_b16 v[34:35], v19 offset:15360
  ds_read_b64_tr_b16 v[36:37], v18 offset:15488
  ds_read_b64_tr_b16 v[38:39], v19 offset:15488
  s_waitcnt lgkmcnt(12)
  v_mfma_f32_16x16x32_bf16 v[48:51], v[172:175], v[4:7], v[48:51]
  v_mfma_f32_16x16x32_bf16 v[68:71], v[252:255], v[4:7], v[68:71]
  s_waitcnt lgkmcnt(10)
  v_mfma_f32_16x16x32_bf16 v[52:55], v[172:175], v[20:23], v[52:55]
  v_mfma_f32_16x16x32_bf16 v[72:75], v[252:255], v[20:23], v[72:75]
  s_waitcnt lgkmcnt(8)
  v_mfma_f32_16x16x32_bf16 v[56:59], v[172:175], v[44:47], v[56:59]
  v_mfma_f32_16x16x32_bf16 v[76:79], v[252:255], v[44:47], v[76:79]
  s_waitcnt lgkmcnt(6)
  v_mfma_f32_16x16x32_bf16 v[60:63], v[172:175], v[88:91], v[60:63]
  v_mfma_f32_16x16x32_bf16 v[80:83], v[252:255], v[88:91], v[80:83]
  s_waitcnt lgkmcnt(4)
  v_mfma_f32_16x16x32_bf16 v[64:67], v[172:175], v[92:95], v[64:67]
  v_mfma_f32_16x16x32_bf16 v[84:87], v[252:255], v[92:95], v[84:87]
  v_dot2c_f32_bf16 v24, s61, v172
  v_dot2c_f32_bf16 v25, v172, v172
  v_dot2c_f32_bf16 v26, s61, v252
  v_dot2c_f32_bf16 v27, v252, v252
  v_dot2c_f32_bf16 v24, s61, v173
  v_dot2c_f32_bf16 v25, v173, v173
  v_dot2c_f32_bf16 v26, s61, v253
  v_dot2c_f32_bf16 v27, v253, v253
  v_dot2c_f32_bf16 v24, s61, v174
  v_dot2c_f32_bf16 v25, v174, v174
  v_dot2c_f32_bf16 v26, s61, v254
  v_dot2c_f32_bf16 v27, v254, v254
  v_dot2c_f32_bf16 v24, s61, v175
  v_dot2c_f32_bf16 v25, v175, v175
  v_dot2c_f32_bf16 v26, s61, v255
  v_dot2c_f32_bf16 v27, v255, v255
  s_waitcnt lgkmcnt(3)
  v_dot2c_f32_bf16 v28, s61, v32
  s_waitcnt lgkmcnt(1)
  v_dot2c_f32_bf16 v29, s61, v36
  v_dot2c_f32_bf16 v28, s61, v33
  v_dot2c_f32_bf16 v29, s61, v37
  v_dot2c_f32_bf16 v28, s61, v34
  s_waitcnt lgkmcnt(0)
  v_dot2c_f32_bf16 v29, s61, v38
  v_dot2c_f32_bf16 v28, s61, v35
  v_dot2c_f32_bf16 v29, s61, v39
  s_waitcnt lgkmcnt(0)
  v_mov_b32 v10, 10
  ds_write_b32 v11, v10 offset:16
  v_mov_b32 v32, v28
  s_nop 1
  v_permlane32_swap_b32 v32, v28
  v_add_f32 v28, v28, v32
  v_mov_b32 v32, v28
  s_nop 1
  v_permlane16_swap_b32 v32, v28
  v_add_f32 v28, v28, v32
  v_mov_b32 v32, v29
  s_nop 1
  v_permlane32_swap_b32 v32, v29
  v_add_f32 v29, v29, v32
  v_mov_b32 v32, v29
  s_nop 1
  v_permlane16_swap_b32 v32, v29
  v_add_f32 v29, v29, v32
  s_lshl_b32 s56, s7, 6
  s_add_u32 s56, s56, 161536
  v_lshl_add_u32 v32, v2, 2, s56
  ds_write_b32 v32, v28
  ds_write_b32 v32, v29 offset:256
  s_waitcnt lgkmcnt(0)
  v_mov_b32 v10, 1
  ds_write_b32 v11, v10 offset:64
  v_mov_b32 v32, v24
  s_nop 1
  v_permlane32_swap_b32 v32, v24
  v_add_f32 v24, v24, v32
  v_mov_b32 v32, v24
  s_nop 1
  v_permlane16_swap_b32 v32, v24
  v_add_f32 v24, v24, v32
  v_mov_b32 v33, v25
  s_nop 1
  v_permlane32_swap_b32 v33, v25
  v_add_f32 v25, v25, v33
  v_mov_b32 v33, v25
  s_nop 1
  v_permlane16_swap_b32 v33, v25
  v_add_f32 v25, v25, v33
  v_mov_b32 v34, v26
  s_nop 1
  v_permlane32_swap_b32 v34, v26
  v_add_f32 v26, v26, v34
  v_mov_b32 v34, v26
  s_nop 1
  v_permlane16_swap_b32 v34, v26
  v_add_f32 v26, v26, v34
  v_mov_b32 v35, v27
  s_nop 1
  v_permlane32_swap_b32 v35, v27
  v_add_f32 v27, v27, v35
  v_mov_b32 v35, v27
  s_nop 1
  v_permlane16_swap_b32 v35, v27
  v_add_f32 v27, v27, v35
  v_mul_f32 v32, 0x3acccccd, v24
  v_mul_f32 v33, 0x3acccccd, v25
  v_fma_f32 v33, -v32, v32, v33
  v_max_f32 v33, 0, v33
  v_cvt_pk_bf16_f32 v21, v32, v32
  v_lshlrev_b32 v21, 16, v21
  v_cvt_pk_bf16_f32 v34, v33, v33
  v_lshlrev_b32 v34, 16, v34
  v_add_f32 v34, 0x3727c5ac, v34
  v_cvt_pk_bf16_f32 v34, v34, v34
  v_lshlrev_b32 v34, 16, v34
  v_sqrt_f32 v34, v34
  s_nop 0
  v_cvt_pk_bf16_f32 v34, v34, v34
  v_lshlrev_b32 v34, 16, v34
  v_rcp_f32 v20, v34
  s_nop 0
  v_mul_f32 v21, v21, v20
  v_mul_f32 v32, 0x3acccccd, v26
  v_mul_f32 v33, 0x3acccccd, v27
  v_fma_f32 v33, -v32, v32, v33
  v_max_f32 v33, 0, v33
  v_cvt_pk_bf16_f32 v23, v32, v32
  v_lshlrev_b32 v23, 16, v23
  v_cvt_pk_bf16_f32 v34, v33, v33
  v_lshlrev_b32 v34, 16, v34
  v_add_f32 v34, 0x3727c5ac, v34
  v_cvt_pk_bf16_f32 v34, v34, v34
  v_lshlrev_b32 v34, 16, v34
  v_sqrt_f32 v34, v34
  s_nop 0
  v_cvt_pk_bf16_f32 v34, v34, v34
  v_lshlrev_b32 v34, 16, v34
  v_rcp_f32 v22, v34
  s_nop 0
  v_mul_f32 v23, v23, v22
  v_lshl_add_u32 v32, v2, 2, s58
  ds_write_b32 v32, v20 offset:2560
  ds_write_b32 v32, v21 offset:2624
  ds_write_b32 v32, v22 offset:2688
  ds_write_b32 v32, v23 offset:2752
  s_waitcnt lgkmcnt(0)
  s_mov_b32 s57, 0
L_22:
  ds_read_b128 v[12:15], v8 offset:64
  s_waitcnt lgkmcnt(0)
  v_min3_u32 v12, v12, v13, v14
  v_min_u32 v12, v12, v15
  s_nop 0
  v_readfirstlane_b32 s56, v12
  s_nop 3
  s_cmp_ge_u32 s56, 1
  s_cbranch_scc1 L_23
  s_add_u32 s57, s57, 1
  s_cmp_lt_u32 s57, 0x400000
  s_cbranch_scc1 L_22
L_23:
  v_lshlrev_b32 v32, 2, v2
  v_add_u32 v32, 161536, v32
  ds_read_b32 v24, v32
  ds_read_b32 v25, v32 offset:64
  ds_read_b32 v26, v32 offset:128
  ds_read_b32 v27, v32 offset:192
  ds_read_b32 v28, v32 offset:256
  v_lshl_add_u32 v29, v3, 4, s58
  v_cmp_gt_u32 s[62:63], 8, v2
  ds_read_b128 v[32:35], v29 offset:2560
  ds_read_b128 v[36:39], v29 offset:2624
  s_waitcnt lgkmcnt(0)
  v_pk_mul_f32 v[40:41], v[36:37], v[26:27] op_sel:[0,1] op_sel_hi:[1,1]
  v_pk_mul_f32 v[42:43], v[38:39], v[26:27] op_sel:[0,1] op_sel_hi:[1,1]
  v_pk_fma_f32 v[60:61], v[60:61], v[32:33], v[40:41] neg_lo:[0,0,1] neg_hi:[0,0,1]
  v_pk_fma_f32 v[62:63], v[62:63], v[34:35], v[42:43] neg_lo:[0,0,1] neg_hi:[0,0,1]
  v_cvt_pk_bf16_f32 v88, v60, v61
  v_cvt_pk_bf16_f32 v89, v62, v63
  v_pk_mul_f32 v[40:41], v[36:37], v[28:29] op_sel_hi:[1,0]
  v_pk_mul_f32 v[42:43], v[38:39], v[28:29] op_sel_hi:[1,0]
  v_pk_fma_f32 v[64:65], v[64:65], v[32:33], v[40:41] neg_lo:[0,0,1] neg_hi:[0,0,1]
  v_pk_fma_f32 v[66:67], v[66:67], v[34:35], v[42:43] neg_lo:[0,0,1] neg_hi:[0,0,1]
  v_cvt_pk_bf16_f32 v92, v64, v65
  v_cvt_pk_bf16_f32 v93, v66, v67
  v_pk_mul_f32 v[40:41], v[36:37], v[24:25] op_sel_hi:[1,0]
  v_pk_mul_f32 v[42:43], v[38:39], v[24:25] op_sel_hi:[1,0]
  v_pk_fma_f32 v[48:49], v[48:49], v[32:33], v[40:41] neg_lo:[0,0,1] neg_hi:[0,0,1]
  v_pk_fma_f32 v[50:51], v[50:51], v[34:35], v[42:43] neg_lo:[0,0,1] neg_hi:[0,0,1]
  v_cvt_pk_bf16_f32 v40, v48, v49
  v_lshlrev_b32 v48, 16, v40
  v_and_b32 v49, 0xffff0000, v40
  v_cvt_pk_bf16_f32 v42, v50, v51
  v_lshlrev_b32 v50, 16, v42
  v_and_b32 v51, 0xffff0000, v42
  v_mul_f32 v40, 0x3fb8aa3b, v48
  v_mul_f32 v41, 0x3fb8aa3b, v49
  v_mul_f32 v42, 0x3fb8aa3b, v50
  v_mul_f32 v43, 0x3fb8aa3b, v51
  v_min_f32 v40, 0, v40
  v_min_f32 v41, 0, v41
  v_min_f32 v42, 0, v42
  v_min_f32 v43, 0, v43
  v_exp_f32 v40, v40
  v_exp_f32 v41, v41
  v_exp_f32 v42, v42
  v_exp_f32 v43, v43
  v_max_f32 v44, 0, v48
  v_max_f32 v45, 0, v49
  v_max_f32 v46, 0, v50
  v_max_f32 v47, 0, v51
  v_pk_add_f32 v[44:45], v[44:45], v[40:41]
  v_pk_add_f32 v[46:47], v[46:47], v[42:43]
  v_cvt_pk_bf16_f32 v40, v44, v45
  v_lshlrev_b32 v44, 16, v40
  v_and_b32 v45, 0xffff0000, v40
  v_cvt_pk_bf16_f32 v42, v46, v47
  v_lshlrev_b32 v46, 16, v42
  v_and_b32 v47, 0xffff0000, v42
  v_add_f32 v44, 0x358637bd, v44
  v_add_f32 v45, 0x358637bd, v45
  v_add_f32 v46, 0x358637bd, v46
  v_add_f32 v47, 0x358637bd, v47
  v_cvt_pk_bf16_f32 v4, v44, v45
  v_cvt_pk_bf16_f32 v5, v46, v47
  v_pk_mul_f32 v[40:41], v[36:37], v[24:25] op_sel:[0,1] op_sel_hi:[1,1]
  v_pk_mul_f32 v[42:43], v[38:39], v[24:25] op_sel:[0,1] op_sel_hi:[1,1]
  v_pk_fma_f32 v[52:53], v[52:53], v[32:33], v[40:41] neg_lo:[0,0,1] neg_hi:[0,0,1]
  v_pk_fma_f32 v[54:55], v[54:55], v[34:35], v[42:43] neg_lo:[0,0,1] neg_hi:[0,0,1]
  v_cvt_pk_bf16_f32 v40, v52, v53
  v_lshlrev_b32 v52, 16, v40
  v_and_b32 v53, 0xffff0000, v40
  v_cvt_pk_bf16_f32 v42, v54, v55
  v_lshlrev_b32 v54, 16, v42
  v_and_b32 v55, 0xffff0000, v42
  v_mul_f32 v40, 0x3fb8aa3b, v52
  v_mul_f32 v41, 0x3fb8aa3b, v53
  v_mul_f32 v42, 0x3fb8aa3b, v54
  v_mul_f32 v43, 0x3fb8aa3b, v55
  v_min_f32 v40, 0, v40
  v_min_f32 v41, 0, v41
  v_min_f32 v42, 0, v42
  v_min_f32 v43, 0, v43
  v_exp_f32 v40, v40
  v_exp_f32 v41, v41
  v_exp_f32 v42, v42
  v_exp_f32 v43, v43
  v_max_f32 v44, 0, v52
  v_max_f32 v45, 0, v53
  v_max_f32 v46, 0, v54
  v_max_f32 v47, 0, v55
  v_pk_add_f32 v[44:45], v[44:45], v[40:41]
  v_pk_add_f32 v[46:47], v[46:47], v[42:43]
  v_cvt_pk_bf16_f32 v40, v44, v45
  v_lshlrev_b32 v44, 16, v40
  v_and_b32 v45, 0xffff0000, v40
  v_cvt_pk_bf16_f32 v42, v46, v47
  v_lshlrev_b32 v46, 16, v42
  v_and_b32 v47, 0xffff0000, v42
  v_add_f32 v44, 0x358637bd, v44
  v_add_f32 v45, 0x358637bd, v45
  v_add_f32 v46, 0x358637bd, v46
  v_add_f32 v47, 0x358637bd, v47
  v_cvt_pk_bf16_f32 v12, v44, v45
  v_cvt_pk_bf16_f32 v13, v46, v47
  v_pk_mul_f32 v[40:41], v[36:37], v[26:27] op_sel_hi:[1,0]
  v_pk_mul_f32 v[42:43], v[38:39], v[26:27] op_sel_hi:[1,0]
  v_pk_fma_f32 v[56:57], v[56:57], v[32:33], v[40:41] neg_lo:[0,0,1] neg_hi:[0,0,1]
  v_pk_fma_f32 v[58:59], v[58:59], v[34:35], v[42:43] neg_lo:[0,0,1] neg_hi:[0,0,1]
  v_cvt_pk_bf16_f32 v40, v56, v57
  v_lshlrev_b32 v56, 16, v40
  v_and_b32 v57, 0xffff0000, v40
  v_cvt_pk_bf16_f32 v42, v58, v59
  v_lshlrev_b32 v58, 16, v42
  v_and_b32 v59, 0xffff0000, v42
  v_mul_f32 v40, 0x3fb8aa3b, v56
  v_mul_f32 v41, 0x3fb8aa3b, v57
  v_mul_f32 v42, 0x3fb8aa3b, v58
  v_mul_f32 v43, 0x3fb8aa3b, v59
  v_min_f32 v40, 0, v40
  v_min_f32 v41, 0, v41
  v_min_f32 v42, 0, v42
  v_min_f32 v43, 0, v43
  v_exp_f32 v40, v40
  v_exp_f32 v41, v41
  v_exp_f32 v42, v42
  v_exp_f32 v43, v43
  v_max_f32 v44, 0, v56
  v_max_f32 v45, 0, v57
  v_max_f32 v46, 0, v58
  v_max_f32 v47, 0, v59
  v_pk_add_f32 v[44:45], v[44:45], v[40:41]
  v_pk_add_f32 v[46:47], v[46:47], v[42:43]
  v_cvt_pk_bf16_f32 v40, v44, v45
  v_lshlrev_b32 v44, 16, v40
  v_and_b32 v45, 0xffff0000, v40
  v_cvt_pk_bf16_f32 v42, v46, v47
  v_lshlrev_b32 v46, 16, v42
  v_and_b32 v47, 0xffff0000, v42
  v_add_f32 v44, 0x358637bd, v44
  v_add_f32 v45, 0x358637bd, v45
  v_add_f32 v46, 0x358637bd, v46
  v_add_f32 v47, 0x358637bd, v47
  v_cndmask_b32 v44, v56, v44, s[62:63]
  v_cndmask_b32 v45, v57, v45, s[62:63]
  v_cndmask_b32 v46, v58, v46, s[62:63]
  v_cndmask_b32 v47, v59, v47, s[62:63]
  v_cvt_pk_bf16_f32 v16, v44, v45
  v_cvt_pk_bf16_f32 v17, v46, v47
  ds_read_b128 v[32:35], v29 offset:2688
  ds_read_b128 v[36:39], v29 offset:2752
  s_waitcnt lgkmcnt(0)
  v_pk_mul_f32 v[40:41], v[36:37], v[26:27] op_sel:[0,1] op_sel_hi:[1,1]
  v_pk_mul_f32 v[42:43], v[38:39], v[26:27] op_sel:[0,1] op_sel_hi:[1,1]
  v_pk_fma_f32 v[80:81], v[80:81], v[32:33], v[40:41] neg_lo:[0,0,1] neg_hi:[0,0,1]
  v_pk_fma_f32 v[82:83], v[82:83], v[34:35], v[42:43] neg_lo:[0,0,1] neg_hi:[0,0,1]
  v_cvt_pk_bf16_f32 v90, v80, v81
  v_cvt_pk_bf16_f32 v91, v82, v83
  v_pk_mul_f32 v[40:41], v[36:37], v[28:29] op_sel_hi:[1,0]
  v_pk_mul_f32 v[42:43], v[38:39], v[28:29] op_sel_hi:[1,0]
  v_pk_fma_f32 v[84:85], v[84:85], v[32:33], v[40:41] neg_lo:[0,0,1] neg_hi:[0,0,1]
  v_pk_fma_f32 v[86:87], v[86:87], v[34:35], v[42:43] neg_lo:[0,0,1] neg_hi:[0,0,1]
  v_cvt_pk_bf16_f32 v94, v84, v85
  v_cvt_pk_bf16_f32 v95, v86, v87
  v_pk_mul_f32 v[40:41], v[36:37], v[24:25] op_sel_hi:[1,0]
  v_pk_mul_f32 v[42:43], v[38:39], v[24:25] op_sel_hi:[1,0]
  v_pk_fma_f32 v[68:69], v[68:69], v[32:33], v[40:41] neg_lo:[0,0,1] neg_hi:[0,0,1]
  v_pk_fma_f32 v[70:71], v[70:71], v[34:35], v[42:43] neg_lo:[0,0,1] neg_hi:[0,0,1]
  v_cvt_pk_bf16_f32 v40, v68, v69
  v_lshlrev_b32 v68, 16, v40
  v_and_b32 v69, 0xffff0000, v40
  v_cvt_pk_bf16_f32 v42, v70, v71
  v_lshlrev_b32 v70, 16, v42
  v_and_b32 v71, 0xffff0000, v42
  v_mul_f32 v40, 0x3fb8aa3b, v68
  v_mul_f32 v41, 0x3fb8aa3b, v69
  v_mul_f32 v42, 0x3fb8aa3b, v70
  v_mul_f32 v43, 0x3fb8aa3b, v71
  v_min_f32 v40, 0, v40
  v_min_f32 v41, 0, v41
  v_min_f32 v42, 0, v42
  v_min_f32 v43, 0, v43
  v_exp_f32 v40, v40
  v_exp_f32 v41, v41
  v_exp_f32 v42, v42
  v_exp_f32 v43, v43
  v_max_f32 v44, 0, v68
  v_max_f32 v45, 0, v69
  v_max_f32 v46, 0, v70
  v_max_f32 v47, 0, v71
  v_pk_add_f32 v[44:45], v[44:45], v[40:41]
  v_pk_add_f32 v[46:47], v[46:47], v[42:43]
  v_cvt_pk_bf16_f32 v40, v44, v45
  v_lshlrev_b32 v44, 16, v40
  v_and_b32 v45, 0xffff0000, v40
  v_cvt_pk_bf16_f32 v42, v46, v47
  v_lshlrev_b32 v46, 16, v42
  v_and_b32 v47, 0xffff0000, v42
  v_add_f32 v44, 0x358637bd, v44
  v_add_f32 v45, 0x358637bd, v45
  v_add_f32 v46, 0x358637bd, v46
  v_add_f32 v47, 0x358637bd, v47
  v_cvt_pk_bf16_f32 v6, v44, v45
  v_cvt_pk_bf16_f32 v7, v46, v47
  v_pk_mul_f32 v[40:41], v[36:37], v[24:25] op_sel:[0,1] op_sel_hi:[1,1]
  v_pk_mul_f32 v[42:43], v[38:39], v[24:25] op_sel:[0,1] op_sel_hi:[1,1]
  v_pk_fma_f32 v[72:73], v[72:73], v[32:33], v[40:41] neg_lo:[0,0,1] neg_hi:[0,0,1]
  v_pk_fma_f32 v[74:75], v[74:75], v[34:35], v[42:43] neg_lo:[0,0,1] neg_hi:[0,0,1]
  v_cvt_pk_bf16_f32 v40, v72, v73
  v_lshlrev_b32 v72, 16, v40
  v_and_b32 v73, 0xffff0000, v40
  v_cvt_pk_bf16_f32 v42, v74, v75
  v_lshlrev_b32 v74, 16, v42
  v_and_b32 v75, 0xffff0000, v42
  v_mul_f32 v40, 0x3fb8aa3b, v72
  v_mul_f32 v41, 0x3fb8aa3b, v73
  v_mul_f32 v42, 0x3fb8aa3b, v74
  v_mul_f32 v43, 0x3fb8aa3b, v75
  v_min_f32 v40, 0, v40
  v_min_f32 v41, 0, v41
  v_min_f32 v42, 0, v42
  v_min_f32 v43, 0, v43
  v_exp_f32 v40, v40
  v_exp_f32 v41, v41
  v_exp_f32 v42, v42
  v_exp_f32 v43, v43
  v_max_f32 v44, 0, v72
  v_max_f32 v45, 0, v73
  v_max_f32 v46, 0, v74
  v_max_f32 v47, 0, v75
  v_pk_add_f32 v[44:45], v[44:45], v[40:41]
  v_pk_add_f32 v[46:47], v[46:47], v[42:43]
  v_cvt_pk_bf16_f32 v40, v44, v45
  v_lshlrev_b32 v44, 16, v40
  v_and_b32 v45, 0xffff0000, v40
  v_cvt_pk_bf16_f32 v42, v46, v47
  v_lshlrev_b32 v46, 16, v42
  v_and_b32 v47, 0xffff0000, v42
  v_add_f32 v44, 0x358637bd, v44
  v_add_f32 v45, 0x358637bd, v45
  v_add_f32 v46, 0x358637bd, v46
  v_add_f32 v47, 0x358637bd, v47
  v_cvt_pk_bf16_f32 v14, v44, v45
  v_cvt_pk_bf16_f32 v15, v46, v47
  v_pk_mul_f32 v[40:41], v[36:37], v[26:27] op_sel_hi:[1,0]
  v_pk_mul_f32 v[42:43], v[38:39], v[26:27] op_sel_hi:[1,0]
  v_pk_fma_f32 v[76:77], v[76:77], v[32:33], v[40:41] neg_lo:[0,0,1] neg_hi:[0,0,1]
  v_pk_fma_f32 v[78:79], v[78:79], v[34:35], v[42:43] neg_lo:[0,0,1] neg_hi:[0,0,1]
  v_cvt_pk_bf16_f32 v40, v76, v77
  v_lshlrev_b32 v76, 16, v40
  v_and_b32 v77, 0xffff0000, v40
  v_cvt_pk_bf16_f32 v42, v78, v79
  v_lshlrev_b32 v78, 16, v42
  v_and_b32 v79, 0xffff0000, v42
  v_mul_f32 v40, 0x3fb8aa3b, v76
  v_mul_f32 v41, 0x3fb8aa3b, v77
  v_mul_f32 v42, 0x3fb8aa3b, v78
  v_mul_f32 v43, 0x3fb8aa3b, v79
  v_min_f32 v40, 0, v40
  v_min_f32 v41, 0, v41
  v_min_f32 v42, 0, v42
  v_min_f32 v43, 0, v43
  v_exp_f32 v40, v40
  v_exp_f32 v41, v41
  v_exp_f32 v42, v42
  v_exp_f32 v43, v43
  v_max_f32 v44, 0, v76
  v_max_f32 v45, 0, v77
  v_max_f32 v46, 0, v78
  v_max_f32 v47, 0, v79
  v_pk_add_f32 v[44:45], v[44:45], v[40:41]
  v_pk_add_f32 v[46:47], v[46:47], v[42:43]
  v_cvt_pk_bf16_f32 v40, v44, v45
  v_lshlrev_b32 v44, 16, v40
  v_and_b32 v45, 0xffff0000, v40
  v_cvt_pk_bf16_f32 v42, v46, v47
  v_lshlrev_b32 v46, 16, v42
  v_and_b32 v47, 0xffff0000, v42
  v_add_f32 v44, 0x358637bd, v44
  v_add_f32 v45, 0x358637bd, v45
  v_add_f32 v46, 0x358637bd, v46
  v_add_f32 v47, 0x358637bd, v47
  v_cndmask_b32 v44, v76, v44, s[62:63]
  v_cndmask_b32 v45, v77, v45, s[62:63]
  v_cndmask_b32 v46, v78, v46, s[62:63]
  v_cndmask_b32 v47, v79, v47, s[62:63]
  v_cvt_pk_bf16_f32 v18, v44, v45
  v_cvt_pk_bf16_f32 v19, v46, v47
  v_mov_b32 v24, s61
  v_mov_b32 v25, s61
  v_mov_b32 v26, s61
  v_mov_b32 v27, s61
  ds_read_b32 v32, v31
  ds_read_b32 v33, v31 offset:256
  ds_read_b32 v34, v31 offset:512
  ds_read_b32 v35, v31 offset:768
  ds_read_b32 v36, v31 offset:1024
  ds_read_b32 v37, v31 offset:1280
  ds_read_b32 v38, v31 offset:1536
  ds_read_b32 v39, v31 offset:1792
  ds_read_b32 v40, v31 offset:2048
  ds_read_b32 v41, v31 offset:2304
  v_mfma_f32_16x16x32_bf16 v[48:51], v[4:7], v[16:19], 0
  v_mfma_f32_16x16x32_bf16 v[52:55], v[4:7], v[88:91], 0
  v_mfma_f32_16x16x32_bf16 v[56:59], v[12:15], v[16:19], 0
  v_mfma_f32_16x16x32_bf16 v[60:63], v[12:15], v[88:91], 0
  v_mfma_f32_16x16x32_bf16 v[64:67], v[12:15], v[92:95], 0
  v_mfma_f32_16x16x32_bf16 v[68:71], v[16:19], v[88:91], 0
  v_mfma_f32_16x16x32_bf16 v[72:75], v[16:19], v[92:95], 0
  v_mfma_f32_16x16x32_bf16 v[76:79], v[4:7], v[24:27], 0
  v_mfma_f32_16x16x32_bf16 v[80:83], v[12:15], v[24:27], 0
  v_mfma_f32_16x16x32_bf16 v[84:87], v[16:19], v[24:27], 0
  s_waitcnt lgkmcnt(0)
  ds_write_b128 v32, v[48:51]
  ds_write_b128 v33, v[52:55]
  ds_write_b128 v34, v[56:59]
  ds_write_b128 v35, v[60:63]
  ds_write_b128 v36, v[64:67]
  ds_write_b128 v37, v[68:71]
  ds_write_b128 v38, v[72:75]
  ds_write_b128 v39, v[76:79]
  ds_write_b128 v40, v[80:83]
  ds_write_b128 v41, v[84:87]
  s_waitcnt lgkmcnt(0)
  v_mov_b32 v10, 1
  ds_write_b32 v11, v10 offset:32
  v_bfe_u32 v32, v0, 2, 2
  v_bfe_u32 v33, v0, 4, 1
  v_lshl_or_b32 v32, v33, 2, v32
  v_lshl_or_b32 v33, v3, 3, v32
  v_mul_u32_u24 v16, 96, v33
  v_xor_b32 v33, 4, v33
  v_mul_u32_u24 v17, 96, v33
  v_and_b32 v32, 3, v0
  v_lshl_add_u32 v16, v32, 3, v16
  v_lshl_add_u32 v17, v32, 3, v17
  v_mov_b32 v43, 155104
  v_mul_u32_u24 v40, 48, v2
  v_min_u32 v41, 4, v2
  v_mul_u32_u24 v41, 48, v41
  v_add_u32 v41, 768, v41
  v_mov_b32 v42, 960
  v_lshl_add_u32 v40, v3, 3, v40
  v_lshl_add_u32 v41, v3, 3, v41
  v_lshl_add_u32 v42, v3, 3, v42
  s_lshl_b32 s3, s2, 2
  s_add_u32 s3, s3, s7
  s_mov_b32 s84, s42
  s_mov_b32 s85, s43
  s_mov_b32 s57, 1080
  s_mov_b32 s31, 819200
  s_mov_b32 s39, 0x80000000
  s_mov_b32 s86, 819200
  s_mov_b32 s38, 102400
  s_cmp_lt_u32 s3, 1080
  s_cselect_b32 s84, s46, s84
  s_cselect_b32 s85, s47, s85
  s_cselect_b32 s57, 540, s57
  s_cselect_b32 s31, 1638400, s31
  s_cselect_b32 s39, 0x80000000, s39
  s_cselect_b32 s86, 2211840, s86
  s_cselect_b32 s38, 276480, s38
  s_mov_b32 s58, 6554
  s_mov_b32 s59, 10
  s_mov_b32 s60, 1280
  s_mov_b32 s62, 2560
  s_cmp_lt_u32 s3, 540
  s_cselect_b32 s84, s44, s84
  s_cselect_b32 s85, s45, s85
  s_cselect_b32 s57, 0, s57
  s_cselect_b32 s31, 3850240, s31
  s_cselect_b32 s39, 6195200, s39
  s_cselect_b32 s38, 0, s38
  s_cselect_b32 s58, 2428, s58
  s_cselect_b32 s59, 27, s59
  s_cselect_b32 s60, 3456, s60
  s_cselect_b32 s62, 6912, s62
  s_mov_b32 s87, 0x00020000
  s_sub_u32 s57, s3, s57
  s_mul_i32 s29, s57, s58
  s_lshr_b32 s29, s29, 16
  s_mul_i32 s59, s29, s59
  s_sub_u32 s57, s57, s59
  s_lshl_b32 s30, s57, 2
  s_mul_i32 s62, s62, s29
  s_add_u32 s39, s39, s62
  s_lshl_b32 s62, s57, 8
  s_add_u32 s39, s39, s62
  s_cmp_lt_u32 s3, 1280
  s_cselect_b32 s31, s31, 0x80000000
  s_lshl_b32 s58, s29, 5
  s_mul_i32 s58, s58, s60
  s_lshl_b32 s57, s57, 7
  s_add_u32 s58, s58, s57
  v_lshrrev_b32 v4, 3, v1
  v_mul_lo_u32 v4, v4, s60
  v_and_b32 v10, 7, v1
  v_lshl_add_u32 v4, v10, 4, v4
  s_lshl_b32 s60, s60, 3
  s_lshl_b32 s57, s7, 12
  s_add_u32 m0, s57, 122880
  s_nop 0
  buffer_load_dwordx4 v4, s[84:87], s58 offen lds
  s_add_u32 s58, s58, s60
  s_add_u32 m0, s57, 123904
  s_nop 0
  buffer_load_dwordx4 v4, s[84:87], s58 offen lds
  s_add_u32 s58, s58, s60
  s_add_u32 m0, s57, 124928
  s_nop 0
  buffer_load_dwordx4 v4, s[84:87], s58 offen lds
  s_add_u32 s58, s58, s60
  s_add_u32 m0, s57, 125952
  s_nop 0
  buffer_load_dwordx4 v4, s[84:87], s58 offen lds
  s_waitcnt lgkmcnt(0)
  s_mov_b32 s57, 0
L_24:
  ds_read_b128 v[12:15], v8 offset:80
  s_waitcnt lgkmcnt(0)
  v_min3_u32 v12, v12, v13, v14
  v_min_u32 v12, v12, v15
  s_nop 0
  v_readfirstlane_b32 s56, v12
  s_nop 3
  s_cmp_ge_u32 s56, 1
  s_cbranch_scc1 L_25
  s_add_u32 s57, s57, 1
  s_cmp_lt_u32 s57, 0x400000
  s_cbranch_scc1 L_24
L_25:
  v_add_u32 v16, 106496, v16
  v_add_u32 v17, 106496, v17
  ds_read_b64_tr_b16 v[4:5], v16
  ds_read_b64_tr_b16 v[6:7], v17
  ds_read_b64_tr_b16 v[88:89], v16 offset:32
  ds_read_b64_tr_b16 v[90:91], v17 offset:32
  ds_read_b64_tr_b16 v[92:93], v16 offset:64
  ds_read_b64_tr_b16 v[94:95], v17 offset:64
  s_waitcnt lgkmcnt(4)
  v_mfma_f32_16x16x32_bf16 v[48:51], v[4:7], v[96:99], 0
  v_mfma_f32_16x16x32_bf16 v[60:63], v[4:7], v[176:179], 0
  ds_read_b64_tr_b16 v[72:73], v16 offset:3072
  ds_read_b64_tr_b16 v[74:75], v17 offset:3072
  s_waitcnt lgkmcnt(4)
  v_mfma_f32_16x16x32_bf16 v[52:55], v[88:91], v[96:99], 0
  v_mfma_f32_16x16x32_bf16 v[64:67], v[88:91], v[176:179], 0
  ds_read_b64_tr_b16 v[76:77], v16 offset:3104
  ds_read_b64_tr_b16 v[78:79], v17 offset:3104
  s_waitcnt lgkmcnt(4)
  v_mfma_f32_16x16x32_bf16 v[56:59], v[92:95], v[96:99], 0
  v_mfma_f32_16x16x32_bf16 v[68:71], v[92:95], v[176:179], 0
  ds_read_b64_tr_b16 v[80:81], v16 offset:3136
  ds_read_b64_tr_b16 v[82:83], v17 offset:3136
  v_add_u32 v24, 153088, v40
  v_add_u32 v25, 153088, v41
  v_add_u32 v26, 153088, v42
  s_waitcnt lgkmcnt(4)
  v_mfma_f32_16x16x32_bf16 v[48:51], v[72:75], v[100:103], v[48:51]
  v_mfma_f32_16x16x32_bf16 v[60:63], v[72:75], v[180:183], v[60:63]
  ds_read_b64_tr_b16 v[4:5], v16 offset:6144
  ds_read_b64_tr_b16 v[6:7], v17 offset:6144
  s_waitcnt lgkmcnt(4)
  v_mfma_f32_16x16x32_bf16 v[52:55], v[76:79], v[100:103], v[52:55]
  v_mfma_f32_16x16x32_bf16 v[64:67], v[76:79], v[180:183], v[64:67]
  ds_read_b64_tr_b16 v[88:89], v16 offset:6176
  ds_read_b64_tr_b16 v[90:91], v17 offset:6176
  s_waitcnt lgkmcnt(4)
  v_mfma_f32_16x16x32_bf16 v[56:59], v[80:83], v[100:103], v[56:59]
  v_mfma_f32_16x16x32_bf16 v[68:71], v[80:83], v[180:183], v[68:71]
  ds_read_b64_tr_b16 v[92:93], v16 offset:6208
  ds_read_b64_tr_b16 v[94:95], v17 offset:6208
  v_cmp_eq_u32 s[72:73], 0, v3
  v_add_u32 v27, 153120, v40
  s_nop 0
  v_cndmask_b32 v27, v43, v27, s[72:73]
  v_add_u32 v28, 153120, v41
  v_cndmask_b32 v28, v43, v28, s[72:73]
  v_add_u32 v29, 153120, v42
  v_cndmask_b32 v29, v43, v29, s[72:73]
  s_waitcnt lgkmcnt(4)
  v_mfma_f32_16x16x32_bf16 v[48:51], v[4:7], v[104:107], v[48:51]
  v_mfma_f32_16x16x32_bf16 v[60:63], v[4:7], v[184:187], v[60:63]
  ds_read_b64_tr_b16 v[72:73], v16 offset:9216
  ds_read_b64_tr_b16 v[74:75], v17 offset:9216
  s_waitcnt lgkmcnt(4)
  v_mfma_f32_16x16x32_bf16 v[52:55], v[88:91], v[104:107], v[52:55]
  v_mfma_f32_16x16x32_bf16 v[64:67], v[88:91], v[184:187], v[64:67]
  ds_read_b64_tr_b16 v[76:77], v16 offset:9248
  ds_read_b64_tr_b16 v[78:79], v17 offset:9248
  s_waitcnt lgkmcnt(4)
  v_mfma_f32_16x16x32_bf16 v[56:59], v[92:95], v[104:107], v[56:59]
  v_mfma_f32_16x16x32_bf16 v[68:71], v[92:95], v[184:187], v[68:71]
  ds_read_b64_tr_b16 v[80:81], v16 offset:9280
  ds_read_b64_tr_b16 v[82:83], v17 offset:9280
  v_cmp_le_u32 s[72:73], 1, v3
  v_add_u32 v30, 154088, v40
  s_nop 0
  v_cndmask_b32 v30, v43, v30, s[72:73]
  v_add_u32 v31, 154088, v41
  v_cndmask_b32 v31, v43, v31, s[72:73]
  v_add_u32 v32, 154088, v42
  v_cndmask_b32 v32, v43, v32, s[72:73]
  v_subrev_u32 v16, 73728, v16
  v_subrev_u32 v17, 73728, v17
  s_waitcnt lgkmcnt(4)
  v_mfma_f32_16x16x32_bf16 v[48:51], v[72:75], v[108:111], v[48:51]
  v_mfma_f32_16x16x32_bf16 v[60:63], v[72:75], v[188:191], v[60:63]
  ds_read_b64_tr_b16 v[4:5], v16
  ds_read_b64_tr_b16 v[6:7], v17
  s_waitcnt lgkmcnt(4)
  v_mfma_f32_16x16x32_bf16 v[52:55], v[76:79], v[108:111], v[52:55]
  v_mfma_f32_16x16x32_bf16 v[64:67], v[76:79], v[188:191], v[64:67]
  ds_read_b64_tr_b16 v[88:89], v16 offset:32
  ds_read_b64_tr_b16 v[90:91], v17 offset:32
  s_waitcnt lgkmcnt(4)
  v_mfma_f32_16x16x32_bf16 v[56:59], v[80:83], v[108:111], v[56:59]
  v_mfma_f32_16x16x32_bf16 v[68:71], v[80:83], v[188:191], v[68:71]
  ds_read_b64_tr_b16 v[92:93], v16 offset:64
  ds_read_b64_tr_b16 v[94:95], v17 offset:64
  v_cmp_ge_u32 s[72:73], 1, v3
  v_add_u32 v33, 154120, v40
  s_nop 0
  v_cndmask_b32 v33, v43, v33, s[72:73]
  v_add_u32 v34, 154120, v41
  v_cndmask_b32 v34, v43, v34, s[72:73]
  v_add_u32 v35, 154120, v42
  v_cndmask_b32 v35, v43, v35, s[72:73]
  v_mov_b32 v10, 11
  ds_write_b32 v11, v10 offset:16
  s_waitcnt lgkmcnt(5)
  v_mfma_f32_16x16x32_bf16 v[48:51], v[4:7], v[112:115], v[48:51]
  v_mfma_f32_16x16x32_bf16 v[60:63], v[4:7], v[192:195], v[60:63]
  ds_read_b64_tr_b16 v[72:73], v16 offset:3072
  ds_read_b64_tr_b16 v[74:75], v17 offset:3072
  s_waitcnt lgkmcnt(5)
  v_mfma_f32_16x16x32_bf16 v[52:55], v[88:91], v[112:115], v[52:55]
  v_mfma_f32_16x16x32_bf16 v[64:67], v[88:91], v[192:195], v[64:67]
  ds_read_b64_tr_b16 v[76:77], v16 offset:3104
  ds_read_b64_tr_b16 v[78:79], v17 offset:3104
  s_waitcnt lgkmcnt(5)
  v_mfma_f32_16x16x32_bf16 v[56:59], v[92:95], v[112:115], v[56:59]
  v_mfma_f32_16x16x32_bf16 v[68:71], v[92:95], v[192:195], v[68:71]
  ds_read_b64_tr_b16 v[80:81], v16 offset:3136
  ds_read_b64_tr_b16 v[82:83], v17 offset:3136
  s_mul_i32 s60, s76, 40
  s_add_u32 s60, s60, 0
  v_lshl_add_u32 v44, v3, 2, s60
  v_lshrrev_b32 v36, 3, v44
  v_lshlrev_b32 v36, 8, v36
  v_lshl_add_u32 v36, v2, 4, v36
  v_bfe_u32 v44, v44, 2, 1
  v_lshl_add_u32 v36, v44, 3, v36
  s_waitcnt lgkmcnt(4)
  v_mfma_f32_16x16x32_bf16 v[48:51], v[72:75], v[116:119], v[48:51]
  v_mfma_f32_16x16x32_bf16 v[60:63], v[72:75], v[196:199], v[60:63]
  ds_read_b64_tr_b16 v[4:5], v16 offset:6144
  ds_read_b64_tr_b16 v[6:7], v17 offset:6144
  s_waitcnt lgkmcnt(4)
  v_mfma_f32_16x16x32_bf16 v[52:55], v[76:79], v[116:119], v[52:55]
  v_mfma_f32_16x16x32_bf16 v[64:67], v[76:79], v[196:199], v[64:67]
  ds_read_b64_tr_b16 v[88:89], v16 offset:6176
  ds_read_b64_tr_b16 v[90:91], v17 offset:6176
  s_waitcnt lgkmcnt(4)
  v_mfma_f32_16x16x32_bf16 v[56:59], v[80:83], v[116:119], v[56:59]
  v_mfma_f32_16x16x32_bf16 v[68:71], v[80:83], v[196:199], v[68:71]
  ds_read_b64_tr_b16 v[92:93], v16 offset:6208
  ds_read_b64_tr_b16 v[94:95], v17 offset:6208
  s_mul_i32 s60, s76, 40
  s_add_u32 s60, s60, 16
  v_lshl_add_u32 v44, v3, 2, s60
  v_lshrrev_b32 v37, 3, v44
  v_lshlrev_b32 v37, 8, v37
  v_lshl_add_u32 v37, v2, 4, v37
  v_bfe_u32 v44, v44, 2, 1
  v_lshl_add_u32 v37, v44, 3, v37
  v_cmp_eq_u32 vcc, 0, v3
  v_bfrev_b32 v44, 1
  s_nop 0
  v_cndmask_b32 v37, v44, v37, vcc
  s_waitcnt lgkmcnt(4)
  v_mfma_f32_16x16x32_bf16 v[48:51], v[4:7], v[120:123], v[48:51]
  v_mfma_f32_16x16x32_bf16 v[60:63], v[4:7], v[200:203], v[60:63]
  ds_read_b64_tr_b16 v[72:73], v16 offset:9216
  ds_read_b64_tr_b16 v[74:75], v17 offset:9216
  s_waitcnt lgkmcnt(4)
  v_mfma_f32_16x16x32_bf16 v[52:55], v[88:91], v[120:123], v[52:55]
  v_mfma_f32_16x16x32_bf16 v[64:67], v[88:91], v[200:203], v[64:67]
  ds_read_b64_tr_b16 v[76:77], v16 offset:9248
  ds_read_b64_tr_b16 v[78:79], v17 offset:9248
  s_waitcnt lgkmcnt(4)
  v_mfma_f32_16x16x32_bf16 v[56:59], v[92:95], v[120:123], v[56:59]
  v_mfma_f32_16x16x32_bf16 v[68:71], v[92:95], v[200:203], v[68:71]
  ds_read_b64_tr_b16 v[80:81], v16 offset:9280
  ds_read_b64_tr_b16 v[82:83], v17 offset:9280
  s_mul_i32 s60, s76, 40
  s_add_u32 s60, s60, 20
  v_lshl_add_u32 v44, v3, 2, s60
  v_lshrrev_b32 v38, 3, v44
  v_lshlrev_b32 v38, 8, v38
  v_lshl_add_u32 v38, v2, 4, v38
  v_bfe_u32 v44, v44, 2, 1
  v_lshl_add_u32 v38, v44, 3, v38
  s_waitcnt lgkmcnt(4)
  v_mfma_f32_16x16x32_bf16 v[48:51], v[72:75], v[124:127], v[48:51]
  v_mfma_f32_16x16x32_bf16 v[60:63], v[72:75], v[204:207], v[60:63]
  ds_read_b64_tr_b16 v[4:5], v16 offset:12288
  ds_read_b64_tr_b16 v[6:7], v17 offset:12288
  s_waitcnt lgkmcnt(4)
  v_mfma_f32_16x16x32_bf16 v[52:55], v[76:79], v[124:127], v[52:55]
  v_mfma_f32_16x16x32_bf16 v[64:67], v[76:79], v[204:207], v[64:67]
  ds_read_b64_tr_b16 v[88:89], v16 offset:12320
  ds_read_b64_tr_b16 v[90:91], v17 offset:12320
  s_waitcnt lgkmcnt(4)
  v_mfma_f32_16x16x32_bf16 v[56:59], v[80:83], v[124:127], v[56:59]
  v_mfma_f32_16x16x32_bf16 v[68:71], v[80:83], v[204:207], v[68:71]
  ds_read_b64_tr_b16 v[92:93], v16 offset:12352
  ds_read_b64_tr_b16 v[94:95], v17 offset:12352
  s_mul_i32 s60, s76, 40
  s_add_u32 s60, s60, 36
  v_lshl_add_u32 v44, v3, 2, s60
  v_lshrrev_b32 v39, 3, v44
  v_lshlrev_b32 v39, 8, v39
  v_lshl_add_u32 v39, v2, 4, v39
  v_bfe_u32 v44, v44, 2, 1
  v_lshl_add_u32 v39, v44, 3, v39
  v_cmp_eq_u32 vcc, 0, v3
  v_bfrev_b32 v44, 1
  s_nop 0
  v_cndmask_b32 v39, v44, v39, vcc
  v_mov_b32 v10, 12
  ds_write_b32 v11, v10 offset:16
  s_waitcnt lgkmcnt(5)
  v_mfma_f32_16x16x32_bf16 v[48:51], v[4:7], v[128:131], v[48:51]
  v_mfma_f32_16x16x32_bf16 v[60:63], v[4:7], v[208:211], v[60:63]
  ds_read_b64_tr_b16 v[72:73], v16 offset:15360
  ds_read_b64_tr_b16 v[74:75], v17 offset:15360
  s_waitcnt lgkmcnt(5)
  v_mfma_f32_16x16x32_bf16 v[52:55], v[88:91], v[128:131], v[52:55]
  v_mfma_f32_16x16x32_bf16 v[64:67], v[88:91], v[208:211], v[64:67]
  ds_read_b64_tr_b16 v[76:77], v16 offset:15392
  ds_read_b64_tr_b16 v[78:79], v17 offset:15392
  s_waitcnt lgkmcnt(5)
  v_mfma_f32_16x16x32_bf16 v[56:59], v[92:95], v[128:131], v[56:59]
  v_mfma_f32_16x16x32_bf16 v[68:71], v[92:95], v[208:211], v[68:71]
  ds_read_b64_tr_b16 v[80:81], v16 offset:15424
  ds_read_b64_tr_b16 v[82:83], v17 offset:15424
  s_mov_b32 s16, s52
  s_mov_b32 s17, s53
  s_mov_b32 s18, 2621440
  s_mov_b32 s19, 0x00020000
  v_lshlrev_b32 v45, 4, v3
  v_add_u32 v45, 162048, v45
  s_waitcnt lgkmcnt(4)
  v_mfma_f32_16x16x32_bf16 v[48:51], v[72:75], v[132:135], v[48:51]
  v_mfma_f32_16x16x32_bf16 v[60:63], v[72:75], v[212:215], v[60:63]
  ds_read_b64_tr_b16 v[4:5], v16 offset:18432
  ds_read_b64_tr_b16 v[6:7], v17 offset:18432
  s_waitcnt lgkmcnt(4)
  v_mfma_f32_16x16x32_bf16 v[52:55], v[76:79], v[132:135], v[52:55]
  v_mfma_f32_16x16x32_bf16 v[64:67], v[76:79], v[212:215], v[64:67]
  ds_read_b64_tr_b16 v[88:89], v16 offset:18464
  ds_read_b64_tr_b16 v[90:91], v17 offset:18464
  s_waitcnt lgkmcnt(4)
  v_mfma_f32_16x16x32_bf16 v[56:59], v[80:83], v[132:135], v[56:59]
  v_mfma_f32_16x16x32_bf16 v[68:71], v[80:83], v[212:215], v[68:71]
  ds_read_b64_tr_b16 v[92:93], v16 offset:18496
  ds_read_b64_tr_b16 v[94:95], v17 offset:18496
  s_waitcnt lgkmcnt(4)
  v_mfma_f32_16x16x32_bf16 v[48:51], v[4:7], v[136:139], v[48:51]
  v_mfma_f32_16x16x32_bf16 v[60:63], v[4:7], v[216:219], v[60:63]
  ds_read_b64_tr_b16 v[72:73], v16 offset:21504
  ds_read_b64_tr_b16 v[74:75], v17 offset:21504
  s_waitcnt lgkmcnt(4)
  v_mfma_f32_16x16x32_bf16 v[52:55], v[88:91], v[136:139], v[52:55]
  v_mfma_f32_16x16x32_bf16 v[64:67], v[88:91], v[216:219], v[64:67]
  ds_read_b64_tr_b16 v[76:77], v16 offset:21536
  ds_read_b64_tr_b16 v[78:79], v17 offset:21536
  s_waitcnt lgkmcnt(4)
  v_mfma_f32_16x16x32_bf16 v[56:59], v[92:95], v[136:139], v[56:59]
  v_mfma_f32_16x16x32_bf16 v[68:71], v[92:95], v[216:219], v[68:71]
  ds_read_b64_tr_b16 v[80:81], v16 offset:21568
  ds_read_b64_tr_b16 v[82:83], v17 offset:21568
  v_subrev_u32 v16, 32768, v16
  v_subrev_u32 v17, 32768, v17
  s_waitcnt lgkmcnt(4)
  v_mfma_f32_16x16x32_bf16 v[48:51], v[72:75], v[140:143], v[48:51]
  v_mfma_f32_16x16x32_bf16 v[60:63], v[72:75], v[220:223], v[60:63]
  ds_read_b64_tr_b16 v[4:5], v16
  ds_read_b64_tr_b16 v[6:7], v17
  s_waitcnt lgkmcnt(4)
  v_mfma_f32_16x16x32_bf16 v[52:55], v[76:79], v[140:143], v[52:55]
  v_mfma_f32_16x16x32_bf16 v[64:67], v[76:79], v[220:223], v[64:67]
  ds_read_b64_tr_b16 v[88:89], v16 offset:32
  ds_read_b64_tr_b16 v[90:91], v17 offset:32
  s_waitcnt lgkmcnt(4)
  v_mfma_f32_16x16x32_bf16 v[56:59], v[80:83], v[140:143], v[56:59]
  v_mfma_f32_16x16x32_bf16 v[68:71], v[80:83], v[220:223], v[68:71]
  ds_read_b64_tr_b16 v[92:93], v16 offset:64
  ds_read_b64_tr_b16 v[94:95], v17 offset:64
  v_mov_b32 v10, 13
  ds_write_b32 v11, v10 offset:16
  s_waitcnt lgkmcnt(5)
  v_mfma_f32_16x16x32_bf16 v[48:51], v[4:7], v[144:147], v[48:51]
  v_mfma_f32_16x16x32_bf16 v[60:63], v[4:7], v[224:227], v[60:63]
  ds_read_b64_tr_b16 v[72:73], v16 offset:3072
  ds_read_b64_tr_b16 v[74:75], v17 offset:3072
  s_waitcnt lgkmcnt(5)
  v_mfma_f32_16x16x32_bf16 v[52:55], v[88:91], v[144:147], v[52:55]
  v_mfma_f32_16x16x32_bf16 v[64:67], v[88:91], v[224:227], v[64:67]
  ds_read_b64_tr_b16 v[76:77], v16 offset:3104
  ds_read_b64_tr_b16 v[78:79], v17 offset:3104
  s_waitcnt lgkmcnt(5)
  v_mfma_f32_16x16x32_bf16 v[56:59], v[92:95], v[144:147], v[56:59]
  v_mfma_f32_16x16x32_bf16 v[68:71], v[92:95], v[224:227], v[68:71]
  ds_read_b64_tr_b16 v[80:81], v16 offset:3136
  ds_read_b64_tr_b16 v[82:83], v17 offset:3136
  s_waitcnt lgkmcnt(4)
  v_mfma_f32_16x16x32_bf16 v[48:51], v[72:75], v[148:151], v[48:51]
  v_mfma_f32_16x16x32_bf16 v[60:63], v[72:75], v[228:231], v[60:63]
  ds_read_b64_tr_b16 v[4:5], v16 offset:6144
  ds_read_b64_tr_b16 v[6:7], v17 offset:6144
  s_waitcnt lgkmcnt(4)
  v_mfma_f32_16x16x32_bf16 v[52:55], v[76:79], v[148:151], v[52:55]
  v_mfma_f32_16x16x32_bf16 v[64:67], v[76:79], v[228:231], v[64:67]
  ds_read_b64_tr_b16 v[88:89], v16 offset:6176
  ds_read_b64_tr_b16 v[90:91], v17 offset:6176
  s_waitcnt lgkmcnt(4)
  v_mfma_f32_16x16x32_bf16 v[56:59], v[80:83], v[148:151], v[56:59]
  v_mfma_f32_16x16x32_bf16 v[68:71], v[80:83], v[228:231], v[68:71]
  ds_read_b64_tr_b16 v[92:93], v16 offset:6208
  ds_read_b64_tr_b16 v[94:95], v17 offset:6208
  s_waitcnt lgkmcnt(4)
  v_mfma_f32_16x16x32_bf16 v[48:51], v[4:7], v[152:155], v[48:51]
  v_mfma_f32_16x16x32_bf16 v[60:63], v[4:7], v[232:235], v[60:63]
  ds_read_b64_tr_b16 v[72:73], v16 offset:9216
  ds_read_b64_tr_b16 v[74:75], v17 offset:9216
  s_waitcnt lgkmcnt(4)
  v_mfma_f32_16x16x32_bf16 v[52:55], v[88:91], v[152:155], v[52:55]
  v_mfma_f32_16x16x32_bf16 v[64:67], v[88:91], v[232:235], v[64:67]
  ds_read_b64_tr_b16 v[76:77], v16 offset:9248
  ds_read_b64_tr_b16 v[78:79], v17 offset:9248
  s_waitcnt lgkmcnt(4)
  v_mfma_f32_16x16x32_bf16 v[56:59], v[92:95], v[152:155], v[56:59]
  v_mfma_f32_16x16x32_bf16 v[68:71], v[92:95], v[232:235], v[68:71]
  ds_read_b64_tr_b16 v[80:81], v16 offset:9280
  ds_read_b64_tr_b16 v[82:83], v17 offset:9280
  s_waitcnt lgkmcnt(4)
  v_mfma_f32_16x16x32_bf16 v[48:51], v[72:75], v[156:159], v[48:51]
  v_mfma_f32_16x16x32_bf16 v[60:63], v[72:75], v[236:239], v[60:63]
  ds_read_b64_tr_b16 v[4:5], v16 offset:12288
  ds_read_b64_tr_b16 v[6:7], v17 offset:12288
  s_waitcnt lgkmcnt(4)
  v_mfma_f32_16x16x32_bf16 v[52:55], v[76:79], v[156:159], v[52:55]
  v_mfma_f32_16x16x32_bf16 v[64:67], v[76:79], v[236:239], v[64:67]
  ds_read_b64_tr_b16 v[88:89], v16 offset:12320
  ds_read_b64_tr_b16 v[90:91], v17 offset:12320
  s_waitcnt lgkmcnt(4)
  v_mfma_f32_16x16x32_bf16 v[56:59], v[80:83], v[156:159], v[56:59]
  v_mfma_f32_16x16x32_bf16 v[68:71], v[80:83], v[236:239], v[68:71]
  ds_read_b64_tr_b16 v[92:93], v16 offset:12352
  ds_read_b64_tr_b16 v[94:95], v17 offset:12352
  v_mov_b32 v10, 14
  ds_write_b32 v11, v10 offset:16
  s_waitcnt lgkmcnt(5)
  v_mfma_f32_16x16x32_bf16 v[48:51], v[4:7], v[160:163], v[48:51]
  v_mfma_f32_16x16x32_bf16 v[60:63], v[4:7], v[240:243], v[60:63]
  ds_read_b64_tr_b16 v[72:73], v16 offset:15360
  ds_read_b64_tr_b16 v[74:75], v17 offset:15360
  s_waitcnt lgkmcnt(5)
  v_mfma_f32_16x16x32_bf16 v[52:55], v[88:91], v[160:163], v[52:55]
  v_mfma_f32_16x16x32_bf16 v[64:67], v[88:91], v[240:243], v[64:67]
  ds_read_b64_tr_b16 v[76:77], v16 offset:15392
  ds_read_b64_tr_b16 v[78:79], v17 offset:15392
  s_waitcnt lgkmcnt(5)
  v_mfma_f32_16x16x32_bf16 v[56:59], v[92:95], v[160:163], v[56:59]
  v_mfma_f32_16x16x32_bf16 v[68:71], v[92:95], v[240:243], v[68:71]
  ds_read_b64_tr_b16 v[80:81], v16 offset:15424
  ds_read_b64_tr_b16 v[82:83], v17 offset:15424
  s_waitcnt lgkmcnt(4)
  v_mfma_f32_16x16x32_bf16 v[48:51], v[72:75], v[164:167], v[48:51]
  v_mfma_f32_16x16x32_bf16 v[60:63], v[72:75], v[244:247], v[60:63]
  ds_read_b64_tr_b16 v[4:5], v16 offset:18432
  ds_read_b64_tr_b16 v[6:7], v17 offset:18432
  s_waitcnt lgkmcnt(4)
  v_mfma_f32_16x16x32_bf16 v[52:55], v[76:79], v[164:167], v[52:55]
  v_mfma_f32_16x16x32_bf16 v[64:67], v[76:79], v[244:247], v[64:67]
  ds_read_b64_tr_b16 v[88:89], v16 offset:18464
  ds_read_b64_tr_b16 v[90:91], v17 offset:18464
  s_waitcnt lgkmcnt(4)
  v_mfma_f32_16x16x32_bf16 v[56:59], v[80:83], v[164:167], v[56:59]
  v_mfma_f32_16x16x32_bf16 v[68:71], v[80:83], v[244:247], v[68:71]
  ds_read_b64_tr_b16 v[92:93], v16 offset:18496
  ds_read_b64_tr_b16 v[94:95], v17 offset:18496
  s_waitcnt lgkmcnt(4)
  v_mfma_f32_16x16x32_bf16 v[48:51], v[4:7], v[168:171], v[48:51]
  v_mfma_f32_16x16x32_bf16 v[60:63], v[4:7], v[248:251], v[60:63]
  ds_read_b64_tr_b16 v[72:73], v16 offset:21504
  ds_read_b64_tr_b16 v[74:75], v17 offset:21504
  s_waitcnt lgkmcnt(4)
  v_mfma_f32_16x16x32_bf16 v[52:55], v[88:91], v[168:171], v[52:55]
  v_mfma_f32_16x16x32_bf16 v[64:67], v[88:91], v[248:251], v[64:67]
  ds_read_b64_tr_b16 v[76:77], v16 offset:21536
  ds_read_b64_tr_b16 v[78:79], v17 offset:21536
  s_waitcnt lgkmcnt(4)
  v_mfma_f32_16x16x32_bf16 v[56:59], v[92:95], v[168:171], v[56:59]
  v_mfma_f32_16x16x32_bf16 v[68:71], v[92:95], v[248:251], v[68:71]
  ds_read_b64_tr_b16 v[80:81], v16 offset:21568
  ds_read_b64_tr_b16 v[82:83], v17 offset:21568
  s_waitcnt lgkmcnt(4)
  v_mfma_f32_16x16x32_bf16 v[48:51], v[72:75], v[172:175], v[48:51]
  v_mfma_f32_16x16x32_bf16 v[60:63], v[72:75], v[252:255], v[60:63]
  s_waitcnt lgkmcnt(2)
  v_mfma_f32_16x16x32_bf16 v[52:55], v[76:79], v[172:175], v[52:55]
  v_mfma_f32_16x16x32_bf16 v[64:67], v[76:79], v[252:255], v[64:67]
  s_waitcnt lgkmcnt(0)
  v_mfma_f32_16x16x32_bf16 v[56:59], v[80:83], v[172:175], v[56:59]
  v_mfma_f32_16x16x32_bf16 v[68:71], v[80:83], v[252:255], v[68:71]
  v_mov_b32 v10, 15
  ds_write_b32 v11, v10 offset:16
  ds_read_b128 v[152:155], v45
  ds_read_b128 v[156:159], v45 offset:64
  ds_read_b128 v[160:163], v45 offset:128
  s_waitcnt vmcnt(0)
  v_mov_b32 v10, 0
  s_mov_b32 s58, 0
L_26:
  buffer_load_dwordx2 v[12:13], v10, s[80:83], 0 offen sc1
  s_waitcnt vmcnt(0)
  v_readfirstlane_b32 s54, v12
  v_readfirstlane_b32 s55, v13
  s_add_u32 s58, s58, 1
  s_nop 4
  s_cmp_lg_u32 s54, 0
  s_cbranch_scc1 L_27
  s_sleep 2
  s_cmp_lt_u32 s58, 0x40000
  s_cbranch_scc1 L_26
L_27:
  s_waitcnt lgkmcnt(2)
  v_pk_mul_f32 v[192:193], v[152:153], v[20:21] op_sel:[0,1] op_sel_hi:[1,1]
  v_pk_mul_f32 v[194:195], v[154:155], v[20:21] op_sel:[0,1] op_sel_hi:[1,1]
  v_pk_fma_f32 v[48:49], v[48:49], v[20:21], v[192:193] op_sel_hi:[1,0,1] neg_lo:[0,0,1] neg_hi:[0,0,1]
  v_pk_fma_f32 v[50:51], v[50:51], v[20:21], v[194:195] op_sel_hi:[1,0,1] neg_lo:[0,0,1] neg_hi:[0,0,1]
  v_cvt_pk_bf16_f32 v192, v48, v49
  v_lshlrev_b32 v48, 16, v192
  v_and_b32 v49, 0xffff0000, v192
  v_cvt_pk_bf16_f32 v194, v50, v51
  v_lshlrev_b32 v50, 16, v194
  v_and_b32 v51, 0xffff0000, v194
  v_mul_f32 v192, 0x3fb8aa3b, v48
  v_mul_f32 v193, 0x3fb8aa3b, v49
  v_mul_f32 v194, 0x3fb8aa3b, v50
  v_mul_f32 v195, 0x3fb8aa3b, v51
  v_min_f32 v192, 0, v192
  v_min_f32 v193, 0, v193
  v_min_f32 v194, 0, v194
  v_min_f32 v195, 0, v195
  v_exp_f32 v192, v192
  v_exp_f32 v193, v193
  v_exp_f32 v194, v194
  v_exp_f32 v195, v195
  v_max_f32 v196, 0, v48
  v_max_f32 v197, 0, v49
  v_max_f32 v198, 0, v50
  v_max_f32 v199, 0, v51
  v_pk_add_f32 v[196:197], v[196:197], v[192:193]
  v_pk_add_f32 v[198:199], v[198:199], v[194:195]
  v_cvt_pk_bf16_f32 v192, v196, v197
  v_lshlrev_b32 v196, 16, v192
  v_and_b32 v197, 0xffff0000, v192
  v_cvt_pk_bf16_f32 v194, v198, v199
  v_lshlrev_b32 v198, 16, v194
  v_and_b32 v199, 0xffff0000, v194
  v_add_f32 v196, 0x358637bd, v196
  v_add_f32 v197, 0x358637bd, v197
  v_add_f32 v198, 0x358637bd, v198
  v_add_f32 v199, 0x358637bd, v199
  v_cvt_pk_bf16_f32 v112, v196, v197
  v_cvt_pk_bf16_f32 v113, v198, v199
  s_waitcnt lgkmcnt(1)
  v_pk_mul_f32 v[192:193], v[156:157], v[20:21] op_sel:[0,1] op_sel_hi:[1,1]
  v_pk_mul_f32 v[194:195], v[158:159], v[20:21] op_sel:[0,1] op_sel_hi:[1,1]
  v_pk_fma_f32 v[52:53], v[52:53], v[20:21], v[192:193] op_sel_hi:[1,0,1] neg_lo:[0,0,1] neg_hi:[0,0,1]
  v_pk_fma_f32 v[54:55], v[54:55], v[20:21], v[194:195] op_sel_hi:[1,0,1] neg_lo:[0,0,1] neg_hi:[0,0,1]
  v_cvt_pk_bf16_f32 v192, v52, v53
  v_lshlrev_b32 v52, 16, v192
  v_and_b32 v53, 0xffff0000, v192
  v_cvt_pk_bf16_f32 v194, v54, v55
  v_lshlrev_b32 v54, 16, v194
  v_and_b32 v55, 0xffff0000, v194
  v_mul_f32 v192, 0x3fb8aa3b, v52
  v_mul_f32 v193, 0x3fb8aa3b, v53
  v_mul_f32 v194, 0x3fb8aa3b, v54
  v_mul_f32 v195, 0x3fb8aa3b, v55
  v_min_f32 v192, 0, v192
  v_min_f32 v193, 0, v193
  v_min_f32 v194, 0, v194
  v_min_f32 v195, 0, v195
  v_exp_f32 v192, v192
  v_exp_f32 v193, v193
  v_exp_f32 v194, v194
  v_exp_f32 v195, v195
  v_max_f32 v196, 0, v52
  v_max_f32 v197, 0, v53
  v_max_f32 v198, 0, v54
  v_max_f32 v199, 0, v55
  v_pk_add_f32 v[196:197], v[196:197], v[192:193]
  v_pk_add_f32 v[198:199], v[198:199], v[194:195]
  v_cvt_pk_bf16_f32 v192, v196, v197
  v_lshlrev_b32 v196, 16, v192
  v_and_b32 v197, 0xffff0000, v192
  v_cvt_pk_bf16_f32 v194, v198, v199
  v_lshlrev_b32 v198, 16, v194
  v_and_b32 v199, 0xffff0000, v194
  v_add_f32 v196, 0x358637bd, v196
  v_add_f32 v197, 0x358637bd, v197
  v_add_f32 v198, 0x358637bd, v198
  v_add_f32 v199, 0x358637bd, v199
  v_cvt_pk_bf16_f32 v114, v196, v197
  v_cvt_pk_bf16_f32 v115, v198, v199
  s_waitcnt lgkmcnt(0)
  v_pk_mul_f32 v[192:193], v[160:161], v[20:21] op_sel:[0,1] op_sel_hi:[1,1]
  v_pk_mul_f32 v[194:195], v[162:163], v[20:21] op_sel:[0,1] op_sel_hi:[1,1]
  v_pk_fma_f32 v[56:57], v[56:57], v[20:21], v[192:193] op_sel_hi:[1,0,1] neg_lo:[0,0,1] neg_hi:[0,0,1]
  v_pk_fma_f32 v[58:59], v[58:59], v[20:21], v[194:195] op_sel_hi:[1,0,1] neg_lo:[0,0,1] neg_hi:[0,0,1]
  v_cvt_pk_bf16_f32 v192, v56, v57
  v_lshlrev_b32 v56, 16, v192
  v_and_b32 v57, 0xffff0000, v192
  v_cvt_pk_bf16_f32 v194, v58, v59
  v_lshlrev_b32 v58, 16, v194
  v_and_b32 v59, 0xffff0000, v194
  v_mul_f32 v192, 0x3fb8aa3b, v56
  v_mul_f32 v193, 0x3fb8aa3b, v57
  v_mul_f32 v194, 0x3fb8aa3b, v58
  v_mul_f32 v195, 0x3fb8aa3b, v59
  v_min_f32 v192, 0, v192
  v_min_f32 v193, 0, v193
  v_min_f32 v194, 0, v194
  v_min_f32 v195, 0, v195
  v_exp_f32 v192, v192
  v_exp_f32 v193, v193
  v_exp_f32 v194, v194
  v_exp_f32 v195, v195
  v_max_f32 v196, 0, v56
  v_max_f32 v197, 0, v57
  v_max_f32 v198, 0, v58
  v_max_f32 v199, 0, v59
  v_pk_add_f32 v[196:197], v[196:197], v[192:193]
  v_pk_add_f32 v[198:199], v[198:199], v[194:195]
  v_cvt_pk_bf16_f32 v192, v196, v197
  v_lshlrev_b32 v196, 16, v192
  v_and_b32 v197, 0xffff0000, v192
  v_cvt_pk_bf16_f32 v194, v198, v199
  v_lshlrev_b32 v198, 16, v194
  v_and_b32 v199, 0xffff0000, v194
  v_add_f32 v196, 0x358637bd, v196
  v_add_f32 v197, 0x358637bd, v197
  v_add_f32 v198, 0x358637bd, v198
  v_add_f32 v199, 0x358637bd, v199
  v_cvt_pk_bf16_f32 v116, v196, v197
  v_cvt_pk_bf16_f32 v117, v198, v199
  v_pk_mul_f32 v[192:193], v[152:153], v[22:23] op_sel:[0,1] op_sel_hi:[1,1]
  v_pk_mul_f32 v[194:195], v[154:155], v[22:23] op_sel:[0,1] op_sel_hi:[1,1]
  v_pk_fma_f32 v[60:61], v[60:61], v[22:23], v[192:193] op_sel_hi:[1,0,1] neg_lo:[0,0,1] neg_hi:[0,0,1]
  v_pk_fma_f32 v[62:63], v[62:63], v[22:23], v[194:195] op_sel_hi:[1,0,1] neg_lo:[0,0,1] neg_hi:[0,0,1]
  v_cvt_pk_bf16_f32 v192, v60, v61
  v_lshlrev_b32 v60, 16, v192
  v_and_b32 v61, 0xffff0000, v192
  v_cvt_pk_bf16_f32 v194, v62, v63
  v_lshlrev_b32 v62, 16, v194
  v_and_b32 v63, 0xffff0000, v194
  v_mul_f32 v192, 0x3fb8aa3b, v60
  v_mul_f32 v193, 0x3fb8aa3b, v61
  v_mul_f32 v194, 0x3fb8aa3b, v62
  v_mul_f32 v195, 0x3fb8aa3b, v63
  v_min_f32 v192, 0, v192
  v_min_f32 v193, 0, v193
  v_min_f32 v194, 0, v194
  v_min_f32 v195, 0, v195
  v_exp_f32 v192, v192
  v_exp_f32 v193, v193
  v_exp_f32 v194, v194
  v_exp_f32 v195, v195
  v_max_f32 v196, 0, v60
  v_max_f32 v197, 0, v61
  v_max_f32 v198, 0, v62
  v_max_f32 v199, 0, v63
  v_pk_add_f32 v[196:197], v[196:197], v[192:193]
  v_pk_add_f32 v[198:199], v[198:199], v[194:195]
  v_cvt_pk_bf16_f32 v192, v196, v197
  v_lshlrev_b32 v196, 16, v192
  v_and_b32 v197, 0xffff0000, v192
  v_cvt_pk_bf16_f32 v194, v198, v199
  v_lshlrev_b32 v198, 16, v194
  v_and_b32 v199, 0xffff0000, v194
  v_add_f32 v196, 0x358637bd, v196
  v_add_f32 v197, 0x358637bd, v197
  v_add_f32 v198, 0x358637bd, v198
  v_add_f32 v199, 0x358637bd, v199
  v_cvt_pk_bf16_f32 v120, v196, v197
  v_cvt_pk_bf16_f32 v121, v198, v199
  v_pk_mul_f32 v[192:193], v[156:157], v[22:23] op_sel:[0,1] op_sel_hi:[1,1]
  v_pk_mul_f32 v[194:195], v[158:159], v[22:23] op_sel:[0,1] op_sel_hi:[1,1]
  v_pk_fma_f32 v[64:65], v[64:65], v[22:23], v[192:193] op_sel_hi:[1,0,1] neg_lo:[0,0,1] neg_hi:[0,0,1]
  v_pk_fma_f32 v[66:67], v[66:67], v[22:23], v[194:195] op_sel_hi:[1,0,1] neg_lo:[0,0,1] neg_hi:[0,0,1]
  v_cvt_pk_bf16_f32 v192, v64, v65
  v_lshlrev_b32 v64, 16, v192
  v_and_b32 v65, 0xffff0000, v192
  v_cvt_pk_bf16_f32 v194, v66, v67
  v_lshlrev_b32 v66, 16, v194
  v_and_b32 v67, 0xffff0000, v194
  v_mul_f32 v192, 0x3fb8aa3b, v64
  v_mul_f32 v193, 0x3fb8aa3b, v65
  v_mul_f32 v194, 0x3fb8aa3b, v66
  v_mul_f32 v195, 0x3fb8aa3b, v67
  v_min_f32 v192, 0, v192
  v_min_f32 v193, 0, v193
  v_min_f32 v194, 0, v194
  v_min_f32 v195, 0, v195
  v_exp_f32 v192, v192
  v_exp_f32 v193, v193
  v_exp_f32 v194, v194
  v_exp_f32 v195, v195
  v_max_f32 v196, 0, v64
  v_max_f32 v197, 0, v65
  v_max_f32 v198, 0, v66
  v_max_f32 v199, 0, v67
  v_pk_add_f32 v[196:197], v[196:197], v[192:193]
  v_pk_add_f32 v[198:199], v[198:199], v[194:195]
  v_cvt_pk_bf16_f32 v192, v196, v197
  v_lshlrev_b32 v196, 16, v192
  v_and_b32 v197, 0xffff0000, v192
  v_cvt_pk_bf16_f32 v194, v198, v199
  v_lshlrev_b32 v198, 16, v194
  v_and_b32 v199, 0xffff0000, v194
  v_add_f32 v196, 0x358637bd, v196
  v_add_f32 v197, 0x358637bd, v197
  v_add_f32 v198, 0x358637bd, v198
  v_add_f32 v199, 0x358637bd, v199
  v_cvt_pk_bf16_f32 v122, v196, v197
  v_cvt_pk_bf16_f32 v123, v198, v199
  v_pk_mul_f32 v[192:193], v[160:161], v[22:23] op_sel:[0,1] op_sel_hi:[1,1]
  v_pk_mul_f32 v[194:195], v[162:163], v[22:23] op_sel:[0,1] op_sel_hi:[1,1]
  v_pk_fma_f32 v[68:69], v[68:69], v[22:23], v[192:193] op_sel_hi:[1,0,1] neg_lo:[0,0,1] neg_hi:[0,0,1]
  v_pk_fma_f32 v[70:71], v[70:71], v[22:23], v[194:195] op_sel_hi:[1,0,1] neg_lo:[0,0,1] neg_hi:[0,0,1]
  v_cvt_pk_bf16_f32 v192, v68, v69
  v_lshlrev_b32 v68, 16, v192
  v_and_b32 v69, 0xffff0000, v192
  v_cvt_pk_bf16_f32 v194, v70, v71
  v_lshlrev_b32 v70, 16, v194
  v_and_b32 v71, 0xffff0000, v194
  v_mul_f32 v192, 0x3fb8aa3b, v68
  v_mul_f32 v193, 0x3fb8aa3b, v69
  v_mul_f32 v194, 0x3fb8aa3b, v70
  v_mul_f32 v195, 0x3fb8aa3b, v71
  v_min_f32 v192, 0, v192
  v_min_f32 v193, 0, v193
  v_min_f32 v194, 0, v194
  v_min_f32 v195, 0, v195
  v_exp_f32 v192, v192
  v_exp_f32 v193, v193
  v_exp_f32 v194, v194
  v_exp_f32 v195, v195
  v_max_f32 v196, 0, v68
  v_max_f32 v197, 0, v69
  v_max_f32 v198, 0, v70
  v_max_f32 v199, 0, v71
  v_pk_add_f32 v[196:197], v[196:197], v[192:193]
  v_pk_add_f32 v[198:199], v[198:199], v[194:195]
  v_cvt_pk_bf16_f32 v192, v196, v197
  v_lshlrev_b32 v196, 16, v192
  v_and_b32 v197, 0xffff0000, v192
  v_cvt_pk_bf16_f32 v194, v198, v199
  v_lshlrev_b32 v198, 16, v194
  v_and_b32 v199, 0xffff0000, v194
  v_add_f32 v196, 0x358637bd, v196
  v_add_f32 v197, 0x358637bd, v197
  v_add_f32 v198, 0x358637bd, v198
  v_add_f32 v199, 0x358637bd, v199
  v_cvt_pk_bf16_f32 v124, v196, v197
  v_cvt_pk_bf16_f32 v125, v198, v199
  v_bfe_u32 v60, v0, 2, 2
  v_lshl_add_u32 v60, v3, 3, v60
  v_lshlrev_b32 v60, 7, v60
  v_and_b32 v61, 3, v0
  v_lshl_add_u32 v60, v61, 3, v60
  s_lshl_b32 s57, s7, 12
  s_add_u32 s57, s57, 122880
  v_add_u32 v60, s57, v60
  s_add_u32 s84, s52, 20971520
  s_addc_u32 s85, s53, 0
  s_mov_b32 s86, 6333440
  s_mov_b32 s87, 0x00020000
  v_lshlrev_b32 v61, 4, v1
  ds_read_b64_tr_b16 v[64:65], v60
  ds_read_b64_tr_b16 v[66:67], v60 offset:512
  ds_read_b64_tr_b16 v[68:69], v60 offset:32
  ds_read_b64_tr_b16 v[70:71], v60 offset:544
  ds_read_b64_tr_b16 v[72:73], v60 offset:64
  ds_read_b64_tr_b16 v[74:75], v60 offset:576
  ds_read_b64_tr_b16 v[76:77], v60 offset:96
  ds_read_b64_tr_b16 v[78:79], v60 offset:608
  s_add_u32 s56, s30, 0
  s_mul_i32 s57, s56, 52
  s_lshr_b32 s57, s57, 8
  s_mul_i32 s58, s57, 5
  s_sub_u32 s58, s56, s58
  s_mul_i32 s57, s57, s38
  s_mul_i32 s59, s29, 5
  s_add_u32 s58, s58, s59
  s_lshl_b32 s58, s58, 10
  s_add_u32 s57, s57, s58
  s_lshl_b32 s58, s56, 2
  s_add_u32 s58, s58, 3
  s_mul_i32 s58, s58, 2428
  s_lshr_b32 s58, s58, 16
  s_mul_i32 s62, s29, 7
  s_add_u32 s62, s62, s56
  s_mul_i32 s59, s58, 27
  s_lshr_b32 s60, s59, 2
  s_sub_u32 s60, s62, s60
  s_lshl_b32 s60, s60, 10
  s_mul_i32 s63, s58, 143360
  s_add_u32 s60, s60, s63
  s_sub_u32 s59, s59, 27
  s_ashr_i32 s59, s59, 2
  s_sub_u32 s3, s56, s59
  s_sub_u32 s59, s62, s59
  s_lshl_b32 s59, s59, 10
  s_add_u32 s59, s59, s63
  s_sub_u32 s59, s59, 143360
  s_cmp_lt_u32 s3, 7
  s_cselect_b32 s59, s59, 0x40000000
  s_cmp_eq_u32 s58, 0
  s_cselect_b32 s59, 0x40000000, s59
  s_cmp_eq_u32 s38, 0
  s_cselect_b32 s60, s60, s57
  s_cselect_b32 s59, s59, 0x40000000
  s_add_u32 s60, s60, s31
  s_add_u32 s59, s59, s31
  s_waitcnt lgkmcnt(6)
  buffer_store_dwordx4 v[64:67], v61, s[84:87], s60 offen sc1
  buffer_store_dwordx4 v[64:67], v61, s[84:87], s59 offen sc1
  v_mov_b32 v84, 0
  v_dot2c_f32_bf16 v84, s61, v64
  v_dot2c_f32_bf16 v84, s61, v65
  v_dot2c_f32_bf16 v84, s61, v66
  v_dot2c_f32_bf16 v84, s61, v67
  s_add_u32 s56, s30, 1
  s_mul_i32 s57, s56, 52
  s_lshr_b32 s57, s57, 8
  s_mul_i32 s58, s57, 5
  s_sub_u32 s58, s56, s58
  s_mul_i32 s57, s57, s38
  s_mul_i32 s59, s29, 5
  s_add_u32 s58, s58, s59
  s_lshl_b32 s58, s58, 10
  s_add_u32 s57, s57, s58
  s_lshl_b32 s58, s56, 2
  s_add_u32 s58, s58, 3
  s_mul_i32 s58, s58, 2428
  s_lshr_b32 s58, s58, 16
  s_mul_i32 s62, s29, 7
  s_add_u32 s62, s62, s56
  s_mul_i32 s59, s58, 27
  s_lshr_b32 s60, s59, 2
  s_sub_u32 s60, s62, s60
  s_lshl_b32 s60, s60, 10
  s_mul_i32 s63, s58, 143360
  s_add_u32 s60, s60, s63
  s_sub_u32 s59, s59, 27
  s_ashr_i32 s59, s59, 2
  s_sub_u32 s3, s56, s59
  s_sub_u32 s59, s62, s59
  s_lshl_b32 s59, s59, 10
  s_add_u32 s59, s59, s63
  s_sub_u32 s59, s59, 143360
  s_cmp_lt_u32 s3, 7
  s_cselect_b32 s59, s59, 0x40000000
  s_cmp_eq_u32 s58, 0
  s_cselect_b32 s59, 0x40000000, s59
  s_cmp_eq_u32 s38, 0
  s_cselect_b32 s60, s60, s57
  s_cselect_b32 s59, s59, 0x40000000
  s_add_u32 s60, s60, s31
  s_add_u32 s59, s59, s31
  s_waitcnt lgkmcnt(4)
  buffer_store_dwordx4 v[68:71], v61, s[84:87], s60 offen sc1
  buffer_store_dwordx4 v[68:71], v61, s[84:87], s59 offen sc1
  v_mov_b32 v85, 0
  v_dot2c_f32_bf16 v85, s61, v68
  v_dot2c_f32_bf16 v85, s61, v69
  v_dot2c_f32_bf16 v85, s61, v70
  v_dot2c_f32_bf16 v85, s61, v71
  s_add_u32 s56, s30, 2
  s_mul_i32 s57, s56, 52
  s_lshr_b32 s57, s57, 8
  s_mul_i32 s58, s57, 5
  s_sub_u32 s58, s56, s58
  s_mul_i32 s57, s57, s38
  s_mul_i32 s59, s29, 5
  s_add_u32 s58, s58, s59
  s_lshl_b32 s58, s58, 10
  s_add_u32 s57, s57, s58
  s_lshl_b32 s58, s56, 2
  s_add_u32 s58, s58, 3
  s_mul_i32 s58, s58, 2428
  s_lshr_b32 s58, s58, 16
  s_mul_i32 s62, s29, 7
  s_add_u32 s62, s62, s56
  s_mul_i32 s59, s58, 27
  s_lshr_b32 s60, s59, 2
  s_sub_u32 s60, s62, s60
  s_lshl_b32 s60, s60, 10
  s_mul_i32 s63, s58, 143360
  s_add_u32 s60, s60, s63
  s_sub_u32 s59, s59, 27
  s_ashr_i32 s59, s59, 2
  s_sub_u32 s3, s56, s59
  s_sub_u32 s59, s62, s59
  s_lshl_b32 s59, s59, 10
  s_add_u32 s59, s59, s63
  s_sub_u32 s59, s59, 143360
  s_cmp_lt_u32 s3, 7
  s_cselect_b32 s59, s59, 0x40000000
  s_cmp_eq_u32 s58, 0
  s_cselect_b32 s59, 0x40000000, s59
  s_cmp_eq_u32 s38, 0
  s_cselect_b32 s60, s60, s57
  s_cselect_b32 s59, s59, 0x40000000
  s_add_u32 s60, s60, s31
  s_add_u32 s59, s59, s31
  s_waitcnt lgkmcnt(2)
  buffer_store_dwordx4 v[72:75], v61, s[84:87], s60 offen sc1
  buffer_store_dwordx4 v[72:75], v61, s[84:87], s59 offen sc1
  v_mov_b32 v86, 0
  v_dot2c_f32_bf16 v86, s61, v72
  v_dot2c_f32_bf16 v86, s61, v73
  v_dot2c_f32_bf16 v86, s61, v74
  v_dot2c_f32_bf16 v86, s61, v75
  s_add_u32 s56, s30, 3
  s_mul_i32 s57, s56, 52
  s_lshr_b32 s57, s57, 8
  s_mul_i32 s58, s57, 5
  s_sub_u32 s58, s56, s58
  s_mul_i32 s57, s57, s38
  s_mul_i32 s59, s29, 5
  s_add_u32 s58, s58, s59
  s_lshl_b32 s58, s58, 10
  s_add_u32 s57, s57, s58
  s_lshl_b32 s58, s56, 2
  s_add_u32 s58, s58, 3
  s_mul_i32 s58, s58, 2428
  s_lshr_b32 s58, s58, 16
  s_mul_i32 s62, s29, 7
  s_add_u32 s62, s62, s56
  s_mul_i32 s59, s58, 27
  s_lshr_b32 s60, s59, 2
  s_sub_u32 s60, s62, s60
  s_lshl_b32 s60, s60, 10
  s_mul_i32 s63, s58, 143360
  s_add_u32 s60, s60, s63
  s_sub_u32 s59, s59, 27
  s_ashr_i32 s59, s59, 2
  s_sub_u32 s3, s56, s59
  s_sub_u32 s59, s62, s59
  s_lshl_b32 s59, s59, 10
  s_add_u32 s59, s59, s63
  s_sub_u32 s59, s59, 143360
  s_cmp_lt_u32 s3, 7
  s_cselect_b32 s59, s59, 0x40000000
  s_cmp_eq_u32 s58, 0
  s_cselect_b32 s59, 0x40000000, s59
  s_cmp_eq_u32 s38, 0
  s_cselect_b32 s60, s60, s57
  s_cselect_b32 s59, s59, 0x40000000
  s_add_u32 s60, s60, s31
  s_add_u32 s59, s59, s31
  s_waitcnt lgkmcnt(0)
  buffer_store_dwordx4 v[76:79], v61, s[84:87], s60 offen sc1
  buffer_store_dwordx4 v[76:79], v61, s[84:87], s59 offen sc1
  v_mov_b32 v87, 0
  v_dot2c_f32_bf16 v87, s61, v76
  v_dot2c_f32_bf16 v87, s61, v77
  v_dot2c_f32_bf16 v87, s61, v78
  v_dot2c_f32_bf16 v87, s61, v79
  v_mov_b32 v62, v84
  s_nop 1
  v_permlane32_swap_b32 v62, v84
  v_add_f32 v84, v84, v62
  v_mov_b32 v62, v84
  s_nop 1
  v_permlane16_swap_b32 v62, v84
  v_add_f32 v84, v84, v62
  v_mov_b32 v62, v85
  s_nop 1
  v_permlane32_swap_b32 v62, v85
  v_add_f32 v85, v85, v62
  v_mov_b32 v62, v85
  s_nop 1
  v_permlane16_swap_b32 v62, v85
  v_add_f32 v85, v85, v62
  v_mov_b32 v62, v86
  s_nop 1
  v_permlane32_swap_b32 v62, v86
  v_add_f32 v86, v86, v62
  v_mov_b32 v62, v86
  s_nop 1
  v_permlane16_swap_b32 v62, v86
  v_add_f32 v86, v86, v62
  v_mov_b32 v62, v87
  s_nop 1
  v_permlane32_swap_b32 v62, v87
  v_add_f32 v87, v87, v62
  v_mov_b32 v62, v87
  s_nop 1
  v_permlane16_swap_b32 v62, v87
  v_add_f32 v87, v87, v62
  v_cmp_eq_u32 vcc, 1, v3
  s_nop 1
  v_cndmask_b32 v84, v84, v85, vcc
  v_cmp_eq_u32 vcc, 2, v3
  s_nop 1
  v_cndmask_b32 v84, v84, v86, vcc
  v_cmp_eq_u32 vcc, 3, v3
  s_nop 1
  v_cndmask_b32 v84, v84, v87, vcc
  v_lshlrev_b32 v62, 2, v1
  buffer_store_dword v84, v62, s[84:87], s39 offen sc1
  s_waitcnt lgkmcnt(0)
  s_waitcnt lgkmcnt(0)
  s_mov_b32 s57, 0
L_28:
  ds_read_b128 v[12:15], v8 offset:48
  s_waitcnt lgkmcnt(0)
  v_min3_u32 v12, v12, v13, v14
  v_min_u32 v12, v12, v15
  s_nop 0
  v_readfirstlane_b32 s56, v12
  s_nop 3
  s_cmp_ge_u32 s56, 1
  s_cbranch_scc1 L_29
  s_add_u32 s57, s57, 1
  s_sleep 1
  s_cmp_lt_u32 s57, 0x400000
  s_cbranch_scc1 L_28
L_29:
  ds_read_b64 v[128:129], v24
  ds_read_b64 v[130:131], v27
  ds_read_b64 v[132:133], v25
  ds_read_b64 v[134:135], v28
  ds_read_b64 v[136:137], v26
  ds_read_b64 v[138:139], v29
  ds_read_b64 v[140:141], v30
  ds_read_b64 v[142:143], v33
  ds_read_b64 v[144:145], v31
  ds_read_b64 v[146:147], v34
  ds_read_b64 v[148:149], v32
  ds_read_b64 v[150:151], v35
  s_waitcnt lgkmcnt(6)
  v_mfma_f32_16x16x32_bf16 v[56:59], v[136:139], v[112:115], 0
  v_mfma_f32_16x16x32_bf16 v[48:51], v[128:131], v[112:115], 0
  v_mfma_f32_16x16x32_bf16 v[52:55], v[132:135], v[112:115], 0
  s_waitcnt lgkmcnt(0)
  v_mfma_f32_16x16x32_bf16 v[68:71], v[148:151], v[114:117], 0
  v_mfma_f32_16x16x32_bf16 v[60:63], v[140:143], v[114:117], 0
  v_mfma_f32_16x16x32_bf16 v[64:67], v[144:147], v[114:117], 0
  v_mfma_f32_16x16x32_bf16 v[80:83], v[136:139], v[120:123], 0
  v_mfma_f32_16x16x32_bf16 v[72:75], v[128:131], v[120:123], 0
  v_mfma_f32_16x16x32_bf16 v[76:79], v[132:135], v[120:123], 0
  v_mfma_f32_16x16x32_bf16 v[92:95], v[148:151], v[122:125], 0
  v_mfma_f32_16x16x32_bf16 v[84:87], v[140:143], v[122:125], 0
  v_mfma_f32_16x16x32_bf16 v[88:91], v[144:147], v[122:125], 0
  v_cvt_pk_bf16_f32 v56, v56, v56
  v_lshlrev_b32 v56, 16, v56
  v_add_f32 v56, 0x358637bd, v56
  v_cvt_pk_bf16_f32 v56, v56, v56
  v_lshlrev_b32 v56, 16, v56
  v_rcp_f32 v56, v56
  v_cvt_pk_bf16_f32 v68, v68, v68
  v_lshlrev_b32 v68, 16, v68
  v_add_f32 v68, 0x358637bd, v68
  v_cvt_pk_bf16_f32 v68, v68, v68
  v_lshlrev_b32 v68, 16, v68
  v_rcp_f32 v68, v68
  v_cvt_pk_bf16_f32 v80, v80, v80
  v_lshlrev_b32 v80, 16, v80
  v_add_f32 v80, 0x358637bd, v80
  v_cvt_pk_bf16_f32 v80, v80, v80
  v_lshlrev_b32 v80, 16, v80
  v_rcp_f32 v80, v80
  v_cvt_pk_bf16_f32 v92, v92, v92
  v_lshlrev_b32 v92, 16, v92
  v_add_f32 v92, 0x358637bd, v92
  v_cvt_pk_bf16_f32 v92, v92, v92
  v_lshlrev_b32 v92, 16, v92
  v_rcp_f32 v92, v92
  v_cvt_pk_bf16_f32 v192, v48, v49
  v_lshlrev_b32 v48, 16, v192
  v_and_b32 v49, 0xffff0000, v192
  v_cvt_pk_bf16_f32 v193, v50, v51
  v_lshlrev_b32 v50, 16, v193
  v_and_b32 v51, 0xffff0000, v193
  v_mul_f32 v48, v48, v56
  v_mul_f32 v49, v49, v56
  v_mul_f32 v50, v50, v56
  v_mul_f32 v51, v51, v56
  v_cvt_pk_bf16_f32 v168, v48, v49
  v_cvt_pk_bf16_f32 v169, v50, v51
  buffer_store_dwordx2 v[168:169], v36, s[16:19], s68 offen sc1
  v_cvt_pk_bf16_f32 v192, v52, v53
  v_lshlrev_b32 v52, 16, v192
  v_and_b32 v53, 0xffff0000, v192
  v_cvt_pk_bf16_f32 v193, v54, v55
  v_lshlrev_b32 v54, 16, v193
  v_and_b32 v55, 0xffff0000, v193
  v_mul_f32 v52, v52, v56
  v_mul_f32 v53, v53, v56
  v_mul_f32 v54, v54, v56
  v_mul_f32 v55, v55, v56
  v_cvt_pk_bf16_f32 v170, v52, v53
  v_cvt_pk_bf16_f32 v171, v54, v55
  buffer_store_dwordx2 v[170:171], v37, s[16:19], s68 offen sc1
  v_cvt_pk_bf16_f32 v192, v60, v61
  v_lshlrev_b32 v60, 16, v192
  v_and_b32 v61, 0xffff0000, v192
  v_cvt_pk_bf16_f32 v193, v62, v63
  v_lshlrev_b32 v62, 16, v193
  v_and_b32 v63, 0xffff0000, v193
  v_mul_f32 v60, v60, v68
  v_mul_f32 v61, v61, v68
  v_mul_f32 v62, v62, v68
  v_mul_f32 v63, v63, v68
  v_cvt_pk_bf16_f32 v172, v60, v61
  v_cvt_pk_bf16_f32 v173, v62, v63
  buffer_store_dwordx2 v[172:173], v38, s[16:19], s68 offen sc1
  v_cvt_pk_bf16_f32 v192, v64, v65
  v_lshlrev_b32 v64, 16, v192
  v_and_b32 v65, 0xffff0000, v192
  v_cvt_pk_bf16_f32 v193, v66, v67
  v_lshlrev_b32 v66, 16, v193
  v_and_b32 v67, 0xffff0000, v193
  v_mul_f32 v64, v64, v68
  v_mul_f32 v65, v65, v68
  v_mul_f32 v66, v66, v68
  v_mul_f32 v67, v67, v68
  v_cvt_pk_bf16_f32 v174, v64, v65
  v_cvt_pk_bf16_f32 v175, v66, v67
  buffer_store_dwordx2 v[174:175], v39, s[16:19], s68 offen sc1
  v_cvt_pk_bf16_f32 v192, v72, v73
  v_lshlrev_b32 v72, 16, v192
  v_and_b32 v73, 0xffff0000, v192
  v_cvt_pk_bf16_f32 v193, v74, v75
  v_lshlrev_b32 v74, 16, v193
  v_and_b32 v75, 0xffff0000, v193
  v_mul_f32 v72, v72, v80
  v_mul_f32 v73, v73, v80
  v_mul_f32 v74, v74, v80
  v_mul_f32 v75, v75, v80
  v_cvt_pk_bf16_f32 v176, v72, v73
  v_cvt_pk_bf16_f32 v177, v74, v75
  buffer_store_dwordx2 v[176:177], v36, s[16:19], s69 offen sc1
  v_cvt_pk_bf16_f32 v192, v76, v77
  v_lshlrev_b32 v76, 16, v192
  v_and_b32 v77, 0xffff0000, v192
  v_cvt_pk_bf16_f32 v193, v78, v79
  v_lshlrev_b32 v78, 16, v193
  v_and_b32 v79, 0xffff0000, v193
  v_mul_f32 v76, v76, v80
  v_mul_f32 v77, v77, v80
  v_mul_f32 v78, v78, v80
  v_mul_f32 v79, v79, v80
  v_cvt_pk_bf16_f32 v178, v76, v77
  v_cvt_pk_bf16_f32 v179, v78, v79
  buffer_store_dwordx2 v[178:179], v37, s[16:19], s69 offen sc1
  v_cvt_pk_bf16_f32 v192, v84, v85
  v_lshlrev_b32 v84, 16, v192
  v_and_b32 v85, 0xffff0000, v192
  v_cvt_pk_bf16_f32 v193, v86, v87
  v_lshlrev_b32 v86, 16, v193
  v_and_b32 v87, 0xffff0000, v193
  v_mul_f32 v84, v84, v92
  v_mul_f32 v85, v85, v92
  v_mul_f32 v86, v86, v92
  v_mul_f32 v87, v87, v92
  v_cvt_pk_bf16_f32 v180, v84, v85
  v_cvt_pk_bf16_f32 v181, v86, v87
  buffer_store_dwordx2 v[180:181], v38, s[16:19], s69 offen sc1
  v_cvt_pk_bf16_f32 v192, v88, v89
  v_lshlrev_b32 v88, 16, v192
  v_and_b32 v89, 0xffff0000, v192
  v_cvt_pk_bf16_f32 v193, v90, v91
  v_lshlrev_b32 v90, 16, v193
  v_and_b32 v91, 0xffff0000, v193
  v_mul_f32 v88, v88, v92
  v_mul_f32 v89, v89, v92
  v_mul_f32 v90, v90, v92
  v_mul_f32 v91, v91, v92
  v_cvt_pk_bf16_f32 v182, v88, v89
  v_cvt_pk_bf16_f32 v183, v90, v91
  buffer_store_dwordx2 v[182:183], v39, s[16:19], s69 offen sc1
  s_lshl_b32 s79, s77, 4
  s_add_u32 s79, s79, s92
  s_add_u32 s56, s54, 2
  v_mov_b32 v12, s56
  v_mov_b32 v13, s55
  v_mov_b32 v10, 0
  s_lshl_b32 s57, s79, 7
  s_add_u32 s57, s57, 131072
  s_mov_b64 s[58:59], exec
  s_waitcnt vmcnt(0)
  s_mov_b64 exec, 1
  buffer_store_dwordx2 v[12:13], v10, s[24:27], s57 offen sc1
  s_mov_b64 exec, s[58:59]
  s_waitcnt lgkmcnt(0)
  v_mov_b32 v10, 1
  ds_write_b32 v11, v10 offset:96
  s_mov_b32 s8, s52
  s_mov_b32 s9, s53
  s_mov_b32 s10, 2621440
  s_mov_b32 s11, 0x00020000
  s_add_u32 s16, s52, 2621440
  s_addc_u32 s17, s53, 0
  s_mov_b32 s18, 2621440
  s_mov_b32 s19, 0x00020000
  v_bfe_u32 v32, v0, 2, 2
  v_bfe_u32 v33, v0, 4, 1
  v_lshl_or_b32 v32, v33, 2, v32
  v_lshl_or_b32 v33, v3, 3, v32
  v_mul_u32_u24 v16, 160, v33
  v_xor_b32 v33, 4, v33
  v_mul_u32_u24 v17, 160, v33
  v_and_b32 v32, 3, v0
  v_lshl_add_u32 v16, v32, 3, v16
  v_lshl_add_u32 v17, v32, 3, v17
  v_lshrrev_b32 v32, 1, v3
  v_lshlrev_b32 v7, 8, v32
  v_lshl_add_u32 v7, v2, 4, v7
  v_and_b32 v32, 1, v3
  v_lshl_add_u32 v7, v32, 3, v7
  s_mul_i32 s69, s90, 20480
  s_mul_i32 s56, s89, 2560
  s_add_u32 s69, s69, s56
  s_mul_i32 s72, s89, 160
  s_lshl_b32 s56, s90, 4
  v_add_u32 v46, s56, v2
  v_mul_u32_u24 v46, 1280, v46
  v_lshl_add_u32 v46, v3, 3, v46
  s_mov_b32 s20, s32
  s_mov_b32 s21, s33
  s_mov_b32 s22, 2621440
  s_mov_b32 s23, 0x00020000
  buffer_load_dwordx2 v[246:247], v46, s[20:23], s72 offen
  buffer_load_dwordx2 v[248:249], v46, s[20:23], s72 offen offset:32
  buffer_load_dwordx2 v[250:251], v46, s[20:23], s72 offen offset:64
  buffer_load_dwordx2 v[252:253], v46, s[20:23], s72 offen offset:96
  buffer_load_dwordx2 v[254:255], v46, s[20:23], s72 offen offset:128
  s_waitcnt vmcnt(4)
  v_lshlrev_b32 v108, 16, v246
  v_and_b32 v109, 0xffff0000, v246
  v_lshlrev_b32 v110, 16, v247
  v_and_b32 v111, 0xffff0000, v247
  s_waitcnt vmcnt(3)
  v_lshlrev_b32 v112, 16, v248
  v_and_b32 v113, 0xffff0000, v248
  v_lshlrev_b32 v114, 16, v249
  v_and_b32 v115, 0xffff0000, v249
  s_waitcnt vmcnt(2)
  v_lshlrev_b32 v116, 16, v250
  v_and_b32 v117, 0xffff0000, v250
  v_lshlrev_b32 v118, 16, v251
  v_and_b32 v119, 0xffff0000, v251
  s_waitcnt vmcnt(1)
  v_lshlrev_b32 v120, 16, v252
  v_and_b32 v121, 0xffff0000, v252
  v_lshlrev_b32 v122, 16, v253
  v_and_b32 v123, 0xffff0000, v253
  s_waitcnt vmcnt(0)
  v_lshlrev_b32 v124, 16, v254
  v_and_b32 v125, 0xffff0000, v254
  v_lshlrev_b32 v126, 16, v255
  v_and_b32 v127, 0xffff0000, v255
  v_mov_b32 v46, v7
  v_lshlrev_b32 v32, 4, v1
  s_mul_i32 s68, s90, 20480
  s_lshr_b32 s62, s90, 1
  s_lshl_b32 s62, s62, 4
  s_add_u32 s56, s54, 2
  v_add_u32 v10, s62, v1
  v_lshlrev_b32 v10, 7, v10
  v_add_u32 v10, 131072, v10
  s_mov_b64 s[58:59], exec
  s_mov_b64 exec, 65535
  s_mov_b32 s57, 0
  s_waitcnt vmcnt(0)
L_30:
  buffer_load_dwordx2 v[12:13], v10, s[24:27], 0 offen sc1
  s_waitcnt vmcnt(0)
  v_cmp_ne_u32 vcc, s56, v12
  v_cmp_ne_u32 s[94:95], s55, v13
  s_add_u32 s57, s57, 1
  s_nop 4
  s_or_b64 vcc, vcc, s[94:95]
  s_cbranch_vccz L_31
  s_cmp_lt_u32 s57, 0x80000
  s_cbranch_scc1 L_30
L_31:
  s_mov_b64 exec, s[58:59]
  v_mov_b32 v10, 2
  ds_write_b32 v11, v10 offset:128
  buffer_load_dwordx4 v[148:151], v32, s[8:11], s68 offen sc1
  buffer_load_dwordx4 v[152:155], v32, s[8:11], s68 offen offset:1024 sc1
  buffer_load_dwordx4 v[156:159], v32, s[8:11], s68 offen offset:2048 sc1
  buffer_load_dwordx4 v[160:163], v32, s[8:11], s68 offen offset:3072 sc1
  s_add_u32 s68, s68, 4096
  buffer_load_dwordx4 v[164:167], v32, s[8:11], s68 offen sc1
  buffer_load_dwordx4 v[168:171], v32, s[8:11], s68 offen offset:1024 sc1
  s_add_u32 s20, s52, 28311552
  s_addc_u32 s21, s53, 0
  s_mov_b32 s22, 131072
  s_mov_b32 s23, 0x00020000
  s_lshl_b32 s73, s90, 10
  s_lshl_b32 s56, s89, 7
  s_add_u32 s73, s73, s56
  v_lshlrev_b32 v4, 3, v2
  v_mov_b32 v20, 0
  v_mov_b32 v21, 0
  v_mov_b32 v22, 0
  v_mov_b32 v23, 0
  s_waitcnt lgkmcnt(0)
  s_mov_b32 s57, 0
L_32:
  ds_read_b128 v[12:15], v8 offset:0
  s_waitcnt lgkmcnt(0)
  v_min3_u32 v12, v12, v13, v14
  v_min_u32 v12, v12, v15
  s_nop 0
  v_readfirstlane_b32 s56, v12
  s_nop 3
  s_cmp_ge_u32 s56, 20
  s_cbranch_scc1 L_33
  s_add_u32 s57, s57, 1
  s_sleep 1
  s_cmp_lt_u32 s57, 0x400000
  s_cbranch_scc1 L_32
L_33:
  v_add_u32 v16, 61440, v16
  v_add_u32 v17, 61440, v17
  ds_read_b64_tr_b16 v[68:69], v16
  ds_read_b64_tr_b16 v[70:71], v17
  ds_read_b64_tr_b16 v[72:73], v16 offset:32
  ds_read_b64_tr_b16 v[74:75], v17 offset:32
  ds_read_b64_tr_b16 v[76:77], v16 offset:64
  ds_read_b64_tr_b16 v[78:79], v17 offset:64
  ds_read_b64_tr_b16 v[80:81], v16 offset:96
  ds_read_b64_tr_b16 v[82:83], v17 offset:96
  ds_read_b64_tr_b16 v[84:85], v16 offset:128
  ds_read_b64_tr_b16 v[86:87], v17 offset:128
  ds_read_b64_tr_b16 v[88:89], v16 offset:5120
  ds_read_b64_tr_b16 v[90:91], v17 offset:5120
  ds_read_b64_tr_b16 v[92:93], v16 offset:5152
  ds_read_b64_tr_b16 v[94:95], v17 offset:5152
  ds_read_b64_tr_b16 v[96:97], v16 offset:5184
  ds_read_b64_tr_b16 v[98:99], v17 offset:5184
  ds_read_b64_tr_b16 v[100:101], v16 offset:5216
  ds_read_b64_tr_b16 v[102:103], v17 offset:5216
  ds_read_b64_tr_b16 v[104:105], v16 offset:5248
  ds_read_b64_tr_b16 v[106:107], v17 offset:5248
  s_waitcnt vmcnt(5) lgkmcnt(15)
  v_mfma_f32_16x16x32_bf16 v[48:51], v[68:71], v[148:151], 0
  ds_read_b64_tr_b16 v[128:129], v16 offset:10240
  ds_read_b64_tr_b16 v[130:131], v17 offset:10240
  s_waitcnt lgkmcnt(15)
  v_mfma_f32_16x16x32_bf16 v[52:55], v[72:75], v[148:151], 0
  ds_read_b64_tr_b16 v[132:133], v16 offset:10272
  ds_read_b64_tr_b16 v[134:135], v17 offset:10272
  s_waitcnt lgkmcnt(15)
  v_mfma_f32_16x16x32_bf16 v[56:59], v[76:79], v[148:151], 0
  ds_read_b64_tr_b16 v[136:137], v16 offset:10304
  ds_read_b64_tr_b16 v[138:139], v17 offset:10304
  s_waitcnt lgkmcnt(15)
  v_mfma_f32_16x16x32_bf16 v[60:63], v[80:83], v[148:151], 0
  ds_read_b64_tr_b16 v[140:141], v16 offset:10336
  ds_read_b64_tr_b16 v[142:143], v17 offset:10336
  s_waitcnt lgkmcnt(15)
  v_mfma_f32_16x16x32_bf16 v[64:67], v[84:87], v[148:151], 0
  ds_read_b64_tr_b16 v[144:145], v16 offset:10368
  ds_read_b64_tr_b16 v[146:147], v17 offset:10368
  buffer_load_dwordx4 v[172:175], v32, s[8:11], s68 offen offset:2048 sc1
  buffer_load_dwordx4 v[176:179], v32, s[8:11], s68 offen offset:3072 sc1
  s_add_u32 s68, s68, 4096
  s_waitcnt vmcnt(6) lgkmcnt(15)
  v_mfma_f32_16x16x32_bf16 v[48:51], v[88:91], v[152:155], v[48:51]
  ds_read_b64_tr_b16 v[68:69], v16 offset:15360
  ds_read_b64_tr_b16 v[70:71], v17 offset:15360
  s_waitcnt lgkmcnt(15)
  v_mfma_f32_16x16x32_bf16 v[52:55], v[92:95], v[152:155], v[52:55]
  ds_read_b64_tr_b16 v[72:73], v16 offset:15392
  ds_read_b64_tr_b16 v[74:75], v17 offset:15392
  s_waitcnt lgkmcnt(15)
  v_mfma_f32_16x16x32_bf16 v[56:59], v[96:99], v[152:155], v[56:59]
  ds_read_b64_tr_b16 v[76:77], v16 offset:15424
  ds_read_b64_tr_b16 v[78:79], v17 offset:15424
  s_waitcnt lgkmcnt(15)
  v_mfma_f32_16x16x32_bf16 v[60:63], v[100:103], v[152:155], v[60:63]
  ds_read_b64_tr_b16 v[80:81], v16 offset:15456
  ds_read_b64_tr_b16 v[82:83], v17 offset:15456
  s_waitcnt lgkmcnt(15)
  v_mfma_f32_16x16x32_bf16 v[64:67], v[104:107], v[152:155], v[64:67]
  ds_read_b64_tr_b16 v[84:85], v16 offset:15488
  ds_read_b64_tr_b16 v[86:87], v17 offset:15488
  buffer_load_dwordx4 v[180:183], v32, s[8:11], s68 offen sc1
  buffer_load_dwordx4 v[184:187], v32, s[8:11], s68 offen offset:1024 sc1
  s_waitcnt vmcnt(7) lgkmcnt(15)
  v_mfma_f32_16x16x32_bf16 v[48:51], v[128:131], v[156:159], v[48:51]
  ds_read_b64_tr_b16 v[88:89], v16 offset:20480
  ds_read_b64_tr_b16 v[90:91], v17 offset:20480
  s_waitcnt lgkmcnt(15)
  v_mfma_f32_16x16x32_bf16 v[52:55], v[132:135], v[156:159], v[52:55]
  ds_read_b64_tr_b16 v[92:93], v16 offset:20512
  ds_read_b64_tr_b16 v[94:95], v17 offset:20512
  s_waitcnt lgkmcnt(15)
  v_mfma_f32_16x16x32_bf16 v[56:59], v[136:139], v[156:159], v[56:59]
  ds_read_b64_tr_b16 v[96:97], v16 offset:20544
  ds_read_b64_tr_b16 v[98:99], v17 offset:20544
  s_waitcnt lgkmcnt(15)
  v_mfma_f32_16x16x32_bf16 v[60:63], v[140:143], v[156:159], v[60:63]
  ds_read_b64_tr_b16 v[100:101], v16 offset:20576
  ds_read_b64_tr_b16 v[102:103], v17 offset:20576
  s_waitcnt lgkmcnt(15)
  v_mfma_f32_16x16x32_bf16 v[64:67], v[144:147], v[156:159], v[64:67]
  ds_read_b64_tr_b16 v[104:105], v16 offset:20608
  ds_read_b64_tr_b16 v[106:107], v17 offset:20608
  buffer_load_dwordx4 v[188:191], v32, s[8:11], s68 offen offset:2048 sc1
  buffer_load_dwordx4 v[192:195], v32, s[8:11], s68 offen offset:3072 sc1
  s_add_u32 s68, s68, 4096
  s_waitcnt vmcnt(8) lgkmcnt(15)
  v_mfma_f32_16x16x32_bf16 v[48:51], v[68:71], v[160:163], v[48:51]
  ds_read_b64_tr_b16 v[128:129], v16 offset:25600
  ds_read_b64_tr_b16 v[130:131], v17 offset:25600
  s_waitcnt lgkmcnt(15)
  v_mfma_f32_16x16x32_bf16 v[52:55], v[72:75], v[160:163], v[52:55]
  ds_read_b64_tr_b16 v[132:133], v16 offset:25632
  ds_read_b64_tr_b16 v[134:135], v17 offset:25632
  s_waitcnt lgkmcnt(15)
  v_mfma_f32_16x16x32_bf16 v[56:59], v[76:79], v[160:163], v[56:59]
  ds_read_b64_tr_b16 v[136:137], v16 offset:25664
  ds_read_b64_tr_b16 v[138:139], v17 offset:25664
  s_waitcnt lgkmcnt(15)
  v_mfma_f32_16x16x32_bf16 v[60:63], v[80:83], v[160:163], v[60:63]
  ds_read_b64_tr_b16 v[140:141], v16 offset:25696
  ds_read_b64_tr_b16 v[142:143], v17 offset:25696
  s_waitcnt lgkmcnt(15)
  v_mfma_f32_16x16x32_bf16 v[64:67], v[84:87], v[160:163], v[64:67]
  ds_read_b64_tr_b16 v[144:145], v16 offset:25728
  ds_read_b64_tr_b16 v[146:147], v17 offset:25728
  buffer_load_dwordx4 v[196:199], v32, s[8:11], s68 offen sc1
  buffer_load_dwordx4 v[200:203], v32, s[8:11], s68 offen offset:1024 sc1
  v_mov_b32 v10, 16
  ds_write_b32 v11, v10 offset:16
  s_waitcnt vmcnt(9) lgkmcnt(15)
  v_mfma_f32_16x16x32_bf16 v[48:51], v[88:91], v[164:167], v[48:51]
  ds_read_b64_tr_b16 v[68:69], v16 offset:30720
  ds_read_b64_tr_b16 v[70:71], v17 offset:30720
  s_waitcnt lgkmcnt(15)
  v_mfma_f32_16x16x32_bf16 v[52:55], v[92:95], v[164:167], v[52:55]
  ds_read_b64_tr_b16 v[72:73], v16 offset:30752
  ds_read_b64_tr_b16 v[74:75], v17 offset:30752
  s_waitcnt lgkmcnt(15)
  v_mfma_f32_16x16x32_bf16 v[56:59], v[96:99], v[164:167], v[56:59]
  ds_read_b64_tr_b16 v[76:77], v16 offset:30784
  ds_read_b64_tr_b16 v[78:79], v17 offset:30784
  s_waitcnt lgkmcnt(15)
  v_mfma_f32_16x16x32_bf16 v[60:63], v[100:103], v[164:167], v[60:63]
  ds_read_b64_tr_b16 v[80:81], v16 offset:30816
  ds_read_b64_tr_b16 v[82:83], v17 offset:30816
  s_waitcnt lgkmcnt(15)
  v_mfma_f32_16x16x32_bf16 v[64:67], v[104:107], v[164:167], v[64:67]
  ds_read_b64_tr_b16 v[84:85], v16 offset:30848
  ds_read_b64_tr_b16 v[86:87], v17 offset:30848
  buffer_load_dwordx4 v[204:207], v32, s[8:11], s68 offen offset:2048 sc1
  buffer_load_dwordx4 v[208:211], v32, s[8:11], s68 offen offset:3072 sc1
  s_add_u32 s68, s68, 4096
  s_waitcnt vmcnt(10) lgkmcnt(15)
  v_mfma_f32_16x16x32_bf16 v[48:51], v[128:131], v[168:171], v[48:51]
  ds_read_b64_tr_b16 v[88:89], v16 offset:35840
  ds_read_b64_tr_b16 v[90:91], v17 offset:35840
  s_waitcnt lgkmcnt(15)
  v_mfma_f32_16x16x32_bf16 v[52:55], v[132:135], v[168:171], v[52:55]
  ds_read_b64_tr_b16 v[92:93], v16 offset:35872
  ds_read_b64_tr_b16 v[94:95], v17 offset:35872
  s_waitcnt lgkmcnt(15)
  v_mfma_f32_16x16x32_bf16 v[56:59], v[136:139], v[168:171], v[56:59]
  ds_read_b64_tr_b16 v[96:97], v16 offset:35904
  ds_read_b64_tr_b16 v[98:99], v17 offset:35904
  s_waitcnt lgkmcnt(15)
  v_mfma_f32_16x16x32_bf16 v[60:63], v[140:143], v[168:171], v[60:63]
  ds_read_b64_tr_b16 v[100:101], v16 offset:35936
  ds_read_b64_tr_b16 v[102:103], v17 offset:35936
  s_waitcnt lgkmcnt(15)
  v_mfma_f32_16x16x32_bf16 v[64:67], v[144:147], v[168:171], v[64:67]
  ds_read_b64_tr_b16 v[104:105], v16 offset:35968
  ds_read_b64_tr_b16 v[106:107], v17 offset:35968
  buffer_load_dwordx4 v[212:215], v32, s[8:11], s68 offen sc1
  buffer_load_dwordx4 v[216:219], v32, s[8:11], s68 offen offset:1024 sc1
  s_waitcnt vmcnt(11) lgkmcnt(15)
  v_mfma_f32_16x16x32_bf16 v[48:51], v[68:71], v[172:175], v[48:51]
  ds_read_b64_tr_b16 v[128:129], v16 offset:40960
  ds_read_b64_tr_b16 v[130:131], v17 offset:40960
  s_waitcnt lgkmcnt(15)
  v_mfma_f32_16x16x32_bf16 v[52:55], v[72:75], v[172:175], v[52:55]
  ds_read_b64_tr_b16 v[132:133], v16 offset:40992
  ds_read_b64_tr_b16 v[134:135], v17 offset:40992
  s_waitcnt lgkmcnt(15)
  v_mfma_f32_16x16x32_bf16 v[56:59], v[76:79], v[172:175], v[56:59]
  ds_read_b64_tr_b16 v[136:137], v16 offset:41024
  ds_read_b64_tr_b16 v[138:139], v17 offset:41024
  s_waitcnt lgkmcnt(15)
  v_mfma_f32_16x16x32_bf16 v[60:63], v[80:83], v[172:175], v[60:63]
  ds_read_b64_tr_b16 v[140:141], v16 offset:41056
  ds_read_b64_tr_b16 v[142:143], v17 offset:41056
  s_waitcnt lgkmcnt(15)
  v_mfma_f32_16x16x32_bf16 v[64:67], v[84:87], v[172:175], v[64:67]
  ds_read_b64_tr_b16 v[144:145], v16 offset:41088
  ds_read_b64_tr_b16 v[146:147], v17 offset:41088
  buffer_load_dwordx4 v[220:223], v32, s[8:11], s68 offen offset:2048 sc1
  buffer_load_dwordx4 v[224:227], v32, s[8:11], s68 offen offset:3072 sc1
  s_add_u32 s68, s68, 4096
  s_waitcnt vmcnt(12) lgkmcnt(15)
  v_mfma_f32_16x16x32_bf16 v[48:51], v[88:91], v[176:179], v[48:51]
  ds_read_b64_tr_b16 v[68:69], v16 offset:46080
  ds_read_b64_tr_b16 v[70:71], v17 offset:46080
  s_waitcnt lgkmcnt(15)
  v_mfma_f32_16x16x32_bf16 v[52:55], v[92:95], v[176:179], v[52:55]
  ds_read_b64_tr_b16 v[72:73], v16 offset:46112
  ds_read_b64_tr_b16 v[74:75], v17 offset:46112
  s_waitcnt lgkmcnt(15)
  v_mfma_f32_16x16x32_bf16 v[56:59], v[96:99], v[176:179], v[56:59]
  ds_read_b64_tr_b16 v[76:77], v16 offset:46144
  ds_read_b64_tr_b16 v[78:79], v17 offset:46144
  s_waitcnt lgkmcnt(15)
  v_mfma_f32_16x16x32_bf16 v[60:63], v[100:103], v[176:179], v[60:63]
  ds_read_b64_tr_b16 v[80:81], v16 offset:46176
  ds_read_b64_tr_b16 v[82:83], v17 offset:46176
  s_waitcnt lgkmcnt(15)
  v_mfma_f32_16x16x32_bf16 v[64:67], v[104:107], v[176:179], v[64:67]
  ds_read_b64_tr_b16 v[84:85], v16 offset:46208
  ds_read_b64_tr_b16 v[86:87], v17 offset:46208
  v_mov_b32 v10, 17
  ds_write_b32 v11, v10 offset:16
  s_waitcnt vmcnt(11) lgkmcnt(15)
  v_mfma_f32_16x16x32_bf16 v[48:51], v[128:131], v[180:183], v[48:51]
  ds_read_b64_tr_b16 v[88:89], v16 offset:51200
  ds_read_b64_tr_b16 v[90:91], v17 offset:51200
  s_waitcnt lgkmcnt(15)
  v_mfma_f32_16x16x32_bf16 v[52:55], v[132:135], v[180:183], v[52:55]
  ds_read_b64_tr_b16 v[92:93], v16 offset:51232
  ds_read_b64_tr_b16 v[94:95], v17 offset:51232
  s_waitcnt lgkmcnt(15)
  v_mfma_f32_16x16x32_bf16 v[56:59], v[136:139], v[180:183], v[56:59]
  ds_read_b64_tr_b16 v[96:97], v16 offset:51264
  ds_read_b64_tr_b16 v[98:99], v17 offset:51264
  s_waitcnt lgkmcnt(15)
  v_mfma_f32_16x16x32_bf16 v[60:63], v[140:143], v[180:183], v[60:63]
  ds_read_b64_tr_b16 v[100:101], v16 offset:51296
  ds_read_b64_tr_b16 v[102:103], v17 offset:51296
  s_waitcnt lgkmcnt(15)
  v_mfma_f32_16x16x32_bf16 v[64:67], v[144:147], v[180:183], v[64:67]
  ds_read_b64_tr_b16 v[104:105], v16 offset:51328
  ds_read_b64_tr_b16 v[106:107], v17 offset:51328
  s_waitcnt vmcnt(10) lgkmcnt(15)
  v_mfma_f32_16x16x32_bf16 v[48:51], v[68:71], v[184:187], v[48:51]
  ds_read_b64_tr_b16 v[128:129], v16 offset:56320
  ds_read_b64_tr_b16 v[130:131], v17 offset:56320
  s_waitcnt lgkmcnt(15)
  v_mfma_f32_16x16x32_bf16 v[52:55], v[72:75], v[184:187], v[52:55]
  ds_read_b64_tr_b16 v[132:133], v16 offset:56352
  ds_read_b64_tr_b16 v[134:135], v17 offset:56352
  s_waitcnt lgkmcnt(15)
  v_mfma_f32_16x16x32_bf16 v[56:59], v[76:79], v[184:187], v[56:59]
  ds_read_b64_tr_b16 v[136:137], v16 offset:56384
  ds_read_b64_tr_b16 v[138:139], v17 offset:56384
  s_waitcnt lgkmcnt(15)
  v_mfma_f32_16x16x32_bf16 v[60:63], v[80:83], v[184:187], v[60:63]
  ds_read_b64_tr_b16 v[140:141], v16 offset:56416
  ds_read_b64_tr_b16 v[142:143], v17 offset:56416
  s_waitcnt lgkmcnt(15)
  v_mfma_f32_16x16x32_bf16 v[64:67], v[84:87], v[184:187], v[64:67]
  ds_read_b64_tr_b16 v[144:145], v16 offset:56448
  ds_read_b64_tr_b16 v[146:147], v17 offset:56448
  v_subrev_u32 v16, 61440, v16
  v_subrev_u32 v17, 61440, v17
  s_waitcnt vmcnt(9) lgkmcnt(15)
  v_mfma_f32_16x16x32_bf16 v[48:51], v[88:91], v[188:191], v[48:51]
  ds_read_b64_tr_b16 v[68:69], v16
  ds_read_b64_tr_b16 v[70:71], v17
  s_waitcnt lgkmcnt(15)
  v_mfma_f32_16x16x32_bf16 v[52:55], v[92:95], v[188:191], v[52:55]
  ds_read_b64_tr_b16 v[72:73], v16 offset:32
  ds_read_b64_tr_b16 v[74:75], v17 offset:32
  s_waitcnt lgkmcnt(15)
  v_mfma_f32_16x16x32_bf16 v[56:59], v[96:99], v[188:191], v[56:59]
  ds_read_b64_tr_b16 v[76:77], v16 offset:64
  ds_read_b64_tr_b16 v[78:79], v17 offset:64
  s_waitcnt lgkmcnt(15)
  v_mfma_f32_16x16x32_bf16 v[60:63], v[100:103], v[188:191], v[60:63]
  ds_read_b64_tr_b16 v[80:81], v16 offset:96
  ds_read_b64_tr_b16 v[82:83], v17 offset:96
  s_waitcnt lgkmcnt(15)
  v_mfma_f32_16x16x32_bf16 v[64:67], v[104:107], v[188:191], v[64:67]
  ds_read_b64_tr_b16 v[84:85], v16 offset:128
  ds_read_b64_tr_b16 v[86:87], v17 offset:128
  s_waitcnt vmcnt(8) lgkmcnt(15)
  v_mfma_f32_16x16x32_bf16 v[48:51], v[128:131], v[192:195], v[48:51]
  ds_read_b64_tr_b16 v[88:89], v16 offset:5120
  ds_read_b64_tr_b16 v[90:91], v17 offset:5120
  s_waitcnt lgkmcnt(15)
  v_mfma_f32_16x16x32_bf16 v[52:55], v[132:135], v[192:195], v[52:55]
  ds_read_b64_tr_b16 v[92:93], v16 offset:5152
  ds_read_b64_tr_b16 v[94:95], v17 offset:5152
  s_waitcnt lgkmcnt(15)
  v_mfma_f32_16x16x32_bf16 v[56:59], v[136:139], v[192:195], v[56:59]
  ds_read_b64_tr_b16 v[96:97], v16 offset:5184
  ds_read_b64_tr_b16 v[98:99], v17 offset:5184
  s_waitcnt lgkmcnt(15)
  v_mfma_f32_16x16x32_bf16 v[60:63], v[140:143], v[192:195], v[60:63]
  ds_read_b64_tr_b16 v[100:101], v16 offset:5216
  ds_read_b64_tr_b16 v[102:103], v17 offset:5216
  s_waitcnt lgkmcnt(15)
  v_mfma_f32_16x16x32_bf16 v[64:67], v[144:147], v[192:195], v[64:67]
  ds_read_b64_tr_b16 v[104:105], v16 offset:5248
  ds_read_b64_tr_b16 v[106:107], v17 offset:5248
  v_mov_b32 v10, 18
  ds_write_b32 v11, v10 offset:16
  s_waitcnt vmcnt(7) lgkmcnt(15)
  v_mfma_f32_16x16x32_bf16 v[48:51], v[68:71], v[196:199], v[48:51]
  ds_read_b64_tr_b16 v[128:129], v16 offset:10240
  ds_read_b64_tr_b16 v[130:131], v17 offset:10240
  s_waitcnt lgkmcnt(15)
  v_mfma_f32_16x16x32_bf16 v[52:55], v[72:75], v[196:199], v[52:55]
  ds_read_b64_tr_b16 v[132:133], v16 offset:10272
  ds_read_b64_tr_b16 v[134:135], v17 offset:10272
  s_waitcnt lgkmcnt(15)
  v_mfma_f32_16x16x32_bf16 v[56:59], v[76:79], v[196:199], v[56:59]
  ds_read_b64_tr_b16 v[136:137], v16 offset:10304
  ds_read_b64_tr_b16 v[138:139], v17 offset:10304
  s_waitcnt lgkmcnt(15)
  v_mfma_f32_16x16x32_bf16 v[60:63], v[80:83], v[196:199], v[60:63]
  ds_read_b64_tr_b16 v[140:141], v16 offset:10336
  ds_read_b64_tr_b16 v[142:143], v17 offset:10336
  s_waitcnt lgkmcnt(15)
  v_mfma_f32_16x16x32_bf16 v[64:67], v[84:87], v[196:199], v[64:67]
  ds_read_b64_tr_b16 v[144:145], v16 offset:10368
  ds_read_b64_tr_b16 v[146:147], v17 offset:10368
  s_waitcnt vmcnt(6) lgkmcnt(15)
  v_mfma_f32_16x16x32_bf16 v[48:51], v[88:91], v[200:203], v[48:51]
  ds_read_b64_tr_b16 v[68:69], v16 offset:15360
  ds_read_b64_tr_b16 v[70:71], v17 offset:15360
  s_waitcnt lgkmcnt(15)
  v_mfma_f32_16x16x32_bf16 v[52:55], v[92:95], v[200:203], v[52:55]
  ds_read_b64_tr_b16 v[72:73], v16 offset:15392
  ds_read_b64_tr_b16 v[74:75], v17 offset:15392
  s_waitcnt lgkmcnt(15)
  v_mfma_f32_16x16x32_bf16 v[56:59], v[96:99], v[200:203], v[56:59]
  ds_read_b64_tr_b16 v[76:77], v16 offset:15424
  ds_read_b64_tr_b16 v[78:79], v17 offset:15424
  s_waitcnt lgkmcnt(15)
  v_mfma_f32_16x16x32_bf16 v[60:63], v[100:103], v[200:203], v[60:63]
  ds_read_b64_tr_b16 v[80:81], v16 offset:15456
  ds_read_b64_tr_b16 v[82:83], v17 offset:15456
  s_waitcnt lgkmcnt(15)
  v_mfma_f32_16x16x32_bf16 v[64:67], v[104:107], v[200:203], v[64:67]
  ds_read_b64_tr_b16 v[84:85], v16 offset:15488
  ds_read_b64_tr_b16 v[86:87], v17 offset:15488
  s_waitcnt vmcnt(5) lgkmcnt(15)
  v_mfma_f32_16x16x32_bf16 v[48:51], v[128:131], v[204:207], v[48:51]
  ds_read_b64_tr_b16 v[88:89], v16 offset:40960
  ds_read_b64_tr_b16 v[90:91], v17 offset:40960
  s_waitcnt lgkmcnt(15)
  v_mfma_f32_16x16x32_bf16 v[52:55], v[132:135], v[204:207], v[52:55]
  ds_read_b64_tr_b16 v[92:93], v16 offset:40992
  ds_read_b64_tr_b16 v[94:95], v17 offset:40992
  s_waitcnt lgkmcnt(15)
  v_mfma_f32_16x16x32_bf16 v[56:59], v[136:139], v[204:207], v[56:59]
  ds_read_b64_tr_b16 v[96:97], v16 offset:41024
  ds_read_b64_tr_b16 v[98:99], v17 offset:41024
  s_waitcnt lgkmcnt(15)
  v_mfma_f32_16x16x32_bf16 v[60:63], v[140:143], v[204:207], v[60:63]
  ds_read_b64_tr_b16 v[100:101], v16 offset:41056
  ds_read_b64_tr_b16 v[102:103], v17 offset:41056
  s_waitcnt lgkmcnt(15)
  v_mfma_f32_16x16x32_bf16 v[64:67], v[144:147], v[204:207], v[64:67]
  ds_read_b64_tr_b16 v[104:105], v16 offset:41088
  ds_read_b64_tr_b16 v[106:107], v17 offset:41088
  s_waitcnt vmcnt(4) lgkmcnt(15)
  v_mfma_f32_16x16x32_bf16 v[48:51], v[68:71], v[208:211], v[48:51]
  ds_read_b64_tr_b16 v[128:129], v16 offset:46080
  ds_read_b64_tr_b16 v[130:131], v17 offset:46080
  s_waitcnt lgkmcnt(15)
  v_mfma_f32_16x16x32_bf16 v[52:55], v[72:75], v[208:211], v[52:55]
  ds_read_b64_tr_b16 v[132:133], v16 offset:46112
  ds_read_b64_tr_b16 v[134:135], v17 offset:46112
  s_waitcnt lgkmcnt(15)
  v_mfma_f32_16x16x32_bf16 v[56:59], v[76:79], v[208:211], v[56:59]
  ds_read_b64_tr_b16 v[136:137], v16 offset:46144
  ds_read_b64_tr_b16 v[138:139], v17 offset:46144
  s_waitcnt lgkmcnt(15)
  v_mfma_f32_16x16x32_bf16 v[60:63], v[80:83], v[208:211], v[60:63]
  ds_read_b64_tr_b16 v[140:141], v16 offset:46176
  ds_read_b64_tr_b16 v[142:143], v17 offset:46176
  s_waitcnt lgkmcnt(15)
  v_mfma_f32_16x16x32_bf16 v[64:67], v[84:87], v[208:211], v[64:67]
  ds_read_b64_tr_b16 v[144:145], v16 offset:46208
  ds_read_b64_tr_b16 v[146:147], v17 offset:46208
  v_mov_b32 v10, 19
  ds_write_b32 v11, v10 offset:16
  s_waitcnt vmcnt(3) lgkmcnt(15)
  v_mfma_f32_16x16x32_bf16 v[48:51], v[88:91], v[212:215], v[48:51]
  ds_read_b64_tr_b16 v[68:69], v16 offset:51200
  ds_read_b64_tr_b16 v[70:71], v17 offset:51200
  s_waitcnt lgkmcnt(15)
  v_mfma_f32_16x16x32_bf16 v[52:55], v[92:95], v[212:215], v[52:55]
  ds_read_b64_tr_b16 v[72:73], v16 offset:51232
  ds_read_b64_tr_b16 v[74:75], v17 offset:51232
  s_waitcnt lgkmcnt(15)
  v_mfma_f32_16x16x32_bf16 v[56:59], v[96:99], v[212:215], v[56:59]
  ds_read_b64_tr_b16 v[76:77], v16 offset:51264
  ds_read_b64_tr_b16 v[78:79], v17 offset:51264
  s_waitcnt lgkmcnt(15)
  v_mfma_f32_16x16x32_bf16 v[60:63], v[100:103], v[212:215], v[60:63]
  ds_read_b64_tr_b16 v[80:81], v16 offset:51296
  ds_read_b64_tr_b16 v[82:83], v17 offset:51296
  s_waitcnt lgkmcnt(15)
  v_mfma_f32_16x16x32_bf16 v[64:67], v[104:107], v[212:215], v[64:67]
  ds_read_b64_tr_b16 v[84:85], v16 offset:51328
  ds_read_b64_tr_b16 v[86:87], v17 offset:51328
  s_waitcnt vmcnt(2) lgkmcnt(15)
  v_mfma_f32_16x16x32_bf16 v[48:51], v[128:131], v[216:219], v[48:51]
  ds_read_b64_tr_b16 v[88:89], v16 offset:56320
  ds_read_b64_tr_b16 v[90:91], v17 offset:56320
  s_waitcnt lgkmcnt(15)
  v_mfma_f32_16x16x32_bf16 v[52:55], v[132:135], v[216:219], v[52:55]
  ds_read_b64_tr_b16 v[92:93], v16 offset:56352
  ds_read_b64_tr_b16 v[94:95], v17 offset:56352
  s_waitcnt lgkmcnt(15)
  v_mfma_f32_16x16x32_bf16 v[56:59], v[136:139], v[216:219], v[56:59]
  ds_read_b64_tr_b16 v[96:97], v16 offset:56384
  ds_read_b64_tr_b16 v[98:99], v17 offset:56384
  s_waitcnt lgkmcnt(15)
  v_mfma_f32_16x16x32_bf16 v[60:63], v[140:143], v[216:219], v[60:63]
  ds_read_b64_tr_b16 v[100:101], v16 offset:56416
  ds_read_b64_tr_b16 v[102:103], v17 offset:56416
  s_waitcnt lgkmcnt(15)
  v_mfma_f32_16x16x32_bf16 v[64:67], v[144:147], v[216:219], v[64:67]
  ds_read_b64_tr_b16 v[104:105], v16 offset:56448
  ds_read_b64_tr_b16 v[106:107], v17 offset:56448
  s_waitcnt vmcnt(1) lgkmcnt(15)
  v_mfma_f32_16x16x32_bf16 v[48:51], v[68:71], v[220:223], v[48:51]
  s_waitcnt lgkmcnt(15)
  v_mfma_f32_16x16x32_bf16 v[52:55], v[72:75], v[220:223], v[52:55]
  s_waitcnt lgkmcnt(14)
  v_mfma_f32_16x16x32_bf16 v[56:59], v[76:79], v[220:223], v[56:59]
  s_waitcnt lgkmcnt(12)
  v_mfma_f32_16x16x32_bf16 v[60:63], v[80:83], v[220:223], v[60:63]
  s_waitcnt lgkmcnt(10)
  v_mfma_f32_16x16x32_bf16 v[64:67], v[84:87], v[220:223], v[64:67]
  v_mov_b32 v10, 0
  ds_write_b32 v11, v10 offset:128
  s_waitcnt vmcnt(0) lgkmcnt(9)
  v_mfma_f32_16x16x32_bf16 v[48:51], v[88:91], v[224:227], v[48:51]
  s_waitcnt lgkmcnt(7)
  v_mfma_f32_16x16x32_bf16 v[52:55], v[92:95], v[224:227], v[52:55]
  s_waitcnt lgkmcnt(5)
  v_mfma_f32_16x16x32_bf16 v[56:59], v[96:99], v[224:227], v[56:59]
  s_waitcnt lgkmcnt(3)
  v_mfma_f32_16x16x32_bf16 v[60:63], v[100:103], v[224:227], v[60:63]
  s_waitcnt lgkmcnt(1)
  v_mfma_f32_16x16x32_bf16 v[64:67], v[104:107], v[224:227], v[64:67]
  v_mov_b32 v10, 20
  ds_write_b32 v11, v10 offset:16
  v_cvt_pk_bf16_f32 v32, v48, v49
  v_lshlrev_b32 v48, 16, v32
  v_and_b32 v49, 0xffff0000, v32
  v_cvt_pk_bf16_f32 v33, v50, v51
  v_lshlrev_b32 v50, 16, v33
  v_and_b32 v51, 0xffff0000, v33
  v_pk_add_f32 v[48:49], v[48:49], v[108:109]
  v_pk_add_f32 v[50:51], v[50:51], v[110:111]
  v_cvt_pk_bf16_f32 v236, v48, v49
  v_cvt_pk_bf16_f32 v237, v50, v51
  buffer_store_dwordx2 v[236:237], v46, s[16:19], s69 offen sc1
  v_dot2c_f32_bf16 v20, s61, v236
  v_dot2c_f32_bf16 v21, v236, v236
  v_dot2c_f32_bf16 v22, s61, v237
  v_dot2c_f32_bf16 v23, v237, v237
  v_cvt_pk_bf16_f32 v32, v52, v53
  v_lshlrev_b32 v52, 16, v32
  v_and_b32 v53, 0xffff0000, v32
  v_cvt_pk_bf16_f32 v33, v54, v55
  v_lshlrev_b32 v54, 16, v33
  v_and_b32 v55, 0xffff0000, v33
  v_pk_add_f32 v[52:53], v[52:53], v[112:113]
  v_pk_add_f32 v[54:55], v[54:55], v[114:115]
  v_cvt_pk_bf16_f32 v238, v52, v53
  v_cvt_pk_bf16_f32 v239, v54, v55
  buffer_store_dwordx2 v[238:239], v46, s[16:19], s69 offen offset:512 sc1
  v_dot2c_f32_bf16 v20, s61, v238
  v_dot2c_f32_bf16 v21, v238, v238
  v_dot2c_f32_bf16 v22, s61, v239
  v_dot2c_f32_bf16 v23, v239, v239
  v_cvt_pk_bf16_f32 v32, v56, v57
  v_lshlrev_b32 v56, 16, v32
  v_and_b32 v57, 0xffff0000, v32
  v_cvt_pk_bf16_f32 v33, v58, v59
  v_lshlrev_b32 v58, 16, v33
  v_and_b32 v59, 0xffff0000, v33
  v_pk_add_f32 v[56:57], v[56:57], v[116:117]
  v_pk_add_f32 v[58:59], v[58:59], v[118:119]
  v_cvt_pk_bf16_f32 v240, v56, v57
  v_cvt_pk_bf16_f32 v241, v58, v59
  buffer_store_dwordx2 v[240:241], v46, s[16:19], s69 offen offset:1024 sc1
  v_dot2c_f32_bf16 v20, s61, v240
  v_dot2c_f32_bf16 v21, v240, v240
  v_dot2c_f32_bf16 v22, s61, v241
  v_dot2c_f32_bf16 v23, v241, v241
  v_cvt_pk_bf16_f32 v32, v60, v61
  v_lshlrev_b32 v60, 16, v32
  v_and_b32 v61, 0xffff0000, v32
  v_cvt_pk_bf16_f32 v33, v62, v63
  v_lshlrev_b32 v62, 16, v33
  v_and_b32 v63, 0xffff0000, v33
  v_pk_add_f32 v[60:61], v[60:61], v[120:121]
  v_pk_add_f32 v[62:63], v[62:63], v[122:123]
  v_cvt_pk_bf16_f32 v242, v60, v61
  v_cvt_pk_bf16_f32 v243, v62, v63
  buffer_store_dwordx2 v[242:243], v46, s[16:19], s69 offen offset:1536 sc1
  v_dot2c_f32_bf16 v20, s61, v242
  v_dot2c_f32_bf16 v21, v242, v242
  v_dot2c_f32_bf16 v22, s61, v243
  v_dot2c_f32_bf16 v23, v243, v243
  v_cvt_pk_bf16_f32 v32, v64, v65
  v_lshlrev_b32 v64, 16, v32
  v_and_b32 v65, 0xffff0000, v32
  v_cvt_pk_bf16_f32 v33, v66, v67
  v_lshlrev_b32 v66, 16, v33
  v_and_b32 v67, 0xffff0000, v33
  v_pk_add_f32 v[64:65], v[64:65], v[124:125]
  v_pk_add_f32 v[66:67], v[66:67], v[126:127]
  v_cvt_pk_bf16_f32 v244, v64, v65
  v_cvt_pk_bf16_f32 v245, v66, v67
  buffer_store_dwordx2 v[244:245], v46, s[16:19], s69 offen offset:2048 sc1
  v_dot2c_f32_bf16 v20, s61, v244
  v_dot2c_f32_bf16 v21, v244, v244
  v_dot2c_f32_bf16 v22, s61, v245
  v_dot2c_f32_bf16 v23, v245, v245
  s_nop 1
  v_add_f32 v20, v20, v22
  v_add_f32 v21, v21, v23
  v_mov_b32 v22, v20
  s_nop 1
  v_permlane32_swap_b32 v22, v20
  v_add_f32 v20, v20, v22
  v_mov_b32 v22, v20
  s_nop 1
  v_permlane16_swap_b32 v22, v20
  v_add_f32 v20, v20, v22
  v_mov_b32 v23, v21
  s_nop 1
  v_permlane32_swap_b32 v23, v21
  v_add_f32 v21, v21, v23
  v_mov_b32 v23, v21
  s_nop 1
  v_permlane16_swap_b32 v23, v21
  v_add_f32 v21, v21, v23
  s_mov_b64 s[58:59], exec
  s_mov_b64 exec, 0xffff
  buffer_store_dwordx2 v[20:21], v4, s[20:23], s73 offen sc1
  s_mov_b64 exec, s[58:59]
  s_lshl_b32 s79, s90, 3
  s_add_u32 s79, s79, s89
  s_add_u32 s56, s54, 4
  v_mov_b32 v12, s56
  v_mov_b32 v13, s55
  v_mov_b32 v10, 0
  s_lshl_b32 s57, s79, 7
  s_add_u32 s57, s57, 262144
  s_mov_b64 s[58:59], exec
  s_waitcnt vmcnt(0)
  s_mov_b64 exec, 1
  buffer_store_dwordx2 v[12:13], v10, s[24:27], s57 offen sc1
  s_mov_b64 exec, s[58:59]
  s_add_u32 s8, s52, 2621440
  s_addc_u32 s9, s53, 0
  s_mov_b32 s10, 2621440
  s_mov_b32 s11, 0x00020000
  s_add_u32 s16, s52, 5242880
  s_addc_u32 s17, s53, 0
  s_mov_b32 s18, 2621440
  s_mov_b32 s19, 0x00020000
  v_bfe_u32 v32, v0, 2, 2
  v_bfe_u32 v33, v0, 4, 1
  v_lshl_or_b32 v32, v33, 2, v32
  v_lshl_or_b32 v33, v3, 3, v32
  v_mul_u32_u24 v16, 160, v33
  v_xor_b32 v33, 4, v33
  v_mul_u32_u24 v17, 160, v33
  v_and_b32 v32, 3, v0
  v_lshl_add_u32 v16, v32, 3, v16
  v_lshl_add_u32 v17, v32, 3, v17
  v_lshrrev_b32 v32, 1, v3
  v_lshlrev_b32 v7, 8, v32
  v_lshl_add_u32 v7, v2, 4, v7
  v_and_b32 v32, 1, v3
  v_lshl_add_u32 v7, v32, 3, v7
  s_mul_i32 s69, s90, 20480
  s_mul_i32 s56, s89, 2560
  s_add_u32 s69, s69, s56
  s_mul_i32 s72, s89, 160
  v_lshlrev_b32 v47, 4, v3
  v_add_u32 v47, 162560, v47
  v_mov_b32 v18, 0xbdd2d3e8
  v_mov_b32 v19, 0xc0135761
  s_add_u32 s20, s52, 28311552
  s_addc_u32 s21, s53, 0
  s_mov_b32 s22, 131072
  s_mov_b32 s23, 0x00020000
  v_lshlrev_b32 v4, 8, v3
  v_lshl_add_u32 v4, v2, 3, v4
  v_mov_b32 v46, v7
  v_lshlrev_b32 v32, 4, v1
  s_mul_i32 s68, s90, 20480
  s_lshl_b32 s62, s90, 3
  s_add_u32 s56, s54, 4
  v_add_u32 v10, s62, v1
  v_lshlrev_b32 v10, 7, v10
  v_add_u32 v10, 262144, v10
  s_mov_b64 s[58:59], exec
  s_mov_b64 exec, 255
  s_mov_b32 s57, 0
  s_waitcnt vmcnt(0)
L_34:
  buffer_load_dwordx2 v[12:13], v10, s[24:27], 0 offen sc1
  s_waitcnt vmcnt(0)
  v_cmp_ne_u32 vcc, s56, v12
  v_cmp_ne_u32 s[94:95], s55, v13
  s_add_u32 s57, s57, 1
  s_nop 4
  s_or_b64 vcc, vcc, s[94:95]
  s_cbranch_vccz L_35
  s_cmp_lt_u32 s57, 0x80000
  s_cbranch_scc1 L_34
L_35:
  s_mov_b64 exec, s[58:59]
  v_mov_b32 v10, 3
  ds_write_b32 v11, v10 offset:128
  s_lshl_b32 s56, s90, 10
  buffer_load_dwordx2 v[20:21], v4, s[20:23], s56 offen sc1
  buffer_load_dwordx2 v[22:23], v4, s[20:23], s56 offen offset:128 sc1
  buffer_load_dwordx4 v[148:151], v32, s[8:11], s68 offen sc1
  buffer_load_dwordx4 v[152:155], v32, s[8:11], s68 offen offset:1024 sc1
  buffer_load_dwordx4 v[156:159], v32, s[8:11], s68 offen offset:2048 sc1
  buffer_load_dwordx4 v[160:163], v32, s[8:11], s68 offen offset:3072 sc1
  s_add_u32 s68, s68, 4096
  buffer_load_dwordx4 v[164:167], v32, s[8:11], s68 offen sc1
  buffer_load_dwordx4 v[168:171], v32, s[8:11], s68 offen offset:1024 sc1
  s_waitcnt lgkmcnt(0)
  s_mov_b32 s57, 0
L_36:
  ds_read_b128 v[12:15], v8 offset:0
  s_waitcnt lgkmcnt(0)
  v_min3_u32 v12, v12, v13, v14
  v_min_u32 v12, v12, v15
  s_nop 0
  v_readfirstlane_b32 s56, v12
  s_nop 3
  s_cmp_ge_u32 s56, 25
  s_cbranch_scc1 L_37
  s_add_u32 s57, s57, 1
  s_sleep 1
  s_cmp_lt_u32 s57, 0x400000
  s_cbranch_scc1 L_36
L_37:
  s_waitcnt lgkmcnt(0)
  s_mov_b32 s57, 0
L_38:
  ds_read_b128 v[12:15], v8 offset:64
  s_waitcnt lgkmcnt(0)
  v_min3_u32 v12, v12, v13, v14
  v_min_u32 v12, v12, v15
  s_nop 0
  v_readfirstlane_b32 s56, v12
  s_nop 3
  s_cmp_ge_u32 s56, 2
  s_cbranch_scc1 L_39
  s_add_u32 s57, s57, 1
  s_sleep 1
  s_cmp_lt_u32 s57, 0x400000
  s_cbranch_scc1 L_38
L_39:
  ds_read_b64_tr_b16 v[68:69], v16 offset:20480
  ds_read_b64_tr_b16 v[70:71], v17 offset:20480
  ds_read_b64_tr_b16 v[72:73], v16 offset:20512
  ds_read_b64_tr_b16 v[74:75], v17 offset:20512
  ds_read_b64_tr_b16 v[76:77], v16 offset:20544
  ds_read_b64_tr_b16 v[78:79], v17 offset:20544
  ds_read_b64_tr_b16 v[80:81], v16 offset:20576
  ds_read_b64_tr_b16 v[82:83], v17 offset:20576
  ds_read_b64_tr_b16 v[84:85], v16 offset:20608
  ds_read_b64_tr_b16 v[86:87], v17 offset:20608
  ds_read_b64_tr_b16 v[88:89], v16 offset:25600
  ds_read_b64_tr_b16 v[90:91], v17 offset:25600
  ds_read_b64_tr_b16 v[92:93], v16 offset:25632
  ds_read_b64_tr_b16 v[94:95], v17 offset:25632
  ds_read_b64_tr_b16 v[96:97], v16 offset:25664
  ds_read_b64_tr_b16 v[98:99], v17 offset:25664
  ds_read_b64_tr_b16 v[100:101], v16 offset:25696
  ds_read_b64_tr_b16 v[102:103], v17 offset:25696
  ds_read_b64_tr_b16 v[104:105], v16 offset:25728
  ds_read_b64_tr_b16 v[106:107], v17 offset:25728
  s_waitcnt vmcnt(5) lgkmcnt(15)
  v_mfma_f32_16x16x32_bf16 v[48:51], v[68:71], v[148:151], 0
  ds_read_b64_tr_b16 v[128:129], v16 offset:30720
  ds_read_b64_tr_b16 v[130:131], v17 offset:30720
  s_waitcnt lgkmcnt(15)
  v_mfma_f32_16x16x32_bf16 v[52:55], v[72:75], v[148:151], 0
  ds_read_b64_tr_b16 v[132:133], v16 offset:30752
  ds_read_b64_tr_b16 v[134:135], v17 offset:30752
  s_waitcnt lgkmcnt(15)
  v_mfma_f32_16x16x32_bf16 v[56:59], v[76:79], v[148:151], 0
  ds_read_b64_tr_b16 v[136:137], v16 offset:30784
  ds_read_b64_tr_b16 v[138:139], v17 offset:30784
  s_waitcnt lgkmcnt(15)
  v_mfma_f32_16x16x32_bf16 v[60:63], v[80:83], v[148:151], 0
  ds_read_b64_tr_b16 v[140:141], v16 offset:30816
  ds_read_b64_tr_b16 v[142:143], v17 offset:30816
  s_waitcnt lgkmcnt(15)
  v_mfma_f32_16x16x32_bf16 v[64:67], v[84:87], v[148:151], 0
  ds_read_b64_tr_b16 v[144:145], v16 offset:30848
  ds_read_b64_tr_b16 v[146:147], v17 offset:30848
  buffer_load_dwordx4 v[172:175], v32, s[8:11], s68 offen offset:2048 sc1
  buffer_load_dwordx4 v[176:179], v32, s[8:11], s68 offen offset:3072 sc1
  s_add_u32 s68, s68, 4096
  s_waitcnt vmcnt(6) lgkmcnt(15)
  v_mfma_f32_16x16x32_bf16 v[48:51], v[88:91], v[152:155], v[48:51]
  ds_read_b64_tr_b16 v[68:69], v16 offset:35840
  ds_read_b64_tr_b16 v[70:71], v17 offset:35840
  s_waitcnt lgkmcnt(15)
  v_mfma_f32_16x16x32_bf16 v[52:55], v[92:95], v[152:155], v[52:55]
  ds_read_b64_tr_b16 v[72:73], v16 offset:35872
  ds_read_b64_tr_b16 v[74:75], v17 offset:35872
  s_waitcnt lgkmcnt(15)
  v_mfma_f32_16x16x32_bf16 v[56:59], v[96:99], v[152:155], v[56:59]
  ds_read_b64_tr_b16 v[76:77], v16 offset:35904
  ds_read_b64_tr_b16 v[78:79], v17 offset:35904
  s_waitcnt lgkmcnt(15)
  v_mfma_f32_16x16x32_bf16 v[60:63], v[100:103], v[152:155], v[60:63]
  ds_read_b64_tr_b16 v[80:81], v16 offset:35936
  ds_read_b64_tr_b16 v[82:83], v17 offset:35936
  s_waitcnt lgkmcnt(15)
  v_mfma_f32_16x16x32_bf16 v[64:67], v[104:107], v[152:155], v[64:67]
  ds_read_b64_tr_b16 v[84:85], v16 offset:35968
  ds_read_b64_tr_b16 v[86:87], v17 offset:35968
  buffer_load_dwordx4 v[180:183], v32, s[8:11], s68 offen sc1
  buffer_load_dwordx4 v[184:187], v32, s[8:11], s68 offen offset:1024 sc1
  v_add_u32 v16, 122880, v16
  v_add_u32 v17, 122880, v17
  s_waitcnt vmcnt(7) lgkmcnt(15)
  v_mfma_f32_16x16x32_bf16 v[48:51], v[128:131], v[156:159], v[48:51]
  ds_read_b64_tr_b16 v[88:89], v16
  ds_read_b64_tr_b16 v[90:91], v17
  s_waitcnt lgkmcnt(15)
  v_mfma_f32_16x16x32_bf16 v[52:55], v[132:135], v[156:159], v[52:55]
  ds_read_b64_tr_b16 v[92:93], v16 offset:32
  ds_read_b64_tr_b16 v[94:95], v17 offset:32
  s_waitcnt lgkmcnt(15)
  v_mfma_f32_16x16x32_bf16 v[56:59], v[136:139], v[156:159], v[56:59]
  ds_read_b64_tr_b16 v[96:97], v16 offset:64
  ds_read_b64_tr_b16 v[98:99], v17 offset:64
  s_waitcnt lgkmcnt(15)
  v_mfma_f32_16x16x32_bf16 v[60:63], v[140:143], v[156:159], v[60:63]
  ds_read_b64_tr_b16 v[100:101], v16 offset:96
  ds_read_b64_tr_b16 v[102:103], v17 offset:96
  s_waitcnt lgkmcnt(15)
  v_mfma_f32_16x16x32_bf16 v[64:67], v[144:147], v[156:159], v[64:67]
  ds_read_b64_tr_b16 v[104:105], v16 offset:128
  ds_read_b64_tr_b16 v[106:107], v17 offset:128
  buffer_load_dwordx4 v[188:191], v32, s[8:11], s68 offen offset:2048 sc1
  buffer_load_dwordx4 v[192:195], v32, s[8:11], s68 offen offset:3072 sc1
  s_add_u32 s68, s68, 4096
  s_waitcnt vmcnt(8) lgkmcnt(15)
  v_mfma_f32_16x16x32_bf16 v[48:51], v[68:71], v[160:163], v[48:51]
  ds_read_b64_tr_b16 v[128:129], v16 offset:5120
  ds_read_b64_tr_b16 v[130:131], v17 offset:5120
  s_waitcnt lgkmcnt(15)
  v_mfma_f32_16x16x32_bf16 v[52:55], v[72:75], v[160:163], v[52:55]
  ds_read_b64_tr_b16 v[132:133], v16 offset:5152
  ds_read_b64_tr_b16 v[134:135], v17 offset:5152
  s_waitcnt lgkmcnt(15)
  v_mfma_f32_16x16x32_bf16 v[56:59], v[76:79], v[160:163], v[56:59]
  ds_read_b64_tr_b16 v[136:137], v16 offset:5184
  ds_read_b64_tr_b16 v[138:139], v17 offset:5184
  s_waitcnt lgkmcnt(15)
  v_mfma_f32_16x16x32_bf16 v[60:63], v[80:83], v[160:163], v[60:63]
  ds_read_b64_tr_b16 v[140:141], v16 offset:5216
  ds_read_b64_tr_b16 v[142:143], v17 offset:5216
  s_waitcnt lgkmcnt(15)
  v_mfma_f32_16x16x32_bf16 v[64:67], v[84:87], v[160:163], v[64:67]
  ds_read_b64_tr_b16 v[144:145], v16 offset:5248
  ds_read_b64_tr_b16 v[146:147], v17 offset:5248
  buffer_load_dwordx4 v[196:199], v32, s[8:11], s68 offen sc1
  buffer_load_dwordx4 v[200:203], v32, s[8:11], s68 offen offset:1024 sc1
  v_mov_b32 v10, 21
  ds_write_b32 v11, v10 offset:16
  s_waitcnt vmcnt(9) lgkmcnt(15)
  v_mfma_f32_16x16x32_bf16 v[48:51], v[88:91], v[164:167], v[48:51]
  ds_read_b64_tr_b16 v[68:69], v16 offset:10240
  ds_read_b64_tr_b16 v[70:71], v17 offset:10240
  s_waitcnt lgkmcnt(15)
  v_mfma_f32_16x16x32_bf16 v[52:55], v[92:95], v[164:167], v[52:55]
  ds_read_b64_tr_b16 v[72:73], v16 offset:10272
  ds_read_b64_tr_b16 v[74:75], v17 offset:10272
  s_waitcnt lgkmcnt(15)
  v_mfma_f32_16x16x32_bf16 v[56:59], v[96:99], v[164:167], v[56:59]
  ds_read_b64_tr_b16 v[76:77], v16 offset:10304
  ds_read_b64_tr_b16 v[78:79], v17 offset:10304
  s_waitcnt lgkmcnt(15)
  v_mfma_f32_16x16x32_bf16 v[60:63], v[100:103], v[164:167], v[60:63]
  ds_read_b64_tr_b16 v[80:81], v16 offset:10336
  ds_read_b64_tr_b16 v[82:83], v17 offset:10336
  s_waitcnt lgkmcnt(15)
  v_mfma_f32_16x16x32_bf16 v[64:67], v[104:107], v[164:167], v[64:67]
  ds_read_b64_tr_b16 v[84:85], v16 offset:10368
  ds_read_b64_tr_b16 v[86:87], v17 offset:10368
  buffer_load_dwordx4 v[204:207], v32, s[8:11], s68 offen offset:2048 sc1
  buffer_load_dwordx4 v[208:211], v32, s[8:11], s68 offen offset:3072 sc1
  s_add_u32 s68, s68, 4096
  s_waitcnt vmcnt(10) lgkmcnt(15)
  v_mfma_f32_16x16x32_bf16 v[48:51], v[128:131], v[168:171], v[48:51]
  ds_read_b64_tr_b16 v[88:89], v16 offset:15360
  ds_read_b64_tr_b16 v[90:91], v17 offset:15360
  s_waitcnt lgkmcnt(15)
  v_mfma_f32_16x16x32_bf16 v[52:55], v[132:135], v[168:171], v[52:55]
  ds_read_b64_tr_b16 v[92:93], v16 offset:15392
  ds_read_b64_tr_b16 v[94:95], v17 offset:15392
  s_waitcnt lgkmcnt(15)
  v_mfma_f32_16x16x32_bf16 v[56:59], v[136:139], v[168:171], v[56:59]
  ds_read_b64_tr_b16 v[96:97], v16 offset:15424
  ds_read_b64_tr_b16 v[98:99], v17 offset:15424
  s_waitcnt lgkmcnt(15)
  v_mfma_f32_16x16x32_bf16 v[60:63], v[140:143], v[168:171], v[60:63]
  ds_read_b64_tr_b16 v[100:101], v16 offset:15456
  ds_read_b64_tr_b16 v[102:103], v17 offset:15456
  s_waitcnt lgkmcnt(15)
  v_mfma_f32_16x16x32_bf16 v[64:67], v[144:147], v[168:171], v[64:67]
  ds_read_b64_tr_b16 v[104:105], v16 offset:15488
  ds_read_b64_tr_b16 v[106:107], v17 offset:15488
  buffer_load_dwordx4 v[212:215], v32, s[8:11], s68 offen sc1
  buffer_load_dwordx4 v[216:219], v32, s[8:11], s68 offen offset:1024 sc1
  v_subrev_u32 v16, 61440, v16
  v_subrev_u32 v17, 61440, v17
  s_waitcnt vmcnt(11) lgkmcnt(15)
  v_mfma_f32_16x16x32_bf16 v[48:51], v[68:71], v[172:175], v[48:51]
  ds_read_b64_tr_b16 v[128:129], v16
  ds_read_b64_tr_b16 v[130:131], v17
  s_waitcnt lgkmcnt(15)
  v_mfma_f32_16x16x32_bf16 v[52:55], v[72:75], v[172:175], v[52:55]
  ds_read_b64_tr_b16 v[132:133], v16 offset:32
  ds_read_b64_tr_b16 v[134:135], v17 offset:32
  s_waitcnt lgkmcnt(15)
  v_mfma_f32_16x16x32_bf16 v[56:59], v[76:79], v[172:175], v[56:59]
  ds_read_b64_tr_b16 v[136:137], v16 offset:64
  ds_read_b64_tr_b16 v[138:139], v17 offset:64
  s_waitcnt lgkmcnt(15)
  v_mfma_f32_16x16x32_bf16 v[60:63], v[80:83], v[172:175], v[60:63]
  ds_read_b64_tr_b16 v[140:141], v16 offset:96
  ds_read_b64_tr_b16 v[142:143], v17 offset:96
  s_waitcnt lgkmcnt(15)
  v_mfma_f32_16x16x32_bf16 v[64:67], v[84:87], v[172:175], v[64:67]
  ds_read_b64_tr_b16 v[144:145], v16 offset:128
  ds_read_b64_tr_b16 v[146:147], v17 offset:128
  buffer_load_dwordx4 v[220:223], v32, s[8:11], s68 offen offset:2048 sc1
  buffer_load_dwordx4 v[224:227], v32, s[8:11], s68 offen offset:3072 sc1
  s_add_u32 s68, s68, 4096
  s_waitcnt vmcnt(12) lgkmcnt(15)
  v_mfma_f32_16x16x32_bf16 v[48:51], v[88:91], v[176:179], v[48:51]
  ds_read_b64_tr_b16 v[68:69], v16 offset:5120
  ds_read_b64_tr_b16 v[70:71], v17 offset:5120
  s_waitcnt lgkmcnt(15)
  v_mfma_f32_16x16x32_bf16 v[52:55], v[92:95], v[176:179], v[52:55]
  ds_read_b64_tr_b16 v[72:73], v16 offset:5152
  ds_read_b64_tr_b16 v[74:75], v17 offset:5152
  s_waitcnt lgkmcnt(15)
  v_mfma_f32_16x16x32_bf16 v[56:59], v[96:99], v[176:179], v[56:59]
  ds_read_b64_tr_b16 v[76:77], v16 offset:5184
  ds_read_b64_tr_b16 v[78:79], v17 offset:5184
  s_waitcnt lgkmcnt(15)
  v_mfma_f32_16x16x32_bf16 v[60:63], v[100:103], v[176:179], v[60:63]
  ds_read_b64_tr_b16 v[80:81], v16 offset:5216
  ds_read_b64_tr_b16 v[82:83], v17 offset:5216
  s_waitcnt lgkmcnt(15)
  v_mfma_f32_16x16x32_bf16 v[64:67], v[104:107], v[176:179], v[64:67]
  ds_read_b64_tr_b16 v[84:85], v16 offset:5248
  ds_read_b64_tr_b16 v[86:87], v17 offset:5248
  v_mov_b32 v10, 22
  ds_write_b32 v11, v10 offset:16
  s_waitcnt vmcnt(11) lgkmcnt(15)
  v_mfma_f32_16x16x32_bf16 v[48:51], v[128:131], v[180:183], v[48:51]
  ds_read_b64_tr_b16 v[88:89], v16 offset:10240
  ds_read_b64_tr_b16 v[90:91], v17 offset:10240
  s_waitcnt lgkmcnt(15)
  v_mfma_f32_16x16x32_bf16 v[52:55], v[132:135], v[180:183], v[52:55]
  ds_read_b64_tr_b16 v[92:93], v16 offset:10272
  ds_read_b64_tr_b16 v[94:95], v17 offset:10272
  s_waitcnt lgkmcnt(15)
  v_mfma_f32_16x16x32_bf16 v[56:59], v[136:139], v[180:183], v[56:59]
  ds_read_b64_tr_b16 v[96:97], v16 offset:10304
  ds_read_b64_tr_b16 v[98:99], v17 offset:10304
  s_waitcnt lgkmcnt(15)
  v_mfma_f32_16x16x32_bf16 v[60:63], v[140:143], v[180:183], v[60:63]
  ds_read_b64_tr_b16 v[100:101], v16 offset:10336
  ds_read_b64_tr_b16 v[102:103], v17 offset:10336
  s_waitcnt lgkmcnt(15)
  v_mfma_f32_16x16x32_bf16 v[64:67], v[144:147], v[180:183], v[64:67]
  ds_read_b64_tr_b16 v[104:105], v16 offset:10368
  ds_read_b64_tr_b16 v[106:107], v17 offset:10368
  v_add_f32 v20, v20, v22
  v_add_f32 v21, v21, v23
  v_mov_b32 v22, v20
  s_nop 1
  v_permlane32_swap_b32 v22, v20
  v_add_f32 v20, v20, v22
  v_mov_b32 v22, v20
  s_nop 1
  v_permlane16_swap_b32 v22, v20
  v_add_f32 v20, v20, v22
  v_mov_b32 v23, v21
  s_nop 1
  v_permlane32_swap_b32 v23, v21
  v_add_f32 v21, v21, v23
  v_mov_b32 v23, v21
  s_nop 1
  v_permlane16_swap_b32 v23, v21
  v_add_f32 v21, v21, v23
  v_mul_f32 v38, 0x3acccccd, v20
  v_mul_f32 v39, 0x3acccccd, v21
  v_fma_f32 v39, -v38, v38, v39
  v_max_f32 v39, 0, v39
  v_cvt_pk_bf16_f32 v37, v38, v38
  v_lshlrev_b32 v37, 16, v37
  v_cvt_pk_bf16_f32 v40, v39, v39
  v_lshlrev_b32 v40, 16, v40
  v_add_f32 v40, 0x3727c5ac, v40
  v_cvt_pk_bf16_f32 v40, v40, v40
  v_lshlrev_b32 v40, 16, v40
  v_sqrt_f32 v40, v40
  s_nop 0
  v_cvt_pk_bf16_f32 v40, v40, v40
  v_lshlrev_b32 v40, 16, v40
  v_rcp_f32 v36, v40
  v_mov_b32 v246, v37
  v_mov_b32 v247, v36
  v_sub_f32 v38, v38, v37
  v_mul_f32 v38, v38, v36
  v_cvt_pk_bf16_f32 v38, v38, v38
  v_lshlrev_b32 v38, 16, v38
  v_mul_f32 v39, v39, v36
  v_mul_f32 v39, v39, v36
  v_cvt_pk_bf16_f32 v39, v39, v39
  v_lshlrev_b32 v39, 16, v39
  v_add_f32 v39, 0x3727c5ac, v39
  v_cvt_pk_bf16_f32 v39, v39, v39
  v_lshlrev_b32 v39, 16, v39
  v_sqrt_f32 v39, v39
  s_nop 0
  v_cvt_pk_bf16_f32 v39, v39, v39
  v_lshlrev_b32 v39, 16, v39
  v_rcp_f32 v39, v39
  v_fma_f32 v37, v37, v36, v38
  v_mul_f32 v37, v37, v39
  v_mul_f32 v36, v36, v39
  s_waitcnt vmcnt(10) lgkmcnt(15)
  v_mfma_f32_16x16x32_bf16 v[48:51], v[68:71], v[184:187], v[48:51]
  ds_read_b64_tr_b16 v[128:129], v16 offset:15360
  ds_read_b64_tr_b16 v[130:131], v17 offset:15360
  s_waitcnt lgkmcnt(15)
  v_mfma_f32_16x16x32_bf16 v[52:55], v[72:75], v[184:187], v[52:55]
  ds_read_b64_tr_b16 v[132:133], v16 offset:15392
  ds_read_b64_tr_b16 v[134:135], v17 offset:15392
  s_waitcnt lgkmcnt(15)
  v_mfma_f32_16x16x32_bf16 v[56:59], v[76:79], v[184:187], v[56:59]
  ds_read_b64_tr_b16 v[136:137], v16 offset:15424
  ds_read_b64_tr_b16 v[138:139], v17 offset:15424
  s_waitcnt lgkmcnt(15)
  v_mfma_f32_16x16x32_bf16 v[60:63], v[80:83], v[184:187], v[60:63]
  ds_read_b64_tr_b16 v[140:141], v16 offset:15456
  ds_read_b64_tr_b16 v[142:143], v17 offset:15456
  s_waitcnt lgkmcnt(15)
  v_mfma_f32_16x16x32_bf16 v[64:67], v[84:87], v[184:187], v[64:67]
  ds_read_b64_tr_b16 v[144:145], v16 offset:15488
  ds_read_b64_tr_b16 v[146:147], v17 offset:15488
  s_waitcnt vmcnt(9) lgkmcnt(15)
  v_mfma_f32_16x16x32_bf16 v[48:51], v[88:91], v[188:191], v[48:51]
  ds_read_b64_tr_b16 v[68:69], v16 offset:20480
  ds_read_b64_tr_b16 v[70:71], v17 offset:20480
  s_waitcnt lgkmcnt(15)
  v_mfma_f32_16x16x32_bf16 v[52:55], v[92:95], v[188:191], v[52:55]
  ds_read_b64_tr_b16 v[72:73], v16 offset:20512
  ds_read_b64_tr_b16 v[74:75], v17 offset:20512
  s_waitcnt lgkmcnt(15)
  v_mfma_f32_16x16x32_bf16 v[56:59], v[96:99], v[188:191], v[56:59]
  ds_read_b64_tr_b16 v[76:77], v16 offset:20544
  ds_read_b64_tr_b16 v[78:79], v17 offset:20544
  s_waitcnt lgkmcnt(15)
  v_mfma_f32_16x16x32_bf16 v[60:63], v[100:103], v[188:191], v[60:63]
  ds_read_b64_tr_b16 v[80:81], v16 offset:20576
  ds_read_b64_tr_b16 v[82:83], v17 offset:20576
  s_waitcnt lgkmcnt(15)
  v_mfma_f32_16x16x32_bf16 v[64:67], v[104:107], v[188:191], v[64:67]
  ds_read_b64_tr_b16 v[84:85], v16 offset:20608
  ds_read_b64_tr_b16 v[86:87], v17 offset:20608
  s_waitcnt vmcnt(8) lgkmcnt(15)
  v_mfma_f32_16x16x32_bf16 v[48:51], v[128:131], v[192:195], v[48:51]
  ds_read_b64_tr_b16 v[88:89], v16 offset:25600
  ds_read_b64_tr_b16 v[90:91], v17 offset:25600
  s_waitcnt lgkmcnt(15)
  v_mfma_f32_16x16x32_bf16 v[52:55], v[132:135], v[192:195], v[52:55]
  ds_read_b64_tr_b16 v[92:93], v16 offset:25632
  ds_read_b64_tr_b16 v[94:95], v17 offset:25632
  s_waitcnt lgkmcnt(15)
  v_mfma_f32_16x16x32_bf16 v[56:59], v[136:139], v[192:195], v[56:59]
  ds_read_b64_tr_b16 v[96:97], v16 offset:25664
  ds_read_b64_tr_b16 v[98:99], v17 offset:25664
  s_waitcnt lgkmcnt(15)
  v_mfma_f32_16x16x32_bf16 v[60:63], v[140:143], v[192:195], v[60:63]
  ds_read_b64_tr_b16 v[100:101], v16 offset:25696
  ds_read_b64_tr_b16 v[102:103], v17 offset:25696
  s_waitcnt lgkmcnt(15)
  v_mfma_f32_16x16x32_bf16 v[64:67], v[144:147], v[192:195], v[64:67]
  ds_read_b64_tr_b16 v[104:105], v16 offset:25728
  ds_read_b64_tr_b16 v[106:107], v17 offset:25728
  v_mov_b32 v10, 23
  ds_write_b32 v11, v10 offset:16
  s_waitcnt vmcnt(7) lgkmcnt(15)
  v_mfma_f32_16x16x32_bf16 v[48:51], v[68:71], v[196:199], v[48:51]
  ds_read_b64_tr_b16 v[128:129], v16 offset:30720
  ds_read_b64_tr_b16 v[130:131], v17 offset:30720
  s_waitcnt lgkmcnt(15)
  v_mfma_f32_16x16x32_bf16 v[52:55], v[72:75], v[196:199], v[52:55]
  ds_read_b64_tr_b16 v[132:133], v16 offset:30752
  ds_read_b64_tr_b16 v[134:135], v17 offset:30752
  s_waitcnt lgkmcnt(15)
  v_mfma_f32_16x16x32_bf16 v[56:59], v[76:79], v[196:199], v[56:59]
  ds_read_b64_tr_b16 v[136:137], v16 offset:30784
  ds_read_b64_tr_b16 v[138:139], v17 offset:30784
  s_waitcnt lgkmcnt(15)
  v_mfma_f32_16x16x32_bf16 v[60:63], v[80:83], v[196:199], v[60:63]
  ds_read_b64_tr_b16 v[140:141], v16 offset:30816
  ds_read_b64_tr_b16 v[142:143], v17 offset:30816
  s_waitcnt lgkmcnt(15)
  v_mfma_f32_16x16x32_bf16 v[64:67], v[84:87], v[196:199], v[64:67]
  ds_read_b64_tr_b16 v[144:145], v16 offset:30848
  ds_read_b64_tr_b16 v[146:147], v17 offset:30848
  s_waitcnt vmcnt(6) lgkmcnt(15)
  v_mfma_f32_16x16x32_bf16 v[48:51], v[88:91], v[200:203], v[48:51]
  ds_read_b64_tr_b16 v[68:69], v16 offset:35840
  ds_read_b64_tr_b16 v[70:71], v17 offset:35840
  s_waitcnt lgkmcnt(15)
  v_mfma_f32_16x16x32_bf16 v[52:55], v[92:95], v[200:203], v[52:55]
  ds_read_b64_tr_b16 v[72:73], v16 offset:35872
  ds_read_b64_tr_b16 v[74:75], v17 offset:35872
  s_waitcnt lgkmcnt(15)
  v_mfma_f32_16x16x32_bf16 v[56:59], v[96:99], v[200:203], v[56:59]
  ds_read_b64_tr_b16 v[76:77], v16 offset:35904
  ds_read_b64_tr_b16 v[78:79], v17 offset:35904
  s_waitcnt lgkmcnt(15)
  v_mfma_f32_16x16x32_bf16 v[60:63], v[100:103], v[200:203], v[60:63]
  ds_read_b64_tr_b16 v[80:81], v16 offset:35936
  ds_read_b64_tr_b16 v[82:83], v17 offset:35936
  s_waitcnt lgkmcnt(15)
  v_mfma_f32_16x16x32_bf16 v[64:67], v[104:107], v[200:203], v[64:67]
  ds_read_b64_tr_b16 v[84:85], v16 offset:35968
  ds_read_b64_tr_b16 v[86:87], v17 offset:35968
  s_waitcnt vmcnt(5) lgkmcnt(15)
  v_mfma_f32_16x16x32_bf16 v[48:51], v[128:131], v[204:207], v[48:51]
  ds_read_b64_tr_b16 v[88:89], v16 offset:40960
  ds_read_b64_tr_b16 v[90:91], v17 offset:40960
  s_waitcnt lgkmcnt(15)
  v_mfma_f32_16x16x32_bf16 v[52:55], v[132:135], v[204:207], v[52:55]
  ds_read_b64_tr_b16 v[92:93], v16 offset:40992
  ds_read_b64_tr_b16 v[94:95], v17 offset:40992
  s_waitcnt lgkmcnt(15)
  v_mfma_f32_16x16x32_bf16 v[56:59], v[136:139], v[204:207], v[56:59]
  ds_read_b64_tr_b16 v[96:97], v16 offset:41024
  ds_read_b64_tr_b16 v[98:99], v17 offset:41024
  s_waitcnt lgkmcnt(15)
  v_mfma_f32_16x16x32_bf16 v[60:63], v[140:143], v[204:207], v[60:63]
  ds_read_b64_tr_b16 v[100:101], v16 offset:41056
  ds_read_b64_tr_b16 v[102:103], v17 offset:41056
  s_waitcnt lgkmcnt(15)
  v_mfma_f32_16x16x32_bf16 v[64:67], v[144:147], v[204:207], v[64:67]
  ds_read_b64_tr_b16 v[104:105], v16 offset:41088
  ds_read_b64_tr_b16 v[106:107], v17 offset:41088
  s_waitcnt vmcnt(4) lgkmcnt(15)
  v_mfma_f32_16x16x32_bf16 v[48:51], v[68:71], v[208:211], v[48:51]
  ds_read_b64_tr_b16 v[128:129], v16 offset:46080
  ds_read_b64_tr_b16 v[130:131], v17 offset:46080
  s_waitcnt lgkmcnt(15)
  v_mfma_f32_16x16x32_bf16 v[52:55], v[72:75], v[208:211], v[52:55]
  ds_read_b64_tr_b16 v[132:133], v16 offset:46112
  ds_read_b64_tr_b16 v[134:135], v17 offset:46112
  s_waitcnt lgkmcnt(15)
  v_mfma_f32_16x16x32_bf16 v[56:59], v[76:79], v[208:211], v[56:59]
  ds_read_b64_tr_b16 v[136:137], v16 offset:46144
  ds_read_b64_tr_b16 v[138:139], v17 offset:46144
  s_waitcnt lgkmcnt(15)
  v_mfma_f32_16x16x32_bf16 v[60:63], v[80:83], v[208:211], v[60:63]
  ds_read_b64_tr_b16 v[140:141], v16 offset:46176
  ds_read_b64_tr_b16 v[142:143], v17 offset:46176
  s_waitcnt lgkmcnt(15)
  v_mfma_f32_16x16x32_bf16 v[64:67], v[84:87], v[208:211], v[64:67]
  ds_read_b64_tr_b16 v[144:145], v16 offset:46208
  ds_read_b64_tr_b16 v[146:147], v17 offset:46208
  v_mov_b32 v10, 24
  ds_write_b32 v11, v10 offset:16
  s_waitcnt vmcnt(3) lgkmcnt(15)
  v_mfma_f32_16x16x32_bf16 v[48:51], v[88:91], v[212:215], v[48:51]
  ds_read_b64_tr_b16 v[68:69], v16 offset:51200
  ds_read_b64_tr_b16 v[70:71], v17 offset:51200
  s_waitcnt lgkmcnt(15)
  v_mfma_f32_16x16x32_bf16 v[52:55], v[92:95], v[212:215], v[52:55]
  ds_read_b64_tr_b16 v[72:73], v16 offset:51232
  ds_read_b64_tr_b16 v[74:75], v17 offset:51232
  s_waitcnt lgkmcnt(15)
  v_mfma_f32_16x16x32_bf16 v[56:59], v[96:99], v[212:215], v[56:59]
  ds_read_b64_tr_b16 v[76:77], v16 offset:51264
  ds_read_b64_tr_b16 v[78:79], v17 offset:51264
  s_waitcnt lgkmcnt(15)
  v_mfma_f32_16x16x32_bf16 v[60:63], v[100:103], v[212:215], v[60:63]
  ds_read_b64_tr_b16 v[80:81], v16 offset:51296
  ds_read_b64_tr_b16 v[82:83], v17 offset:51296
  s_waitcnt lgkmcnt(15)
  v_mfma_f32_16x16x32_bf16 v[64:67], v[104:107], v[212:215], v[64:67]
  ds_read_b64_tr_b16 v[84:85], v16 offset:51328
  ds_read_b64_tr_b16 v[86:87], v17 offset:51328
  s_waitcnt vmcnt(2) lgkmcnt(15)
  v_mfma_f32_16x16x32_bf16 v[48:51], v[128:131], v[216:219], v[48:51]
  ds_read_b64_tr_b16 v[88:89], v16 offset:56320
  ds_read_b64_tr_b16 v[90:91], v17 offset:56320
  s_waitcnt lgkmcnt(15)
  v_mfma_f32_16x16x32_bf16 v[52:55], v[132:135], v[216:219], v[52:55]
  ds_read_b64_tr_b16 v[92:93], v16 offset:56352
  ds_read_b64_tr_b16 v[94:95], v17 offset:56352
  s_waitcnt lgkmcnt(15)
  v_mfma_f32_16x16x32_bf16 v[56:59], v[136:139], v[216:219], v[56:59]
  ds_read_b64_tr_b16 v[96:97], v16 offset:56384
  ds_read_b64_tr_b16 v[98:99], v17 offset:56384
  s_waitcnt lgkmcnt(15)
  v_mfma_f32_16x16x32_bf16 v[60:63], v[140:143], v[216:219], v[60:63]
  ds_read_b64_tr_b16 v[100:101], v16 offset:56416
  ds_read_b64_tr_b16 v[102:103], v17 offset:56416
  s_waitcnt lgkmcnt(15)
  v_mfma_f32_16x16x32_bf16 v[64:67], v[144:147], v[216:219], v[64:67]
  ds_read_b64_tr_b16 v[104:105], v16 offset:56448
  ds_read_b64_tr_b16 v[106:107], v17 offset:56448
  s_waitcnt vmcnt(1) lgkmcnt(15)
  v_mfma_f32_16x16x32_bf16 v[48:51], v[68:71], v[220:223], v[48:51]
  s_waitcnt lgkmcnt(15)
  v_mfma_f32_16x16x32_bf16 v[52:55], v[72:75], v[220:223], v[52:55]
  s_waitcnt lgkmcnt(14)
  v_mfma_f32_16x16x32_bf16 v[56:59], v[76:79], v[220:223], v[56:59]
  s_waitcnt lgkmcnt(12)
  v_mfma_f32_16x16x32_bf16 v[60:63], v[80:83], v[220:223], v[60:63]
  s_waitcnt lgkmcnt(10)
  v_mfma_f32_16x16x32_bf16 v[64:67], v[84:87], v[220:223], v[64:67]
  v_mov_b32 v10, 0
  ds_write_b32 v11, v10 offset:128
  s_waitcnt vmcnt(0) lgkmcnt(9)
  v_mfma_f32_16x16x32_bf16 v[48:51], v[88:91], v[224:227], v[48:51]
  s_waitcnt lgkmcnt(7)
  v_mfma_f32_16x16x32_bf16 v[52:55], v[92:95], v[224:227], v[52:55]
  s_waitcnt lgkmcnt(5)
  v_mfma_f32_16x16x32_bf16 v[56:59], v[96:99], v[224:227], v[56:59]
  s_waitcnt lgkmcnt(3)
  v_mfma_f32_16x16x32_bf16 v[60:63], v[100:103], v[224:227], v[60:63]
  s_waitcnt lgkmcnt(1)
  v_mfma_f32_16x16x32_bf16 v[64:67], v[104:107], v[224:227], v[64:67]
  v_mov_b32 v10, 25
  ds_write_b32 v11, v10 offset:16
  ds_read_b128 v[68:71], v47
  ds_read_b128 v[72:75], v47 offset:64
  ds_read_b128 v[76:79], v47 offset:128
  ds_read_b128 v[80:83], v47 offset:192
  ds_read_b128 v[84:87], v47 offset:256
  s_waitcnt lgkmcnt(4)
  v_pk_mul_f32 v[68:69], v[68:69], v[36:37] op_sel:[0,1] op_sel_hi:[1,1]
  v_pk_mul_f32 v[70:71], v[70:71], v[36:37] op_sel:[0,1] op_sel_hi:[1,1]
  v_pk_fma_f32 v[48:49], v[48:49], v[36:37], v[68:69] op_sel_hi:[1,0,1] neg_lo:[0,0,1] neg_hi:[0,0,1]
  v_pk_fma_f32 v[50:51], v[50:51], v[36:37], v[70:71] op_sel_hi:[1,0,1] neg_lo:[0,0,1] neg_hi:[0,0,1]
  v_cvt_pk_bf16_f32 v40, v48, v49
  v_lshlrev_b32 v48, 16, v40
  v_and_b32 v49, 0xffff0000, v40
  v_cvt_pk_bf16_f32 v42, v50, v51
  v_lshlrev_b32 v50, 16, v42
  v_and_b32 v51, 0xffff0000, v42
  v_pk_mul_f32 v[40:41], v[48:49], v[48:49]
  v_pk_mul_f32 v[42:43], v[50:51], v[50:51]
  v_pk_fma_f32 v[40:41], v[40:41], v[18:19], v[18:19] op_sel:[0,0,1] op_sel_hi:[1,0,1]
  v_pk_fma_f32 v[42:43], v[42:43], v[18:19], v[18:19] op_sel:[0,0,1] op_sel_hi:[1,0,1]
  v_pk_mul_f32 v[40:41], v[40:41], v[48:49]
  v_pk_mul_f32 v[42:43], v[42:43], v[50:51]
  v_exp_f32 v40, v40
  v_exp_f32 v41, v41
  v_exp_f32 v42, v42
  v_exp_f32 v43, v43
  v_pk_add_f32 v[40:41], v[40:41], 1.0 op_sel_hi:[1,0]
  v_pk_add_f32 v[42:43], v[42:43], 1.0 op_sel_hi:[1,0]
  v_rcp_f32 v40, v40
  v_rcp_f32 v41, v41
  v_rcp_f32 v42, v42
  v_rcp_f32 v43, v43
  v_pk_mul_f32 v[48:49], v[48:49], v[40:41]
  v_pk_mul_f32 v[50:51], v[50:51], v[42:43]
  v_cvt_pk_bf16_f32 v88, v48, v49
  v_cvt_pk_bf16_f32 v89, v50, v51
  buffer_store_dwordx2 v[88:89], v46, s[16:19], s69 offen sc1
  s_waitcnt lgkmcnt(3)
  v_pk_mul_f32 v[72:73], v[72:73], v[36:37] op_sel:[0,1] op_sel_hi:[1,1]
  v_pk_mul_f32 v[74:75], v[74:75], v[36:37] op_sel:[0,1] op_sel_hi:[1,1]
  v_pk_fma_f32 v[52:53], v[52:53], v[36:37], v[72:73] op_sel_hi:[1,0,1] neg_lo:[0,0,1] neg_hi:[0,0,1]
  v_pk_fma_f32 v[54:55], v[54:55], v[36:37], v[74:75] op_sel_hi:[1,0,1] neg_lo:[0,0,1] neg_hi:[0,0,1]
  v_cvt_pk_bf16_f32 v32, v52, v53
  v_lshlrev_b32 v52, 16, v32
  v_and_b32 v53, 0xffff0000, v32
  v_cvt_pk_bf16_f32 v34, v54, v55
  v_lshlrev_b32 v54, 16, v34
  v_and_b32 v55, 0xffff0000, v34
  v_pk_mul_f32 v[32:33], v[52:53], v[52:53]
  v_pk_mul_f32 v[34:35], v[54:55], v[54:55]
  v_pk_fma_f32 v[32:33], v[32:33], v[18:19], v[18:19] op_sel:[0,0,1] op_sel_hi:[1,0,1]
  v_pk_fma_f32 v[34:35], v[34:35], v[18:19], v[18:19] op_sel:[0,0,1] op_sel_hi:[1,0,1]
  v_pk_mul_f32 v[32:33], v[32:33], v[52:53]
  v_pk_mul_f32 v[34:35], v[34:35], v[54:55]
  v_exp_f32 v32, v32
  v_exp_f32 v33, v33
  v_exp_f32 v34, v34
  v_exp_f32 v35, v35
  v_pk_add_f32 v[32:33], v[32:33], 1.0 op_sel_hi:[1,0]
  v_pk_add_f32 v[34:35], v[34:35], 1.0 op_sel_hi:[1,0]
  v_rcp_f32 v32, v32
  v_rcp_f32 v33, v33
  v_rcp_f32 v34, v34
  v_rcp_f32 v35, v35
  v_pk_mul_f32 v[52:53], v[52:53], v[32:33]
  v_pk_mul_f32 v[54:55], v[54:55], v[34:35]
  v_cvt_pk_bf16_f32 v90, v52, v53
  v_cvt_pk_bf16_f32 v91, v54, v55
  buffer_store_dwordx2 v[90:91], v46, s[16:19], s69 offen offset:512 sc1
  s_waitcnt lgkmcnt(2)
  v_pk_mul_f32 v[76:77], v[76:77], v[36:37] op_sel:[0,1] op_sel_hi:[1,1]
  v_pk_mul_f32 v[78:79], v[78:79], v[36:37] op_sel:[0,1] op_sel_hi:[1,1]
  v_pk_fma_f32 v[56:57], v[56:57], v[36:37], v[76:77] op_sel_hi:[1,0,1] neg_lo:[0,0,1] neg_hi:[0,0,1]
  v_pk_fma_f32 v[58:59], v[58:59], v[36:37], v[78:79] op_sel_hi:[1,0,1] neg_lo:[0,0,1] neg_hi:[0,0,1]
  v_cvt_pk_bf16_f32 v40, v56, v57
  v_lshlrev_b32 v56, 16, v40
  v_and_b32 v57, 0xffff0000, v40
  v_cvt_pk_bf16_f32 v42, v58, v59
  v_lshlrev_b32 v58, 16, v42
  v_and_b32 v59, 0xffff0000, v42
  v_pk_mul_f32 v[40:41], v[56:57], v[56:57]
  v_pk_mul_f32 v[42:43], v[58:59], v[58:59]
  v_pk_fma_f32 v[40:41], v[40:41], v[18:19], v[18:19] op_sel:[0,0,1] op_sel_hi:[1,0,1]
  v_pk_fma_f32 v[42:43], v[42:43], v[18:19], v[18:19] op_sel:[0,0,1] op_sel_hi:[1,0,1]
  v_pk_mul_f32 v[40:41], v[40:41], v[56:57]
  v_pk_mul_f32 v[42:43], v[42:43], v[58:59]
  v_exp_f32 v40, v40
  v_exp_f32 v41, v41
  v_exp_f32 v42, v42
  v_exp_f32 v43, v43
  v_pk_add_f32 v[40:41], v[40:41], 1.0 op_sel_hi:[1,0]
  v_pk_add_f32 v[42:43], v[42:43], 1.0 op_sel_hi:[1,0]
  v_rcp_f32 v40, v40
  v_rcp_f32 v41, v41
  v_rcp_f32 v42, v42
  v_rcp_f32 v43, v43
  v_pk_mul_f32 v[56:57], v[56:57], v[40:41]
  v_pk_mul_f32 v[58:59], v[58:59], v[42:43]
  v_cvt_pk_bf16_f32 v92, v56, v57
  v_cvt_pk_bf16_f32 v93, v58, v59
  buffer_store_dwordx2 v[92:93], v46, s[16:19], s69 offen offset:1024 sc1
  s_waitcnt lgkmcnt(1)
  v_pk_mul_f32 v[80:81], v[80:81], v[36:37] op_sel:[0,1] op_sel_hi:[1,1]
  v_pk_mul_f32 v[82:83], v[82:83], v[36:37] op_sel:[0,1] op_sel_hi:[1,1]
  v_pk_fma_f32 v[60:61], v[60:61], v[36:37], v[80:81] op_sel_hi:[1,0,1] neg_lo:[0,0,1] neg_hi:[0,0,1]
  v_pk_fma_f32 v[62:63], v[62:63], v[36:37], v[82:83] op_sel_hi:[1,0,1] neg_lo:[0,0,1] neg_hi:[0,0,1]
  v_cvt_pk_bf16_f32 v32, v60, v61
  v_lshlrev_b32 v60, 16, v32
  v_and_b32 v61, 0xffff0000, v32
  v_cvt_pk_bf16_f32 v34, v62, v63
  v_lshlrev_b32 v62, 16, v34
  v_and_b32 v63, 0xffff0000, v34
  v_pk_mul_f32 v[32:33], v[60:61], v[60:61]
  v_pk_mul_f32 v[34:35], v[62:63], v[62:63]
  v_pk_fma_f32 v[32:33], v[32:33], v[18:19], v[18:19] op_sel:[0,0,1] op_sel_hi:[1,0,1]
  v_pk_fma_f32 v[34:35], v[34:35], v[18:19], v[18:19] op_sel:[0,0,1] op_sel_hi:[1,0,1]
  v_pk_mul_f32 v[32:33], v[32:33], v[60:61]
  v_pk_mul_f32 v[34:35], v[34:35], v[62:63]
  v_exp_f32 v32, v32
  v_exp_f32 v33, v33
  v_exp_f32 v34, v34
  v_exp_f32 v35, v35
  v_pk_add_f32 v[32:33], v[32:33], 1.0 op_sel_hi:[1,0]
  v_pk_add_f32 v[34:35], v[34:35], 1.0 op_sel_hi:[1,0]
  v_rcp_f32 v32, v32
  v_rcp_f32 v33, v33
  v_rcp_f32 v34, v34
  v_rcp_f32 v35, v35
  v_pk_mul_f32 v[60:61], v[60:61], v[32:33]
  v_pk_mul_f32 v[62:63], v[62:63], v[34:35]
  v_cvt_pk_bf16_f32 v94, v60, v61
  v_cvt_pk_bf16_f32 v95, v62, v63
  buffer_store_dwordx2 v[94:95], v46, s[16:19], s69 offen offset:1536 sc1
  s_waitcnt lgkmcnt(0)
  v_pk_mul_f32 v[84:85], v[84:85], v[36:37] op_sel:[0,1] op_sel_hi:[1,1]
  v_pk_mul_f32 v[86:87], v[86:87], v[36:37] op_sel:[0,1] op_sel_hi:[1,1]
  v_pk_fma_f32 v[64:65], v[64:65], v[36:37], v[84:85] op_sel_hi:[1,0,1] neg_lo:[0,0,1] neg_hi:[0,0,1]
  v_pk_fma_f32 v[66:67], v[66:67], v[36:37], v[86:87] op_sel_hi:[1,0,1] neg_lo:[0,0,1] neg_hi:[0,0,1]
  v_cvt_pk_bf16_f32 v40, v64, v65
  v_lshlrev_b32 v64, 16, v40
  v_and_b32 v65, 0xffff0000, v40
  v_cvt_pk_bf16_f32 v42, v66, v67
  v_lshlrev_b32 v66, 16, v42
  v_and_b32 v67, 0xffff0000, v42
  v_pk_mul_f32 v[40:41], v[64:65], v[64:65]
  v_pk_mul_f32 v[42:43], v[66:67], v[66:67]
  v_pk_fma_f32 v[40:41], v[40:41], v[18:19], v[18:19] op_sel:[0,0,1] op_sel_hi:[1,0,1]
  v_pk_fma_f32 v[42:43], v[42:43], v[18:19], v[18:19] op_sel:[0,0,1] op_sel_hi:[1,0,1]
  v_pk_mul_f32 v[40:41], v[40:41], v[64:65]
  v_pk_mul_f32 v[42:43], v[42:43], v[66:67]
  v_exp_f32 v40, v40
  v_exp_f32 v41, v41
  v_exp_f32 v42, v42
  v_exp_f32 v43, v43
  v_pk_add_f32 v[40:41], v[40:41], 1.0 op_sel_hi:[1,0]
  v_pk_add_f32 v[42:43], v[42:43], 1.0 op_sel_hi:[1,0]
  v_rcp_f32 v40, v40
  v_rcp_f32 v41, v41
  v_rcp_f32 v42, v42
  v_rcp_f32 v43, v43
  v_pk_mul_f32 v[64:65], v[64:65], v[40:41]
  v_pk_mul_f32 v[66:67], v[66:67], v[42:43]
  v_cvt_pk_bf16_f32 v96, v64, v65
  v_cvt_pk_bf16_f32 v97, v66, v67
  buffer_store_dwordx2 v[96:97], v46, s[16:19], s69 offen offset:2048 sc1
  s_add_u32 s56, s54, 6
  v_mov_b32 v12, s56
  v_mov_b32 v13, s55
  v_mov_b32 v10, 0
  s_lshl_b32 s57, s79, 7
  s_add_u32 s57, s57, 393216
  s_mov_b64 s[58:59], exec
  s_waitcnt vmcnt(0)
  s_mov_b64 exec, 1
  buffer_store_dwordx2 v[12:13], v10, s[24:27], s57 offen sc1
  s_mov_b64 exec, s[58:59]
  s_add_u32 s8, s52, 5242880
  s_addc_u32 s9, s53, 0
  s_mov_b32 s10, 2621440
  s_mov_b32 s11, 0x00020000
  s_add_u32 s16, s52, 7864320
  s_addc_u32 s17, s53, 0
  s_mov_b32 s18, 2621440
  s_mov_b32 s19, 0x00020000
  v_lshlrev_b32 v16, 4, v1
  v_lshrrev_b32 v32, 1, v3
  v_lshlrev_b32 v7, 8, v32
  v_lshl_add_u32 v7, v2, 4, v7
  v_and_b32 v32, 1, v3
  v_lshl_add_u32 v7, v32, 3, v7
  s_mul_i32 s69, s90, 20480
  s_mul_i32 s56, s89, 2560
  s_add_u32 s69, s69, s56
  s_mul_i32 s72, s89, 160
  v_mov_b32 v46, v7
  s_lshl_b32 s56, s90, 4
  v_add_u32 v36, s56, v2
  v_lshlrev_b32 v37, 8, v3
  v_subrev_u32 v38, 1, v36
  v_lshrrev_b32 v39, 4, v38
  v_mul_u32_u24 v39, 20480, v39
  v_and_b32 v32, 15, v38
  v_lshl_add_u32 v32, v32, 4, v37
  v_add_u32 v32, v32, v39
  v_cmp_lt_u32 vcc, 2047, v38
  v_bfrev_b32 v39, 1
  s_nop 0
  v_cndmask_b32 v32, v32, v39, vcc
  v_subrev_u32 v38, -1, v36
  v_lshrrev_b32 v39, 4, v38
  v_mul_u32_u24 v39, 20480, v39
  v_and_b32 v33, 15, v38
  v_lshl_add_u32 v33, v33, 4, v37
  v_add_u32 v33, v33, v39
  v_cmp_lt_u32 vcc, 2047, v38
  v_bfrev_b32 v39, 1
  s_nop 0
  v_cndmask_b32 v33, v33, v39, vcc
  v_subrev_u32 v38, 2, v36
  v_lshrrev_b32 v39, 4, v38
  v_mul_u32_u24 v39, 20480, v39
  v_and_b32 v34, 15, v38
  v_lshl_add_u32 v34, v34, 4, v37
  v_add_u32 v34, v34, v39
  v_cmp_lt_u32 vcc, 2047, v38
  v_bfrev_b32 v39, 1
  s_nop 0
  v_cndmask_b32 v34, v34, v39, vcc
  v_subrev_u32 v38, -2, v36
  v_lshrrev_b32 v39, 4, v38
  v_mul_u32_u24 v39, 20480, v39
  v_and_b32 v35, 15, v38
  v_lshl_add_u32 v35, v35, 4, v37
  v_add_u32 v35, v35, v39
  v_cmp_lt_u32 vcc, 2047, v38
  v_bfrev_b32 v39, 1
  s_nop 0
  v_cndmask_b32 v35, v35, v39, vcc
  s_mov_b32 s68, 0
  v_lshlrev_b32 v108, 16, v236
  v_and_b32 v109, 0xffff0000, v236
  v_sub_f32 v108, v108, v246
  v_sub_f32 v109, v109, v246
  v_cvt_pk_bf16_f32 v40, v108, v109
  v_lshlrev_b32 v108, 16, v40
  v_and_b32 v109, 0xffff0000, v40
  v_mul_f32 v108, v108, v247
  v_mul_f32 v109, v109, v247
  v_cvt_pk_bf16_f32 v40, v108, v109
  v_lshlrev_b32 v108, 16, v40
  v_and_b32 v109, 0xffff0000, v40
  v_lshlrev_b32 v110, 16, v237
  v_and_b32 v111, 0xffff0000, v237
  v_sub_f32 v110, v110, v246
  v_sub_f32 v111, v111, v246
  v_cvt_pk_bf16_f32 v40, v110, v111
  v_lshlrev_b32 v110, 16, v40
  v_and_b32 v111, 0xffff0000, v40
  v_mul_f32 v110, v110, v247
  v_mul_f32 v111, v111, v247
  v_cvt_pk_bf16_f32 v40, v110, v111
  v_lshlrev_b32 v110, 16, v40
  v_and_b32 v111, 0xffff0000, v40
  v_lshlrev_b32 v112, 16, v238
  v_and_b32 v113, 0xffff0000, v238
  v_sub_f32 v112, v112, v246
  v_sub_f32 v113, v113, v246
  v_cvt_pk_bf16_f32 v40, v112, v113
  v_lshlrev_b32 v112, 16, v40
  v_and_b32 v113, 0xffff0000, v40
  v_mul_f32 v112, v112, v247
  v_mul_f32 v113, v113, v247
  v_cvt_pk_bf16_f32 v40, v112, v113
  v_lshlrev_b32 v112, 16, v40
  v_and_b32 v113, 0xffff0000, v40
  v_lshlrev_b32 v114, 16, v239
  v_and_b32 v115, 0xffff0000, v239
  v_sub_f32 v114, v114, v246
  v_sub_f32 v115, v115, v246
  v_cvt_pk_bf16_f32 v40, v114, v115
  v_lshlrev_b32 v114, 16, v40
  v_and_b32 v115, 0xffff0000, v40
  v_mul_f32 v114, v114, v247
  v_mul_f32 v115, v115, v247
  v_cvt_pk_bf16_f32 v40, v114, v115
  v_lshlrev_b32 v114, 16, v40
  v_and_b32 v115, 0xffff0000, v40
  v_lshlrev_b32 v116, 16, v240
  v_and_b32 v117, 0xffff0000, v240
  v_sub_f32 v116, v116, v246
  v_sub_f32 v117, v117, v246
  v_cvt_pk_bf16_f32 v40, v116, v117
  v_lshlrev_b32 v116, 16, v40
  v_and_b32 v117, 0xffff0000, v40
  v_mul_f32 v116, v116, v247
  v_mul_f32 v117, v117, v247
  v_cvt_pk_bf16_f32 v40, v116, v117
  v_lshlrev_b32 v116, 16, v40
  v_and_b32 v117, 0xffff0000, v40
  v_lshlrev_b32 v118, 16, v241
  v_and_b32 v119, 0xffff0000, v241
  v_sub_f32 v118, v118, v246
  v_sub_f32 v119, v119, v246
  v_cvt_pk_bf16_f32 v40, v118, v119
  v_lshlrev_b32 v118, 16, v40
  v_and_b32 v119, 0xffff0000, v40
  v_mul_f32 v118, v118, v247
  v_mul_f32 v119, v119, v247
  v_cvt_pk_bf16_f32 v40, v118, v119
  v_lshlrev_b32 v118, 16, v40
  v_and_b32 v119, 0xffff0000, v40
  v_lshlrev_b32 v120, 16, v242
  v_and_b32 v121, 0xffff0000, v242
  v_sub_f32 v120, v120, v246
  v_sub_f32 v121, v121, v246
  v_cvt_pk_bf16_f32 v40, v120, v121
  v_lshlrev_b32 v120, 16, v40
  v_and_b32 v121, 0xffff0000, v40
  v_mul_f32 v120, v120, v247
  v_mul_f32 v121, v121, v247
  v_cvt_pk_bf16_f32 v40, v120, v121
  v_lshlrev_b32 v120, 16, v40
  v_and_b32 v121, 0xffff0000, v40
  v_lshlrev_b32 v122, 16, v243
  v_and_b32 v123, 0xffff0000, v243
  v_sub_f32 v122, v122, v246
  v_sub_f32 v123, v123, v246
  v_cvt_pk_bf16_f32 v40, v122, v123
  v_lshlrev_b32 v122, 16, v40
  v_and_b32 v123, 0xffff0000, v40
  v_mul_f32 v122, v122, v247
  v_mul_f32 v123, v123, v247
  v_cvt_pk_bf16_f32 v40, v122, v123
  v_lshlrev_b32 v122, 16, v40
  v_and_b32 v123, 0xffff0000, v40
  v_lshlrev_b32 v124, 16, v244
  v_and_b32 v125, 0xffff0000, v244
  v_sub_f32 v124, v124, v246
  v_sub_f32 v125, v125, v246
  v_cvt_pk_bf16_f32 v40, v124, v125
  v_lshlrev_b32 v124, 16, v40
  v_and_b32 v125, 0xffff0000, v40
  v_mul_f32 v124, v124, v247
  v_mul_f32 v125, v125, v247
  v_cvt_pk_bf16_f32 v40, v124, v125
  v_lshlrev_b32 v124, 16, v40
  v_and_b32 v125, 0xffff0000, v40
  v_lshlrev_b32 v126, 16, v245
  v_and_b32 v127, 0xffff0000, v245
  v_sub_f32 v126, v126, v246
  v_sub_f32 v127, v127, v246
  v_cvt_pk_bf16_f32 v40, v126, v127
  v_lshlrev_b32 v126, 16, v40
  v_and_b32 v127, 0xffff0000, v40
  v_mul_f32 v126, v126, v247
  v_mul_f32 v127, v127, v247
  v_cvt_pk_bf16_f32 v40, v126, v127
  v_lshlrev_b32 v126, 16, v40
  v_and_b32 v127, 0xffff0000, v40
  s_lshl_b32 s62, s90, 3
  s_sub_u32 s62, s62, 8
  s_cmp_eq_u32 s90, 0
  s_cselect_b32 s63, 8, 0
  s_cmp_eq_u32 s90, 127
  s_cselect_b32 s93, 16, 24
  s_add_u32 s56, s54, 6
  v_add_u32 v10, s62, v1
  v_lshlrev_b32 v10, 7, v10
  v_add_u32 v10, 393216, v10
  s_mov_b64 s[58:59], exec
  v_cmp_le_u32 vcc, s63, v1
  v_cmp_gt_u32 s[94:95], s93, v1
  s_nop 3
  s_and_b64 exec, vcc, s[94:95]
  s_and_b64 exec, exec, 0xCCFF33
  s_mov_b32 s57, 0
  s_waitcnt vmcnt(0)
L_40:
  buffer_load_dwordx2 v[12:13], v10, s[24:27], 0 offen sc1
  s_waitcnt vmcnt(0)
  v_cmp_ne_u32 vcc, s56, v12
  v_cmp_ne_u32 s[94:95], s55, v13
  s_add_u32 s57, s57, 1
  s_nop 4
  s_or_b64 vcc, vcc, s[94:95]
  s_cbranch_vccz L_41
  s_cmp_lt_u32 s57, 0x80000
  s_cbranch_scc1 L_40
L_41:
  s_mov_b64 exec, s[58:59]
  v_mov_b32 v10, 4
  ds_write_b32 v11, v10 offset:128
  buffer_load_dwordx4 v[148:151], v32, s[8:11], s68 offen sc1
  buffer_load_dwordx4 v[152:155], v32, s[8:11], s68 offen offset:1024 sc1
  buffer_load_dwordx4 v[156:159], v32, s[8:11], s68 offen offset:2048 sc1
  buffer_load_dwordx4 v[160:163], v32, s[8:11], s68 offen offset:3072 sc1
  s_add_u32 s68, s68, 4096
  buffer_load_dwordx4 v[164:167], v32, s[8:11], s68 offen sc1
  buffer_load_dwordx4 v[168:171], v33, s[8:11], s68 offen offset:1024 sc1
  s_add_u32 s20, s52, 28442624
  s_addc_u32 s21, s53, 0
  s_mov_b32 s22, 131072
  s_mov_b32 s23, 0x00020000
  s_lshl_b32 s73, s90, 10
  s_lshl_b32 s56, s89, 7
  s_add_u32 s73, s73, s56
  v_lshlrev_b32 v4, 3, v2
  v_mov_b32 v20, 0
  v_mov_b32 v21, 0
  v_mov_b32 v22, 0
  v_mov_b32 v23, 0
  s_waitcnt lgkmcnt(0)
  s_mov_b32 s57, 0
L_42:
  ds_read_b128 v[12:15], v8 offset:0
  s_waitcnt lgkmcnt(0)
  v_min3_u32 v12, v12, v13, v14
  v_min_u32 v12, v12, v15
  s_nop 0
  v_readfirstlane_b32 s56, v12
  s_nop 3
  s_cmp_ge_u32 s56, 30
  s_cbranch_scc1 L_43
  s_add_u32 s57, s57, 1
  s_sleep 1
  s_cmp_lt_u32 s57, 0x400000
  s_cbranch_scc1 L_42
L_43:
  ds_read_b128 v[68:71], v16
  ds_read_b128 v[72:75], v16 offset:1024
  ds_read_b128 v[76:79], v16 offset:2048
  ds_read_b128 v[80:83], v16 offset:3072
  ds_read_b128 v[84:87], v16 offset:4096
  ds_read_b128 v[88:91], v16 offset:5120
  ds_read_b128 v[92:95], v16 offset:6144
  ds_read_b128 v[96:99], v16 offset:7168
  ds_read_b128 v[100:103], v16 offset:8192
  ds_read_b128 v[104:107], v16 offset:9216
  s_waitcnt vmcnt(5) lgkmcnt(9)
  v_mfma_f32_16x16x32_bf16 v[48:51], v[68:71], v[148:151], 0
  ds_read_b128 v[128:131], v16 offset:10240
  s_waitcnt lgkmcnt(9)
  v_mfma_f32_16x16x32_bf16 v[52:55], v[72:75], v[148:151], 0
  ds_read_b128 v[132:135], v16 offset:11264
  s_waitcnt lgkmcnt(9)
  v_mfma_f32_16x16x32_bf16 v[56:59], v[76:79], v[148:151], 0
  ds_read_b128 v[136:139], v16 offset:12288
  s_waitcnt lgkmcnt(9)
  v_mfma_f32_16x16x32_bf16 v[60:63], v[80:83], v[148:151], 0
  ds_read_b128 v[140:143], v16 offset:13312
  s_waitcnt lgkmcnt(9)
  v_mfma_f32_16x16x32_bf16 v[64:67], v[84:87], v[148:151], 0
  ds_read_b128 v[144:147], v16 offset:14336
  buffer_load_dwordx4 v[172:175], v33, s[8:11], s68 offen offset:2048 sc1
  buffer_load_dwordx4 v[176:179], v33, s[8:11], s68 offen offset:3072 sc1
  s_add_u32 s68, s68, 4096
  s_waitcnt vmcnt(6) lgkmcnt(9)
  v_mfma_f32_16x16x32_bf16 v[48:51], v[88:91], v[152:155], v[48:51]
  ds_read_b128 v[68:71], v16 offset:15360
  s_waitcnt lgkmcnt(9)
  v_mfma_f32_16x16x32_bf16 v[52:55], v[92:95], v[152:155], v[52:55]
  ds_read_b128 v[72:75], v16 offset:16384
  s_waitcnt lgkmcnt(9)
  v_mfma_f32_16x16x32_bf16 v[56:59], v[96:99], v[152:155], v[56:59]
  ds_read_b128 v[76:79], v16 offset:17408
  s_waitcnt lgkmcnt(9)
  v_mfma_f32_16x16x32_bf16 v[60:63], v[100:103], v[152:155], v[60:63]
  ds_read_b128 v[80:83], v16 offset:18432
  s_waitcnt lgkmcnt(9)
  v_mfma_f32_16x16x32_bf16 v[64:67], v[104:107], v[152:155], v[64:67]
  ds_read_b128 v[84:87], v16 offset:19456
  buffer_load_dwordx4 v[180:183], v33, s[8:11], s68 offen sc1
  buffer_load_dwordx4 v[184:187], v33, s[8:11], s68 offen offset:1024 sc1
  s_waitcnt vmcnt(7) lgkmcnt(9)
  v_mfma_f32_16x16x32_bf16 v[48:51], v[128:131], v[156:159], v[48:51]
  ds_read_b128 v[88:91], v16 offset:40960
  s_waitcnt lgkmcnt(9)
  v_mfma_f32_16x16x32_bf16 v[52:55], v[132:135], v[156:159], v[52:55]
  ds_read_b128 v[92:95], v16 offset:41984
  s_waitcnt lgkmcnt(9)
  v_mfma_f32_16x16x32_bf16 v[56:59], v[136:139], v[156:159], v[56:59]
  ds_read_b128 v[96:99], v16 offset:43008
  s_waitcnt lgkmcnt(9)
  v_mfma_f32_16x16x32_bf16 v[60:63], v[140:143], v[156:159], v[60:63]
  ds_read_b128 v[100:103], v16 offset:44032
  s_waitcnt lgkmcnt(9)
  v_mfma_f32_16x16x32_bf16 v[64:67], v[144:147], v[156:159], v[64:67]
  ds_read_b128 v[104:107], v16 offset:45056
  buffer_load_dwordx4 v[188:191], v34, s[8:11], s68 offen offset:2048 sc1
  buffer_load_dwordx4 v[192:195], v34, s[8:11], s68 offen offset:3072 sc1
  s_add_u32 s68, s68, 4096
  s_waitcnt vmcnt(8) lgkmcnt(9)
  v_mfma_f32_16x16x32_bf16 v[48:51], v[68:71], v[160:163], v[48:51]
  ds_read_b128 v[128:131], v16 offset:46080
  s_waitcnt lgkmcnt(9)
  v_mfma_f32_16x16x32_bf16 v[52:55], v[72:75], v[160:163], v[52:55]
  ds_read_b128 v[132:135], v16 offset:47104
  s_waitcnt lgkmcnt(9)
  v_mfma_f32_16x16x32_bf16 v[56:59], v[76:79], v[160:163], v[56:59]
  ds_read_b128 v[136:139], v16 offset:48128
  s_waitcnt lgkmcnt(9)
  v_mfma_f32_16x16x32_bf16 v[60:63], v[80:83], v[160:163], v[60:63]
  ds_read_b128 v[140:143], v16 offset:49152
  s_waitcnt lgkmcnt(9)
  v_mfma_f32_16x16x32_bf16 v[64:67], v[84:87], v[160:163], v[64:67]
  ds_read_b128 v[144:147], v16 offset:50176
  buffer_load_dwordx4 v[196:199], v34, s[8:11], s68 offen sc1
  buffer_load_dwordx4 v[200:203], v34, s[8:11], s68 offen offset:1024 sc1
  v_mov_b32 v10, 26
  ds_write_b32 v11, v10 offset:16
  s_waitcnt vmcnt(9) lgkmcnt(10)
  v_mfma_f32_16x16x32_bf16 v[48:51], v[88:91], v[164:167], v[48:51]
  ds_read_b128 v[68:71], v16 offset:51200
  s_waitcnt lgkmcnt(10)
  v_mfma_f32_16x16x32_bf16 v[52:55], v[92:95], v[164:167], v[52:55]
  ds_read_b128 v[72:75], v16 offset:52224
  s_waitcnt lgkmcnt(10)
  v_mfma_f32_16x16x32_bf16 v[56:59], v[96:99], v[164:167], v[56:59]
  ds_read_b128 v[76:79], v16 offset:53248
  s_waitcnt lgkmcnt(10)
  v_mfma_f32_16x16x32_bf16 v[60:63], v[100:103], v[164:167], v[60:63]
  ds_read_b128 v[80:83], v16 offset:54272
  s_waitcnt lgkmcnt(10)
  v_mfma_f32_16x16x32_bf16 v[64:67], v[104:107], v[164:167], v[64:67]
  ds_read_b128 v[84:87], v16 offset:55296
  buffer_load_dwordx4 v[204:207], v34, s[8:11], s68 offen offset:2048 sc1
  buffer_load_dwordx4 v[208:211], v35, s[8:11], s68 offen offset:3072 sc1
  s_add_u32 s68, s68, 4096
  s_waitcnt vmcnt(10) lgkmcnt(10)
  v_mfma_f32_16x16x32_bf16 v[48:51], v[128:131], v[168:171], v[48:51]
  ds_read_b128 v[88:91], v16 offset:56320
  s_waitcnt lgkmcnt(10)
  v_mfma_f32_16x16x32_bf16 v[52:55], v[132:135], v[168:171], v[52:55]
  ds_read_b128 v[92:95], v16 offset:57344
  s_waitcnt lgkmcnt(10)
  v_mfma_f32_16x16x32_bf16 v[56:59], v[136:139], v[168:171], v[56:59]
  ds_read_b128 v[96:99], v16 offset:58368
  s_waitcnt lgkmcnt(10)
  v_mfma_f32_16x16x32_bf16 v[60:63], v[140:143], v[168:171], v[60:63]
  ds_read_b128 v[100:103], v16 offset:59392
  s_waitcnt lgkmcnt(10)
  v_mfma_f32_16x16x32_bf16 v[64:67], v[144:147], v[168:171], v[64:67]
  ds_read_b128 v[104:107], v16 offset:60416
  buffer_load_dwordx4 v[212:215], v35, s[8:11], s68 offen sc1
  buffer_load_dwordx4 v[216:219], v35, s[8:11], s68 offen offset:1024 sc1
  s_waitcnt vmcnt(11) lgkmcnt(9)
  v_mfma_f32_16x16x32_bf16 v[48:51], v[68:71], v[172:175], v[48:51]
  ds_read_b128 v[128:131], v16 offset:20480
  s_waitcnt lgkmcnt(9)
  v_mfma_f32_16x16x32_bf16 v[52:55], v[72:75], v[172:175], v[52:55]
  ds_read_b128 v[132:135], v16 offset:21504
  s_waitcnt lgkmcnt(9)
  v_mfma_f32_16x16x32_bf16 v[56:59], v[76:79], v[172:175], v[56:59]
  ds_read_b128 v[136:139], v16 offset:22528
  s_waitcnt lgkmcnt(9)
  v_mfma_f32_16x16x32_bf16 v[60:63], v[80:83], v[172:175], v[60:63]
  ds_read_b128 v[140:143], v16 offset:23552
  s_waitcnt lgkmcnt(9)
  v_mfma_f32_16x16x32_bf16 v[64:67], v[84:87], v[172:175], v[64:67]
  ds_read_b128 v[144:147], v16 offset:24576
  buffer_load_dwordx4 v[220:223], v35, s[8:11], s68 offen offset:2048 sc1
  buffer_load_dwordx4 v[224:227], v35, s[8:11], s68 offen offset:3072 sc1
  s_add_u32 s68, s68, 4096
  s_waitcnt vmcnt(12) lgkmcnt(9)
  v_mfma_f32_16x16x32_bf16 v[48:51], v[88:91], v[176:179], v[48:51]
  ds_read_b128 v[68:71], v16 offset:25600
  s_waitcnt lgkmcnt(9)
  v_mfma_f32_16x16x32_bf16 v[52:55], v[92:95], v[176:179], v[52:55]
  ds_read_b128 v[72:75], v16 offset:26624
  s_waitcnt lgkmcnt(9)
  v_mfma_f32_16x16x32_bf16 v[56:59], v[96:99], v[176:179], v[56:59]
  ds_read_b128 v[76:79], v16 offset:27648
  s_waitcnt lgkmcnt(9)
  v_mfma_f32_16x16x32_bf16 v[60:63], v[100:103], v[176:179], v[60:63]
  ds_read_b128 v[80:83], v16 offset:28672
  s_waitcnt lgkmcnt(9)
  v_mfma_f32_16x16x32_bf16 v[64:67], v[104:107], v[176:179], v[64:67]
  ds_read_b128 v[84:87], v16 offset:29696
  v_mov_b32 v10, 27
  ds_write_b32 v11, v10 offset:16
  s_waitcnt vmcnt(11) lgkmcnt(10)
  v_mfma_f32_16x16x32_bf16 v[48:51], v[128:131], v[180:183], v[48:51]
  ds_read_b128 v[88:91], v16 offset:30720
  s_waitcnt lgkmcnt(10)
  v_mfma_f32_16x16x32_bf16 v[52:55], v[132:135], v[180:183], v[52:55]
  ds_read_b128 v[92:95], v16 offset:31744
  s_waitcnt lgkmcnt(10)
  v_mfma_f32_16x16x32_bf16 v[56:59], v[136:139], v[180:183], v[56:59]
  ds_read_b128 v[96:99], v16 offset:32768
  s_waitcnt lgkmcnt(10)
  v_mfma_f32_16x16x32_bf16 v[60:63], v[140:143], v[180:183], v[60:63]
  ds_read_b128 v[100:103], v16 offset:33792
  s_waitcnt lgkmcnt(10)
  v_mfma_f32_16x16x32_bf16 v[64:67], v[144:147], v[180:183], v[64:67]
  ds_read_b128 v[104:107], v16 offset:34816
  s_waitcnt vmcnt(10) lgkmcnt(10)
  v_mfma_f32_16x16x32_bf16 v[48:51], v[68:71], v[184:187], v[48:51]
  ds_read_b128 v[128:131], v16 offset:35840
  s_waitcnt lgkmcnt(10)
  v_mfma_f32_16x16x32_bf16 v[52:55], v[72:75], v[184:187], v[52:55]
  ds_read_b128 v[132:135], v16 offset:36864
  s_waitcnt lgkmcnt(10)
  v_mfma_f32_16x16x32_bf16 v[56:59], v[76:79], v[184:187], v[56:59]
  ds_read_b128 v[136:139], v16 offset:37888
  s_waitcnt lgkmcnt(10)
  v_mfma_f32_16x16x32_bf16 v[60:63], v[80:83], v[184:187], v[60:63]
  ds_read_b128 v[140:143], v16 offset:38912
  s_waitcnt lgkmcnt(10)
  v_mfma_f32_16x16x32_bf16 v[64:67], v[84:87], v[184:187], v[64:67]
  ds_read_b128 v[144:147], v16 offset:39936
  v_add_u32 v16, 61440, v16
  s_waitcnt vmcnt(9) lgkmcnt(9)
  v_mfma_f32_16x16x32_bf16 v[48:51], v[88:91], v[188:191], v[48:51]
  ds_read_b128 v[68:71], v16
  s_waitcnt lgkmcnt(9)
  v_mfma_f32_16x16x32_bf16 v[52:55], v[92:95], v[188:191], v[52:55]
  ds_read_b128 v[72:75], v16 offset:1024
  s_waitcnt lgkmcnt(9)
  v_mfma_f32_16x16x32_bf16 v[56:59], v[96:99], v[188:191], v[56:59]
  ds_read_b128 v[76:79], v16 offset:2048
  s_waitcnt lgkmcnt(9)
  v_mfma_f32_16x16x32_bf16 v[60:63], v[100:103], v[188:191], v[60:63]
  ds_read_b128 v[80:83], v16 offset:3072
  s_waitcnt lgkmcnt(9)
  v_mfma_f32_16x16x32_bf16 v[64:67], v[104:107], v[188:191], v[64:67]
  ds_read_b128 v[84:87], v16 offset:4096
  s_waitcnt vmcnt(8) lgkmcnt(9)
  v_mfma_f32_16x16x32_bf16 v[48:51], v[128:131], v[192:195], v[48:51]
  ds_read_b128 v[88:91], v16 offset:5120
  s_waitcnt lgkmcnt(9)
  v_mfma_f32_16x16x32_bf16 v[52:55], v[132:135], v[192:195], v[52:55]
  ds_read_b128 v[92:95], v16 offset:6144
  s_waitcnt lgkmcnt(9)
  v_mfma_f32_16x16x32_bf16 v[56:59], v[136:139], v[192:195], v[56:59]
  ds_read_b128 v[96:99], v16 offset:7168
  s_waitcnt lgkmcnt(9)
  v_mfma_f32_16x16x32_bf16 v[60:63], v[140:143], v[192:195], v[60:63]
  ds_read_b128 v[100:103], v16 offset:8192
  s_waitcnt lgkmcnt(9)
  v_mfma_f32_16x16x32_bf16 v[64:67], v[144:147], v[192:195], v[64:67]
  ds_read_b128 v[104:107], v16 offset:9216
  v_mov_b32 v10, 28
  ds_write_b32 v11, v10 offset:16
  s_waitcnt vmcnt(7) lgkmcnt(10)
  v_mfma_f32_16x16x32_bf16 v[48:51], v[68:71], v[196:199], v[48:51]
  ds_read_b128 v[128:131], v16 offset:10240
  s_waitcnt lgkmcnt(10)
  v_mfma_f32_16x16x32_bf16 v[52:55], v[72:75], v[196:199], v[52:55]
  ds_read_b128 v[132:135], v16 offset:11264
  s_waitcnt lgkmcnt(10)
  v_mfma_f32_16x16x32_bf16 v[56:59], v[76:79], v[196:199], v[56:59]
  ds_read_b128 v[136:139], v16 offset:12288
  s_waitcnt lgkmcnt(10)
  v_mfma_f32_16x16x32_bf16 v[60:63], v[80:83], v[196:199], v[60:63]
  ds_read_b128 v[140:143], v16 offset:13312
  s_waitcnt lgkmcnt(10)
  v_mfma_f32_16x16x32_bf16 v[64:67], v[84:87], v[196:199], v[64:67]
  ds_read_b128 v[144:147], v16 offset:14336
  s_waitcnt vmcnt(6) lgkmcnt(10)
  v_mfma_f32_16x16x32_bf16 v[48:51], v[88:91], v[200:203], v[48:51]
  ds_read_b128 v[68:71], v16 offset:15360
  s_waitcnt lgkmcnt(10)
  v_mfma_f32_16x16x32_bf16 v[52:55], v[92:95], v[200:203], v[52:55]
  ds_read_b128 v[72:75], v16 offset:16384
  s_waitcnt lgkmcnt(10)
  v_mfma_f32_16x16x32_bf16 v[56:59], v[96:99], v[200:203], v[56:59]
  ds_read_b128 v[76:79], v16 offset:17408
  s_waitcnt lgkmcnt(10)
  v_mfma_f32_16x16x32_bf16 v[60:63], v[100:103], v[200:203], v[60:63]
  ds_read_b128 v[80:83], v16 offset:18432
  s_waitcnt lgkmcnt(10)
  v_mfma_f32_16x16x32_bf16 v[64:67], v[104:107], v[200:203], v[64:67]
  ds_read_b128 v[84:87], v16 offset:19456
  s_waitcnt vmcnt(5) lgkmcnt(9)
  v_mfma_f32_16x16x32_bf16 v[48:51], v[128:131], v[204:207], v[48:51]
  ds_read_b128 v[88:91], v16 offset:20480
  s_waitcnt lgkmcnt(9)
  v_mfma_f32_16x16x32_bf16 v[52:55], v[132:135], v[204:207], v[52:55]
  ds_read_b128 v[92:95], v16 offset:21504
  s_waitcnt lgkmcnt(9)
  v_mfma_f32_16x16x32_bf16 v[56:59], v[136:139], v[204:207], v[56:59]
  ds_read_b128 v[96:99], v16 offset:22528
  s_waitcnt lgkmcnt(9)
  v_mfma_f32_16x16x32_bf16 v[60:63], v[140:143], v[204:207], v[60:63]
  ds_read_b128 v[100:103], v16 offset:23552
  s_waitcnt lgkmcnt(9)
  v_mfma_f32_16x16x32_bf16 v[64:67], v[144:147], v[204:207], v[64:67]
  ds_read_b128 v[104:107], v16 offset:24576
  s_waitcnt vmcnt(4) lgkmcnt(9)
  v_mfma_f32_16x16x32_bf16 v[48:51], v[68:71], v[208:211], v[48:51]
  ds_read_b128 v[128:131], v16 offset:25600
  s_waitcnt lgkmcnt(9)
  v_mfma_f32_16x16x32_bf16 v[52:55], v[72:75], v[208:211], v[52:55]
  ds_read_b128 v[132:135], v16 offset:26624
  s_waitcnt lgkmcnt(9)
  v_mfma_f32_16x16x32_bf16 v[56:59], v[76:79], v[208:211], v[56:59]
  ds_read_b128 v[136:139], v16 offset:27648
  s_waitcnt lgkmcnt(9)
  v_mfma_f32_16x16x32_bf16 v[60:63], v[80:83], v[208:211], v[60:63]
  ds_read_b128 v[140:143], v16 offset:28672
  s_waitcnt lgkmcnt(9)
  v_mfma_f32_16x16x32_bf16 v[64:67], v[84:87], v[208:211], v[64:67]
  ds_read_b128 v[144:147], v16 offset:29696
  v_mov_b32 v10, 29
  ds_write_b32 v11, v10 offset:16
  s_waitcnt vmcnt(3) lgkmcnt(10)
  v_mfma_f32_16x16x32_bf16 v[48:51], v[88:91], v[212:215], v[48:51]
  ds_read_b128 v[68:71], v16 offset:30720
  s_waitcnt lgkmcnt(10)
  v_mfma_f32_16x16x32_bf16 v[52:55], v[92:95], v[212:215], v[52:55]
  ds_read_b128 v[72:75], v16 offset:31744
  s_waitcnt lgkmcnt(10)
  v_mfma_f32_16x16x32_bf16 v[56:59], v[96:99], v[212:215], v[56:59]
  ds_read_b128 v[76:79], v16 offset:32768
  s_waitcnt lgkmcnt(10)
  v_mfma_f32_16x16x32_bf16 v[60:63], v[100:103], v[212:215], v[60:63]
  ds_read_b128 v[80:83], v16 offset:33792
  s_waitcnt lgkmcnt(10)
  v_mfma_f32_16x16x32_bf16 v[64:67], v[104:107], v[212:215], v[64:67]
  ds_read_b128 v[84:87], v16 offset:34816
  s_waitcnt vmcnt(2) lgkmcnt(10)
  v_mfma_f32_16x16x32_bf16 v[48:51], v[128:131], v[216:219], v[48:51]
  ds_read_b128 v[88:91], v16 offset:35840
  s_waitcnt lgkmcnt(10)
  v_mfma_f32_16x16x32_bf16 v[52:55], v[132:135], v[216:219], v[52:55]
  ds_read_b128 v[92:95], v16 offset:36864
  s_waitcnt lgkmcnt(10)
  v_mfma_f32_16x16x32_bf16 v[56:59], v[136:139], v[216:219], v[56:59]
  ds_read_b128 v[96:99], v16 offset:37888
  s_waitcnt lgkmcnt(10)
  v_mfma_f32_16x16x32_bf16 v[60:63], v[140:143], v[216:219], v[60:63]
  ds_read_b128 v[100:103], v16 offset:38912
  s_waitcnt lgkmcnt(10)
  v_mfma_f32_16x16x32_bf16 v[64:67], v[144:147], v[216:219], v[64:67]
  ds_read_b128 v[104:107], v16 offset:39936
  s_waitcnt vmcnt(1) lgkmcnt(9)
  v_mfma_f32_16x16x32_bf16 v[48:51], v[68:71], v[220:223], v[48:51]
  s_waitcnt lgkmcnt(8)
  v_mfma_f32_16x16x32_bf16 v[52:55], v[72:75], v[220:223], v[52:55]
  s_waitcnt lgkmcnt(7)
  v_mfma_f32_16x16x32_bf16 v[56:59], v[76:79], v[220:223], v[56:59]
  s_waitcnt lgkmcnt(6)
  v_mfma_f32_16x16x32_bf16 v[60:63], v[80:83], v[220:223], v[60:63]
  s_waitcnt lgkmcnt(5)
  v_mfma_f32_16x16x32_bf16 v[64:67], v[84:87], v[220:223], v[64:67]
  v_mov_b32 v10, 0
  ds_write_b32 v11, v10 offset:128
  s_waitcnt vmcnt(0) lgkmcnt(5)
  v_mfma_f32_16x16x32_bf16 v[48:51], v[88:91], v[224:227], v[48:51]
  s_waitcnt lgkmcnt(4)
  v_mfma_f32_16x16x32_bf16 v[52:55], v[92:95], v[224:227], v[52:55]
  s_waitcnt lgkmcnt(3)
  v_mfma_f32_16x16x32_bf16 v[56:59], v[96:99], v[224:227], v[56:59]
  s_waitcnt lgkmcnt(2)
  v_mfma_f32_16x16x32_bf16 v[60:63], v[100:103], v[224:227], v[60:63]
  s_waitcnt lgkmcnt(1)
  v_mfma_f32_16x16x32_bf16 v[64:67], v[104:107], v[224:227], v[64:67]
  v_mov_b32 v10, 30
  ds_write_b32 v11, v10 offset:16
  v_cvt_pk_bf16_f32 v32, v48, v49
  v_lshlrev_b32 v48, 16, v32
  v_and_b32 v49, 0xffff0000, v32
  v_cvt_pk_bf16_f32 v33, v50, v51
  v_lshlrev_b32 v50, 16, v33
  v_and_b32 v51, 0xffff0000, v33
  v_pk_add_f32 v[48:49], v[48:49], v[108:109]
  v_pk_add_f32 v[50:51], v[50:51], v[110:111]
  v_cvt_pk_bf16_f32 v246, v48, v49
  v_cvt_pk_bf16_f32 v247, v50, v51
  buffer_store_dwordx2 v[246:247], v46, s[16:19], s69 offen sc1
  v_dot2c_f32_bf16 v20, s61, v246
  v_dot2c_f32_bf16 v21, v246, v246
  v_dot2c_f32_bf16 v22, s61, v247
  v_dot2c_f32_bf16 v23, v247, v247
  v_cvt_pk_bf16_f32 v32, v52, v53
  v_lshlrev_b32 v52, 16, v32
  v_and_b32 v53, 0xffff0000, v32
  v_cvt_pk_bf16_f32 v33, v54, v55
  v_lshlrev_b32 v54, 16, v33
  v_and_b32 v55, 0xffff0000, v33
  v_pk_add_f32 v[52:53], v[52:53], v[112:113]
  v_pk_add_f32 v[54:55], v[54:55], v[114:115]
  v_cvt_pk_bf16_f32 v248, v52, v53
  v_cvt_pk_bf16_f32 v249, v54, v55
  buffer_store_dwordx2 v[248:249], v46, s[16:19], s69 offen offset:512 sc1
  v_dot2c_f32_bf16 v20, s61, v248
  v_dot2c_f32_bf16 v21, v248, v248
  v_dot2c_f32_bf16 v22, s61, v249
  v_dot2c_f32_bf16 v23, v249, v249
  v_cvt_pk_bf16_f32 v32, v56, v57
  v_lshlrev_b32 v56, 16, v32
  v_and_b32 v57, 0xffff0000, v32
  v_cvt_pk_bf16_f32 v33, v58, v59
  v_lshlrev_b32 v58, 16, v33
  v_and_b32 v59, 0xffff0000, v33
  v_pk_add_f32 v[56:57], v[56:57], v[116:117]
  v_pk_add_f32 v[58:59], v[58:59], v[118:119]
  v_cvt_pk_bf16_f32 v250, v56, v57
  v_cvt_pk_bf16_f32 v251, v58, v59
  buffer_store_dwordx2 v[250:251], v46, s[16:19], s69 offen offset:1024 sc1
  v_dot2c_f32_bf16 v20, s61, v250
  v_dot2c_f32_bf16 v21, v250, v250
  v_dot2c_f32_bf16 v22, s61, v251
  v_dot2c_f32_bf16 v23, v251, v251
  v_cvt_pk_bf16_f32 v32, v60, v61
  v_lshlrev_b32 v60, 16, v32
  v_and_b32 v61, 0xffff0000, v32
  v_cvt_pk_bf16_f32 v33, v62, v63
  v_lshlrev_b32 v62, 16, v33
  v_and_b32 v63, 0xffff0000, v33
  v_pk_add_f32 v[60:61], v[60:61], v[120:121]
  v_pk_add_f32 v[62:63], v[62:63], v[122:123]
  v_cvt_pk_bf16_f32 v252, v60, v61
  v_cvt_pk_bf16_f32 v253, v62, v63
  buffer_store_dwordx2 v[252:253], v46, s[16:19], s69 offen offset:1536 sc1
  v_dot2c_f32_bf16 v20, s61, v252
  v_dot2c_f32_bf16 v21, v252, v252
  v_dot2c_f32_bf16 v22, s61, v253
  v_dot2c_f32_bf16 v23, v253, v253
  v_cvt_pk_bf16_f32 v32, v64, v65
  v_lshlrev_b32 v64, 16, v32
  v_and_b32 v65, 0xffff0000, v32
  v_cvt_pk_bf16_f32 v33, v66, v67
  v_lshlrev_b32 v66, 16, v33
  v_and_b32 v67, 0xffff0000, v33
  v_pk_add_f32 v[64:65], v[64:65], v[124:125]
  v_pk_add_f32 v[66:67], v[66:67], v[126:127]
  v_cvt_pk_bf16_f32 v254, v64, v65
  v_cvt_pk_bf16_f32 v255, v66, v67
  buffer_store_dwordx2 v[254:255], v46, s[16:19], s69 offen offset:2048 sc1
  v_dot2c_f32_bf16 v20, s61, v254
  v_dot2c_f32_bf16 v21, v254, v254
  v_dot2c_f32_bf16 v22, s61, v255
  v_dot2c_f32_bf16 v23, v255, v255
  s_nop 1
  v_add_f32 v20, v20, v22
  v_add_f32 v21, v21, v23
  v_mov_b32 v22, v20
  s_nop 1
  v_permlane32_swap_b32 v22, v20
  v_add_f32 v20, v20, v22
  v_mov_b32 v22, v20
  s_nop 1
  v_permlane16_swap_b32 v22, v20
  v_add_f32 v20, v20, v22
  v_mov_b32 v23, v21
  s_nop 1
  v_permlane32_swap_b32 v23, v21
  v_add_f32 v21, v21, v23
  v_mov_b32 v23, v21
  s_nop 1
  v_permlane16_swap_b32 v23, v21
  v_add_f32 v21, v21, v23
  s_mov_b64 s[58:59], exec
  s_mov_b64 exec, 0xffff
  buffer_store_dwordx2 v[20:21], v4, s[20:23], s73 offen sc1
  s_mov_b64 exec, s[58:59]
  s_add_u32 s56, s54, 8
  v_mov_b32 v12, s56
  v_mov_b32 v13, s55
  v_mov_b32 v10, 0
  s_lshl_b32 s57, s79, 7
  s_add_u32 s57, s57, 524288
  s_mov_b64 s[58:59], exec
  s_waitcnt vmcnt(0)
  s_mov_b64 exec, 1
  buffer_store_dwordx2 v[12:13], v10, s[24:27], s57 offen sc1
  s_mov_b64 exec, s[58:59]
  s_add_u32 s8, s52, 7864320
  s_addc_u32 s9, s53, 0
  s_mov_b32 s10, 2621440
  s_mov_b32 s11, 0x00020000
  s_add_u32 s16, s52, 10485760
  s_addc_u32 s17, s53, 0
  s_mov_b32 s18, 7077888
  s_mov_b32 s19, 0x00020000
  v_lshlrev_b32 v16, 4, v1
  v_lshrrev_b32 v32, 1, v3
  v_lshlrev_b32 v7, 8, v32
  v_lshl_add_u32 v7, v2, 4, v7
  v_and_b32 v32, 1, v3
  v_lshl_add_u32 v7, v32, 3, v7
  v_mov_b32 v18, 0xbdd2d3e8
  v_mov_b32 v19, 0xc0135761
  s_add_u32 s20, s52, 28442624
  s_addc_u32 s21, s53, 0
  s_mov_b32 s22, 131072
  s_mov_b32 s23, 0x00020000
  v_lshlrev_b32 v4, 8, v3
  v_lshl_add_u32 v4, v2, 3, v4
  s_add_u32 s75, s74, 1
  v_lshlrev_b32 v44, 4, v3
  v_add_u32 v44, 163072, v44
  v_lshlrev_b32 v45, 4, v1
  s_mul_i32 s68, s74, 20480
  s_add_u32 s69, s68, 20480
  s_mul_i32 s67, s92, 27
  s_lshr_b32 s67, s67, 2
  s_mul_i32 s72, s74, 55296
  s_lshl_b32 s56, s67, 9
  s_add_u32 s72, s72, s56
  s_add_u32 s73, s72, 55296
  s_lshl_b32 s62, s74, 3
  s_add_u32 s56, s54, 8
  v_add_u32 v10, s62, v1
  v_lshlrev_b32 v10, 7, v10
  v_add_u32 v10, 524288, v10
  s_mov_b64 s[58:59], exec
  s_mov_b64 exec, 65535
  s_mov_b32 s57, 0
  s_waitcnt vmcnt(0)
L_44:
  buffer_load_dwordx2 v[12:13], v10, s[24:27], 0 offen sc1
  s_waitcnt vmcnt(0)
  v_cmp_ne_u32 vcc, s56, v12
  v_cmp_ne_u32 s[94:95], s55, v13
  s_add_u32 s57, s57, 1
  s_nop 4
  s_or_b64 vcc, vcc, s[94:95]
  s_cbranch_vccz L_45
  s_cmp_lt_u32 s57, 0x80000
  s_cbranch_scc1 L_44
L_45:
  s_mov_b64 exec, s[58:59]
  v_mov_b32 v10, 5
  ds_write_b32 v11, v10 offset:128
  s_lshl_b32 s56, s74, 10
  buffer_load_dwordx2 v[20:21], v4, s[20:23], s56 offen sc1
  buffer_load_dwordx2 v[22:23], v4, s[20:23], s56 offen offset:128 sc1
  s_lshl_b32 s56, s75, 10
  buffer_load_dwordx2 v[24:25], v4, s[20:23], s56 offen sc1
  buffer_load_dwordx2 v[26:27], v4, s[20:23], s56 offen offset:128 sc1
  buffer_load_dwordx4 v[132:135], v45, s[8:11], s68 offen sc1
  buffer_load_dwordx4 v[172:175], v45, s[8:11], s69 offen sc1
  buffer_load_dwordx4 v[136:139], v45, s[8:11], s68 offen offset:1024 sc1
  buffer_load_dwordx4 v[176:179], v45, s[8:11], s69 offen offset:1024 sc1
  buffer_load_dwordx4 v[140:143], v45, s[8:11], s68 offen offset:2048 sc1
  buffer_load_dwordx4 v[180:183], v45, s[8:11], s69 offen offset:2048 sc1
  buffer_load_dwordx4 v[144:147], v45, s[8:11], s68 offen offset:3072 sc1
  buffer_load_dwordx4 v[184:187], v45, s[8:11], s69 offen offset:3072 sc1
  s_add_u32 s68, s68, 4096
  s_add_u32 s69, s69, 4096
  s_waitcnt lgkmcnt(0)
  s_mov_b32 s57, 0
L_46:
  ds_read_b128 v[12:15], v8 offset:0
  s_waitcnt lgkmcnt(0)
  v_min3_u32 v12, v12, v13, v14
  v_min_u32 v12, v12, v15
  s_nop 0
  v_readfirstlane_b32 s56, v12
  s_nop 3
  s_cmp_ge_u32 s56, 34
  s_cbranch_scc1 L_47
  s_add_u32 s57, s57, 1
  s_sleep 1
  s_cmp_lt_u32 s57, 0x400000
  s_cbranch_scc1 L_46
L_47:
  v_add_u32 v16, 102400, v16
  ds_read_b128 v[104:107], v16
  ds_read_b128 v[108:111], v16 offset:1024
  ds_read_b128 v[112:115], v16 offset:2048
  ds_read_b128 v[116:119], v16 offset:3072
  ds_read_b128 v[120:123], v16 offset:4096
  ds_read_b128 v[124:127], v16 offset:5120
  ds_read_b128 v[128:131], v16 offset:6144
  s_waitcnt vmcnt(7) lgkmcnt(6)
  v_mfma_f32_16x16x32_bf16 v[48:51], v[104:107], v[132:135], 0
  s_waitcnt vmcnt(6)
  v_mfma_f32_16x16x32_bf16 v[76:79], v[104:107], v[172:175], 0
  ds_read_b128 v[104:107], v16 offset:7168
  s_waitcnt lgkmcnt(6)
  v_mfma_f32_16x16x32_bf16 v[52:55], v[108:111], v[132:135], 0
  v_mfma_f32_16x16x32_bf16 v[80:83], v[108:111], v[172:175], 0
  ds_read_b128 v[108:111], v16 offset:8192
  s_waitcnt lgkmcnt(6)
  v_mfma_f32_16x16x32_bf16 v[56:59], v[112:115], v[132:135], 0
  v_mfma_f32_16x16x32_bf16 v[84:87], v[112:115], v[172:175], 0
  ds_read_b128 v[112:115], v16 offset:9216
  s_waitcnt lgkmcnt(6)
  v_mfma_f32_16x16x32_bf16 v[60:63], v[116:119], v[132:135], 0
  v_mfma_f32_16x16x32_bf16 v[88:91], v[116:119], v[172:175], 0
  ds_read_b128 v[116:119], v16 offset:10240
  s_waitcnt lgkmcnt(6)
  v_mfma_f32_16x16x32_bf16 v[64:67], v[120:123], v[132:135], 0
  v_mfma_f32_16x16x32_bf16 v[92:95], v[120:123], v[172:175], 0
  ds_read_b128 v[120:123], v16 offset:11264
  s_waitcnt lgkmcnt(6)
  v_mfma_f32_16x16x32_bf16 v[68:71], v[124:127], v[132:135], 0
  v_mfma_f32_16x16x32_bf16 v[96:99], v[124:127], v[172:175], 0
  ds_read_b128 v[124:127], v16 offset:12288
  s_waitcnt lgkmcnt(6)
  v_mfma_f32_16x16x32_bf16 v[72:75], v[128:131], v[132:135], 0
  v_mfma_f32_16x16x32_bf16 v[100:103], v[128:131], v[172:175], 0
  ds_read_b128 v[128:131], v16 offset:13312
  buffer_load_dwordx4 v[148:151], v45, s[8:11], s68 offen sc1
  buffer_load_dwordx4 v[188:191], v45, s[8:11], s69 offen sc1
  buffer_load_dwordx4 v[152:155], v45, s[8:11], s68 offen offset:1024 sc1
  buffer_load_dwordx4 v[192:195], v45, s[8:11], s69 offen offset:1024 sc1
  s_waitcnt vmcnt(9) lgkmcnt(6)
  v_mfma_f32_16x16x32_bf16 v[48:51], v[104:107], v[136:139], v[48:51]
  s_waitcnt vmcnt(8)
  v_mfma_f32_16x16x32_bf16 v[76:79], v[104:107], v[176:179], v[76:79]
  ds_read_b128 v[104:107], v16 offset:14336
  s_waitcnt lgkmcnt(6)
  v_mfma_f32_16x16x32_bf16 v[52:55], v[108:111], v[136:139], v[52:55]
  v_mfma_f32_16x16x32_bf16 v[80:83], v[108:111], v[176:179], v[80:83]
  ds_read_b128 v[108:111], v16 offset:15360
  s_waitcnt lgkmcnt(6)
  v_mfma_f32_16x16x32_bf16 v[56:59], v[112:115], v[136:139], v[56:59]
  v_mfma_f32_16x16x32_bf16 v[84:87], v[112:115], v[176:179], v[84:87]
  ds_read_b128 v[112:115], v16 offset:16384
  s_waitcnt lgkmcnt(6)
  v_mfma_f32_16x16x32_bf16 v[60:63], v[116:119], v[136:139], v[60:63]
  v_mfma_f32_16x16x32_bf16 v[88:91], v[116:119], v[176:179], v[88:91]
  ds_read_b128 v[116:119], v16 offset:17408
  s_waitcnt lgkmcnt(6)
  v_mfma_f32_16x16x32_bf16 v[64:67], v[120:123], v[136:139], v[64:67]
  v_mfma_f32_16x16x32_bf16 v[92:95], v[120:123], v[176:179], v[92:95]
  ds_read_b128 v[120:123], v16 offset:18432
  s_waitcnt lgkmcnt(6)
  v_mfma_f32_16x16x32_bf16 v[68:71], v[124:127], v[136:139], v[68:71]
  v_mfma_f32_16x16x32_bf16 v[96:99], v[124:127], v[176:179], v[96:99]
  ds_read_b128 v[124:127], v16 offset:19456
  s_waitcnt lgkmcnt(6)
  v_mfma_f32_16x16x32_bf16 v[72:75], v[128:131], v[136:139], v[72:75]
  v_mfma_f32_16x16x32_bf16 v[100:103], v[128:131], v[176:179], v[100:103]
  ds_read_b128 v[128:131], v16 offset:20480
  buffer_load_dwordx4 v[156:159], v45, s[8:11], s68 offen offset:2048 sc1
  buffer_load_dwordx4 v[196:199], v45, s[8:11], s69 offen offset:2048 sc1
  buffer_load_dwordx4 v[160:163], v45, s[8:11], s68 offen offset:3072 sc1
  buffer_load_dwordx4 v[200:203], v45, s[8:11], s69 offen offset:3072 sc1
  s_add_u32 s68, s68, 4096
  s_add_u32 s69, s69, 4096
  s_waitcnt vmcnt(11) lgkmcnt(6)
  v_mfma_f32_16x16x32_bf16 v[48:51], v[104:107], v[140:143], v[48:51]
  s_waitcnt vmcnt(10)
  v_mfma_f32_16x16x32_bf16 v[76:79], v[104:107], v[180:183], v[76:79]
  ds_read_b128 v[104:107], v16 offset:21504
  s_waitcnt lgkmcnt(6)
  v_mfma_f32_16x16x32_bf16 v[52:55], v[108:111], v[140:143], v[52:55]
  v_mfma_f32_16x16x32_bf16 v[80:83], v[108:111], v[180:183], v[80:83]
  ds_read_b128 v[108:111], v16 offset:22528
  s_waitcnt lgkmcnt(6)
  v_mfma_f32_16x16x32_bf16 v[56:59], v[112:115], v[140:143], v[56:59]
  v_mfma_f32_16x16x32_bf16 v[84:87], v[112:115], v[180:183], v[84:87]
  ds_read_b128 v[112:115], v16 offset:23552
  s_waitcnt lgkmcnt(6)
  v_mfma_f32_16x16x32_bf16 v[60:63], v[116:119], v[140:143], v[60:63]
  v_mfma_f32_16x16x32_bf16 v[88:91], v[116:119], v[180:183], v[88:91]
  ds_read_b128 v[116:119], v16 offset:24576
  s_waitcnt lgkmcnt(6)
  v_mfma_f32_16x16x32_bf16 v[64:67], v[120:123], v[140:143], v[64:67]
  v_mfma_f32_16x16x32_bf16 v[92:95], v[120:123], v[180:183], v[92:95]
  ds_read_b128 v[120:123], v16 offset:25600
  s_waitcnt lgkmcnt(6)
  v_mfma_f32_16x16x32_bf16 v[68:71], v[124:127], v[140:143], v[68:71]
  v_mfma_f32_16x16x32_bf16 v[96:99], v[124:127], v[180:183], v[96:99]
  ds_read_b128 v[124:127], v16 offset:26624
  s_waitcnt lgkmcnt(6)
  v_mfma_f32_16x16x32_bf16 v[72:75], v[128:131], v[140:143], v[72:75]
  v_mfma_f32_16x16x32_bf16 v[100:103], v[128:131], v[180:183], v[100:103]
  ds_read_b128 v[128:131], v16 offset:27648
  buffer_load_dwordx4 v[164:167], v45, s[8:11], s68 offen sc1
  buffer_load_dwordx4 v[204:207], v45, s[8:11], s69 offen sc1
  buffer_load_dwordx4 v[168:171], v45, s[8:11], s68 offen offset:1024 sc1
  buffer_load_dwordx4 v[208:211], v45, s[8:11], s69 offen offset:1024 sc1
  s_waitcnt vmcnt(13) lgkmcnt(6)
  v_mfma_f32_16x16x32_bf16 v[48:51], v[104:107], v[144:147], v[48:51]
  s_waitcnt vmcnt(12)
  v_mfma_f32_16x16x32_bf16 v[76:79], v[104:107], v[184:187], v[76:79]
  ds_read_b128 v[104:107], v16 offset:28672
  s_waitcnt lgkmcnt(6)
  v_mfma_f32_16x16x32_bf16 v[52:55], v[108:111], v[144:147], v[52:55]
  v_mfma_f32_16x16x32_bf16 v[80:83], v[108:111], v[184:187], v[80:83]
  ds_read_b128 v[108:111], v16 offset:29696
  s_waitcnt lgkmcnt(6)
  v_mfma_f32_16x16x32_bf16 v[56:59], v[112:115], v[144:147], v[56:59]
  v_mfma_f32_16x16x32_bf16 v[84:87], v[112:115], v[184:187], v[84:87]
  ds_read_b128 v[112:115], v16 offset:30720
  s_waitcnt lgkmcnt(6)
  v_mfma_f32_16x16x32_bf16 v[60:63], v[116:119], v[144:147], v[60:63]
  v_mfma_f32_16x16x32_bf16 v[88:91], v[116:119], v[184:187], v[88:91]
  ds_read_b128 v[116:119], v16 offset:31744
  s_waitcnt lgkmcnt(6)
  v_mfma_f32_16x16x32_bf16 v[64:67], v[120:123], v[144:147], v[64:67]
  v_mfma_f32_16x16x32_bf16 v[92:95], v[120:123], v[184:187], v[92:95]
  ds_read_b128 v[120:123], v16 offset:32768
  s_waitcnt lgkmcnt(6)
  v_mfma_f32_16x16x32_bf16 v[68:71], v[124:127], v[144:147], v[68:71]
  v_mfma_f32_16x16x32_bf16 v[96:99], v[124:127], v[184:187], v[96:99]
  ds_read_b128 v[124:127], v16 offset:33792
  s_waitcnt lgkmcnt(6)
  v_mfma_f32_16x16x32_bf16 v[72:75], v[128:131], v[144:147], v[72:75]
  v_mfma_f32_16x16x32_bf16 v[100:103], v[128:131], v[184:187], v[100:103]
  ds_read_b128 v[128:131], v16 offset:34816
  buffer_load_dwordx4 v[132:135], v45, s[8:11], s68 offen offset:2048 sc1
  buffer_load_dwordx4 v[172:175], v45, s[8:11], s69 offen offset:2048 sc1
  buffer_load_dwordx4 v[136:139], v45, s[8:11], s68 offen offset:3072 sc1
  buffer_load_dwordx4 v[176:179], v45, s[8:11], s69 offen offset:3072 sc1
  s_add_u32 s68, s68, 4096
  s_add_u32 s69, s69, 4096
  v_mov_b32 v10, 31
  ds_write_b32 v11, v10 offset:16
  s_waitcnt vmcnt(15) lgkmcnt(7)
  v_mfma_f32_16x16x32_bf16 v[48:51], v[104:107], v[148:151], v[48:51]
  s_waitcnt vmcnt(14)
  v_mfma_f32_16x16x32_bf16 v[76:79], v[104:107], v[188:191], v[76:79]
  ds_read_b128 v[104:107], v16 offset:35840
  s_waitcnt lgkmcnt(7)
  v_mfma_f32_16x16x32_bf16 v[52:55], v[108:111], v[148:151], v[52:55]
  v_mfma_f32_16x16x32_bf16 v[80:83], v[108:111], v[188:191], v[80:83]
  ds_read_b128 v[108:111], v16 offset:36864
  s_waitcnt lgkmcnt(7)
  v_mfma_f32_16x16x32_bf16 v[56:59], v[112:115], v[148:151], v[56:59]
  v_mfma_f32_16x16x32_bf16 v[84:87], v[112:115], v[188:191], v[84:87]
  ds_read_b128 v[112:115], v16 offset:37888
  s_waitcnt lgkmcnt(7)
  v_mfma_f32_16x16x32_bf16 v[60:63], v[116:119], v[148:151], v[60:63]
  v_mfma_f32_16x16x32_bf16 v[88:91], v[116:119], v[188:191], v[88:91]
  ds_read_b128 v[116:119], v16 offset:38912
  s_waitcnt lgkmcnt(7)
  v_mfma_f32_16x16x32_bf16 v[64:67], v[120:123], v[148:151], v[64:67]
  v_mfma_f32_16x16x32_bf16 v[92:95], v[120:123], v[188:191], v[92:95]
  ds_read_b128 v[120:123], v16 offset:39936
  s_waitcnt lgkmcnt(7)
  v_mfma_f32_16x16x32_bf16 v[68:71], v[124:127], v[148:151], v[68:71]
  v_mfma_f32_16x16x32_bf16 v[96:99], v[124:127], v[188:191], v[96:99]
  ds_read_b128 v[124:127], v16 offset:40960
  s_waitcnt lgkmcnt(7)
  v_mfma_f32_16x16x32_bf16 v[72:75], v[128:131], v[148:151], v[72:75]
  v_mfma_f32_16x16x32_bf16 v[100:103], v[128:131], v[188:191], v[100:103]
  ds_read_b128 v[128:131], v16 offset:41984
  buffer_load_dwordx4 v[140:143], v45, s[8:11], s68 offen sc1
  buffer_load_dwordx4 v[180:183], v45, s[8:11], s69 offen sc1
  buffer_load_dwordx4 v[144:147], v45, s[8:11], s68 offen offset:1024 sc1
  buffer_load_dwordx4 v[184:187], v45, s[8:11], s69 offen offset:1024 sc1
  s_waitcnt vmcnt(17) lgkmcnt(6)
  v_mfma_f32_16x16x32_bf16 v[48:51], v[104:107], v[152:155], v[48:51]
  s_waitcnt vmcnt(16)
  v_mfma_f32_16x16x32_bf16 v[76:79], v[104:107], v[192:195], v[76:79]
  ds_read_b128 v[104:107], v16 offset:43008
  s_waitcnt lgkmcnt(6)
  v_mfma_f32_16x16x32_bf16 v[52:55], v[108:111], v[152:155], v[52:55]
  v_mfma_f32_16x16x32_bf16 v[80:83], v[108:111], v[192:195], v[80:83]
  ds_read_b128 v[108:111], v16 offset:44032
  s_waitcnt lgkmcnt(6)
  v_mfma_f32_16x16x32_bf16 v[56:59], v[112:115], v[152:155], v[56:59]
  v_mfma_f32_16x16x32_bf16 v[84:87], v[112:115], v[192:195], v[84:87]
  ds_read_b128 v[112:115], v16 offset:45056
  s_waitcnt lgkmcnt(6)
  v_mfma_f32_16x16x32_bf16 v[60:63], v[116:119], v[152:155], v[60:63]
  v_mfma_f32_16x16x32_bf16 v[88:91], v[116:119], v[192:195], v[88:91]
  ds_read_b128 v[116:119], v16 offset:46080
  s_waitcnt lgkmcnt(6)
  v_mfma_f32_16x16x32_bf16 v[64:67], v[120:123], v[152:155], v[64:67]
  v_mfma_f32_16x16x32_bf16 v[92:95], v[120:123], v[192:195], v[92:95]
  ds_read_b128 v[120:123], v16 offset:47104
  s_waitcnt lgkmcnt(6)
  v_mfma_f32_16x16x32_bf16 v[68:71], v[124:127], v[152:155], v[68:71]
  v_mfma_f32_16x16x32_bf16 v[96:99], v[124:127], v[192:195], v[96:99]
  ds_read_b128 v[124:127], v16 offset:48128
  s_waitcnt lgkmcnt(6)
  v_mfma_f32_16x16x32_bf16 v[72:75], v[128:131], v[152:155], v[72:75]
  v_mfma_f32_16x16x32_bf16 v[100:103], v[128:131], v[192:195], v[100:103]
  ds_read_b128 v[128:131], v16 offset:49152
  buffer_load_dwordx4 v[148:151], v45, s[8:11], s68 offen offset:2048 sc1
  buffer_load_dwordx4 v[188:191], v45, s[8:11], s69 offen offset:2048 sc1
  buffer_load_dwordx4 v[152:155], v45, s[8:11], s68 offen offset:3072 sc1
  buffer_load_dwordx4 v[192:195], v45, s[8:11], s69 offen offset:3072 sc1
  s_add_u32 s68, s68, 4096
  s_add_u32 s69, s69, 4096
  v_add_f32 v20, v20, v22
  v_add_f32 v21, v21, v23
  v_mov_b32 v22, v20
  s_nop 1
  v_permlane32_swap_b32 v22, v20
  v_add_f32 v20, v20, v22
  v_mov_b32 v22, v20
  s_nop 1
  v_permlane16_swap_b32 v22, v20
  v_add_f32 v20, v20, v22
  v_mov_b32 v23, v21
  s_nop 1
  v_permlane32_swap_b32 v23, v21
  v_add_f32 v21, v21, v23
  v_mov_b32 v23, v21
  s_nop 1
  v_permlane16_swap_b32 v23, v21
  v_add_f32 v21, v21, v23
  v_mul_f32 v40, 0x3acccccd, v20
  v_mul_f32 v41, 0x3acccccd, v21
  v_fma_f32 v41, -v40, v40, v41
  v_max_f32 v41, 0, v41
  v_cvt_pk_bf16_f32 v37, v40, v40
  v_lshlrev_b32 v37, 16, v37
  v_cvt_pk_bf16_f32 v42, v41, v41
  v_lshlrev_b32 v42, 16, v42
  v_add_f32 v42, 0x3727c5ac, v42
  v_cvt_pk_bf16_f32 v42, v42, v42
  v_lshlrev_b32 v42, 16, v42
  v_sqrt_f32 v42, v42
  s_nop 0
  v_cvt_pk_bf16_f32 v42, v42, v42
  v_lshlrev_b32 v42, 16, v42
  v_rcp_f32 v36, v42
  s_nop 0
  v_mul_f32 v37, v37, v36
  s_waitcnt vmcnt(19) lgkmcnt(6)
  v_mfma_f32_16x16x32_bf16 v[48:51], v[104:107], v[156:159], v[48:51]
  s_waitcnt vmcnt(18)
  v_mfma_f32_16x16x32_bf16 v[76:79], v[104:107], v[196:199], v[76:79]
  ds_read_b128 v[104:107], v16 offset:50176
  s_waitcnt lgkmcnt(6)
  v_mfma_f32_16x16x32_bf16 v[52:55], v[108:111], v[156:159], v[52:55]
  v_mfma_f32_16x16x32_bf16 v[80:83], v[108:111], v[196:199], v[80:83]
  ds_read_b128 v[108:111], v16 offset:51200
  s_waitcnt lgkmcnt(6)
  v_mfma_f32_16x16x32_bf16 v[56:59], v[112:115], v[156:159], v[56:59]
  v_mfma_f32_16x16x32_bf16 v[84:87], v[112:115], v[196:199], v[84:87]
  ds_read_b128 v[112:115], v16 offset:52224
  s_waitcnt lgkmcnt(6)
  v_mfma_f32_16x16x32_bf16 v[60:63], v[116:119], v[156:159], v[60:63]
  v_mfma_f32_16x16x32_bf16 v[88:91], v[116:119], v[196:199], v[88:91]
  ds_read_b128 v[116:119], v16 offset:53248
  s_waitcnt lgkmcnt(6)
  v_mfma_f32_16x16x32_bf16 v[64:67], v[120:123], v[156:159], v[64:67]
  v_mfma_f32_16x16x32_bf16 v[92:95], v[120:123], v[196:199], v[92:95]
  ds_read_b128 v[120:123], v16 offset:54272
  s_waitcnt lgkmcnt(6)
  v_mfma_f32_16x16x32_bf16 v[68:71], v[124:127], v[156:159], v[68:71]
  v_mfma_f32_16x16x32_bf16 v[96:99], v[124:127], v[196:199], v[96:99]
  ds_read_b128 v[124:127], v16 offset:55296
  s_waitcnt lgkmcnt(6)
  v_mfma_f32_16x16x32_bf16 v[72:75], v[128:131], v[156:159], v[72:75]
  v_mfma_f32_16x16x32_bf16 v[100:103], v[128:131], v[196:199], v[100:103]
  ds_read_b128 v[128:131], v16 offset:56320
  buffer_load_dwordx4 v[156:159], v45, s[8:11], s68 offen sc1
  buffer_load_dwordx4 v[196:199], v45, s[8:11], s69 offen sc1
  v_add_f32 v24, v24, v26
  v_add_f32 v25, v25, v27
  v_mov_b32 v26, v24
  s_nop 1
  v_permlane32_swap_b32 v26, v24
  v_add_f32 v24, v24, v26
  v_mov_b32 v26, v24
  s_nop 1
  v_permlane16_swap_b32 v26, v24
  v_add_f32 v24, v24, v26
  v_mov_b32 v27, v25
  s_nop 1
  v_permlane32_swap_b32 v27, v25
  v_add_f32 v25, v25, v27
  v_mov_b32 v27, v25
  s_nop 1
  v_permlane16_swap_b32 v27, v25
  v_add_f32 v25, v25, v27
  v_mul_f32 v40, 0x3acccccd, v24
  v_mul_f32 v41, 0x3acccccd, v25
  v_fma_f32 v41, -v40, v40, v41
  v_max_f32 v41, 0, v41
  v_cvt_pk_bf16_f32 v39, v40, v40
  v_lshlrev_b32 v39, 16, v39
  v_cvt_pk_bf16_f32 v42, v41, v41
  v_lshlrev_b32 v42, 16, v42
  v_add_f32 v42, 0x3727c5ac, v42
  v_cvt_pk_bf16_f32 v42, v42, v42
  v_lshlrev_b32 v42, 16, v42
  v_sqrt_f32 v42, v42
  s_nop 0
  v_cvt_pk_bf16_f32 v42, v42, v42
  v_lshlrev_b32 v42, 16, v42
  v_rcp_f32 v38, v42
  s_nop 0
  v_mul_f32 v39, v39, v38
  v_subrev_u32 v16, 102400, v16
  s_waitcnt vmcnt(19) lgkmcnt(6)
  v_mfma_f32_16x16x32_bf16 v[48:51], v[104:107], v[160:163], v[48:51]
  s_waitcnt vmcnt(18)
  v_mfma_f32_16x16x32_bf16 v[76:79], v[104:107], v[200:203], v[76:79]
  ds_read_b128 v[104:107], v16
  s_waitcnt lgkmcnt(6)
  v_mfma_f32_16x16x32_bf16 v[52:55], v[108:111], v[160:163], v[52:55]
  v_mfma_f32_16x16x32_bf16 v[80:83], v[108:111], v[200:203], v[80:83]
  ds_read_b128 v[108:111], v16 offset:1024
  s_waitcnt lgkmcnt(6)
  v_mfma_f32_16x16x32_bf16 v[56:59], v[112:115], v[160:163], v[56:59]
  v_mfma_f32_16x16x32_bf16 v[84:87], v[112:115], v[200:203], v[84:87]
  ds_read_b128 v[112:115], v16 offset:2048
  s_waitcnt lgkmcnt(6)
  v_mfma_f32_16x16x32_bf16 v[60:63], v[116:119], v[160:163], v[60:63]
  v_mfma_f32_16x16x32_bf16 v[88:91], v[116:119], v[200:203], v[88:91]
  ds_read_b128 v[116:119], v16 offset:3072
  s_waitcnt lgkmcnt(6)
  v_mfma_f32_16x16x32_bf16 v[64:67], v[120:123], v[160:163], v[64:67]
  v_mfma_f32_16x16x32_bf16 v[92:95], v[120:123], v[200:203], v[92:95]
  ds_read_b128 v[120:123], v16 offset:4096
  s_waitcnt lgkmcnt(6)
  v_mfma_f32_16x16x32_bf16 v[68:71], v[124:127], v[160:163], v[68:71]
  v_mfma_f32_16x16x32_bf16 v[96:99], v[124:127], v[200:203], v[96:99]
  ds_read_b128 v[124:127], v16 offset:5120
  s_waitcnt lgkmcnt(6)
  v_mfma_f32_16x16x32_bf16 v[72:75], v[128:131], v[160:163], v[72:75]
  v_mfma_f32_16x16x32_bf16 v[100:103], v[128:131], v[200:203], v[100:103]
  ds_read_b128 v[128:131], v16 offset:6144
  buffer_load_dwordx4 v[160:163], v45, s[8:11], s68 offen offset:1024 sc1
  buffer_load_dwordx4 v[200:203], v45, s[8:11], s69 offen offset:1024 sc1
  v_mov_b32 v10, 32
  ds_write_b32 v11, v10 offset:16
  s_waitcnt vmcnt(19) lgkmcnt(7)
  v_mfma_f32_16x16x32_bf16 v[48:51], v[104:107], v[164:167], v[48:51]
  s_waitcnt vmcnt(18)
  v_mfma_f32_16x16x32_bf16 v[76:79], v[104:107], v[204:207], v[76:79]
  ds_read_b128 v[104:107], v16 offset:7168
  s_waitcnt lgkmcnt(7)
  v_mfma_f32_16x16x32_bf16 v[52:55], v[108:111], v[164:167], v[52:55]
  v_mfma_f32_16x16x32_bf16 v[80:83], v[108:111], v[204:207], v[80:83]
  ds_read_b128 v[108:111], v16 offset:8192
  s_waitcnt lgkmcnt(7)
  v_mfma_f32_16x16x32_bf16 v[56:59], v[112:115], v[164:167], v[56:59]
  v_mfma_f32_16x16x32_bf16 v[84:87], v[112:115], v[204:207], v[84:87]
  ds_read_b128 v[112:115], v16 offset:9216
  s_waitcnt lgkmcnt(7)
  v_mfma_f32_16x16x32_bf16 v[60:63], v[116:119], v[164:167], v[60:63]
  v_mfma_f32_16x16x32_bf16 v[88:91], v[116:119], v[204:207], v[88:91]
  ds_read_b128 v[116:119], v16 offset:10240
  s_waitcnt lgkmcnt(7)
  v_mfma_f32_16x16x32_bf16 v[64:67], v[120:123], v[164:167], v[64:67]
  v_mfma_f32_16x16x32_bf16 v[92:95], v[120:123], v[204:207], v[92:95]
  ds_read_b128 v[120:123], v16 offset:11264
  s_waitcnt lgkmcnt(7)
  v_mfma_f32_16x16x32_bf16 v[68:71], v[124:127], v[164:167], v[68:71]
  v_mfma_f32_16x16x32_bf16 v[96:99], v[124:127], v[204:207], v[96:99]
  ds_read_b128 v[124:127], v16 offset:12288
  s_waitcnt lgkmcnt(7)
  v_mfma_f32_16x16x32_bf16 v[72:75], v[128:131], v[164:167], v[72:75]
  v_mfma_f32_16x16x32_bf16 v[100:103], v[128:131], v[204:207], v[100:103]
  ds_read_b128 v[128:131], v16 offset:13312
  buffer_load_dwordx4 v[164:167], v45, s[8:11], s68 offen offset:2048 sc1
  buffer_load_dwordx4 v[204:207], v45, s[8:11], s69 offen offset:2048 sc1
  s_waitcnt vmcnt(19) lgkmcnt(6)
  v_mfma_f32_16x16x32_bf16 v[48:51], v[104:107], v[168:171], v[48:51]
  s_waitcnt vmcnt(18)
  v_mfma_f32_16x16x32_bf16 v[76:79], v[104:107], v[208:211], v[76:79]
  ds_read_b128 v[104:107], v16 offset:14336
  s_waitcnt lgkmcnt(6)
  v_mfma_f32_16x16x32_bf16 v[52:55], v[108:111], v[168:171], v[52:55]
  v_mfma_f32_16x16x32_bf16 v[80:83], v[108:111], v[208:211], v[80:83]
  ds_read_b128 v[108:111], v16 offset:15360
  s_waitcnt lgkmcnt(6)
  v_mfma_f32_16x16x32_bf16 v[56:59], v[112:115], v[168:171], v[56:59]
  v_mfma_f32_16x16x32_bf16 v[84:87], v[112:115], v[208:211], v[84:87]
  ds_read_b128 v[112:115], v16 offset:16384
  s_waitcnt lgkmcnt(6)
  v_mfma_f32_16x16x32_bf16 v[60:63], v[116:119], v[168:171], v[60:63]
  v_mfma_f32_16x16x32_bf16 v[88:91], v[116:119], v[208:211], v[88:91]
  ds_read_b128 v[116:119], v16 offset:17408
  s_waitcnt lgkmcnt(6)
  v_mfma_f32_16x16x32_bf16 v[64:67], v[120:123], v[168:171], v[64:67]
  v_mfma_f32_16x16x32_bf16 v[92:95], v[120:123], v[208:211], v[92:95]
  ds_read_b128 v[120:123], v16 offset:18432
  s_waitcnt lgkmcnt(6)
  v_mfma_f32_16x16x32_bf16 v[68:71], v[124:127], v[168:171], v[68:71]
  v_mfma_f32_16x16x32_bf16 v[96:99], v[124:127], v[208:211], v[96:99]
  ds_read_b128 v[124:127], v16 offset:19456
  s_waitcnt lgkmcnt(6)
  v_mfma_f32_16x16x32_bf16 v[72:75], v[128:131], v[168:171], v[72:75]
  v_mfma_f32_16x16x32_bf16 v[100:103], v[128:131], v[208:211], v[100:103]
  ds_read_b128 v[128:131], v16 offset:20480
  buffer_load_dwordx4 v[168:171], v45, s[8:11], s68 offen offset:3072 sc1
  buffer_load_dwordx4 v[208:211], v45, s[8:11], s69 offen offset:3072 sc1
  s_add_u32 s68, s68, 4096
  s_add_u32 s69, s69, 4096
  s_waitcnt vmcnt(19) lgkmcnt(6)
  v_mfma_f32_16x16x32_bf16 v[48:51], v[104:107], v[132:135], v[48:51]
  s_waitcnt vmcnt(18)
  v_mfma_f32_16x16x32_bf16 v[76:79], v[104:107], v[172:175], v[76:79]
  ds_read_b128 v[104:107], v16 offset:21504
  s_waitcnt lgkmcnt(6)
  v_mfma_f32_16x16x32_bf16 v[52:55], v[108:111], v[132:135], v[52:55]
  v_mfma_f32_16x16x32_bf16 v[80:83], v[108:111], v[172:175], v[80:83]
  ds_read_b128 v[108:111], v16 offset:22528
  s_waitcnt lgkmcnt(6)
  v_mfma_f32_16x16x32_bf16 v[56:59], v[112:115], v[132:135], v[56:59]
  v_mfma_f32_16x16x32_bf16 v[84:87], v[112:115], v[172:175], v[84:87]
  ds_read_b128 v[112:115], v16 offset:23552
  s_waitcnt lgkmcnt(6)
  v_mfma_f32_16x16x32_bf16 v[60:63], v[116:119], v[132:135], v[60:63]
  v_mfma_f32_16x16x32_bf16 v[88:91], v[116:119], v[172:175], v[88:91]
  ds_read_b128 v[116:119], v16 offset:24576
  s_waitcnt lgkmcnt(6)
  v_mfma_f32_16x16x32_bf16 v[64:67], v[120:123], v[132:135], v[64:67]
  v_mfma_f32_16x16x32_bf16 v[92:95], v[120:123], v[172:175], v[92:95]
  ds_read_b128 v[120:123], v16 offset:25600
  s_waitcnt lgkmcnt(6)
  v_mfma_f32_16x16x32_bf16 v[68:71], v[124:127], v[132:135], v[68:71]
  v_mfma_f32_16x16x32_bf16 v[96:99], v[124:127], v[172:175], v[96:99]
  ds_read_b128 v[124:127], v16 offset:26624
  s_waitcnt lgkmcnt(6)
  v_mfma_f32_16x16x32_bf16 v[72:75], v[128:131], v[132:135], v[72:75]
  v_mfma_f32_16x16x32_bf16 v[100:103], v[128:131], v[172:175], v[100:103]
  ds_read_b128 v[128:131], v16 offset:27648
  s_waitcnt vmcnt(17) lgkmcnt(6)
  v_mfma_f32_16x16x32_bf16 v[48:51], v[104:107], v[136:139], v[48:51]
  s_waitcnt vmcnt(16)
  v_mfma_f32_16x16x32_bf16 v[76:79], v[104:107], v[176:179], v[76:79]
  ds_read_b128 v[104:107], v16 offset:28672
  s_waitcnt lgkmcnt(6)
  v_mfma_f32_16x16x32_bf16 v[52:55], v[108:111], v[136:139], v[52:55]
  v_mfma_f32_16x16x32_bf16 v[80:83], v[108:111], v[176:179], v[80:83]
  ds_read_b128 v[108:111], v16 offset:29696
  s_waitcnt lgkmcnt(6)
  v_mfma_f32_16x16x32_bf16 v[56:59], v[112:115], v[136:139], v[56:59]
  v_mfma_f32_16x16x32_bf16 v[84:87], v[112:115], v[176:179], v[84:87]
  ds_read_b128 v[112:115], v16 offset:30720
  s_waitcnt lgkmcnt(6)
  v_mfma_f32_16x16x32_bf16 v[60:63], v[116:119], v[136:139], v[60:63]
  v_mfma_f32_16x16x32_bf16 v[88:91], v[116:119], v[176:179], v[88:91]
  ds_read_b128 v[116:119], v16 offset:31744
  s_waitcnt lgkmcnt(6)
  v_mfma_f32_16x16x32_bf16 v[64:67], v[120:123], v[136:139], v[64:67]
  v_mfma_f32_16x16x32_bf16 v[92:95], v[120:123], v[176:179], v[92:95]
  ds_read_b128 v[120:123], v16 offset:32768
  s_waitcnt lgkmcnt(6)
  v_mfma_f32_16x16x32_bf16 v[68:71], v[124:127], v[136:139], v[68:71]
  v_mfma_f32_16x16x32_bf16 v[96:99], v[124:127], v[176:179], v[96:99]
  ds_read_b128 v[124:127], v16 offset:33792
  s_waitcnt lgkmcnt(6)
  v_mfma_f32_16x16x32_bf16 v[72:75], v[128:131], v[136:139], v[72:75]
  v_mfma_f32_16x16x32_bf16 v[100:103], v[128:131], v[176:179], v[100:103]
  ds_read_b128 v[128:131], v16 offset:34816
  v_mov_b32 v10, 33
  ds_write_b32 v11, v10 offset:16
  s_waitcnt vmcnt(15) lgkmcnt(7)
  v_mfma_f32_16x16x32_bf16 v[48:51], v[104:107], v[140:143], v[48:51]
  s_waitcnt vmcnt(14)
  v_mfma_f32_16x16x32_bf16 v[76:79], v[104:107], v[180:183], v[76:79]
  ds_read_b128 v[104:107], v16 offset:35840
  s_waitcnt lgkmcnt(7)
  v_mfma_f32_16x16x32_bf16 v[52:55], v[108:111], v[140:143], v[52:55]
  v_mfma_f32_16x16x32_bf16 v[80:83], v[108:111], v[180:183], v[80:83]
  ds_read_b128 v[108:111], v16 offset:36864
  s_waitcnt lgkmcnt(7)
  v_mfma_f32_16x16x32_bf16 v[56:59], v[112:115], v[140:143], v[56:59]
  v_mfma_f32_16x16x32_bf16 v[84:87], v[112:115], v[180:183], v[84:87]
  ds_read_b128 v[112:115], v16 offset:37888
  s_waitcnt lgkmcnt(7)
  v_mfma_f32_16x16x32_bf16 v[60:63], v[116:119], v[140:143], v[60:63]
  v_mfma_f32_16x16x32_bf16 v[88:91], v[116:119], v[180:183], v[88:91]
  ds_read_b128 v[116:119], v16 offset:38912
  s_waitcnt lgkmcnt(7)
  v_mfma_f32_16x16x32_bf16 v[64:67], v[120:123], v[140:143], v[64:67]
  v_mfma_f32_16x16x32_bf16 v[92:95], v[120:123], v[180:183], v[92:95]
  ds_read_b128 v[120:123], v16 offset:39936
  s_waitcnt lgkmcnt(7)
  v_mfma_f32_16x16x32_bf16 v[68:71], v[124:127], v[140:143], v[68:71]
  v_mfma_f32_16x16x32_bf16 v[96:99], v[124:127], v[180:183], v[96:99]
  ds_read_b128 v[124:127], v16 offset:40960
  s_waitcnt lgkmcnt(7)
  v_mfma_f32_16x16x32_bf16 v[72:75], v[128:131], v[140:143], v[72:75]
  v_mfma_f32_16x16x32_bf16 v[100:103], v[128:131], v[180:183], v[100:103]
  ds_read_b128 v[128:131], v16 offset:41984
  s_waitcnt vmcnt(13) lgkmcnt(6)
  v_mfma_f32_16x16x32_bf16 v[48:51], v[104:107], v[144:147], v[48:51]
  s_waitcnt vmcnt(12)
  v_mfma_f32_16x16x32_bf16 v[76:79], v[104:107], v[184:187], v[76:79]
  ds_read_b128 v[104:107], v16 offset:43008
  s_waitcnt lgkmcnt(6)
  v_mfma_f32_16x16x32_bf16 v[52:55], v[108:111], v[144:147], v[52:55]
  v_mfma_f32_16x16x32_bf16 v[80:83], v[108:111], v[184:187], v[80:83]
  ds_read_b128 v[108:111], v16 offset:44032
  s_waitcnt lgkmcnt(6)
  v_mfma_f32_16x16x32_bf16 v[56:59], v[112:115], v[144:147], v[56:59]
  v_mfma_f32_16x16x32_bf16 v[84:87], v[112:115], v[184:187], v[84:87]
  ds_read_b128 v[112:115], v16 offset:45056
  s_waitcnt lgkmcnt(6)
  v_mfma_f32_16x16x32_bf16 v[60:63], v[116:119], v[144:147], v[60:63]
  v_mfma_f32_16x16x32_bf16 v[88:91], v[116:119], v[184:187], v[88:91]
  ds_read_b128 v[116:119], v16 offset:46080
  s_waitcnt lgkmcnt(6)
  v_mfma_f32_16x16x32_bf16 v[64:67], v[120:123], v[144:147], v[64:67]
  v_mfma_f32_16x16x32_bf16 v[92:95], v[120:123], v[184:187], v[92:95]
  ds_read_b128 v[120:123], v16 offset:47104
  s_waitcnt lgkmcnt(6)
  v_mfma_f32_16x16x32_bf16 v[68:71], v[124:127], v[144:147], v[68:71]
  v_mfma_f32_16x16x32_bf16 v[96:99], v[124:127], v[184:187], v[96:99]
  ds_read_b128 v[124:127], v16 offset:48128
  s_waitcnt lgkmcnt(6)
  v_mfma_f32_16x16x32_bf16 v[72:75], v[128:131], v[144:147], v[72:75]
  v_mfma_f32_16x16x32_bf16 v[100:103], v[128:131], v[184:187], v[100:103]
  ds_read_b128 v[128:131], v16 offset:49152
  s_waitcnt vmcnt(11) lgkmcnt(6)
  v_mfma_f32_16x16x32_bf16 v[48:51], v[104:107], v[148:151], v[48:51]
  s_waitcnt vmcnt(10)
  v_mfma_f32_16x16x32_bf16 v[76:79], v[104:107], v[188:191], v[76:79]
  ds_read_b128 v[104:107], v16 offset:50176
  s_waitcnt lgkmcnt(6)
  v_mfma_f32_16x16x32_bf16 v[52:55], v[108:111], v[148:151], v[52:55]
  v_mfma_f32_16x16x32_bf16 v[80:83], v[108:111], v[188:191], v[80:83]
  ds_read_b128 v[108:111], v16 offset:51200
  s_waitcnt lgkmcnt(6)
  v_mfma_f32_16x16x32_bf16 v[56:59], v[112:115], v[148:151], v[56:59]
  v_mfma_f32_16x16x32_bf16 v[84:87], v[112:115], v[188:191], v[84:87]
  ds_read_b128 v[112:115], v16 offset:52224
  s_waitcnt lgkmcnt(6)
  v_mfma_f32_16x16x32_bf16 v[60:63], v[116:119], v[148:151], v[60:63]
  v_mfma_f32_16x16x32_bf16 v[88:91], v[116:119], v[188:191], v[88:91]
  ds_read_b128 v[116:119], v16 offset:53248
  s_waitcnt lgkmcnt(6)
  v_mfma_f32_16x16x32_bf16 v[64:67], v[120:123], v[148:151], v[64:67]
  v_mfma_f32_16x16x32_bf16 v[92:95], v[120:123], v[188:191], v[92:95]
  ds_read_b128 v[120:123], v16 offset:54272
  s_waitcnt lgkmcnt(6)
  v_mfma_f32_16x16x32_bf16 v[68:71], v[124:127], v[148:151], v[68:71]
  v_mfma_f32_16x16x32_bf16 v[96:99], v[124:127], v[188:191], v[96:99]
  ds_read_b128 v[124:127], v16 offset:55296
  s_waitcnt lgkmcnt(6)
  v_mfma_f32_16x16x32_bf16 v[72:75], v[128:131], v[148:151], v[72:75]
  v_mfma_f32_16x16x32_bf16 v[100:103], v[128:131], v[188:191], v[100:103]
  ds_read_b128 v[128:131], v16 offset:56320
  s_waitcnt vmcnt(9) lgkmcnt(6)
  v_mfma_f32_16x16x32_bf16 v[48:51], v[104:107], v[152:155], v[48:51]
  s_waitcnt vmcnt(8)
  v_mfma_f32_16x16x32_bf16 v[76:79], v[104:107], v[192:195], v[76:79]
  s_waitcnt lgkmcnt(5)
  v_mfma_f32_16x16x32_bf16 v[52:55], v[108:111], v[152:155], v[52:55]
  v_mfma_f32_16x16x32_bf16 v[80:83], v[108:111], v[192:195], v[80:83]
  s_waitcnt lgkmcnt(4)
  v_mfma_f32_16x16x32_bf16 v[56:59], v[112:115], v[152:155], v[56:59]
  v_mfma_f32_16x16x32_bf16 v[84:87], v[112:115], v[192:195], v[84:87]
  s_waitcnt lgkmcnt(3)
  v_mfma_f32_16x16x32_bf16 v[60:63], v[116:119], v[152:155], v[60:63]
  v_mfma_f32_16x16x32_bf16 v[88:91], v[116:119], v[192:195], v[88:91]
  s_waitcnt lgkmcnt(2)
  v_mfma_f32_16x16x32_bf16 v[64:67], v[120:123], v[152:155], v[64:67]
  v_mfma_f32_16x16x32_bf16 v[92:95], v[120:123], v[192:195], v[92:95]
  s_waitcnt lgkmcnt(1)
  v_mfma_f32_16x16x32_bf16 v[68:71], v[124:127], v[152:155], v[68:71]
  v_mfma_f32_16x16x32_bf16 v[96:99], v[124:127], v[192:195], v[96:99]
  s_waitcnt lgkmcnt(0)
  v_mfma_f32_16x16x32_bf16 v[72:75], v[128:131], v[152:155], v[72:75]
  v_mfma_f32_16x16x32_bf16 v[100:103], v[128:131], v[192:195], v[100:103]
  v_mov_b32 v10, 34
  ds_write_b32 v11, v10 offset:16
  s_waitcnt lgkmcnt(0)
  s_mov_b32 s57, 0
L_48:
  ds_read_b128 v[12:15], v8 offset:0
  s_waitcnt lgkmcnt(0)
  v_min3_u32 v12, v12, v13, v14
  v_min_u32 v12, v12, v15
  s_nop 0
  v_readfirstlane_b32 s56, v12
  s_nop 3
  s_cmp_ge_u32 s56, 35
  s_cbranch_scc1 L_49
  s_add_u32 s57, s57, 1
  s_sleep 1
  s_cmp_lt_u32 s57, 0x400000
  s_cbranch_scc1 L_48
L_49:
  ds_read_b128 v[104:107], v16 offset:57344
  ds_read_b128 v[108:111], v16 offset:58368
  ds_read_b128 v[112:115], v16 offset:59392
  ds_read_b128 v[116:119], v16 offset:60416
  ds_read_b128 v[120:123], v16 offset:61440
  ds_read_b128 v[124:127], v16 offset:62464
  ds_read_b128 v[128:131], v16 offset:63488
  v_add_u32 v16, 64512, v16
  s_waitcnt vmcnt(7) lgkmcnt(6)
  v_mfma_f32_16x16x32_bf16 v[48:51], v[104:107], v[156:159], v[48:51]
  s_waitcnt vmcnt(6)
  v_mfma_f32_16x16x32_bf16 v[76:79], v[104:107], v[196:199], v[76:79]
  ds_read_b128 v[104:107], v16
  s_waitcnt lgkmcnt(6)
  v_mfma_f32_16x16x32_bf16 v[52:55], v[108:111], v[156:159], v[52:55]
  v_mfma_f32_16x16x32_bf16 v[80:83], v[108:111], v[196:199], v[80:83]
  ds_read_b128 v[108:111], v16 offset:1024
  s_waitcnt lgkmcnt(6)
  v_mfma_f32_16x16x32_bf16 v[56:59], v[112:115], v[156:159], v[56:59]
  v_mfma_f32_16x16x32_bf16 v[84:87], v[112:115], v[196:199], v[84:87]
  ds_read_b128 v[112:115], v16 offset:2048
  s_waitcnt lgkmcnt(6)
  v_mfma_f32_16x16x32_bf16 v[60:63], v[116:119], v[156:159], v[60:63]
  v_mfma_f32_16x16x32_bf16 v[88:91], v[116:119], v[196:199], v[88:91]
  ds_read_b128 v[116:119], v16 offset:3072
  s_waitcnt lgkmcnt(6)
  v_mfma_f32_16x16x32_bf16 v[64:67], v[120:123], v[156:159], v[64:67]
  v_mfma_f32_16x16x32_bf16 v[92:95], v[120:123], v[196:199], v[92:95]
  ds_read_b128 v[120:123], v16 offset:4096
  s_waitcnt lgkmcnt(6)
  v_mfma_f32_16x16x32_bf16 v[68:71], v[124:127], v[156:159], v[68:71]
  v_mfma_f32_16x16x32_bf16 v[96:99], v[124:127], v[196:199], v[96:99]
  ds_read_b128 v[124:127], v16 offset:5120
  s_waitcnt lgkmcnt(6)
  v_mfma_f32_16x16x32_bf16 v[72:75], v[128:131], v[156:159], v[72:75]
  v_mfma_f32_16x16x32_bf16 v[100:103], v[128:131], v[196:199], v[100:103]
  ds_read_b128 v[128:131], v16 offset:6144
  s_waitcnt vmcnt(5) lgkmcnt(6)
  v_mfma_f32_16x16x32_bf16 v[48:51], v[104:107], v[160:163], v[48:51]
  s_waitcnt vmcnt(4)
  v_mfma_f32_16x16x32_bf16 v[76:79], v[104:107], v[200:203], v[76:79]
  ds_read_b128 v[104:107], v16 offset:7168
  s_waitcnt lgkmcnt(6)
  v_mfma_f32_16x16x32_bf16 v[52:55], v[108:111], v[160:163], v[52:55]
  v_mfma_f32_16x16x32_bf16 v[80:83], v[108:111], v[200:203], v[80:83]
  ds_read_b128 v[108:111], v16 offset:8192
  s_waitcnt lgkmcnt(6)
  v_mfma_f32_16x16x32_bf16 v[56:59], v[112:115], v[160:163], v[56:59]
  v_mfma_f32_16x16x32_bf16 v[84:87], v[112:115], v[200:203], v[84:87]
  ds_read_b128 v[112:115], v16 offset:9216
  s_waitcnt lgkmcnt(6)
  v_mfma_f32_16x16x32_bf16 v[60:63], v[116:119], v[160:163], v[60:63]
  v_mfma_f32_16x16x32_bf16 v[88:91], v[116:119], v[200:203], v[88:91]
  ds_read_b128 v[116:119], v16 offset:10240
  s_waitcnt lgkmcnt(6)
  v_mfma_f32_16x16x32_bf16 v[64:67], v[120:123], v[160:163], v[64:67]
  v_mfma_f32_16x16x32_bf16 v[92:95], v[120:123], v[200:203], v[92:95]
  ds_read_b128 v[120:123], v16 offset:11264
  s_waitcnt lgkmcnt(6)
  v_mfma_f32_16x16x32_bf16 v[68:71], v[124:127], v[160:163], v[68:71]
  v_mfma_f32_16x16x32_bf16 v[96:99], v[124:127], v[200:203], v[96:99]
  ds_read_b128 v[124:127], v16 offset:12288
  s_waitcnt lgkmcnt(6)
  v_mfma_f32_16x16x32_bf16 v[72:75], v[128:131], v[160:163], v[72:75]
  v_mfma_f32_16x16x32_bf16 v[100:103], v[128:131], v[200:203], v[100:103]
  ds_read_b128 v[128:131], v16 offset:13312
  v_mov_b32 v10, 0
  ds_write_b32 v11, v10 offset:128
  s_waitcnt vmcnt(3) lgkmcnt(7)
  v_mfma_f32_16x16x32_bf16 v[48:51], v[104:107], v[164:167], v[48:51]
  s_waitcnt vmcnt(2)
  v_mfma_f32_16x16x32_bf16 v[76:79], v[104:107], v[204:207], v[76:79]
  ds_read_b128 v[104:107], v16 offset:14336
  s_waitcnt lgkmcnt(7)
  v_mfma_f32_16x16x32_bf16 v[52:55], v[108:111], v[164:167], v[52:55]
  v_mfma_f32_16x16x32_bf16 v[80:83], v[108:111], v[204:207], v[80:83]
  ds_read_b128 v[108:111], v16 offset:15360
  s_waitcnt lgkmcnt(7)
  v_mfma_f32_16x16x32_bf16 v[56:59], v[112:115], v[164:167], v[56:59]
  v_mfma_f32_16x16x32_bf16 v[84:87], v[112:115], v[204:207], v[84:87]
  ds_read_b128 v[112:115], v16 offset:16384
  s_waitcnt lgkmcnt(7)
  v_mfma_f32_16x16x32_bf16 v[60:63], v[116:119], v[164:167], v[60:63]
  v_mfma_f32_16x16x32_bf16 v[88:91], v[116:119], v[204:207], v[88:91]
  ds_read_b128 v[116:119], v16 offset:17408
  s_waitcnt lgkmcnt(7)
  v_mfma_f32_16x16x32_bf16 v[64:67], v[120:123], v[164:167], v[64:67]
  v_mfma_f32_16x16x32_bf16 v[92:95], v[120:123], v[204:207], v[92:95]
  ds_read_b128 v[120:123], v16 offset:18432
  s_waitcnt lgkmcnt(7)
  v_mfma_f32_16x16x32_bf16 v[68:71], v[124:127], v[164:167], v[68:71]
  v_mfma_f32_16x16x32_bf16 v[96:99], v[124:127], v[204:207], v[96:99]
  ds_read_b128 v[124:127], v16 offset:19456
  s_waitcnt lgkmcnt(7)
  v_mfma_f32_16x16x32_bf16 v[72:75], v[128:131], v[164:167], v[72:75]
  v_mfma_f32_16x16x32_bf16 v[100:103], v[128:131], v[204:207], v[100:103]
  ds_read_b128 v[128:131], v16 offset:20480
  s_waitcnt vmcnt(1) lgkmcnt(6)
  v_mfma_f32_16x16x32_bf16 v[48:51], v[104:107], v[168:171], v[48:51]
  s_waitcnt vmcnt(0)
  v_mfma_f32_16x16x32_bf16 v[76:79], v[104:107], v[208:211], v[76:79]
  s_waitcnt lgkmcnt(5)
  v_mfma_f32_16x16x32_bf16 v[52:55], v[108:111], v[168:171], v[52:55]
  v_mfma_f32_16x16x32_bf16 v[80:83], v[108:111], v[208:211], v[80:83]
  s_waitcnt lgkmcnt(4)
  v_mfma_f32_16x16x32_bf16 v[56:59], v[112:115], v[168:171], v[56:59]
  v_mfma_f32_16x16x32_bf16 v[84:87], v[112:115], v[208:211], v[84:87]
  s_waitcnt lgkmcnt(3)
  v_mfma_f32_16x16x32_bf16 v[60:63], v[116:119], v[168:171], v[60:63]
  v_mfma_f32_16x16x32_bf16 v[88:91], v[116:119], v[208:211], v[88:91]
  s_waitcnt lgkmcnt(2)
  v_mfma_f32_16x16x32_bf16 v[64:67], v[120:123], v[168:171], v[64:67]
  v_mfma_f32_16x16x32_bf16 v[92:95], v[120:123], v[208:211], v[92:95]
  s_waitcnt lgkmcnt(1)
  v_mfma_f32_16x16x32_bf16 v[68:71], v[124:127], v[168:171], v[68:71]
  v_mfma_f32_16x16x32_bf16 v[96:99], v[124:127], v[208:211], v[96:99]
  s_waitcnt lgkmcnt(0)
  v_mfma_f32_16x16x32_bf16 v[72:75], v[128:131], v[168:171], v[72:75]
  v_mfma_f32_16x16x32_bf16 v[100:103], v[128:131], v[208:211], v[100:103]
  v_mov_b32 v10, 35
  ds_write_b32 v11, v10 offset:16
  s_waitcnt lgkmcnt(0)
  s_mov_b32 s57, 0
L_50:
  ds_read_b128 v[12:15], v8 offset:80
  s_waitcnt lgkmcnt(0)
  v_min3_u32 v12, v12, v13, v14
  v_min_u32 v12, v12, v15
  s_nop 0
  v_readfirstlane_b32 s56, v12
  s_nop 3
  s_cmp_ge_u32 s56, 2
  s_cbranch_scc1 L_51
  s_add_u32 s57, s57, 1
  s_sleep 1
  s_cmp_lt_u32 s57, 0x400000
  s_cbranch_scc1 L_50
L_51:
  ds_read_b128 v[132:135], v44
  ds_read_b128 v[136:139], v44 offset:64
  ds_read_b128 v[140:143], v44 offset:128
  ds_read_b128 v[144:147], v44 offset:192
  ds_read_b128 v[148:151], v44 offset:256
  ds_read_b128 v[152:155], v44 offset:320
  ds_read_b128 v[156:159], v44 offset:384
  s_waitcnt lgkmcnt(6)
  v_pk_mul_f32 v[104:105], v[132:133], v[36:37] op_sel:[0,1] op_sel_hi:[1,1]
  v_pk_mul_f32 v[106:107], v[134:135], v[36:37] op_sel:[0,1] op_sel_hi:[1,1]
  v_pk_fma_f32 v[48:49], v[48:49], v[36:37], v[104:105] op_sel_hi:[1,0,1] neg_lo:[0,0,1] neg_hi:[0,0,1]
  v_pk_fma_f32 v[50:51], v[50:51], v[36:37], v[106:107] op_sel_hi:[1,0,1] neg_lo:[0,0,1] neg_hi:[0,0,1]
  v_cvt_pk_bf16_f32 v108, v48, v49
  v_lshlrev_b32 v48, 16, v108
  v_and_b32 v49, 0xffff0000, v108
  v_cvt_pk_bf16_f32 v110, v50, v51
  v_lshlrev_b32 v50, 16, v110
  v_and_b32 v51, 0xffff0000, v110
  v_pk_mul_f32 v[108:109], v[48:49], v[48:49]
  v_pk_mul_f32 v[110:111], v[50:51], v[50:51]
  v_pk_fma_f32 v[108:109], v[108:109], v[18:19], v[18:19] op_sel:[0,0,1] op_sel_hi:[1,0,1]
  v_pk_fma_f32 v[110:111], v[110:111], v[18:19], v[18:19] op_sel:[0,0,1] op_sel_hi:[1,0,1]
  v_pk_mul_f32 v[108:109], v[108:109], v[48:49]
  v_pk_mul_f32 v[110:111], v[110:111], v[50:51]
  v_exp_f32 v108, v108
  v_exp_f32 v109, v109
  v_exp_f32 v110, v110
  v_exp_f32 v111, v111
  v_pk_add_f32 v[108:109], v[108:109], 1.0 op_sel_hi:[1,0]
  v_pk_add_f32 v[110:111], v[110:111], 1.0 op_sel_hi:[1,0]
  v_rcp_f32 v108, v108
  v_rcp_f32 v109, v109
  v_rcp_f32 v110, v110
  v_rcp_f32 v111, v111
  v_pk_mul_f32 v[48:49], v[48:49], v[108:109]
  v_pk_mul_f32 v[50:51], v[50:51], v[110:111]
  v_cvt_pk_bf16_f32 v164, v48, v49
  v_cvt_pk_bf16_f32 v165, v50, v51
  buffer_store_dwordx2 v[164:165], v7, s[16:19], s72 offen sc1
  s_waitcnt lgkmcnt(5)
  v_pk_mul_f32 v[112:113], v[136:137], v[36:37] op_sel:[0,1] op_sel_hi:[1,1]
  v_pk_mul_f32 v[114:115], v[138:139], v[36:37] op_sel:[0,1] op_sel_hi:[1,1]
  v_pk_fma_f32 v[52:53], v[52:53], v[36:37], v[112:113] op_sel_hi:[1,0,1] neg_lo:[0,0,1] neg_hi:[0,0,1]
  v_pk_fma_f32 v[54:55], v[54:55], v[36:37], v[114:115] op_sel_hi:[1,0,1] neg_lo:[0,0,1] neg_hi:[0,0,1]
  v_cvt_pk_bf16_f32 v116, v52, v53
  v_lshlrev_b32 v52, 16, v116
  v_and_b32 v53, 0xffff0000, v116
  v_cvt_pk_bf16_f32 v118, v54, v55
  v_lshlrev_b32 v54, 16, v118
  v_and_b32 v55, 0xffff0000, v118
  v_pk_mul_f32 v[116:117], v[52:53], v[52:53]
  v_pk_mul_f32 v[118:119], v[54:55], v[54:55]
  v_pk_fma_f32 v[116:117], v[116:117], v[18:19], v[18:19] op_sel:[0,0,1] op_sel_hi:[1,0,1]
  v_pk_fma_f32 v[118:119], v[118:119], v[18:19], v[18:19] op_sel:[0,0,1] op_sel_hi:[1,0,1]
  v_pk_mul_f32 v[116:117], v[116:117], v[52:53]
  v_pk_mul_f32 v[118:119], v[118:119], v[54:55]
  v_exp_f32 v116, v116
  v_exp_f32 v117, v117
  v_exp_f32 v118, v118
  v_exp_f32 v119, v119
  v_pk_add_f32 v[116:117], v[116:117], 1.0 op_sel_hi:[1,0]
  v_pk_add_f32 v[118:119], v[118:119], 1.0 op_sel_hi:[1,0]
  v_rcp_f32 v116, v116
  v_rcp_f32 v117, v117
  v_rcp_f32 v118, v118
  v_rcp_f32 v119, v119
  v_pk_mul_f32 v[52:53], v[52:53], v[116:117]
  v_pk_mul_f32 v[54:55], v[54:55], v[118:119]
  v_cvt_pk_bf16_f32 v166, v52, v53
  v_cvt_pk_bf16_f32 v167, v54, v55
  buffer_store_dwordx2 v[166:167], v7, s[16:19], s72 offen offset:512 sc1
  s_waitcnt lgkmcnt(4)
  v_pk_mul_f32 v[104:105], v[140:141], v[36:37] op_sel:[0,1] op_sel_hi:[1,1]
  v_pk_mul_f32 v[106:107], v[142:143], v[36:37] op_sel:[0,1] op_sel_hi:[1,1]
  v_pk_fma_f32 v[56:57], v[56:57], v[36:37], v[104:105] op_sel_hi:[1,0,1] neg_lo:[0,0,1] neg_hi:[0,0,1]
  v_pk_fma_f32 v[58:59], v[58:59], v[36:37], v[106:107] op_sel_hi:[1,0,1] neg_lo:[0,0,1] neg_hi:[0,0,1]
  v_cvt_pk_bf16_f32 v108, v56, v57
  v_lshlrev_b32 v56, 16, v108
  v_and_b32 v57, 0xffff0000, v108
  v_cvt_pk_bf16_f32 v110, v58, v59
  v_lshlrev_b32 v58, 16, v110
  v_and_b32 v59, 0xffff0000, v110
  v_pk_mul_f32 v[108:109], v[56:57], v[56:57]
  v_pk_mul_f32 v[110:111], v[58:59], v[58:59]
  v_pk_fma_f32 v[108:109], v[108:109], v[18:19], v[18:19] op_sel:[0,0,1] op_sel_hi:[1,0,1]
  v_pk_fma_f32 v[110:111], v[110:111], v[18:19], v[18:19] op_sel:[0,0,1] op_sel_hi:[1,0,1]
  v_pk_mul_f32 v[108:109], v[108:109], v[56:57]
  v_pk_mul_f32 v[110:111], v[110:111], v[58:59]
  v_exp_f32 v108, v108
  v_exp_f32 v109, v109
  v_exp_f32 v110, v110
  v_exp_f32 v111, v111
  v_pk_add_f32 v[108:109], v[108:109], 1.0 op_sel_hi:[1,0]
  v_pk_add_f32 v[110:111], v[110:111], 1.0 op_sel_hi:[1,0]
  v_rcp_f32 v108, v108
  v_rcp_f32 v109, v109
  v_rcp_f32 v110, v110
  v_rcp_f32 v111, v111
  v_pk_mul_f32 v[56:57], v[56:57], v[108:109]
  v_pk_mul_f32 v[58:59], v[58:59], v[110:111]
  v_cvt_pk_bf16_f32 v168, v56, v57
  v_cvt_pk_bf16_f32 v169, v58, v59
  buffer_store_dwordx2 v[168:169], v7, s[16:19], s72 offen offset:1024 sc1
  s_waitcnt lgkmcnt(3)
  v_pk_mul_f32 v[112:113], v[144:145], v[36:37] op_sel:[0,1] op_sel_hi:[1,1]
  v_pk_mul_f32 v[114:115], v[146:147], v[36:37] op_sel:[0,1] op_sel_hi:[1,1]
  v_pk_fma_f32 v[60:61], v[60:61], v[36:37], v[112:113] op_sel_hi:[1,0,1] neg_lo:[0,0,1] neg_hi:[0,0,1]
  v_pk_fma_f32 v[62:63], v[62:63], v[36:37], v[114:115] op_sel_hi:[1,0,1] neg_lo:[0,0,1] neg_hi:[0,0,1]
  v_cvt_pk_bf16_f32 v116, v60, v61
  v_lshlrev_b32 v60, 16, v116
  v_and_b32 v61, 0xffff0000, v116
  v_cvt_pk_bf16_f32 v118, v62, v63
  v_lshlrev_b32 v62, 16, v118
  v_and_b32 v63, 0xffff0000, v118
  v_pk_mul_f32 v[116:117], v[60:61], v[60:61]
  v_pk_mul_f32 v[118:119], v[62:63], v[62:63]
  v_pk_fma_f32 v[116:117], v[116:117], v[18:19], v[18:19] op_sel:[0,0,1] op_sel_hi:[1,0,1]
  v_pk_fma_f32 v[118:119], v[118:119], v[18:19], v[18:19] op_sel:[0,0,1] op_sel_hi:[1,0,1]
  v_pk_mul_f32 v[116:117], v[116:117], v[60:61]
  v_pk_mul_f32 v[118:119], v[118:119], v[62:63]
  v_exp_f32 v116, v116
  v_exp_f32 v117, v117
  v_exp_f32 v118, v118
  v_exp_f32 v119, v119
  v_pk_add_f32 v[116:117], v[116:117], 1.0 op_sel_hi:[1,0]
  v_pk_add_f32 v[118:119], v[118:119], 1.0 op_sel_hi:[1,0]
  v_rcp_f32 v116, v116
  v_rcp_f32 v117, v117
  v_rcp_f32 v118, v118
  v_rcp_f32 v119, v119
  v_pk_mul_f32 v[60:61], v[60:61], v[116:117]
  v_pk_mul_f32 v[62:63], v[62:63], v[118:119]
  v_cvt_pk_bf16_f32 v170, v60, v61
  v_cvt_pk_bf16_f32 v171, v62, v63
  buffer_store_dwordx2 v[170:171], v7, s[16:19], s72 offen offset:1536 sc1
  s_waitcnt lgkmcnt(2)
  v_pk_mul_f32 v[104:105], v[148:149], v[36:37] op_sel:[0,1] op_sel_hi:[1,1]
  v_pk_mul_f32 v[106:107], v[150:151], v[36:37] op_sel:[0,1] op_sel_hi:[1,1]
  v_pk_fma_f32 v[64:65], v[64:65], v[36:37], v[104:105] op_sel_hi:[1,0,1] neg_lo:[0,0,1] neg_hi:[0,0,1]
  v_pk_fma_f32 v[66:67], v[66:67], v[36:37], v[106:107] op_sel_hi:[1,0,1] neg_lo:[0,0,1] neg_hi:[0,0,1]
  v_cvt_pk_bf16_f32 v108, v64, v65
  v_lshlrev_b32 v64, 16, v108
  v_and_b32 v65, 0xffff0000, v108
  v_cvt_pk_bf16_f32 v110, v66, v67
  v_lshlrev_b32 v66, 16, v110
  v_and_b32 v67, 0xffff0000, v110
  v_pk_mul_f32 v[108:109], v[64:65], v[64:65]
  v_pk_mul_f32 v[110:111], v[66:67], v[66:67]
  v_pk_fma_f32 v[108:109], v[108:109], v[18:19], v[18:19] op_sel:[0,0,1] op_sel_hi:[1,0,1]
  v_pk_fma_f32 v[110:111], v[110:111], v[18:19], v[18:19] op_sel:[0,0,1] op_sel_hi:[1,0,1]
  v_pk_mul_f32 v[108:109], v[108:109], v[64:65]
  v_pk_mul_f32 v[110:111], v[110:111], v[66:67]
  v_exp_f32 v108, v108
  v_exp_f32 v109, v109
  v_exp_f32 v110, v110
  v_exp_f32 v111, v111
  v_pk_add_f32 v[108:109], v[108:109], 1.0 op_sel_hi:[1,0]
  v_pk_add_f32 v[110:111], v[110:111], 1.0 op_sel_hi:[1,0]
  v_rcp_f32 v108, v108
  v_rcp_f32 v109, v109
  v_rcp_f32 v110, v110
  v_rcp_f32 v111, v111
  v_pk_mul_f32 v[64:65], v[64:65], v[108:109]
  v_pk_mul_f32 v[66:67], v[66:67], v[110:111]
  v_cvt_pk_bf16_f32 v172, v64, v65
  v_cvt_pk_bf16_f32 v173, v66, v67
  buffer_store_dwordx2 v[172:173], v7, s[16:19], s72 offen offset:2048 sc1
  s_waitcnt lgkmcnt(1)
  v_pk_mul_f32 v[112:113], v[152:153], v[36:37] op_sel:[0,1] op_sel_hi:[1,1]
  v_pk_mul_f32 v[114:115], v[154:155], v[36:37] op_sel:[0,1] op_sel_hi:[1,1]
  v_pk_fma_f32 v[68:69], v[68:69], v[36:37], v[112:113] op_sel_hi:[1,0,1] neg_lo:[0,0,1] neg_hi:[0,0,1]
  v_pk_fma_f32 v[70:71], v[70:71], v[36:37], v[114:115] op_sel_hi:[1,0,1] neg_lo:[0,0,1] neg_hi:[0,0,1]
  v_cvt_pk_bf16_f32 v116, v68, v69
  v_lshlrev_b32 v68, 16, v116
  v_and_b32 v69, 0xffff0000, v116
  v_cvt_pk_bf16_f32 v118, v70, v71
  v_lshlrev_b32 v70, 16, v118
  v_and_b32 v71, 0xffff0000, v118
  v_pk_mul_f32 v[116:117], v[68:69], v[68:69]
  v_pk_mul_f32 v[118:119], v[70:71], v[70:71]
  v_pk_fma_f32 v[116:117], v[116:117], v[18:19], v[18:19] op_sel:[0,0,1] op_sel_hi:[1,0,1]
  v_pk_fma_f32 v[118:119], v[118:119], v[18:19], v[18:19] op_sel:[0,0,1] op_sel_hi:[1,0,1]
  v_pk_mul_f32 v[116:117], v[116:117], v[68:69]
  v_pk_mul_f32 v[118:119], v[118:119], v[70:71]
  v_exp_f32 v116, v116
  v_exp_f32 v117, v117
  v_exp_f32 v118, v118
  v_exp_f32 v119, v119
  v_pk_add_f32 v[116:117], v[116:117], 1.0 op_sel_hi:[1,0]
  v_pk_add_f32 v[118:119], v[118:119], 1.0 op_sel_hi:[1,0]
  v_rcp_f32 v116, v116
  v_rcp_f32 v117, v117
  v_rcp_f32 v118, v118
  v_rcp_f32 v119, v119
  v_pk_mul_f32 v[68:69], v[68:69], v[116:117]
  v_pk_mul_f32 v[70:71], v[70:71], v[118:119]
  v_cvt_pk_bf16_f32 v174, v68, v69
  v_cvt_pk_bf16_f32 v175, v70, v71
  buffer_store_dwordx2 v[174:175], v7, s[16:19], s72 offen offset:2560 sc1
  s_waitcnt lgkmcnt(0)
  v_pk_mul_f32 v[104:105], v[156:157], v[36:37] op_sel:[0,1] op_sel_hi:[1,1]
  v_pk_mul_f32 v[106:107], v[158:159], v[36:37] op_sel:[0,1] op_sel_hi:[1,1]
  v_pk_fma_f32 v[72:73], v[72:73], v[36:37], v[104:105] op_sel_hi:[1,0,1] neg_lo:[0,0,1] neg_hi:[0,0,1]
  v_pk_fma_f32 v[74:75], v[74:75], v[36:37], v[106:107] op_sel_hi:[1,0,1] neg_lo:[0,0,1] neg_hi:[0,0,1]
  v_cvt_pk_bf16_f32 v108, v72, v73
  v_lshlrev_b32 v72, 16, v108
  v_and_b32 v73, 0xffff0000, v108
  v_cvt_pk_bf16_f32 v110, v74, v75
  v_lshlrev_b32 v74, 16, v110
  v_and_b32 v75, 0xffff0000, v110
  v_pk_mul_f32 v[108:109], v[72:73], v[72:73]
  v_pk_mul_f32 v[110:111], v[74:75], v[74:75]
  v_pk_fma_f32 v[108:109], v[108:109], v[18:19], v[18:19] op_sel:[0,0,1] op_sel_hi:[1,0,1]
  v_pk_fma_f32 v[110:111], v[110:111], v[18:19], v[18:19] op_sel:[0,0,1] op_sel_hi:[1,0,1]
  v_pk_mul_f32 v[108:109], v[108:109], v[72:73]
  v_pk_mul_f32 v[110:111], v[110:111], v[74:75]
  v_exp_f32 v108, v108
  v_exp_f32 v109, v109
  v_exp_f32 v110, v110
  v_exp_f32 v111, v111
  v_pk_add_f32 v[108:109], v[108:109], 1.0 op_sel_hi:[1,0]
  v_pk_add_f32 v[110:111], v[110:111], 1.0 op_sel_hi:[1,0]
  v_rcp_f32 v108, v108
  v_rcp_f32 v109, v109
  v_rcp_f32 v110, v110
  v_rcp_f32 v111, v111
  v_pk_mul_f32 v[72:73], v[72:73], v[108:109]
  v_pk_mul_f32 v[74:75], v[74:75], v[110:111]
  v_cvt_pk_bf16_f32 v176, v72, v73
  v_cvt_pk_bf16_f32 v177, v74, v75
  buffer_store_dwordx2 v[176:177], v7, s[16:19], s72 offen offset:3072 sc1
  v_pk_mul_f32 v[104:105], v[132:133], v[38:39] op_sel:[0,1] op_sel_hi:[1,1]
  v_pk_mul_f32 v[106:107], v[134:135], v[38:39] op_sel:[0,1] op_sel_hi:[1,1]
  v_pk_fma_f32 v[76:77], v[76:77], v[38:39], v[104:105] op_sel_hi:[1,0,1] neg_lo:[0,0,1] neg_hi:[0,0,1]
  v_pk_fma_f32 v[78:79], v[78:79], v[38:39], v[106:107] op_sel_hi:[1,0,1] neg_lo:[0,0,1] neg_hi:[0,0,1]
  v_cvt_pk_bf16_f32 v108, v76, v77
  v_lshlrev_b32 v76, 16, v108
  v_and_b32 v77, 0xffff0000, v108
  v_cvt_pk_bf16_f32 v110, v78, v79
  v_lshlrev_b32 v78, 16, v110
  v_and_b32 v79, 0xffff0000, v110
  v_pk_mul_f32 v[108:109], v[76:77], v[76:77]
  v_pk_mul_f32 v[110:111], v[78:79], v[78:79]
  v_pk_fma_f32 v[108:109], v[108:109], v[18:19], v[18:19] op_sel:[0,0,1] op_sel_hi:[1,0,1]
  v_pk_fma_f32 v[110:111], v[110:111], v[18:19], v[18:19] op_sel:[0,0,1] op_sel_hi:[1,0,1]
  v_pk_mul_f32 v[108:109], v[108:109], v[76:77]
  v_pk_mul_f32 v[110:111], v[110:111], v[78:79]
  v_exp_f32 v108, v108
  v_exp_f32 v109, v109
  v_exp_f32 v110, v110
  v_exp_f32 v111, v111
  v_pk_add_f32 v[108:109], v[108:109], 1.0 op_sel_hi:[1,0]
  v_pk_add_f32 v[110:111], v[110:111], 1.0 op_sel_hi:[1,0]
  v_rcp_f32 v108, v108
  v_rcp_f32 v109, v109
  v_rcp_f32 v110, v110
  v_rcp_f32 v111, v111
  v_pk_mul_f32 v[76:77], v[76:77], v[108:109]
  v_pk_mul_f32 v[78:79], v[78:79], v[110:111]
  v_cvt_pk_bf16_f32 v178, v76, v77
  v_cvt_pk_bf16_f32 v179, v78, v79
  buffer_store_dwordx2 v[178:179], v7, s[16:19], s73 offen sc1
  v_pk_mul_f32 v[112:113], v[136:137], v[38:39] op_sel:[0,1] op_sel_hi:[1,1]
  v_pk_mul_f32 v[114:115], v[138:139], v[38:39] op_sel:[0,1] op_sel_hi:[1,1]
  v_pk_fma_f32 v[80:81], v[80:81], v[38:39], v[112:113] op_sel_hi:[1,0,1] neg_lo:[0,0,1] neg_hi:[0,0,1]
  v_pk_fma_f32 v[82:83], v[82:83], v[38:39], v[114:115] op_sel_hi:[1,0,1] neg_lo:[0,0,1] neg_hi:[0,0,1]
  v_cvt_pk_bf16_f32 v116, v80, v81
  v_lshlrev_b32 v80, 16, v116
  v_and_b32 v81, 0xffff0000, v116
  v_cvt_pk_bf16_f32 v118, v82, v83
  v_lshlrev_b32 v82, 16, v118
  v_and_b32 v83, 0xffff0000, v118
  v_pk_mul_f32 v[116:117], v[80:81], v[80:81]
  v_pk_mul_f32 v[118:119], v[82:83], v[82:83]
  v_pk_fma_f32 v[116:117], v[116:117], v[18:19], v[18:19] op_sel:[0,0,1] op_sel_hi:[1,0,1]
  v_pk_fma_f32 v[118:119], v[118:119], v[18:19], v[18:19] op_sel:[0,0,1] op_sel_hi:[1,0,1]
  v_pk_mul_f32 v[116:117], v[116:117], v[80:81]
  v_pk_mul_f32 v[118:119], v[118:119], v[82:83]
  v_exp_f32 v116, v116
  v_exp_f32 v117, v117
  v_exp_f32 v118, v118
  v_exp_f32 v119, v119
  v_pk_add_f32 v[116:117], v[116:117], 1.0 op_sel_hi:[1,0]
  v_pk_add_f32 v[118:119], v[118:119], 1.0 op_sel_hi:[1,0]
  v_rcp_f32 v116, v116
  v_rcp_f32 v117, v117
  v_rcp_f32 v118, v118
  v_rcp_f32 v119, v119
  v_pk_mul_f32 v[80:81], v[80:81], v[116:117]
  v_pk_mul_f32 v[82:83], v[82:83], v[118:119]
  v_cvt_pk_bf16_f32 v180, v80, v81
  v_cvt_pk_bf16_f32 v181, v82, v83
  buffer_store_dwordx2 v[180:181], v7, s[16:19], s73 offen offset:512 sc1
  v_pk_mul_f32 v[104:105], v[140:141], v[38:39] op_sel:[0,1] op_sel_hi:[1,1]
  v_pk_mul_f32 v[106:107], v[142:143], v[38:39] op_sel:[0,1] op_sel_hi:[1,1]
  v_pk_fma_f32 v[84:85], v[84:85], v[38:39], v[104:105] op_sel_hi:[1,0,1] neg_lo:[0,0,1] neg_hi:[0,0,1]
  v_pk_fma_f32 v[86:87], v[86:87], v[38:39], v[106:107] op_sel_hi:[1,0,1] neg_lo:[0,0,1] neg_hi:[0,0,1]
  v_cvt_pk_bf16_f32 v108, v84, v85
  v_lshlrev_b32 v84, 16, v108
  v_and_b32 v85, 0xffff0000, v108
  v_cvt_pk_bf16_f32 v110, v86, v87
  v_lshlrev_b32 v86, 16, v110
  v_and_b32 v87, 0xffff0000, v110
  v_pk_mul_f32 v[108:109], v[84:85], v[84:85]
  v_pk_mul_f32 v[110:111], v[86:87], v[86:87]
  v_pk_fma_f32 v[108:109], v[108:109], v[18:19], v[18:19] op_sel:[0,0,1] op_sel_hi:[1,0,1]
  v_pk_fma_f32 v[110:111], v[110:111], v[18:19], v[18:19] op_sel:[0,0,1] op_sel_hi:[1,0,1]
  v_pk_mul_f32 v[108:109], v[108:109], v[84:85]
  v_pk_mul_f32 v[110:111], v[110:111], v[86:87]
  v_exp_f32 v108, v108
  v_exp_f32 v109, v109
  v_exp_f32 v110, v110
  v_exp_f32 v111, v111
  v_pk_add_f32 v[108:109], v[108:109], 1.0 op_sel_hi:[1,0]
  v_pk_add_f32 v[110:111], v[110:111], 1.0 op_sel_hi:[1,0]
  v_rcp_f32 v108, v108
  v_rcp_f32 v109, v109
  v_rcp_f32 v110, v110
  v_rcp_f32 v111, v111
  v_pk_mul_f32 v[84:85], v[84:85], v[108:109]
  v_pk_mul_f32 v[86:87], v[86:87], v[110:111]
  v_cvt_pk_bf16_f32 v182, v84, v85
  v_cvt_pk_bf16_f32 v183, v86, v87
  buffer_store_dwordx2 v[182:183], v7, s[16:19], s73 offen offset:1024 sc1
  v_pk_mul_f32 v[112:113], v[144:145], v[38:39] op_sel:[0,1] op_sel_hi:[1,1]
  v_pk_mul_f32 v[114:115], v[146:147], v[38:39] op_sel:[0,1] op_sel_hi:[1,1]
  v_pk_fma_f32 v[88:89], v[88:89], v[38:39], v[112:113] op_sel_hi:[1,0,1] neg_lo:[0,0,1] neg_hi:[0,0,1]
  v_pk_fma_f32 v[90:91], v[90:91], v[38:39], v[114:115] op_sel_hi:[1,0,1] neg_lo:[0,0,1] neg_hi:[0,0,1]
  v_cvt_pk_bf16_f32 v116, v88, v89
  v_lshlrev_b32 v88, 16, v116
  v_and_b32 v89, 0xffff0000, v116
  v_cvt_pk_bf16_f32 v118, v90, v91
  v_lshlrev_b32 v90, 16, v118
  v_and_b32 v91, 0xffff0000, v118
  v_pk_mul_f32 v[116:117], v[88:89], v[88:89]
  v_pk_mul_f32 v[118:119], v[90:91], v[90:91]
  v_pk_fma_f32 v[116:117], v[116:117], v[18:19], v[18:19] op_sel:[0,0,1] op_sel_hi:[1,0,1]
  v_pk_fma_f32 v[118:119], v[118:119], v[18:19], v[18:19] op_sel:[0,0,1] op_sel_hi:[1,0,1]
  v_pk_mul_f32 v[116:117], v[116:117], v[88:89]
  v_pk_mul_f32 v[118:119], v[118:119], v[90:91]
  v_exp_f32 v116, v116
  v_exp_f32 v117, v117
  v_exp_f32 v118, v118
  v_exp_f32 v119, v119
  v_pk_add_f32 v[116:117], v[116:117], 1.0 op_sel_hi:[1,0]
  v_pk_add_f32 v[118:119], v[118:119], 1.0 op_sel_hi:[1,0]
  v_rcp_f32 v116, v116
  v_rcp_f32 v117, v117
  v_rcp_f32 v118, v118
  v_rcp_f32 v119, v119
  v_pk_mul_f32 v[88:89], v[88:89], v[116:117]
  v_pk_mul_f32 v[90:91], v[90:91], v[118:119]
  v_cvt_pk_bf16_f32 v184, v88, v89
  v_cvt_pk_bf16_f32 v185, v90, v91
  buffer_store_dwordx2 v[184:185], v7, s[16:19], s73 offen offset:1536 sc1
  v_pk_mul_f32 v[104:105], v[148:149], v[38:39] op_sel:[0,1] op_sel_hi:[1,1]
  v_pk_mul_f32 v[106:107], v[150:151], v[38:39] op_sel:[0,1] op_sel_hi:[1,1]
  v_pk_fma_f32 v[92:93], v[92:93], v[38:39], v[104:105] op_sel_hi:[1,0,1] neg_lo:[0,0,1] neg_hi:[0,0,1]
  v_pk_fma_f32 v[94:95], v[94:95], v[38:39], v[106:107] op_sel_hi:[1,0,1] neg_lo:[0,0,1] neg_hi:[0,0,1]
  v_cvt_pk_bf16_f32 v108, v92, v93
  v_lshlrev_b32 v92, 16, v108
  v_and_b32 v93, 0xffff0000, v108
  v_cvt_pk_bf16_f32 v110, v94, v95
  v_lshlrev_b32 v94, 16, v110
  v_and_b32 v95, 0xffff0000, v110
  v_pk_mul_f32 v[108:109], v[92:93], v[92:93]
  v_pk_mul_f32 v[110:111], v[94:95], v[94:95]
  v_pk_fma_f32 v[108:109], v[108:109], v[18:19], v[18:19] op_sel:[0,0,1] op_sel_hi:[1,0,1]
  v_pk_fma_f32 v[110:111], v[110:111], v[18:19], v[18:19] op_sel:[0,0,1] op_sel_hi:[1,0,1]
  v_pk_mul_f32 v[108:109], v[108:109], v[92:93]
  v_pk_mul_f32 v[110:111], v[110:111], v[94:95]
  v_exp_f32 v108, v108
  v_exp_f32 v109, v109
  v_exp_f32 v110, v110
  v_exp_f32 v111, v111
  v_pk_add_f32 v[108:109], v[108:109], 1.0 op_sel_hi:[1,0]
  v_pk_add_f32 v[110:111], v[110:111], 1.0 op_sel_hi:[1,0]
  v_rcp_f32 v108, v108
  v_rcp_f32 v109, v109
  v_rcp_f32 v110, v110
  v_rcp_f32 v111, v111
  v_pk_mul_f32 v[92:93], v[92:93], v[108:109]
  v_pk_mul_f32 v[94:95], v[94:95], v[110:111]
  v_cvt_pk_bf16_f32 v186, v92, v93
  v_cvt_pk_bf16_f32 v187, v94, v95
  buffer_store_dwordx2 v[186:187], v7, s[16:19], s73 offen offset:2048 sc1
  v_pk_mul_f32 v[112:113], v[152:153], v[38:39] op_sel:[0,1] op_sel_hi:[1,1]
  v_pk_mul_f32 v[114:115], v[154:155], v[38:39] op_sel:[0,1] op_sel_hi:[1,1]
  v_pk_fma_f32 v[96:97], v[96:97], v[38:39], v[112:113] op_sel_hi:[1,0,1] neg_lo:[0,0,1] neg_hi:[0,0,1]
  v_pk_fma_f32 v[98:99], v[98:99], v[38:39], v[114:115] op_sel_hi:[1,0,1] neg_lo:[0,0,1] neg_hi:[0,0,1]
  v_cvt_pk_bf16_f32 v116, v96, v97
  v_lshlrev_b32 v96, 16, v116
  v_and_b32 v97, 0xffff0000, v116
  v_cvt_pk_bf16_f32 v118, v98, v99
  v_lshlrev_b32 v98, 16, v118
  v_and_b32 v99, 0xffff0000, v118
  v_pk_mul_f32 v[116:117], v[96:97], v[96:97]
  v_pk_mul_f32 v[118:119], v[98:99], v[98:99]
  v_pk_fma_f32 v[116:117], v[116:117], v[18:19], v[18:19] op_sel:[0,0,1] op_sel_hi:[1,0,1]
  v_pk_fma_f32 v[118:119], v[118:119], v[18:19], v[18:19] op_sel:[0,0,1] op_sel_hi:[1,0,1]
  v_pk_mul_f32 v[116:117], v[116:117], v[96:97]
  v_pk_mul_f32 v[118:119], v[118:119], v[98:99]
  v_exp_f32 v116, v116
  v_exp_f32 v117, v117
  v_exp_f32 v118, v118
  v_exp_f32 v119, v119
  v_pk_add_f32 v[116:117], v[116:117], 1.0 op_sel_hi:[1,0]
  v_pk_add_f32 v[118:119], v[118:119], 1.0 op_sel_hi:[1,0]
  v_rcp_f32 v116, v116
  v_rcp_f32 v117, v117
  v_rcp_f32 v118, v118
  v_rcp_f32 v119, v119
  v_pk_mul_f32 v[96:97], v[96:97], v[116:117]
  v_pk_mul_f32 v[98:99], v[98:99], v[118:119]
  v_cvt_pk_bf16_f32 v188, v96, v97
  v_cvt_pk_bf16_f32 v189, v98, v99
  buffer_store_dwordx2 v[188:189], v7, s[16:19], s73 offen offset:2560 sc1
  v_pk_mul_f32 v[104:105], v[156:157], v[38:39] op_sel:[0,1] op_sel_hi:[1,1]
  v_pk_mul_f32 v[106:107], v[158:159], v[38:39] op_sel:[0,1] op_sel_hi:[1,1]
  v_pk_fma_f32 v[100:101], v[100:101], v[38:39], v[104:105] op_sel_hi:[1,0,1] neg_lo:[0,0,1] neg_hi:[0,0,1]
  v_pk_fma_f32 v[102:103], v[102:103], v[38:39], v[106:107] op_sel_hi:[1,0,1] neg_lo:[0,0,1] neg_hi:[0,0,1]
  v_cvt_pk_bf16_f32 v108, v100, v101
  v_lshlrev_b32 v100, 16, v108
  v_and_b32 v101, 0xffff0000, v108
  v_cvt_pk_bf16_f32 v110, v102, v103
  v_lshlrev_b32 v102, 16, v110
  v_and_b32 v103, 0xffff0000, v110
  v_pk_mul_f32 v[108:109], v[100:101], v[100:101]
  v_pk_mul_f32 v[110:111], v[102:103], v[102:103]
  v_pk_fma_f32 v[108:109], v[108:109], v[18:19], v[18:19] op_sel:[0,0,1] op_sel_hi:[1,0,1]
  v_pk_fma_f32 v[110:111], v[110:111], v[18:19], v[18:19] op_sel:[0,0,1] op_sel_hi:[1,0,1]
  v_pk_mul_f32 v[108:109], v[108:109], v[100:101]
  v_pk_mul_f32 v[110:111], v[110:111], v[102:103]
  v_exp_f32 v108, v108
  v_exp_f32 v109, v109
  v_exp_f32 v110, v110
  v_exp_f32 v111, v111
  v_pk_add_f32 v[108:109], v[108:109], 1.0 op_sel_hi:[1,0]
  v_pk_add_f32 v[110:111], v[110:111], 1.0 op_sel_hi:[1,0]
  v_rcp_f32 v108, v108
  v_rcp_f32 v109, v109
  v_rcp_f32 v110, v110
  v_rcp_f32 v111, v111
  v_pk_mul_f32 v[100:101], v[100:101], v[108:109]
  v_pk_mul_f32 v[102:103], v[102:103], v[110:111]
  v_cvt_pk_bf16_f32 v190, v100, v101
  v_cvt_pk_bf16_f32 v191, v102, v103
  buffer_store_dwordx2 v[190:191], v7, s[16:19], s73 offen offset:3072 sc1
  s_lshl_b32 s79, s77, 4
  s_add_u32 s79, s79, s92
  s_add_u32 s56, s54, 10
  v_mov_b32 v12, s56
  v_mov_b32 v13, s55
  v_mov_b32 v10, 0
  s_lshl_b32 s57, s79, 7
  s_add_u32 s57, s57, 655360
  s_mov_b64 s[58:59], exec
  s_waitcnt vmcnt(0)
  s_mov_b64 exec, 1
  buffer_store_dwordx2 v[12:13], v10, s[24:27], s57 offen sc1
  s_mov_b64 exec, s[58:59]
  s_add_u32 s8, s52, 10485760
  s_addc_u32 s9, s53, 0
  s_mov_b32 s10, 7077888
  s_mov_b32 s11, 0x00020000
  s_mov_b32 s16, s48
  s_mov_b32 s17, s49
  s_mov_b32 s18, 2621440
  s_mov_b32 s19, 0x00020000
  v_lshlrev_b32 v16, 4, v1
  v_lshrrev_b32 v32, 1, v3
  v_lshlrev_b32 v7, 8, v32
  v_lshl_add_u32 v7, v2, 4, v7
  v_and_b32 v32, 1, v3
  v_lshl_add_u32 v7, v32, 3, v7
  s_mul_i32 s69, s90, 20480
  s_mul_i32 s56, s89, 2560
  s_add_u32 s69, s69, s56
  s_mul_i32 s72, s89, 160
  s_lshl_b32 s56, s90, 4
  v_add_u32 v46, s56, v2
  v_mul_u32_u24 v46, 1280, v46
  v_lshl_add_u32 v46, v3, 3, v46
  v_lshlrev_b32 v32, 4, v1
  s_mul_i32 s68, s90, 55296
  v_lshlrev_b32 v108, 16, v236
  v_and_b32 v109, 0xffff0000, v236
  v_lshlrev_b32 v128, 16, v246
  v_and_b32 v129, 0xffff0000, v246
  v_lshlrev_b32 v110, 16, v237
  v_and_b32 v111, 0xffff0000, v237
  v_lshlrev_b32 v130, 16, v247
  v_and_b32 v131, 0xffff0000, v247
  v_lshlrev_b32 v112, 16, v238
  v_and_b32 v113, 0xffff0000, v238
  v_lshlrev_b32 v132, 16, v248
  v_and_b32 v133, 0xffff0000, v248
  v_lshlrev_b32 v114, 16, v239
  v_and_b32 v115, 0xffff0000, v239
  v_lshlrev_b32 v134, 16, v249
  v_and_b32 v135, 0xffff0000, v249
  v_lshlrev_b32 v116, 16, v240
  v_and_b32 v117, 0xffff0000, v240
  v_lshlrev_b32 v136, 16, v250
  v_and_b32 v137, 0xffff0000, v250
  v_lshlrev_b32 v118, 16, v241
  v_and_b32 v119, 0xffff0000, v241
  v_lshlrev_b32 v138, 16, v251
  v_and_b32 v139, 0xffff0000, v251
  v_lshlrev_b32 v120, 16, v242
  v_and_b32 v121, 0xffff0000, v242
  v_lshlrev_b32 v140, 16, v252
  v_and_b32 v141, 0xffff0000, v252
  v_lshlrev_b32 v122, 16, v243
  v_and_b32 v123, 0xffff0000, v243
  v_lshlrev_b32 v142, 16, v253
  v_and_b32 v143, 0xffff0000, v253
  v_lshlrev_b32 v124, 16, v244
  v_and_b32 v125, 0xffff0000, v244
  v_lshlrev_b32 v144, 16, v254
  v_and_b32 v145, 0xffff0000, v254
  v_lshlrev_b32 v126, 16, v245
  v_and_b32 v127, 0xffff0000, v245
  v_lshlrev_b32 v146, 16, v255
  v_and_b32 v147, 0xffff0000, v255
  s_lshr_b32 s62, s90, 1
  s_lshl_b32 s62, s62, 4
  s_add_u32 s56, s54, 10
  v_add_u32 v10, s62, v1
  v_lshlrev_b32 v10, 7, v10
  v_add_u32 v10, 655360, v10
  s_mov_b64 s[58:59], exec
  s_mov_b64 exec, 65535
  s_mov_b32 s57, 0
  s_waitcnt vmcnt(0)
L_52:
  buffer_load_dwordx2 v[12:13], v10, s[24:27], 0 offen sc1
  s_waitcnt vmcnt(0)
  v_cmp_ne_u32 vcc, s56, v12
  v_cmp_ne_u32 s[94:95], s55, v13
  s_add_u32 s57, s57, 1
  s_nop 4
  s_or_b64 vcc, vcc, s[94:95]
  s_cbranch_vccz L_53
  s_cmp_lt_u32 s57, 0x80000
  s_cbranch_scc1 L_52
L_53:
  s_mov_b64 exec, s[58:59]
  v_mov_b32 v10, 6
  ds_write_b32 v11, v10 offset:128
  buffer_load_dwordx4 v[148:151], v32, s[8:11], s68 offen sc1
  buffer_load_dwordx4 v[152:155], v32, s[8:11], s68 offen offset:1024 sc1
  buffer_load_dwordx4 v[156:159], v32, s[8:11], s68 offen offset:2048 sc1
  buffer_load_dwordx4 v[160:163], v32, s[8:11], s68 offen offset:3072 sc1
  s_add_u32 s68, s68, 4096
  buffer_load_dwordx4 v[164:167], v32, s[8:11], s68 offen sc1
  buffer_load_dwordx4 v[168:171], v32, s[8:11], s68 offen offset:1024 sc1
  s_waitcnt lgkmcnt(0)
  s_mov_b32 s57, 0
L_54:
  ds_read_b128 v[12:15], v8 offset:0
  s_waitcnt lgkmcnt(0)
  v_min3_u32 v12, v12, v13, v14
  v_min_u32 v12, v12, v15
  s_nop 0
  v_readfirstlane_b32 s56, v12
  s_nop 3
  s_cmp_ge_u32 s56, 36
  s_cbranch_scc1 L_55
  s_add_u32 s57, s57, 1
  s_sleep 1
  s_cmp_lt_u32 s57, 0x400000
  s_cbranch_scc1 L_54
L_55:
  v_add_u32 v16, 102400, v16
  ds_read_b128 v[68:71], v16
  ds_read_b128 v[72:75], v16 offset:1024
  ds_read_b128 v[76:79], v16 offset:2048
  ds_read_b128 v[80:83], v16 offset:3072
  ds_read_b128 v[84:87], v16 offset:4096
  ds_read_b128 v[88:91], v16 offset:5120
  ds_read_b128 v[92:95], v16 offset:6144
  ds_read_b128 v[96:99], v16 offset:7168
  ds_read_b128 v[100:103], v16 offset:8192
  ds_read_b128 v[104:107], v16 offset:9216
  s_waitcnt vmcnt(5) lgkmcnt(9)
  v_mfma_f32_16x16x32_bf16 v[48:51], v[68:71], v[148:151], 0
  ds_read_b128 v[216:219], v16 offset:10240
  s_waitcnt lgkmcnt(9)
  v_mfma_f32_16x16x32_bf16 v[52:55], v[72:75], v[148:151], 0
  ds_read_b128 v[220:223], v16 offset:11264
  s_waitcnt lgkmcnt(9)
  v_mfma_f32_16x16x32_bf16 v[56:59], v[76:79], v[148:151], 0
  ds_read_b128 v[224:227], v16 offset:12288
  s_waitcnt lgkmcnt(9)
  v_mfma_f32_16x16x32_bf16 v[60:63], v[80:83], v[148:151], 0
  ds_read_b128 v[228:231], v16 offset:13312
  s_waitcnt lgkmcnt(9)
  v_mfma_f32_16x16x32_bf16 v[64:67], v[84:87], v[148:151], 0
  ds_read_b128 v[232:235], v16 offset:14336
  buffer_load_dwordx4 v[172:175], v32, s[8:11], s68 offen offset:2048 sc1
  buffer_load_dwordx4 v[176:179], v32, s[8:11], s68 offen offset:3072 sc1
  s_add_u32 s68, s68, 4096
  s_waitcnt vmcnt(6) lgkmcnt(9)
  v_mfma_f32_16x16x32_bf16 v[48:51], v[88:91], v[152:155], v[48:51]
  ds_read_b128 v[68:71], v16 offset:15360
  s_waitcnt lgkmcnt(9)
  v_mfma_f32_16x16x32_bf16 v[52:55], v[92:95], v[152:155], v[52:55]
  ds_read_b128 v[72:75], v16 offset:16384
  s_waitcnt lgkmcnt(9)
  v_mfma_f32_16x16x32_bf16 v[56:59], v[96:99], v[152:155], v[56:59]
  ds_read_b128 v[76:79], v16 offset:17408
  s_waitcnt lgkmcnt(9)
  v_mfma_f32_16x16x32_bf16 v[60:63], v[100:103], v[152:155], v[60:63]
  ds_read_b128 v[80:83], v16 offset:18432
  s_waitcnt lgkmcnt(9)
  v_mfma_f32_16x16x32_bf16 v[64:67], v[104:107], v[152:155], v[64:67]
  ds_read_b128 v[84:87], v16 offset:19456
  buffer_load_dwordx4 v[180:183], v32, s[8:11], s68 offen sc1
  buffer_load_dwordx4 v[184:187], v32, s[8:11], s68 offen offset:1024 sc1
  s_waitcnt lgkmcnt(0)
  s_mov_b32 s57, 0
L_56:
  ds_read_b128 v[12:15], v8 offset:0
  s_waitcnt lgkmcnt(0)
  v_min3_u32 v12, v12, v13, v14
  v_min_u32 v12, v12, v15
  s_nop 0
  v_readfirstlane_b32 s56, v12
  s_nop 3
  s_cmp_ge_u32 s56, 37
  s_cbranch_scc1 L_57
  s_add_u32 s57, s57, 1
  s_sleep 1
  s_cmp_lt_u32 s57, 0x400000
  s_cbranch_scc1 L_56
L_57:
  s_waitcnt vmcnt(7)
  v_mfma_f32_16x16x32_bf16 v[48:51], v[216:219], v[156:159], v[48:51]
  ds_read_b128 v[88:91], v16 offset:20480
  v_mfma_f32_16x16x32_bf16 v[52:55], v[220:223], v[156:159], v[52:55]
  ds_read_b128 v[92:95], v16 offset:21504
  v_mfma_f32_16x16x32_bf16 v[56:59], v[224:227], v[156:159], v[56:59]
  ds_read_b128 v[96:99], v16 offset:22528
  v_mfma_f32_16x16x32_bf16 v[60:63], v[228:231], v[156:159], v[60:63]
  ds_read_b128 v[100:103], v16 offset:23552
  v_mfma_f32_16x16x32_bf16 v[64:67], v[232:235], v[156:159], v[64:67]
  ds_read_b128 v[104:107], v16 offset:24576
  buffer_load_dwordx4 v[188:191], v32, s[8:11], s68 offen offset:2048 sc1
  buffer_load_dwordx4 v[192:195], v32, s[8:11], s68 offen offset:3072 sc1
  s_add_u32 s68, s68, 4096
  s_waitcnt vmcnt(8)
  v_mfma_f32_16x16x32_bf16 v[48:51], v[68:71], v[160:163], v[48:51]
  ds_read_b128 v[216:219], v16 offset:25600
  v_mfma_f32_16x16x32_bf16 v[52:55], v[72:75], v[160:163], v[52:55]
  ds_read_b128 v[220:223], v16 offset:26624
  v_mfma_f32_16x16x32_bf16 v[56:59], v[76:79], v[160:163], v[56:59]
  ds_read_b128 v[224:227], v16 offset:27648
  v_mfma_f32_16x16x32_bf16 v[60:63], v[80:83], v[160:163], v[60:63]
  ds_read_b128 v[228:231], v16 offset:28672
  v_mfma_f32_16x16x32_bf16 v[64:67], v[84:87], v[160:163], v[64:67]
  ds_read_b128 v[232:235], v16 offset:29696
  buffer_load_dwordx4 v[196:199], v32, s[8:11], s68 offen sc1
  buffer_load_dwordx4 v[200:203], v32, s[8:11], s68 offen offset:1024 sc1
  v_mov_b32 v10, 36
  ds_write_b32 v11, v10 offset:16
  s_waitcnt vmcnt(9) lgkmcnt(10)
  v_mfma_f32_16x16x32_bf16 v[48:51], v[88:91], v[164:167], v[48:51]
  ds_read_b128 v[68:71], v16 offset:30720
  s_waitcnt lgkmcnt(10)
  v_mfma_f32_16x16x32_bf16 v[52:55], v[92:95], v[164:167], v[52:55]
  ds_read_b128 v[72:75], v16 offset:31744
  s_waitcnt lgkmcnt(10)
  v_mfma_f32_16x16x32_bf16 v[56:59], v[96:99], v[164:167], v[56:59]
  ds_read_b128 v[76:79], v16 offset:32768
  s_waitcnt lgkmcnt(10)
  v_mfma_f32_16x16x32_bf16 v[60:63], v[100:103], v[164:167], v[60:63]
  ds_read_b128 v[80:83], v16 offset:33792
  s_waitcnt lgkmcnt(10)
  v_mfma_f32_16x16x32_bf16 v[64:67], v[104:107], v[164:167], v[64:67]
  ds_read_b128 v[84:87], v16 offset:34816
  buffer_load_dwordx4 v[204:207], v32, s[8:11], s68 offen offset:2048 sc1
  buffer_load_dwordx4 v[208:211], v32, s[8:11], s68 offen offset:3072 sc1
  s_add_u32 s68, s68, 4096
  s_waitcnt vmcnt(10) lgkmcnt(10)
  v_mfma_f32_16x16x32_bf16 v[48:51], v[216:219], v[168:171], v[48:51]
  ds_read_b128 v[88:91], v16 offset:35840
  s_waitcnt lgkmcnt(10)
  v_mfma_f32_16x16x32_bf16 v[52:55], v[220:223], v[168:171], v[52:55]
  ds_read_b128 v[92:95], v16 offset:36864
  s_waitcnt lgkmcnt(10)
  v_mfma_f32_16x16x32_bf16 v[56:59], v[224:227], v[168:171], v[56:59]
  ds_read_b128 v[96:99], v16 offset:37888
  s_waitcnt lgkmcnt(10)
  v_mfma_f32_16x16x32_bf16 v[60:63], v[228:231], v[168:171], v[60:63]
  ds_read_b128 v[100:103], v16 offset:38912
  s_waitcnt lgkmcnt(10)
  v_mfma_f32_16x16x32_bf16 v[64:67], v[232:235], v[168:171], v[64:67]
  ds_read_b128 v[104:107], v16 offset:39936
  buffer_load_dwordx4 v[212:215], v32, s[8:11], s68 offen sc1
  buffer_load_dwordx4 v[148:151], v32, s[8:11], s68 offen offset:1024 sc1
  s_waitcnt lgkmcnt(0)
  s_mov_b32 s57, 0
L_58:
  ds_read_b128 v[12:15], v8 offset:0
  s_waitcnt lgkmcnt(0)
  v_min3_u32 v12, v12, v13, v14
  v_min_u32 v12, v12, v15
  s_nop 0
  v_readfirstlane_b32 s56, v12
  s_nop 3
  s_cmp_ge_u32 s56, 38
  s_cbranch_scc1 L_59
  s_add_u32 s57, s57, 1
  s_sleep 1
  s_cmp_lt_u32 s57, 0x400000
  s_cbranch_scc1 L_58
L_59:
  v_subrev_u32 v16, 102400, v16
  s_waitcnt vmcnt(11)
  v_mfma_f32_16x16x32_bf16 v[48:51], v[68:71], v[172:175], v[48:51]
  ds_read_b128 v[216:219], v16
  v_mfma_f32_16x16x32_bf16 v[52:55], v[72:75], v[172:175], v[52:55]
  ds_read_b128 v[220:223], v16 offset:1024
  v_mfma_f32_16x16x32_bf16 v[56:59], v[76:79], v[172:175], v[56:59]
  ds_read_b128 v[224:227], v16 offset:2048
  v_mfma_f32_16x16x32_bf16 v[60:63], v[80:83], v[172:175], v[60:63]
  ds_read_b128 v[228:231], v16 offset:3072
  v_mfma_f32_16x16x32_bf16 v[64:67], v[84:87], v[172:175], v[64:67]
  ds_read_b128 v[232:235], v16 offset:4096
  buffer_load_dwordx4 v[152:155], v32, s[8:11], s68 offen offset:2048 sc1
  buffer_load_dwordx4 v[156:159], v32, s[8:11], s68 offen offset:3072 sc1
  s_add_u32 s68, s68, 4096
  s_waitcnt vmcnt(12)
  v_mfma_f32_16x16x32_bf16 v[48:51], v[88:91], v[176:179], v[48:51]
  ds_read_b128 v[68:71], v16 offset:5120
  v_mfma_f32_16x16x32_bf16 v[52:55], v[92:95], v[176:179], v[52:55]
  ds_read_b128 v[72:75], v16 offset:6144
  v_mfma_f32_16x16x32_bf16 v[56:59], v[96:99], v[176:179], v[56:59]
  ds_read_b128 v[76:79], v16 offset:7168
  v_mfma_f32_16x16x32_bf16 v[60:63], v[100:103], v[176:179], v[60:63]
  ds_read_b128 v[80:83], v16 offset:8192
  v_mfma_f32_16x16x32_bf16 v[64:67], v[104:107], v[176:179], v[64:67]
  ds_read_b128 v[84:87], v16 offset:9216
  buffer_load_dwordx4 v[160:163], v32, s[8:11], s68 offen sc1
  buffer_load_dwordx4 v[164:167], v32, s[8:11], s68 offen offset:1024 sc1
  v_mov_b32 v10, 37
  ds_write_b32 v11, v10 offset:16
  s_waitcnt vmcnt(13) lgkmcnt(10)
  v_mfma_f32_16x16x32_bf16 v[48:51], v[216:219], v[180:183], v[48:51]
  ds_read_b128 v[88:91], v16 offset:10240
  s_waitcnt lgkmcnt(10)
  v_mfma_f32_16x16x32_bf16 v[52:55], v[220:223], v[180:183], v[52:55]
  ds_read_b128 v[92:95], v16 offset:11264
  s_waitcnt lgkmcnt(10)
  v_mfma_f32_16x16x32_bf16 v[56:59], v[224:227], v[180:183], v[56:59]
  ds_read_b128 v[96:99], v16 offset:12288
  s_waitcnt lgkmcnt(10)
  v_mfma_f32_16x16x32_bf16 v[60:63], v[228:231], v[180:183], v[60:63]
  ds_read_b128 v[100:103], v16 offset:13312
  s_waitcnt lgkmcnt(10)
  v_mfma_f32_16x16x32_bf16 v[64:67], v[232:235], v[180:183], v[64:67]
  ds_read_b128 v[104:107], v16 offset:14336
  buffer_load_dwordx4 v[168:171], v32, s[8:11], s68 offen offset:2048 sc1
  buffer_load_dwordx4 v[172:175], v32, s[8:11], s68 offen offset:3072 sc1
  s_add_u32 s68, s68, 4096
  s_waitcnt vmcnt(14) lgkmcnt(10)
  v_mfma_f32_16x16x32_bf16 v[48:51], v[68:71], v[184:187], v[48:51]
  ds_read_b128 v[216:219], v16 offset:15360
  s_waitcnt lgkmcnt(10)
  v_mfma_f32_16x16x32_bf16 v[52:55], v[72:75], v[184:187], v[52:55]
  ds_read_b128 v[220:223], v16 offset:16384
  s_waitcnt lgkmcnt(10)
  v_mfma_f32_16x16x32_bf16 v[56:59], v[76:79], v[184:187], v[56:59]
  ds_read_b128 v[224:227], v16 offset:17408
  s_waitcnt lgkmcnt(10)
  v_mfma_f32_16x16x32_bf16 v[60:63], v[80:83], v[184:187], v[60:63]
  ds_read_b128 v[228:231], v16 offset:18432
  s_waitcnt lgkmcnt(10)
  v_mfma_f32_16x16x32_bf16 v[64:67], v[84:87], v[184:187], v[64:67]
  ds_read_b128 v[232:235], v16 offset:19456
  buffer_load_dwordx4 v[176:179], v32, s[8:11], s68 offen sc1
  buffer_load_dwordx4 v[180:183], v32, s[8:11], s68 offen offset:1024 sc1
  s_waitcnt lgkmcnt(0)
  s_mov_b32 s57, 0
L_60:
  ds_read_b128 v[12:15], v8 offset:0
  s_waitcnt lgkmcnt(0)
  v_min3_u32 v12, v12, v13, v14
  v_min_u32 v12, v12, v15
  s_nop 0
  v_readfirstlane_b32 s56, v12
  s_nop 3
  s_cmp_ge_u32 s56, 39
  s_cbranch_scc1 L_61
  s_add_u32 s57, s57, 1
  s_sleep 1
  s_cmp_lt_u32 s57, 0x400000
  s_cbranch_scc1 L_60
L_61:
  s_waitcnt vmcnt(15)
  v_mfma_f32_16x16x32_bf16 v[48:51], v[88:91], v[188:191], v[48:51]
  ds_read_b128 v[68:71], v16 offset:20480
  v_mfma_f32_16x16x32_bf16 v[52:55], v[92:95], v[188:191], v[52:55]
  ds_read_b128 v[72:75], v16 offset:21504
  v_mfma_f32_16x16x32_bf16 v[56:59], v[96:99], v[188:191], v[56:59]
  ds_read_b128 v[76:79], v16 offset:22528
  v_mfma_f32_16x16x32_bf16 v[60:63], v[100:103], v[188:191], v[60:63]
  ds_read_b128 v[80:83], v16 offset:23552
  v_mfma_f32_16x16x32_bf16 v[64:67], v[104:107], v[188:191], v[64:67]
  ds_read_b128 v[84:87], v16 offset:24576
  buffer_load_dwordx4 v[184:187], v32, s[8:11], s68 offen offset:2048 sc1
  buffer_load_dwordx4 v[188:191], v32, s[8:11], s68 offen offset:3072 sc1
  s_add_u32 s68, s68, 4096
  s_waitcnt vmcnt(16)
  v_mfma_f32_16x16x32_bf16 v[48:51], v[216:219], v[192:195], v[48:51]
  ds_read_b128 v[88:91], v16 offset:25600
  v_mfma_f32_16x16x32_bf16 v[52:55], v[220:223], v[192:195], v[52:55]
  ds_read_b128 v[92:95], v16 offset:26624
  v_mfma_f32_16x16x32_bf16 v[56:59], v[224:227], v[192:195], v[56:59]
  ds_read_b128 v[96:99], v16 offset:27648
  v_mfma_f32_16x16x32_bf16 v[60:63], v[228:231], v[192:195], v[60:63]
  ds_read_b128 v[100:103], v16 offset:28672
  v_mfma_f32_16x16x32_bf16 v[64:67], v[232:235], v[192:195], v[64:67]
  ds_read_b128 v[104:107], v16 offset:29696
  buffer_load_dwordx4 v[192:195], v32, s[8:11], s68 offen sc1
  v_mov_b32 v10, 38
  ds_write_b32 v11, v10 offset:16
  s_waitcnt vmcnt(16) lgkmcnt(10)
  v_mfma_f32_16x16x32_bf16 v[48:51], v[68:71], v[196:199], v[48:51]
  ds_read_b128 v[216:219], v16 offset:30720
  s_waitcnt lgkmcnt(10)
  v_mfma_f32_16x16x32_bf16 v[52:55], v[72:75], v[196:199], v[52:55]
  ds_read_b128 v[220:223], v16 offset:31744
  s_waitcnt lgkmcnt(10)
  v_mfma_f32_16x16x32_bf16 v[56:59], v[76:79], v[196:199], v[56:59]
  ds_read_b128 v[224:227], v16 offset:32768
  s_waitcnt lgkmcnt(10)
  v_mfma_f32_16x16x32_bf16 v[60:63], v[80:83], v[196:199], v[60:63]
  ds_read_b128 v[228:231], v16 offset:33792
  s_waitcnt lgkmcnt(10)
  v_mfma_f32_16x16x32_bf16 v[64:67], v[84:87], v[196:199], v[64:67]
  ds_read_b128 v[232:235], v16 offset:34816
  buffer_load_dwordx4 v[196:199], v32, s[8:11], s68 offen offset:1024 sc1
  s_waitcnt vmcnt(16) lgkmcnt(10)
  v_mfma_f32_16x16x32_bf16 v[48:51], v[88:91], v[200:203], v[48:51]
  ds_read_b128 v[68:71], v16 offset:35840
  s_waitcnt lgkmcnt(10)
  v_mfma_f32_16x16x32_bf16 v[52:55], v[92:95], v[200:203], v[52:55]
  ds_read_b128 v[72:75], v16 offset:36864
  s_waitcnt lgkmcnt(10)
  v_mfma_f32_16x16x32_bf16 v[56:59], v[96:99], v[200:203], v[56:59]
  ds_read_b128 v[76:79], v16 offset:37888
  s_waitcnt lgkmcnt(10)
  v_mfma_f32_16x16x32_bf16 v[60:63], v[100:103], v[200:203], v[60:63]
  ds_read_b128 v[80:83], v16 offset:38912
  s_waitcnt lgkmcnt(10)
  v_mfma_f32_16x16x32_bf16 v[64:67], v[104:107], v[200:203], v[64:67]
  ds_read_b128 v[84:87], v16 offset:39936
  buffer_load_dwordx4 v[200:203], v32, s[8:11], s68 offen offset:2048 sc1
  s_waitcnt lgkmcnt(0)
  s_mov_b32 s57, 0
L_62:
  ds_read_b128 v[12:15], v8 offset:0
  s_waitcnt lgkmcnt(0)
  v_min3_u32 v12, v12, v13, v14
  v_min_u32 v12, v12, v15
  s_nop 0
  v_readfirstlane_b32 s56, v12
  s_nop 3
  s_cmp_ge_u32 s56, 40
  s_cbranch_scc1 L_63
  s_add_u32 s57, s57, 1
  s_sleep 1
  s_cmp_lt_u32 s57, 0x400000
  s_cbranch_scc1 L_62
L_63:
  s_waitcnt vmcnt(16)
  v_mfma_f32_16x16x32_bf16 v[48:51], v[216:219], v[204:207], v[48:51]
  ds_read_b128 v[88:91], v16 offset:40960
  v_mfma_f32_16x16x32_bf16 v[52:55], v[220:223], v[204:207], v[52:55]
  ds_read_b128 v[92:95], v16 offset:41984
  v_mfma_f32_16x16x32_bf16 v[56:59], v[224:227], v[204:207], v[56:59]
  ds_read_b128 v[96:99], v16 offset:43008
  v_mfma_f32_16x16x32_bf16 v[60:63], v[228:231], v[204:207], v[60:63]
  ds_read_b128 v[100:103], v16 offset:44032
  v_mfma_f32_16x16x32_bf16 v[64:67], v[232:235], v[204:207], v[64:67]
  ds_read_b128 v[104:107], v16 offset:45056
  buffer_load_dwordx4 v[204:207], v32, s[8:11], s68 offen offset:3072 sc1
  s_add_u32 s68, s68, 4096
  s_waitcnt vmcnt(16)
  v_mfma_f32_16x16x32_bf16 v[48:51], v[68:71], v[208:211], v[48:51]
  ds_read_b128 v[216:219], v16 offset:46080
  v_mfma_f32_16x16x32_bf16 v[52:55], v[72:75], v[208:211], v[52:55]
  ds_read_b128 v[220:223], v16 offset:47104
  v_mfma_f32_16x16x32_bf16 v[56:59], v[76:79], v[208:211], v[56:59]
  ds_read_b128 v[224:227], v16 offset:48128
  v_mfma_f32_16x16x32_bf16 v[60:63], v[80:83], v[208:211], v[60:63]
  ds_read_b128 v[228:231], v16 offset:49152
  v_mfma_f32_16x16x32_bf16 v[64:67], v[84:87], v[208:211], v[64:67]
  ds_read_b128 v[232:235], v16 offset:50176
  buffer_load_dwordx4 v[208:211], v32, s[8:11], s68 offen sc1
  v_mov_b32 v10, 39
  ds_write_b32 v11, v10 offset:16
  s_waitcnt vmcnt(16) lgkmcnt(10)
  v_mfma_f32_16x16x32_bf16 v[48:51], v[88:91], v[212:215], v[48:51]
  ds_read_b128 v[68:71], v16 offset:51200
  s_waitcnt lgkmcnt(10)
  v_mfma_f32_16x16x32_bf16 v[52:55], v[92:95], v[212:215], v[52:55]
  ds_read_b128 v[72:75], v16 offset:52224
  s_waitcnt lgkmcnt(10)
  v_mfma_f32_16x16x32_bf16 v[56:59], v[96:99], v[212:215], v[56:59]
  ds_read_b128 v[76:79], v16 offset:53248
  s_waitcnt lgkmcnt(10)
  v_mfma_f32_16x16x32_bf16 v[60:63], v[100:103], v[212:215], v[60:63]
  ds_read_b128 v[80:83], v16 offset:54272
  s_waitcnt lgkmcnt(10)
  v_mfma_f32_16x16x32_bf16 v[64:67], v[104:107], v[212:215], v[64:67]
  ds_read_b128 v[84:87], v16 offset:55296
  buffer_load_dwordx4 v[212:215], v32, s[8:11], s68 offen offset:1024 sc1
  s_waitcnt vmcnt(16) lgkmcnt(10)
  v_mfma_f32_16x16x32_bf16 v[48:51], v[216:219], v[148:151], v[48:51]
  ds_read_b128 v[88:91], v16 offset:56320
  s_waitcnt lgkmcnt(10)
  v_mfma_f32_16x16x32_bf16 v[52:55], v[220:223], v[148:151], v[52:55]
  ds_read_b128 v[92:95], v16 offset:57344
  s_waitcnt lgkmcnt(10)
  v_mfma_f32_16x16x32_bf16 v[56:59], v[224:227], v[148:151], v[56:59]
  ds_read_b128 v[96:99], v16 offset:58368
  s_waitcnt lgkmcnt(10)
  v_mfma_f32_16x16x32_bf16 v[60:63], v[228:231], v[148:151], v[60:63]
  ds_read_b128 v[100:103], v16 offset:59392
  s_waitcnt lgkmcnt(10)
  v_mfma_f32_16x16x32_bf16 v[64:67], v[232:235], v[148:151], v[64:67]
  ds_read_b128 v[104:107], v16 offset:60416
  buffer_load_dwordx4 v[148:151], v32, s[8:11], s68 offen offset:2048 sc1
  s_waitcnt lgkmcnt(0)
  s_mov_b32 s57, 0
L_64:
  ds_read_b128 v[12:15], v8 offset:0
  s_waitcnt lgkmcnt(0)
  v_min3_u32 v12, v12, v13, v14
  v_min_u32 v12, v12, v15
  s_nop 0
  v_readfirstlane_b32 s56, v12
  s_nop 3
  s_cmp_ge_u32 s56, 41
  s_cbranch_scc1 L_65
  s_add_u32 s57, s57, 1
  s_sleep 1
  s_cmp_lt_u32 s57, 0x400000
  s_cbranch_scc1 L_64
L_65:
  v_add_u32 v16, 61440, v16
  s_waitcnt vmcnt(16)
  v_mfma_f32_16x16x32_bf16 v[48:51], v[68:71], v[152:155], v[48:51]
  ds_read_b128 v[216:219], v16
  v_mfma_f32_16x16x32_bf16 v[52:55], v[72:75], v[152:155], v[52:55]
  ds_read_b128 v[220:223], v16 offset:1024
  v_mfma_f32_16x16x32_bf16 v[56:59], v[76:79], v[152:155], v[56:59]
  ds_read_b128 v[224:227], v16 offset:2048
  v_mfma_f32_16x16x32_bf16 v[60:63], v[80:83], v[152:155], v[60:63]
  ds_read_b128 v[228:231], v16 offset:3072
  v_mfma_f32_16x16x32_bf16 v[64:67], v[84:87], v[152:155], v[64:67]
  ds_read_b128 v[232:235], v16 offset:4096
  buffer_load_dwordx4 v[152:155], v32, s[8:11], s68 offen offset:3072 sc1
  s_add_u32 s68, s68, 4096
  s_waitcnt vmcnt(16)
  v_mfma_f32_16x16x32_bf16 v[48:51], v[88:91], v[156:159], v[48:51]
  ds_read_b128 v[68:71], v16 offset:5120
  v_mfma_f32_16x16x32_bf16 v[52:55], v[92:95], v[156:159], v[52:55]
  ds_read_b128 v[72:75], v16 offset:6144
  v_mfma_f32_16x16x32_bf16 v[56:59], v[96:99], v[156:159], v[56:59]
  ds_read_b128 v[76:79], v16 offset:7168
  v_mfma_f32_16x16x32_bf16 v[60:63], v[100:103], v[156:159], v[60:63]
  ds_read_b128 v[80:83], v16 offset:8192
  v_mfma_f32_16x16x32_bf16 v[64:67], v[104:107], v[156:159], v[64:67]
  ds_read_b128 v[84:87], v16 offset:9216
  buffer_load_dwordx4 v[156:159], v32, s[8:11], s68 offen sc1
  v_mov_b32 v10, 40
  ds_write_b32 v11, v10 offset:16
  s_waitcnt vmcnt(16) lgkmcnt(10)
  v_mfma_f32_16x16x32_bf16 v[48:51], v[216:219], v[160:163], v[48:51]
  ds_read_b128 v[88:91], v16 offset:10240
  s_waitcnt lgkmcnt(10)
  v_mfma_f32_16x16x32_bf16 v[52:55], v[220:223], v[160:163], v[52:55]
  ds_read_b128 v[92:95], v16 offset:11264
  s_waitcnt lgkmcnt(10)
  v_mfma_f32_16x16x32_bf16 v[56:59], v[224:227], v[160:163], v[56:59]
  ds_read_b128 v[96:99], v16 offset:12288
  s_waitcnt lgkmcnt(10)
  v_mfma_f32_16x16x32_bf16 v[60:63], v[228:231], v[160:163], v[60:63]
  ds_read_b128 v[100:103], v16 offset:13312
  s_waitcnt lgkmcnt(10)
  v_mfma_f32_16x16x32_bf16 v[64:67], v[232:235], v[160:163], v[64:67]
  ds_read_b128 v[104:107], v16 offset:14336
  buffer_load_dwordx4 v[160:163], v32, s[8:11], s68 offen offset:1024 sc1
  s_waitcnt vmcnt(16) lgkmcnt(10)
  v_mfma_f32_16x16x32_bf16 v[48:51], v[68:71], v[164:167], v[48:51]
  ds_read_b128 v[216:219], v16 offset:15360
  s_waitcnt lgkmcnt(10)
  v_mfma_f32_16x16x32_bf16 v[52:55], v[72:75], v[164:167], v[52:55]
  ds_read_b128 v[220:223], v16 offset:16384
  s_waitcnt lgkmcnt(10)
  v_mfma_f32_16x16x32_bf16 v[56:59], v[76:79], v[164:167], v[56:59]
  ds_read_b128 v[224:227], v16 offset:17408
  s_waitcnt lgkmcnt(10)
  v_mfma_f32_16x16x32_bf16 v[60:63], v[80:83], v[164:167], v[60:63]
  ds_read_b128 v[228:231], v16 offset:18432
  s_waitcnt lgkmcnt(10)
  v_mfma_f32_16x16x32_bf16 v[64:67], v[84:87], v[164:167], v[64:67]
  ds_read_b128 v[232:235], v16 offset:19456
  buffer_load_dwordx4 v[164:167], v32, s[8:11], s68 offen offset:2048 sc1
  s_waitcnt lgkmcnt(0)
  s_mov_b32 s57, 0
L_66:
  ds_read_b128 v[12:15], v8 offset:0
  s_waitcnt lgkmcnt(0)
  v_min3_u32 v12, v12, v13, v14
  v_min_u32 v12, v12, v15
  s_nop 0
  v_readfirstlane_b32 s56, v12
  s_nop 3
  s_cmp_ge_u32 s56, 42
  s_cbranch_scc1 L_67
  s_add_u32 s57, s57, 1
  s_sleep 1
  s_cmp_lt_u32 s57, 0x400000
  s_cbranch_scc1 L_66
L_67:
  s_waitcnt vmcnt(16)
  v_mfma_f32_16x16x32_bf16 v[48:51], v[88:91], v[168:171], v[48:51]
  ds_read_b128 v[68:71], v16 offset:20480
  v_mfma_f32_16x16x32_bf16 v[52:55], v[92:95], v[168:171], v[52:55]
  ds_read_b128 v[72:75], v16 offset:21504
  v_mfma_f32_16x16x32_bf16 v[56:59], v[96:99], v[168:171], v[56:59]
  ds_read_b128 v[76:79], v16 offset:22528
  v_mfma_f32_16x16x32_bf16 v[60:63], v[100:103], v[168:171], v[60:63]
  ds_read_b128 v[80:83], v16 offset:23552
  v_mfma_f32_16x16x32_bf16 v[64:67], v[104:107], v[168:171], v[64:67]
  ds_read_b128 v[84:87], v16 offset:24576
  buffer_load_dwordx4 v[168:171], v32, s[8:11], s68 offen offset:3072 sc1
  s_add_u32 s68, s68, 4096
  s_waitcnt vmcnt(16)
  v_mfma_f32_16x16x32_bf16 v[48:51], v[216:219], v[172:175], v[48:51]
  ds_read_b128 v[88:91], v16 offset:25600
  v_mfma_f32_16x16x32_bf16 v[52:55], v[220:223], v[172:175], v[52:55]
  ds_read_b128 v[92:95], v16 offset:26624
  v_mfma_f32_16x16x32_bf16 v[56:59], v[224:227], v[172:175], v[56:59]
  ds_read_b128 v[96:99], v16 offset:27648
  v_mfma_f32_16x16x32_bf16 v[60:63], v[228:231], v[172:175], v[60:63]
  ds_read_b128 v[100:103], v16 offset:28672
  v_mfma_f32_16x16x32_bf16 v[64:67], v[232:235], v[172:175], v[64:67]
  ds_read_b128 v[104:107], v16 offset:29696
  buffer_load_dwordx4 v[172:175], v32, s[8:11], s68 offen sc1
  v_mov_b32 v10, 41
  ds_write_b32 v11, v10 offset:16
  s_waitcnt vmcnt(16) lgkmcnt(10)
  v_mfma_f32_16x16x32_bf16 v[48:51], v[68:71], v[176:179], v[48:51]
  ds_read_b128 v[216:219], v16 offset:30720
  s_waitcnt lgkmcnt(10)
  v_mfma_f32_16x16x32_bf16 v[52:55], v[72:75], v[176:179], v[52:55]
  ds_read_b128 v[220:223], v16 offset:31744
  s_waitcnt lgkmcnt(10)
  v_mfma_f32_16x16x32_bf16 v[56:59], v[76:79], v[176:179], v[56:59]
  ds_read_b128 v[224:227], v16 offset:32768
  s_waitcnt lgkmcnt(10)
  v_mfma_f32_16x16x32_bf16 v[60:63], v[80:83], v[176:179], v[60:63]
  ds_read_b128 v[228:231], v16 offset:33792
  s_waitcnt lgkmcnt(10)
  v_mfma_f32_16x16x32_bf16 v[64:67], v[84:87], v[176:179], v[64:67]
  ds_read_b128 v[232:235], v16 offset:34816
  buffer_load_dwordx4 v[176:179], v32, s[8:11], s68 offen offset:1024 sc1
  s_waitcnt vmcnt(16) lgkmcnt(10)
  v_mfma_f32_16x16x32_bf16 v[48:51], v[88:91], v[180:183], v[48:51]
  ds_read_b128 v[68:71], v16 offset:35840
  s_waitcnt lgkmcnt(10)
  v_mfma_f32_16x16x32_bf16 v[52:55], v[92:95], v[180:183], v[52:55]
  ds_read_b128 v[72:75], v16 offset:36864
  s_waitcnt lgkmcnt(10)
  v_mfma_f32_16x16x32_bf16 v[56:59], v[96:99], v[180:183], v[56:59]
  ds_read_b128 v[76:79], v16 offset:37888
  s_waitcnt lgkmcnt(10)
  v_mfma_f32_16x16x32_bf16 v[60:63], v[100:103], v[180:183], v[60:63]
  ds_read_b128 v[80:83], v16 offset:38912
  s_waitcnt lgkmcnt(10)
  v_mfma_f32_16x16x32_bf16 v[64:67], v[104:107], v[180:183], v[64:67]
  ds_read_b128 v[84:87], v16 offset:39936
  buffer_load_dwordx4 v[180:183], v32, s[8:11], s68 offen offset:2048 sc1
  s_waitcnt lgkmcnt(0)
  s_mov_b32 s57, 0
L_68:
  ds_read_b128 v[12:15], v8 offset:0
  s_waitcnt lgkmcnt(0)
  v_min3_u32 v12, v12, v13, v14
  v_min_u32 v12, v12, v15
  s_nop 0
  v_readfirstlane_b32 s56, v12
  s_nop 3
  s_cmp_ge_u32 s56, 43
  s_cbranch_scc1 L_69
  s_add_u32 s57, s57, 1
  s_sleep 1
  s_cmp_lt_u32 s57, 0x400000
  s_cbranch_scc1 L_68
L_69:
  s_waitcnt vmcnt(16)
  v_mfma_f32_16x16x32_bf16 v[48:51], v[216:219], v[184:187], v[48:51]
  ds_read_b128 v[88:91], v16 offset:40960
  v_mfma_f32_16x16x32_bf16 v[52:55], v[220:223], v[184:187], v[52:55]
  ds_read_b128 v[92:95], v16 offset:41984
  v_mfma_f32_16x16x32_bf16 v[56:59], v[224:227], v[184:187], v[56:59]
  ds_read_b128 v[96:99], v16 offset:43008
  v_mfma_f32_16x16x32_bf16 v[60:63], v[228:231], v[184:187], v[60:63]
  ds_read_b128 v[100:103], v16 offset:44032
  v_mfma_f32_16x16x32_bf16 v[64:67], v[232:235], v[184:187], v[64:67]
  ds_read_b128 v[104:107], v16 offset:45056
  buffer_load_dwordx4 v[184:187], v32, s[8:11], s68 offen offset:3072 sc1
  s_add_u32 s68, s68, 4096
  s_waitcnt vmcnt(16)
  v_mfma_f32_16x16x32_bf16 v[48:51], v[68:71], v[188:191], v[48:51]
  ds_read_b128 v[216:219], v16 offset:46080
  v_mfma_f32_16x16x32_bf16 v[52:55], v[72:75], v[188:191], v[52:55]
  ds_read_b128 v[220:223], v16 offset:47104
  v_mfma_f32_16x16x32_bf16 v[56:59], v[76:79], v[188:191], v[56:59]
  ds_read_b128 v[224:227], v16 offset:48128
  v_mfma_f32_16x16x32_bf16 v[60:63], v[80:83], v[188:191], v[60:63]
  ds_read_b128 v[228:231], v16 offset:49152
  v_mfma_f32_16x16x32_bf16 v[64:67], v[84:87], v[188:191], v[64:67]
  ds_read_b128 v[232:235], v16 offset:50176
  buffer_load_dwordx4 v[188:191], v32, s[8:11], s68 offen sc1
  v_mov_b32 v10, 42
  ds_write_b32 v11, v10 offset:16
  s_waitcnt vmcnt(16) lgkmcnt(10)
  v_mfma_f32_16x16x32_bf16 v[48:51], v[88:91], v[192:195], v[48:51]
  ds_read_b128 v[68:71], v16 offset:51200
  s_waitcnt lgkmcnt(10)
  v_mfma_f32_16x16x32_bf16 v[52:55], v[92:95], v[192:195], v[52:55]
  ds_read_b128 v[72:75], v16 offset:52224
  s_waitcnt lgkmcnt(10)
  v_mfma_f32_16x16x32_bf16 v[56:59], v[96:99], v[192:195], v[56:59]
  ds_read_b128 v[76:79], v16 offset:53248
  s_waitcnt lgkmcnt(10)
  v_mfma_f32_16x16x32_bf16 v[60:63], v[100:103], v[192:195], v[60:63]
  ds_read_b128 v[80:83], v16 offset:54272
  s_waitcnt lgkmcnt(10)
  v_mfma_f32_16x16x32_bf16 v[64:67], v[104:107], v[192:195], v[64:67]
  ds_read_b128 v[84:87], v16 offset:55296
  buffer_load_dwordx4 v[192:195], v32, s[8:11], s68 offen offset:1024 sc1
  s_waitcnt vmcnt(16) lgkmcnt(10)
  v_mfma_f32_16x16x32_bf16 v[48:51], v[216:219], v[196:199], v[48:51]
  ds_read_b128 v[88:91], v16 offset:56320
  s_waitcnt lgkmcnt(10)
  v_mfma_f32_16x16x32_bf16 v[52:55], v[220:223], v[196:199], v[52:55]
  ds_read_b128 v[92:95], v16 offset:57344
  s_waitcnt lgkmcnt(10)
  v_mfma_f32_16x16x32_bf16 v[56:59], v[224:227], v[196:199], v[56:59]
  ds_read_b128 v[96:99], v16 offset:58368
  s_waitcnt lgkmcnt(10)
  v_mfma_f32_16x16x32_bf16 v[60:63], v[228:231], v[196:199], v[60:63]
  ds_read_b128 v[100:103], v16 offset:59392
  s_waitcnt lgkmcnt(10)
  v_mfma_f32_16x16x32_bf16 v[64:67], v[232:235], v[196:199], v[64:67]
  ds_read_b128 v[104:107], v16 offset:60416
  buffer_load_dwordx4 v[196:199], v32, s[8:11], s68 offen offset:2048 sc1
  s_waitcnt lgkmcnt(0)
  s_mov_b32 s57, 0
L_70:
  ds_read_b128 v[12:15], v8 offset:0
  s_waitcnt lgkmcnt(0)
  v_min3_u32 v12, v12, v13, v14
  v_min_u32 v12, v12, v15
  s_nop 0
  v_readfirstlane_b32 s56, v12
  s_nop 3
  s_cmp_ge_u32 s56, 44
  s_cbranch_scc1 L_71
  s_add_u32 s57, s57, 1
  s_sleep 1
  s_cmp_lt_u32 s57, 0x400000
  s_cbranch_scc1 L_70
L_71:
  v_add_u32 v16, 61440, v16
  s_waitcnt vmcnt(16)
  v_mfma_f32_16x16x32_bf16 v[48:51], v[68:71], v[200:203], v[48:51]
  ds_read_b128 v[216:219], v16
  v_mfma_f32_16x16x32_bf16 v[52:55], v[72:75], v[200:203], v[52:55]
  ds_read_b128 v[220:223], v16 offset:1024
  v_mfma_f32_16x16x32_bf16 v[56:59], v[76:79], v[200:203], v[56:59]
  ds_read_b128 v[224:227], v16 offset:2048
  v_mfma_f32_16x16x32_bf16 v[60:63], v[80:83], v[200:203], v[60:63]
  ds_read_b128 v[228:231], v16 offset:3072
  v_mfma_f32_16x16x32_bf16 v[64:67], v[84:87], v[200:203], v[64:67]
  ds_read_b128 v[232:235], v16 offset:4096
  buffer_load_dwordx4 v[200:203], v32, s[8:11], s68 offen offset:3072 sc1
  s_add_u32 s68, s68, 4096
  s_waitcnt vmcnt(16)
  v_mfma_f32_16x16x32_bf16 v[48:51], v[88:91], v[204:207], v[48:51]
  ds_read_b128 v[68:71], v16 offset:5120
  v_mfma_f32_16x16x32_bf16 v[52:55], v[92:95], v[204:207], v[52:55]
  ds_read_b128 v[72:75], v16 offset:6144
  v_mfma_f32_16x16x32_bf16 v[56:59], v[96:99], v[204:207], v[56:59]
  ds_read_b128 v[76:79], v16 offset:7168
  v_mfma_f32_16x16x32_bf16 v[60:63], v[100:103], v[204:207], v[60:63]
  ds_read_b128 v[80:83], v16 offset:8192
  v_mfma_f32_16x16x32_bf16 v[64:67], v[104:107], v[204:207], v[64:67]
  ds_read_b128 v[84:87], v16 offset:9216
  buffer_load_dwordx4 v[204:207], v32, s[8:11], s68 offen sc1
  v_mov_b32 v10, 43
  ds_write_b32 v11, v10 offset:16
  s_waitcnt vmcnt(16) lgkmcnt(10)
  v_mfma_f32_16x16x32_bf16 v[48:51], v[216:219], v[208:211], v[48:51]
  ds_read_b128 v[88:91], v16 offset:10240
  s_waitcnt lgkmcnt(10)
  v_mfma_f32_16x16x32_bf16 v[52:55], v[220:223], v[208:211], v[52:55]
  ds_read_b128 v[92:95], v16 offset:11264
  s_waitcnt lgkmcnt(10)
  v_mfma_f32_16x16x32_bf16 v[56:59], v[224:227], v[208:211], v[56:59]
  ds_read_b128 v[96:99], v16 offset:12288
  s_waitcnt lgkmcnt(10)
  v_mfma_f32_16x16x32_bf16 v[60:63], v[228:231], v[208:211], v[60:63]
  ds_read_b128 v[100:103], v16 offset:13312
  s_waitcnt lgkmcnt(10)
  v_mfma_f32_16x16x32_bf16 v[64:67], v[232:235], v[208:211], v[64:67]
  ds_read_b128 v[104:107], v16 offset:14336
  buffer_load_dwordx4 v[208:211], v32, s[8:11], s68 offen offset:1024 sc1
  s_waitcnt vmcnt(16) lgkmcnt(10)
  v_mfma_f32_16x16x32_bf16 v[48:51], v[68:71], v[212:215], v[48:51]
  ds_read_b128 v[216:219], v16 offset:15360
  s_waitcnt lgkmcnt(10)
  v_mfma_f32_16x16x32_bf16 v[52:55], v[72:75], v[212:215], v[52:55]
  ds_read_b128 v[220:223], v16 offset:16384
  s_waitcnt lgkmcnt(10)
  v_mfma_f32_16x16x32_bf16 v[56:59], v[76:79], v[212:215], v[56:59]
  ds_read_b128 v[224:227], v16 offset:17408
  s_waitcnt lgkmcnt(10)
  v_mfma_f32_16x16x32_bf16 v[60:63], v[80:83], v[212:215], v[60:63]
  ds_read_b128 v[228:231], v16 offset:18432
  s_waitcnt lgkmcnt(10)
  v_mfma_f32_16x16x32_bf16 v[64:67], v[84:87], v[212:215], v[64:67]
  ds_read_b128 v[232:235], v16 offset:19456
  buffer_load_dwordx4 v[212:215], v32, s[8:11], s68 offen offset:2048 sc1
  s_waitcnt lgkmcnt(0)
  s_mov_b32 s57, 0
L_72:
  ds_read_b128 v[12:15], v8 offset:0
  s_waitcnt lgkmcnt(0)
  v_min3_u32 v12, v12, v13, v14
  v_min_u32 v12, v12, v15
  s_nop 0
  v_readfirstlane_b32 s56, v12
  s_nop 3
  s_cmp_ge_u32 s56, 45
  s_cbranch_scc1 L_73
  s_add_u32 s57, s57, 1
  s_sleep 1
  s_cmp_lt_u32 s57, 0x400000
  s_cbranch_scc1 L_72
L_73:
  v_subrev_u32 v16, 122880, v16
  s_waitcnt vmcnt(16)
  v_mfma_f32_16x16x32_bf16 v[48:51], v[88:91], v[148:151], v[48:51]
  ds_read_b128 v[68:71], v16
  v_mfma_f32_16x16x32_bf16 v[52:55], v[92:95], v[148:151], v[52:55]
  ds_read_b128 v[72:75], v16 offset:1024
  v_mfma_f32_16x16x32_bf16 v[56:59], v[96:99], v[148:151], v[56:59]
  ds_read_b128 v[76:79], v16 offset:2048
  v_mfma_f32_16x16x32_bf16 v[60:63], v[100:103], v[148:151], v[60:63]
  ds_read_b128 v[80:83], v16 offset:3072
  v_mfma_f32_16x16x32_bf16 v[64:67], v[104:107], v[148:151], v[64:67]
  ds_read_b128 v[84:87], v16 offset:4096
  buffer_load_dwordx4 v[148:151], v32, s[8:11], s68 offen offset:3072 sc1
  s_add_u32 s68, s68, 4096
  s_waitcnt vmcnt(16)
  v_mfma_f32_16x16x32_bf16 v[48:51], v[216:219], v[152:155], v[48:51]
  ds_read_b128 v[88:91], v16 offset:5120
  v_mfma_f32_16x16x32_bf16 v[52:55], v[220:223], v[152:155], v[52:55]
  ds_read_b128 v[92:95], v16 offset:6144
  v_mfma_f32_16x16x32_bf16 v[56:59], v[224:227], v[152:155], v[56:59]
  ds_read_b128 v[96:99], v16 offset:7168
  v_mfma_f32_16x16x32_bf16 v[60:63], v[228:231], v[152:155], v[60:63]
  ds_read_b128 v[100:103], v16 offset:8192
  v_mfma_f32_16x16x32_bf16 v[64:67], v[232:235], v[152:155], v[64:67]
  ds_read_b128 v[104:107], v16 offset:9216
  buffer_load_dwordx4 v[152:155], v32, s[8:11], s68 offen sc1
  v_mov_b32 v10, 44
  ds_write_b32 v11, v10 offset:16
  s_waitcnt vmcnt(16) lgkmcnt(10)
  v_mfma_f32_16x16x32_bf16 v[48:51], v[68:71], v[156:159], v[48:51]
  ds_read_b128 v[216:219], v16 offset:10240
  s_waitcnt lgkmcnt(10)
  v_mfma_f32_16x16x32_bf16 v[52:55], v[72:75], v[156:159], v[52:55]
  ds_read_b128 v[220:223], v16 offset:11264
  s_waitcnt lgkmcnt(10)
  v_mfma_f32_16x16x32_bf16 v[56:59], v[76:79], v[156:159], v[56:59]
  ds_read_b128 v[224:227], v16 offset:12288
  s_waitcnt lgkmcnt(10)
  v_mfma_f32_16x16x32_bf16 v[60:63], v[80:83], v[156:159], v[60:63]
  ds_read_b128 v[228:231], v16 offset:13312
  s_waitcnt lgkmcnt(10)
  v_mfma_f32_16x16x32_bf16 v[64:67], v[84:87], v[156:159], v[64:67]
  ds_read_b128 v[232:235], v16 offset:14336
  buffer_load_dwordx4 v[156:159], v32, s[8:11], s68 offen offset:1024 sc1
  s_waitcnt vmcnt(16) lgkmcnt(10)
  v_mfma_f32_16x16x32_bf16 v[48:51], v[88:91], v[160:163], v[48:51]
  ds_read_b128 v[68:71], v16 offset:15360
  s_waitcnt lgkmcnt(10)
  v_mfma_f32_16x16x32_bf16 v[52:55], v[92:95], v[160:163], v[52:55]
  ds_read_b128 v[72:75], v16 offset:16384
  s_waitcnt lgkmcnt(10)
  v_mfma_f32_16x16x32_bf16 v[56:59], v[96:99], v[160:163], v[56:59]
  ds_read_b128 v[76:79], v16 offset:17408
  s_waitcnt lgkmcnt(10)
  v_mfma_f32_16x16x32_bf16 v[60:63], v[100:103], v[160:163], v[60:63]
  ds_read_b128 v[80:83], v16 offset:18432
  s_waitcnt lgkmcnt(10)
  v_mfma_f32_16x16x32_bf16 v[64:67], v[104:107], v[160:163], v[64:67]
  ds_read_b128 v[84:87], v16 offset:19456
  s_waitcnt lgkmcnt(0)
  s_mov_b32 s57, 0
L_74:
  ds_read_b128 v[12:15], v8 offset:0
  s_waitcnt lgkmcnt(0)
  v_min3_u32 v12, v12, v13, v14
  v_min_u32 v12, v12, v15
  s_nop 0
  v_readfirstlane_b32 s56, v12
  s_nop 3
  s_cmp_ge_u32 s56, 46
  s_cbranch_scc1 L_75
  s_add_u32 s57, s57, 1
  s_sleep 1
  s_cmp_lt_u32 s57, 0x400000
  s_cbranch_scc1 L_74
L_75:
  s_waitcnt vmcnt(15)
  v_mfma_f32_16x16x32_bf16 v[48:51], v[216:219], v[164:167], v[48:51]
  ds_read_b128 v[88:91], v16 offset:20480
  v_mfma_f32_16x16x32_bf16 v[52:55], v[220:223], v[164:167], v[52:55]
  ds_read_b128 v[92:95], v16 offset:21504
  v_mfma_f32_16x16x32_bf16 v[56:59], v[224:227], v[164:167], v[56:59]
  ds_read_b128 v[96:99], v16 offset:22528
  v_mfma_f32_16x16x32_bf16 v[60:63], v[228:231], v[164:167], v[60:63]
  ds_read_b128 v[100:103], v16 offset:23552
  v_mfma_f32_16x16x32_bf16 v[64:67], v[232:235], v[164:167], v[64:67]
  ds_read_b128 v[104:107], v16 offset:24576
  s_waitcnt vmcnt(14)
  v_mfma_f32_16x16x32_bf16 v[48:51], v[68:71], v[168:171], v[48:51]
  ds_read_b128 v[216:219], v16 offset:25600
  v_mfma_f32_16x16x32_bf16 v[52:55], v[72:75], v[168:171], v[52:55]
  ds_read_b128 v[220:223], v16 offset:26624
  v_mfma_f32_16x16x32_bf16 v[56:59], v[76:79], v[168:171], v[56:59]
  ds_read_b128 v[224:227], v16 offset:27648
  v_mfma_f32_16x16x32_bf16 v[60:63], v[80:83], v[168:171], v[60:63]
  ds_read_b128 v[228:231], v16 offset:28672
  v_mfma_f32_16x16x32_bf16 v[64:67], v[84:87], v[168:171], v[64:67]
  ds_read_b128 v[232:235], v16 offset:29696
  v_mov_b32 v10, 45
  ds_write_b32 v11, v10 offset:16
  s_waitcnt vmcnt(13) lgkmcnt(10)
  v_mfma_f32_16x16x32_bf16 v[48:51], v[88:91], v[172:175], v[48:51]
  ds_read_b128 v[68:71], v16 offset:30720
  s_waitcnt lgkmcnt(10)
  v_mfma_f32_16x16x32_bf16 v[52:55], v[92:95], v[172:175], v[52:55]
  ds_read_b128 v[72:75], v16 offset:31744
  s_waitcnt lgkmcnt(10)
  v_mfma_f32_16x16x32_bf16 v[56:59], v[96:99], v[172:175], v[56:59]
  ds_read_b128 v[76:79], v16 offset:32768
  s_waitcnt lgkmcnt(10)
  v_mfma_f32_16x16x32_bf16 v[60:63], v[100:103], v[172:175], v[60:63]
  ds_read_b128 v[80:83], v16 offset:33792
  s_waitcnt lgkmcnt(10)
  v_mfma_f32_16x16x32_bf16 v[64:67], v[104:107], v[172:175], v[64:67]
  ds_read_b128 v[84:87], v16 offset:34816
  s_waitcnt vmcnt(12) lgkmcnt(10)
  v_mfma_f32_16x16x32_bf16 v[48:51], v[216:219], v[176:179], v[48:51]
  ds_read_b128 v[88:91], v16 offset:35840
  s_waitcnt lgkmcnt(10)
  v_mfma_f32_16x16x32_bf16 v[52:55], v[220:223], v[176:179], v[52:55]
  ds_read_b128 v[92:95], v16 offset:36864
  s_waitcnt lgkmcnt(10)
  v_mfma_f32_16x16x32_bf16 v[56:59], v[224:227], v[176:179], v[56:59]
  ds_read_b128 v[96:99], v16 offset:37888
  s_waitcnt lgkmcnt(10)
  v_mfma_f32_16x16x32_bf16 v[60:63], v[228:231], v[176:179], v[60:63]
  ds_read_b128 v[100:103], v16 offset:38912
  s_waitcnt lgkmcnt(10)
  v_mfma_f32_16x16x32_bf16 v[64:67], v[232:235], v[176:179], v[64:67]
  ds_read_b128 v[104:107], v16 offset:39936
  s_waitcnt lgkmcnt(0)
  s_mov_b32 s57, 0
L_76:
  ds_read_b128 v[12:15], v8 offset:0
  s_waitcnt lgkmcnt(0)
  v_min3_u32 v12, v12, v13, v14
  v_min_u32 v12, v12, v15
  s_nop 0
  v_readfirstlane_b32 s56, v12
  s_nop 3
  s_cmp_ge_u32 s56, 47
  s_cbranch_scc1 L_77
  s_add_u32 s57, s57, 1
  s_sleep 1
  s_cmp_lt_u32 s57, 0x400000
  s_cbranch_scc1 L_76
L_77:
  s_waitcnt vmcnt(11)
  v_mfma_f32_16x16x32_bf16 v[48:51], v[68:71], v[180:183], v[48:51]
  ds_read_b128 v[216:219], v16 offset:40960
  v_mfma_f32_16x16x32_bf16 v[52:55], v[72:75], v[180:183], v[52:55]
  ds_read_b128 v[220:223], v16 offset:41984
  v_mfma_f32_16x16x32_bf16 v[56:59], v[76:79], v[180:183], v[56:59]
  ds_read_b128 v[224:227], v16 offset:43008
  v_mfma_f32_16x16x32_bf16 v[60:63], v[80:83], v[180:183], v[60:63]
  ds_read_b128 v[228:231], v16 offset:44032
  v_mfma_f32_16x16x32_bf16 v[64:67], v[84:87], v[180:183], v[64:67]
  ds_read_b128 v[232:235], v16 offset:45056
  s_waitcnt vmcnt(10)
  v_mfma_f32_16x16x32_bf16 v[48:51], v[88:91], v[184:187], v[48:51]
  ds_read_b128 v[68:71], v16 offset:46080
  v_mfma_f32_16x16x32_bf16 v[52:55], v[92:95], v[184:187], v[52:55]
  ds_read_b128 v[72:75], v16 offset:47104
  v_mfma_f32_16x16x32_bf16 v[56:59], v[96:99], v[184:187], v[56:59]
  ds_read_b128 v[76:79], v16 offset:48128
  v_mfma_f32_16x16x32_bf16 v[60:63], v[100:103], v[184:187], v[60:63]
  ds_read_b128 v[80:83], v16 offset:49152
  v_mfma_f32_16x16x32_bf16 v[64:67], v[104:107], v[184:187], v[64:67]
  ds_read_b128 v[84:87], v16 offset:50176
  v_mov_b32 v10, 46
  ds_write_b32 v11, v10 offset:16
  s_waitcnt vmcnt(9) lgkmcnt(10)
  v_mfma_f32_16x16x32_bf16 v[48:51], v[216:219], v[188:191], v[48:51]
  ds_read_b128 v[88:91], v16 offset:51200
  s_waitcnt lgkmcnt(10)
  v_mfma_f32_16x16x32_bf16 v[52:55], v[220:223], v[188:191], v[52:55]
  ds_read_b128 v[92:95], v16 offset:52224
  s_waitcnt lgkmcnt(10)
  v_mfma_f32_16x16x32_bf16 v[56:59], v[224:227], v[188:191], v[56:59]
  ds_read_b128 v[96:99], v16 offset:53248
  s_waitcnt lgkmcnt(10)
  v_mfma_f32_16x16x32_bf16 v[60:63], v[228:231], v[188:191], v[60:63]
  ds_read_b128 v[100:103], v16 offset:54272
  s_waitcnt lgkmcnt(10)
  v_mfma_f32_16x16x32_bf16 v[64:67], v[232:235], v[188:191], v[64:67]
  ds_read_b128 v[104:107], v16 offset:55296
  s_waitcnt vmcnt(8) lgkmcnt(10)
  v_mfma_f32_16x16x32_bf16 v[48:51], v[68:71], v[192:195], v[48:51]
  ds_read_b128 v[216:219], v16 offset:56320
  s_waitcnt lgkmcnt(10)
  v_mfma_f32_16x16x32_bf16 v[52:55], v[72:75], v[192:195], v[52:55]
  ds_read_b128 v[220:223], v16 offset:57344
  s_waitcnt lgkmcnt(10)
  v_mfma_f32_16x16x32_bf16 v[56:59], v[76:79], v[192:195], v[56:59]
  ds_read_b128 v[224:227], v16 offset:58368
  s_waitcnt lgkmcnt(10)
  v_mfma_f32_16x16x32_bf16 v[60:63], v[80:83], v[192:195], v[60:63]
  ds_read_b128 v[228:231], v16 offset:59392
  s_waitcnt lgkmcnt(10)
  v_mfma_f32_16x16x32_bf16 v[64:67], v[84:87], v[192:195], v[64:67]
  ds_read_b128 v[232:235], v16 offset:60416
  s_waitcnt lgkmcnt(0)
  s_mov_b32 s57, 0
L_78:
  ds_read_b128 v[12:15], v8 offset:0
  s_waitcnt lgkmcnt(0)
  v_min3_u32 v12, v12, v13, v14
  v_min_u32 v12, v12, v15
  s_nop 0
  v_readfirstlane_b32 s56, v12
  s_nop 3
  s_cmp_ge_u32 s56, 48
  s_cbranch_scc1 L_79
  s_add_u32 s57, s57, 1
  s_sleep 1
  s_cmp_lt_u32 s57, 0x400000
  s_cbranch_scc1 L_78
L_79:
  v_add_u32 v16, 61440, v16
  s_waitcnt vmcnt(7)
  v_mfma_f32_16x16x32_bf16 v[48:51], v[88:91], v[196:199], v[48:51]
  ds_read_b128 v[68:71], v16
  v_mfma_f32_16x16x32_bf16 v[52:55], v[92:95], v[196:199], v[52:55]
  ds_read_b128 v[72:75], v16 offset:1024
  v_mfma_f32_16x16x32_bf16 v[56:59], v[96:99], v[196:199], v[56:59]
  ds_read_b128 v[76:79], v16 offset:2048
  v_mfma_f32_16x16x32_bf16 v[60:63], v[100:103], v[196:199], v[60:63]
  ds_read_b128 v[80:83], v16 offset:3072
  v_mfma_f32_16x16x32_bf16 v[64:67], v[104:107], v[196:199], v[64:67]
  ds_read_b128 v[84:87], v16 offset:4096
  s_waitcnt vmcnt(6)
  v_mfma_f32_16x16x32_bf16 v[48:51], v[216:219], v[200:203], v[48:51]
  ds_read_b128 v[88:91], v16 offset:5120
  v_mfma_f32_16x16x32_bf16 v[52:55], v[220:223], v[200:203], v[52:55]
  ds_read_b128 v[92:95], v16 offset:6144
  v_mfma_f32_16x16x32_bf16 v[56:59], v[224:227], v[200:203], v[56:59]
  ds_read_b128 v[96:99], v16 offset:7168
  v_mfma_f32_16x16x32_bf16 v[60:63], v[228:231], v[200:203], v[60:63]
  ds_read_b128 v[100:103], v16 offset:8192
  v_mfma_f32_16x16x32_bf16 v[64:67], v[232:235], v[200:203], v[64:67]
  ds_read_b128 v[104:107], v16 offset:9216
  v_mov_b32 v10, 47
  ds_write_b32 v11, v10 offset:16
  s_waitcnt vmcnt(5) lgkmcnt(10)
  v_mfma_f32_16x16x32_bf16 v[48:51], v[68:71], v[204:207], v[48:51]
  ds_read_b128 v[216:219], v16 offset:10240
  s_waitcnt lgkmcnt(10)
  v_mfma_f32_16x16x32_bf16 v[52:55], v[72:75], v[204:207], v[52:55]
  ds_read_b128 v[220:223], v16 offset:11264
  s_waitcnt lgkmcnt(10)
  v_mfma_f32_16x16x32_bf16 v[56:59], v[76:79], v[204:207], v[56:59]
  ds_read_b128 v[224:227], v16 offset:12288
  s_waitcnt lgkmcnt(10)
  v_mfma_f32_16x16x32_bf16 v[60:63], v[80:83], v[204:207], v[60:63]
  ds_read_b128 v[228:231], v16 offset:13312
  s_waitcnt lgkmcnt(10)
  v_mfma_f32_16x16x32_bf16 v[64:67], v[84:87], v[204:207], v[64:67]
  ds_read_b128 v[232:235], v16 offset:14336
  s_waitcnt vmcnt(4) lgkmcnt(10)
  v_mfma_f32_16x16x32_bf16 v[48:51], v[88:91], v[208:211], v[48:51]
  ds_read_b128 v[68:71], v16 offset:15360
  s_waitcnt lgkmcnt(10)
  v_mfma_f32_16x16x32_bf16 v[52:55], v[92:95], v[208:211], v[52:55]
  ds_read_b128 v[72:75], v16 offset:16384
  s_waitcnt lgkmcnt(10)
  v_mfma_f32_16x16x32_bf16 v[56:59], v[96:99], v[208:211], v[56:59]
  ds_read_b128 v[76:79], v16 offset:17408
  s_waitcnt lgkmcnt(10)
  v_mfma_f32_16x16x32_bf16 v[60:63], v[100:103], v[208:211], v[60:63]
  ds_read_b128 v[80:83], v16 offset:18432
  s_waitcnt lgkmcnt(10)
  v_mfma_f32_16x16x32_bf16 v[64:67], v[104:107], v[208:211], v[64:67]
  ds_read_b128 v[84:87], v16 offset:19456
  s_waitcnt lgkmcnt(0)
  s_mov_b32 s57, 0
L_80:
  ds_read_b128 v[12:15], v8 offset:0
  s_waitcnt lgkmcnt(0)
  v_min3_u32 v12, v12, v13, v14
  v_min_u32 v12, v12, v15
  s_nop 0
  v_readfirstlane_b32 s56, v12
  s_nop 3
  s_cmp_ge_u32 s56, 49
  s_cbranch_scc1 L_81
  s_add_u32 s57, s57, 1
  s_sleep 1
  s_cmp_lt_u32 s57, 0x400000
  s_cbranch_scc1 L_80
L_81:
  s_waitcnt vmcnt(3)
  v_mfma_f32_16x16x32_bf16 v[48:51], v[216:219], v[212:215], v[48:51]
  ds_read_b128 v[88:91], v16 offset:20480
  v_mfma_f32_16x16x32_bf16 v[52:55], v[220:223], v[212:215], v[52:55]
  ds_read_b128 v[92:95], v16 offset:21504
  v_mfma_f32_16x16x32_bf16 v[56:59], v[224:227], v[212:215], v[56:59]
  ds_read_b128 v[96:99], v16 offset:22528
  v_mfma_f32_16x16x32_bf16 v[60:63], v[228:231], v[212:215], v[60:63]
  ds_read_b128 v[100:103], v16 offset:23552
  v_mfma_f32_16x16x32_bf16 v[64:67], v[232:235], v[212:215], v[64:67]
  ds_read_b128 v[104:107], v16 offset:24576
  s_waitcnt vmcnt(2)
  v_mfma_f32_16x16x32_bf16 v[48:51], v[68:71], v[148:151], v[48:51]
  ds_read_b128 v[216:219], v16 offset:25600
  v_mfma_f32_16x16x32_bf16 v[52:55], v[72:75], v[148:151], v[52:55]
  ds_read_b128 v[220:223], v16 offset:26624
  v_mfma_f32_16x16x32_bf16 v[56:59], v[76:79], v[148:151], v[56:59]
  ds_read_b128 v[224:227], v16 offset:27648
  v_mfma_f32_16x16x32_bf16 v[60:63], v[80:83], v[148:151], v[60:63]
  ds_read_b128 v[228:231], v16 offset:28672
  v_mfma_f32_16x16x32_bf16 v[64:67], v[84:87], v[148:151], v[64:67]
  ds_read_b128 v[232:235], v16 offset:29696
  v_mov_b32 v10, 48
  ds_write_b32 v11, v10 offset:16
  s_waitcnt vmcnt(1) lgkmcnt(10)
  v_mfma_f32_16x16x32_bf16 v[48:51], v[88:91], v[152:155], v[48:51]
  s_waitcnt lgkmcnt(9)
  v_mfma_f32_16x16x32_bf16 v[52:55], v[92:95], v[152:155], v[52:55]
  s_waitcnt lgkmcnt(8)
  v_mfma_f32_16x16x32_bf16 v[56:59], v[96:99], v[152:155], v[56:59]
  s_waitcnt lgkmcnt(7)
  v_mfma_f32_16x16x32_bf16 v[60:63], v[100:103], v[152:155], v[60:63]
  s_waitcnt lgkmcnt(6)
  v_mfma_f32_16x16x32_bf16 v[64:67], v[104:107], v[152:155], v[64:67]
  v_mov_b32 v10, 0
  ds_write_b32 v11, v10 offset:128
  s_waitcnt vmcnt(0) lgkmcnt(6)
  v_mfma_f32_16x16x32_bf16 v[48:51], v[216:219], v[156:159], v[48:51]
  s_waitcnt lgkmcnt(5)
  v_mfma_f32_16x16x32_bf16 v[52:55], v[220:223], v[156:159], v[52:55]
  s_waitcnt lgkmcnt(4)
  v_mfma_f32_16x16x32_bf16 v[56:59], v[224:227], v[156:159], v[56:59]
  s_waitcnt lgkmcnt(3)
  v_mfma_f32_16x16x32_bf16 v[60:63], v[228:231], v[156:159], v[60:63]
  s_waitcnt lgkmcnt(2)
  v_mfma_f32_16x16x32_bf16 v[64:67], v[232:235], v[156:159], v[64:67]
  v_mov_b32 v10, 49
  ds_write_b32 v11, v10 offset:16
  v_cvt_pk_bf16_f32 v32, v48, v49
  v_lshlrev_b32 v48, 16, v32
  v_and_b32 v49, 0xffff0000, v32
  v_cvt_pk_bf16_f32 v33, v50, v51
  v_lshlrev_b32 v50, 16, v33
  v_and_b32 v51, 0xffff0000, v33
  v_pk_add_f32 v[48:49], v[48:49], v[128:129]
  v_pk_add_f32 v[50:51], v[50:51], v[130:131]
  v_cvt_pk_bf16_f32 v32, v48, v49
  v_lshlrev_b32 v48, 16, v32
  v_and_b32 v49, 0xffff0000, v32
  v_cvt_pk_bf16_f32 v33, v50, v51
  v_lshlrev_b32 v50, 16, v33
  v_and_b32 v51, 0xffff0000, v33
  v_pk_add_f32 v[48:49], v[48:49], v[108:109]
  v_pk_add_f32 v[50:51], v[50:51], v[110:111]
  v_cvt_pk_bf16_f32 v88, v48, v49
  v_cvt_pk_bf16_f32 v89, v50, v51
  buffer_store_dwordx2 v[88:89], v46, s[16:19], s72 offen
  v_cvt_pk_bf16_f32 v32, v52, v53
  v_lshlrev_b32 v52, 16, v32
  v_and_b32 v53, 0xffff0000, v32
  v_cvt_pk_bf16_f32 v33, v54, v55
  v_lshlrev_b32 v54, 16, v33
  v_and_b32 v55, 0xffff0000, v33
  v_pk_add_f32 v[52:53], v[52:53], v[132:133]
  v_pk_add_f32 v[54:55], v[54:55], v[134:135]
  v_cvt_pk_bf16_f32 v32, v52, v53
  v_lshlrev_b32 v52, 16, v32
  v_and_b32 v53, 0xffff0000, v32
  v_cvt_pk_bf16_f32 v33, v54, v55
  v_lshlrev_b32 v54, 16, v33
  v_and_b32 v55, 0xffff0000, v33
  v_pk_add_f32 v[52:53], v[52:53], v[112:113]
  v_pk_add_f32 v[54:55], v[54:55], v[114:115]
  v_cvt_pk_bf16_f32 v90, v52, v53
  v_cvt_pk_bf16_f32 v91, v54, v55
  buffer_store_dwordx2 v[90:91], v46, s[16:19], s72 offen offset:32
  v_cvt_pk_bf16_f32 v32, v56, v57
  v_lshlrev_b32 v56, 16, v32
  v_and_b32 v57, 0xffff0000, v32
  v_cvt_pk_bf16_f32 v33, v58, v59
  v_lshlrev_b32 v58, 16, v33
  v_and_b32 v59, 0xffff0000, v33
  v_pk_add_f32 v[56:57], v[56:57], v[136:137]
  v_pk_add_f32 v[58:59], v[58:59], v[138:139]
  v_cvt_pk_bf16_f32 v32, v56, v57
  v_lshlrev_b32 v56, 16, v32
  v_and_b32 v57, 0xffff0000, v32
  v_cvt_pk_bf16_f32 v33, v58, v59
  v_lshlrev_b32 v58, 16, v33
  v_and_b32 v59, 0xffff0000, v33
  v_pk_add_f32 v[56:57], v[56:57], v[116:117]
  v_pk_add_f32 v[58:59], v[58:59], v[118:119]
  v_cvt_pk_bf16_f32 v92, v56, v57
  v_cvt_pk_bf16_f32 v93, v58, v59
  buffer_store_dwordx2 v[92:93], v46, s[16:19], s72 offen offset:64
  v_cvt_pk_bf16_f32 v32, v60, v61
  v_lshlrev_b32 v60, 16, v32
  v_and_b32 v61, 0xffff0000, v32
  v_cvt_pk_bf16_f32 v33, v62, v63
  v_lshlrev_b32 v62, 16, v33
  v_and_b32 v63, 0xffff0000, v33
  v_pk_add_f32 v[60:61], v[60:61], v[140:141]
  v_pk_add_f32 v[62:63], v[62:63], v[142:143]
  v_cvt_pk_bf16_f32 v32, v60, v61
  v_lshlrev_b32 v60, 16, v32
  v_and_b32 v61, 0xffff0000, v32
  v_cvt_pk_bf16_f32 v33, v62, v63
  v_lshlrev_b32 v62, 16, v33
  v_and_b32 v63, 0xffff0000, v33
  v_pk_add_f32 v[60:61], v[60:61], v[120:121]
  v_pk_add_f32 v[62:63], v[62:63], v[122:123]
  v_cvt_pk_bf16_f32 v94, v60, v61
  v_cvt_pk_bf16_f32 v95, v62, v63
  buffer_store_dwordx2 v[94:95], v46, s[16:19], s72 offen offset:96
  v_cvt_pk_bf16_f32 v32, v64, v65
  v_lshlrev_b32 v64, 16, v32
  v_and_b32 v65, 0xffff0000, v32
  v_cvt_pk_bf16_f32 v33, v66, v67
  v_lshlrev_b32 v66, 16, v33
  v_and_b32 v67, 0xffff0000, v33
  v_pk_add_f32 v[64:65], v[64:65], v[144:145]
  v_pk_add_f32 v[66:67], v[66:67], v[146:147]
  v_cvt_pk_bf16_f32 v32, v64, v65
  v_lshlrev_b32 v64, 16, v32
  v_and_b32 v65, 0xffff0000, v32
  v_cvt_pk_bf16_f32 v33, v66, v67
  v_lshlrev_b32 v66, 16, v33
  v_and_b32 v67, 0xffff0000, v33
  v_pk_add_f32 v[64:65], v[64:65], v[124:125]
  v_pk_add_f32 v[66:67], v[66:67], v[126:127]
  v_cvt_pk_bf16_f32 v96, v64, v65
  v_cvt_pk_bf16_f32 v97, v66, v67
  buffer_store_dwordx2 v[96:97], v46, s[16:19], s72 offen offset:128
  s_endpgm
L_helper:
  s_mov_b32 s12, s34
  s_mov_b32 s13, s35
  s_mov_b32 s14, 2457600
  s_mov_b32 s15, 0x00020000
  s_lshl_b32 s64, s7, 10
  s_mul_i32 s62, s92, 80
  s_add_u32 s62, s62, 1280
  s_mul_i32 s56, s5, 52
  s_lshr_b32 s56, s56, 8
  s_mul_i32 s56, s56, 5
  s_sub_u32 s65, s5, s56
  s_mov_b32 s65, 0
  s_add_u32 s66, s65, 1
  s_cmp_eq_u32 s66, 5
  s_cselect_b32 s66, 0, s66
  s_add_u32 s67, s66, 1
  s_cmp_eq_u32 s67, 5
  s_cselect_b32 s67, 0, s67
  s_add_u32 s68, s67, 1
  s_cmp_eq_u32 s68, 5
  s_cselect_b32 s68, 0, s68
  s_add_u32 s69, s68, 1
  s_cmp_eq_u32 s69, 5
  s_cselect_b32 s69, 0, s69
  s_mov_b32 s20, s32
  s_mov_b32 s21, s33
  s_mov_b32 s22, 2621440
  s_mov_b32 s23, 0x00020000
  s_mul_i32 s63, s91, 163840
  s_lshl_b32 s56, s7, 2
  v_add_u32 v31, s56, v3
  v_xor_b32 v30, v31, v2
  v_lshlrev_b32 v30, 4, v30
  v_mul_u32_u24 v31, 1280, v31
  v_add_u32 v30, v30, v31
  s_add_u32 m0, s64, 0
  s_lshl_b32 s58, s65, 8
  s_add_u32 s58, s58, s63
  s_add_u32 s58, s58, 0
  buffer_load_dwordx4 v30, s[20:23], s58 offen lds
  s_add_u32 m0, s64, 4096
  s_lshl_b32 s58, s65, 8
  s_add_u32 s58, s58, s63
  s_add_u32 s58, s58, 20480
  buffer_load_dwordx4 v30, s[20:23], s58 offen lds
  s_add_u32 m0, s64, 8192
  s_lshl_b32 s58, s65, 8
  s_add_u32 s58, s58, s63
  s_add_u32 s58, s58, 40960
  buffer_load_dwordx4 v30, s[20:23], s58 offen lds
  s_add_u32 m0, s64, 12288
  s_lshl_b32 s58, s65, 8
  s_add_u32 s58, s58, s63
  s_add_u32 s58, s58, 61440
  buffer_load_dwordx4 v30, s[20:23], s58 offen lds
  s_add_u32 m0, s64, 16384
  s_lshl_b32 s58, s65, 8
  s_add_u32 s58, s58, s63
  s_add_u32 s58, s58, 81920
  buffer_load_dwordx4 v30, s[20:23], s58 offen lds
  s_add_u32 m0, s64, 20480
  s_lshl_b32 s58, s65, 8
  s_add_u32 s58, s58, s63
  s_add_u32 s58, s58, 102400
  buffer_load_dwordx4 v30, s[20:23], s58 offen lds
  s_add_u32 m0, s64, 24576
  s_lshl_b32 s58, s65, 8
  s_add_u32 s58, s58, s63
  s_add_u32 s58, s58, 122880
  buffer_load_dwordx4 v30, s[20:23], s58 offen lds
  s_add_u32 m0, s64, 28672
  s_lshl_b32 s58, s65, 8
  s_add_u32 s58, s58, s63
  s_add_u32 s58, s58, 143360
  buffer_load_dwordx4 v30, s[20:23], s58 offen lds
  s_mov_b32 s56, 3840
  v_add_u32 v32, -256, v0
  v_mul_u32_u24 v33, 6554, v32
  v_lshrrev_b32 v33, 16, v33
  v_mul_u32_u24 v34, 10, v33
  v_sub_u32 v32, v32, v34
  v_bfe_u32 v34, v33, 3, 1
  v_lshlrev_b32 v34, 2, v34
  v_xor_b32 v33, v33, v34
  v_mul_lo_u32 v16, v33, s56
  v_lshl_add_u32 v16, v32, 4, v16
  v_add_u32 v16, s62, v16
  v_cmp_lt_u32 vcc, 4, v32
  v_add_u32 v33, 1200, v16
  s_nop 0
  v_cndmask_b32 v16, v16, v33, vcc
  v_add_u32 v32, 0, v0
  v_mul_u32_u24 v33, 6554, v32
  v_lshrrev_b32 v33, 16, v33
  v_mul_u32_u24 v34, 10, v33
  v_sub_u32 v32, v32, v34
  v_bfe_u32 v34, v33, 3, 1
  v_lshlrev_b32 v34, 2, v34
  v_xor_b32 v33, v33, v34
  v_mul_lo_u32 v17, v33, s56
  v_lshl_add_u32 v17, v32, 4, v17
  v_add_u32 v17, s62, v17
  v_cmp_lt_u32 vcc, 4, v32
  v_add_u32 v33, 1200, v17
  s_nop 0
  v_cndmask_b32 v17, v17, v33, vcc
  v_add_u32 v32, 256, v0
  v_mul_u32_u24 v33, 6554, v32
  v_lshrrev_b32 v33, 16, v33
  v_mul_u32_u24 v34, 10, v33
  v_sub_u32 v32, v32, v34
  v_bfe_u32 v34, v33, 3, 1
  v_lshlrev_b32 v34, 2, v34
  v_xor_b32 v33, v33, v34
  v_mul_lo_u32 v18, v33, s56
  v_lshl_add_u32 v18, v32, 4, v18
  v_add_u32 v18, s62, v18
  v_cmp_lt_u32 vcc, 4, v32
  v_add_u32 v33, 1200, v18
  s_nop 0
  v_cndmask_b32 v18, v18, v33, vcc
  v_add_u32 v32, 512, v0
  v_mul_u32_u24 v33, 6554, v32
  v_lshrrev_b32 v33, 16, v33
  v_mul_u32_u24 v34, 10, v33
  v_sub_u32 v32, v32, v34
  v_bfe_u32 v34, v33, 3, 1
  v_lshlrev_b32 v34, 2, v34
  v_xor_b32 v33, v33, v34
  v_mul_lo_u32 v19, v33, s56
  v_lshl_add_u32 v19, v32, 4, v19
  v_add_u32 v19, s62, v19
  v_cmp_lt_u32 vcc, 4, v32
  v_add_u32 v33, 1200, v19
  s_nop 0
  v_cndmask_b32 v19, v19, v33, vcc
  v_add_u32 v32, 768, v0
  v_mul_u32_u24 v33, 6554, v32
  v_lshrrev_b32 v33, 16, v33
  v_mul_u32_u24 v34, 10, v33
  v_sub_u32 v32, v32, v34
  v_bfe_u32 v34, v33, 3, 1
  v_lshlrev_b32 v34, 2, v34
  v_xor_b32 v33, v33, v34
  v_mul_lo_u32 v20, v33, s56
  v_lshl_add_u32 v20, v32, 4, v20
  v_add_u32 v20, s62, v20
  v_cmp_lt_u32 vcc, 4, v32
  v_add_u32 v33, 1200, v20
  s_nop 0
  v_cndmask_b32 v20, v20, v33, vcc
  s_add_u32 m0, s64, 32768
  s_lshl_b32 s58, s66, 8
  s_add_u32 s58, s58, s63
  s_add_u32 s58, s58, 0
  buffer_load_dwordx4 v30, s[20:23], s58 offen lds
  s_add_u32 m0, s64, 36864
  s_lshl_b32 s58, s66, 8
  s_add_u32 s58, s58, s63
  s_add_u32 s58, s58, 20480
  buffer_load_dwordx4 v30, s[20:23], s58 offen lds
  s_add_u32 m0, s64, 40960
  s_lshl_b32 s58, s66, 8
  s_add_u32 s58, s58, s63
  s_add_u32 s58, s58, 40960
  buffer_load_dwordx4 v30, s[20:23], s58 offen lds
  s_add_u32 m0, s64, 45056
  s_lshl_b32 s58, s66, 8
  s_add_u32 s58, s58, s63
  s_add_u32 s58, s58, 61440
  buffer_load_dwordx4 v30, s[20:23], s58 offen lds
  s_add_u32 m0, s64, 49152
  s_lshl_b32 s58, s66, 8
  s_add_u32 s58, s58, s63
  s_add_u32 s58, s58, 81920
  buffer_load_dwordx4 v30, s[20:23], s58 offen lds
  s_add_u32 m0, s64, 53248
  s_lshl_b32 s58, s66, 8
  s_add_u32 s58, s58, s63
  s_add_u32 s58, s58, 102400
  buffer_load_dwordx4 v30, s[20:23], s58 offen lds
  s_add_u32 m0, s64, 57344
  s_lshl_b32 s58, s66, 8
  s_add_u32 s58, s58, s63
  s_add_u32 s58, s58, 122880
  buffer_load_dwordx4 v30, s[20:23], s58 offen lds
  s_add_u32 m0, s64, 61440
  s_lshl_b32 s58, s66, 8
  s_add_u32 s58, s58, s63
  s_add_u32 s58, s58, 143360
  buffer_load_dwordx4 v30, s[20:23], s58 offen lds
  s_waitcnt vmcnt(8)
  v_mov_b32 v10, 1
  ds_write_b32 v11, v10
  s_add_u32 m0, s64, 65536
  s_mul_i32 s58, s65, 491520
  buffer_load_dwordx4 v16, s[12:15], s58 offen lds
  s_add_u32 m0, s64, 69632
  s_mul_i32 s58, s65, 491520
  buffer_load_dwordx4 v17, s[12:15], s58 offen lds
  s_add_u32 m0, s64, 73728
  s_mul_i32 s58, s65, 491520
  buffer_load_dwordx4 v18, s[12:15], s58 offen lds
  s_add_u32 m0, s64, 77824
  s_mul_i32 s58, s65, 491520
  buffer_load_dwordx4 v19, s[12:15], s58 offen lds
  s_add_u32 m0, s64, 81920
  s_mul_i32 s58, s65, 491520
  buffer_load_dwordx4 v20, s[12:15], s58 offen lds
  s_waitcnt vmcnt(5)
  v_mov_b32 v10, 2
  ds_write_b32 v11, v10
  s_mul_i32 s62, s76, 80
  s_mov_b32 s56, 3840
  v_add_u32 v32, -256, v0
  v_mul_u32_u24 v33, 10923, v32
  v_lshrrev_b32 v33, 16, v33
  v_mul_u32_u24 v34, 6, v33
  v_sub_u32 v32, v32, v34
  v_bfe_u32 v34, v33, 3, 1
  v_lshlrev_b32 v34, 2, v34
  v_xor_b32 v33, v33, v34
  v_mul_lo_u32 v21, v33, s56
  v_lshl_add_u32 v21, v32, 4, v21
  v_add_u32 v21, s62, v21
  v_cmp_lt_u32 vcc, 4, v32
  v_bfrev_b32 v33, 1
  s_nop 0
  v_cndmask_b32 v21, v21, v33, vcc
  v_add_u32 v32, 0, v0
  v_mul_u32_u24 v33, 10923, v32
  v_lshrrev_b32 v33, 16, v33
  v_mul_u32_u24 v34, 6, v33
  v_sub_u32 v32, v32, v34
  v_bfe_u32 v34, v33, 3, 1
  v_lshlrev_b32 v34, 2, v34
  v_xor_b32 v33, v33, v34
  v_mul_lo_u32 v22, v33, s56
  v_lshl_add_u32 v22, v32, 4, v22
  v_add_u32 v22, s62, v22
  v_cmp_lt_u32 vcc, 4, v32
  v_bfrev_b32 v33, 1
  s_nop 0
  v_cndmask_b32 v22, v22, v33, vcc
  v_add_u32 v32, 256, v0
  v_mul_u32_u24 v33, 10923, v32
  v_lshrrev_b32 v33, 16, v33
  v_mul_u32_u24 v34, 6, v33
  v_sub_u32 v32, v32, v34
  v_bfe_u32 v34, v33, 3, 1
  v_lshlrev_b32 v34, 2, v34
  v_xor_b32 v33, v33, v34
  v_mul_lo_u32 v23, v33, s56
  v_lshl_add_u32 v23, v32, 4, v23
  v_add_u32 v23, s62, v23
  v_cmp_lt_u32 vcc, 4, v32
  v_bfrev_b32 v33, 1
  s_nop 0
  v_cndmask_b32 v23, v23, v33, vcc
  s_mov_b32 s8, s36
  s_mov_b32 s9, s37
  s_mov_b32 s10, 819200
  s_mov_b32 s11, 0x00020000
  s_mul_i32 s62, s89, 160
  s_mov_b32 s56, 1280
  v_add_u32 v32, -256, v0
  v_mul_u32_u24 v33, 6554, v32
  v_lshrrev_b32 v33, 16, v33
  v_mul_u32_u24 v34, 10, v33
  v_sub_u32 v32, v32, v34
  v_bfe_u32 v34, v33, 3, 1
  v_lshlrev_b32 v34, 2, v34
  v_xor_b32 v33, v33, v34
  v_mul_lo_u32 v24, v33, s56
  v_lshl_add_u32 v24, v32, 4, v24
  v_add_u32 v24, s62, v24
  v_add_u32 v32, 0, v0
  v_mul_u32_u24 v33, 6554, v32
  v_lshrrev_b32 v33, 16, v33
  v_mul_u32_u24 v34, 10, v33
  v_sub_u32 v32, v32, v34
  v_bfe_u32 v34, v33, 3, 1
  v_lshlrev_b32 v34, 2, v34
  v_xor_b32 v33, v33, v34
  v_mul_lo_u32 v25, v33, s56
  v_lshl_add_u32 v25, v32, 4, v25
  v_add_u32 v25, s62, v25
  v_add_u32 v32, 256, v0
  v_mul_u32_u24 v33, 6554, v32
  v_lshrrev_b32 v33, 16, v33
  v_mul_u32_u24 v34, 10, v33
  v_sub_u32 v32, v32, v34
  v_bfe_u32 v34, v33, 3, 1
  v_lshlrev_b32 v34, 2, v34
  v_xor_b32 v33, v33, v34
  v_mul_lo_u32 v26, v33, s56
  v_lshl_add_u32 v26, v32, 4, v26
  v_add_u32 v26, s62, v26
  v_add_u32 v32, 512, v0
  v_mul_u32_u24 v33, 6554, v32
  v_lshrrev_b32 v33, 16, v33
  v_mul_u32_u24 v34, 10, v33
  v_sub_u32 v32, v32, v34
  v_bfe_u32 v34, v33, 3, 1
  v_lshlrev_b32 v34, 2, v34
  v_xor_b32 v33, v33, v34
  v_mul_lo_u32 v27, v33, s56
  v_lshl_add_u32 v27, v32, 4, v27
  v_add_u32 v27, s62, v27
  v_add_u32 v32, 768, v0
  v_mul_u32_u24 v33, 6554, v32
  v_lshrrev_b32 v33, 16, v33
  v_mul_u32_u24 v34, 10, v33
  v_sub_u32 v32, v32, v34
  v_bfe_u32 v34, v33, 3, 1
  v_lshlrev_b32 v34, 2, v34
  v_xor_b32 v33, v33, v34
  v_mul_lo_u32 v28, v33, s56
  v_lshl_add_u32 v28, v32, 4, v28
  v_add_u32 v28, s62, v28
  v_lshlrev_b32 v29, 4, v0
  v_subrev_u32 v29, 4096, v29
  s_waitcnt lgkmcnt(0)
  ds_read_b128 v[12:15], v8 offset:16
  s_waitcnt lgkmcnt(0)
  v_min3_u32 v12, v12, v13, v14
  v_min_u32 v12, v12, v15
  s_nop 0
  v_readfirstlane_b32 s56, v12
  s_nop 3
  s_cmp_ge_u32 s56, 1
  s_cbranch_scc1 L_100001
  s_waitcnt vmcnt(0)
  v_mov_b32 v10, 3
  ds_write_b32 v11, v10 offset:0
  s_waitcnt lgkmcnt(0)
  s_mov_b32 s57, 0
L_100002:
  ds_read_b128 v[12:15], v8 offset:16
  s_waitcnt lgkmcnt(0)
  v_min3_u32 v12, v12, v13, v14
  v_min_u32 v12, v12, v15
  s_nop 0
  v_readfirstlane_b32 s56, v12
  s_nop 3
  s_cmp_ge_u32 s56, 1
  s_cbranch_scc1 L_100003
  s_add_u32 s57, s57, 1
  s_sleep 1
  s_cmp_lt_u32 s57, 0x400000
  s_cbranch_scc1 L_100002
L_100003:
L_100001:
  s_add_u32 m0, s64, 0
  s_lshl_b32 s58, s67, 8
  s_add_u32 s58, s58, s63
  s_add_u32 s58, s58, 0
  buffer_load_dwordx4 v30, s[20:23], s58 offen lds
  s_add_u32 m0, s64, 4096
  s_lshl_b32 s58, s67, 8
  s_add_u32 s58, s58, s63
  s_add_u32 s58, s58, 20480
  buffer_load_dwordx4 v30, s[20:23], s58 offen lds
  s_add_u32 m0, s64, 8192
  s_lshl_b32 s58, s67, 8
  s_add_u32 s58, s58, s63
  s_add_u32 s58, s58, 40960
  buffer_load_dwordx4 v30, s[20:23], s58 offen lds
  s_add_u32 m0, s64, 12288
  s_lshl_b32 s58, s67, 8
  s_add_u32 s58, s58, s63
  s_add_u32 s58, s58, 61440
  buffer_load_dwordx4 v30, s[20:23], s58 offen lds
  s_add_u32 m0, s64, 16384
  s_lshl_b32 s58, s67, 8
  s_add_u32 s58, s58, s63
  s_add_u32 s58, s58, 81920
  buffer_load_dwordx4 v30, s[20:23], s58 offen lds
  s_add_u32 m0, s64, 20480
  s_lshl_b32 s58, s67, 8
  s_add_u32 s58, s58, s63
  s_add_u32 s58, s58, 102400
  buffer_load_dwordx4 v30, s[20:23], s58 offen lds
  s_add_u32 m0, s64, 24576
  s_lshl_b32 s58, s67, 8
  s_add_u32 s58, s58, s63
  s_add_u32 s58, s58, 122880
  buffer_load_dwordx4 v30, s[20:23], s58 offen lds
  s_add_u32 m0, s64, 28672
  s_lshl_b32 s58, s67, 8
  s_add_u32 s58, s58, s63
  s_add_u32 s58, s58, 143360
  buffer_load_dwordx4 v30, s[20:23], s58 offen lds
  s_waitcnt vmcnt(8)
  v_mov_b32 v10, 3
  ds_write_b32 v11, v10
  s_add_u32 m0, s64, 86016
  s_mul_i32 s58, s66, 491520
  buffer_load_dwordx4 v16, s[12:15], s58 offen lds
  s_add_u32 m0, s64, 90112
  s_mul_i32 s58, s66, 491520
  buffer_load_dwordx4 v17, s[12:15], s58 offen lds
  s_add_u32 m0, s64, 94208
  s_mul_i32 s58, s66, 491520
  buffer_load_dwordx4 v18, s[12:15], s58 offen lds
  s_add_u32 m0, s64, 98304
  s_mul_i32 s58, s66, 491520
  buffer_load_dwordx4 v19, s[12:15], s58 offen lds
  s_add_u32 m0, s64, 102400
  s_mul_i32 s58, s66, 491520
  buffer_load_dwordx4 v20, s[12:15], s58 offen lds
  s_waitcnt vmcnt(5)
  v_mov_b32 v10, 4
  ds_write_b32 v11, v10
  s_waitcnt lgkmcnt(0)
  ds_read_b128 v[12:15], v8 offset:16
  s_waitcnt lgkmcnt(0)
  v_min3_u32 v12, v12, v13, v14
  v_min_u32 v12, v12, v15
  s_nop 0
  v_readfirstlane_b32 s56, v12
  s_nop 3
  s_cmp_ge_u32 s56, 2
  s_cbranch_scc1 L_100004
  s_waitcnt vmcnt(0)
  v_mov_b32 v10, 5
  ds_write_b32 v11, v10 offset:0
  s_waitcnt lgkmcnt(0)
  s_mov_b32 s57, 0
L_100005:
  ds_read_b128 v[12:15], v8 offset:16
  s_waitcnt lgkmcnt(0)
  v_min3_u32 v12, v12, v13, v14
  v_min_u32 v12, v12, v15
  s_nop 0
  v_readfirstlane_b32 s56, v12
  s_nop 3
  s_cmp_ge_u32 s56, 2
  s_cbranch_scc1 L_100006
  s_add_u32 s57, s57, 1
  s_sleep 1
  s_cmp_lt_u32 s57, 0x400000
  s_cbranch_scc1 L_100005
L_100006:
L_100004:
  s_add_u32 m0, s64, 32768
  s_lshl_b32 s58, s68, 8
  s_add_u32 s58, s58, s63
  s_add_u32 s58, s58, 0
  buffer_load_dwordx4 v30, s[20:23], s58 offen lds
  s_add_u32 m0, s64, 36864
  s_lshl_b32 s58, s68, 8
  s_add_u32 s58, s58, s63
  s_add_u32 s58, s58, 20480
  buffer_load_dwordx4 v30, s[20:23], s58 offen lds
  s_add_u32 m0, s64, 40960
  s_lshl_b32 s58, s68, 8
  s_add_u32 s58, s58, s63
  s_add_u32 s58, s58, 40960
  buffer_load_dwordx4 v30, s[20:23], s58 offen lds
  s_add_u32 m0, s64, 45056
  s_lshl_b32 s58, s68, 8
  s_add_u32 s58, s58, s63
  s_add_u32 s58, s58, 61440
  buffer_load_dwordx4 v30, s[20:23], s58 offen lds
  s_add_u32 m0, s64, 49152
  s_lshl_b32 s58, s68, 8
  s_add_u32 s58, s58, s63
  s_add_u32 s58, s58, 81920
  buffer_load_dwordx4 v30, s[20:23], s58 offen lds
  s_add_u32 m0, s64, 53248
  s_lshl_b32 s58, s68, 8
  s_add_u32 s58, s58, s63
  s_add_u32 s58, s58, 102400
  buffer_load_dwordx4 v30, s[20:23], s58 offen lds
  s_add_u32 m0, s64, 57344
  s_lshl_b32 s58, s68, 8
  s_add_u32 s58, s58, s63
  s_add_u32 s58, s58, 122880
  buffer_load_dwordx4 v30, s[20:23], s58 offen lds
  s_add_u32 m0, s64, 61440
  s_lshl_b32 s58, s68, 8
  s_add_u32 s58, s58, s63
  s_add_u32 s58, s58, 143360
  buffer_load_dwordx4 v30, s[20:23], s58 offen lds
  s_waitcnt vmcnt(8)
  v_mov_b32 v10, 5
  ds_write_b32 v11, v10
  s_waitcnt lgkmcnt(0)
  ds_read_b128 v[12:15], v8 offset:16
  s_waitcnt lgkmcnt(0)
  v_min3_u32 v12, v12, v13, v14
  v_min_u32 v12, v12, v15
  s_nop 0
  v_readfirstlane_b32 s56, v12
  s_nop 3
  s_cmp_ge_u32 s56, 3
  s_cbranch_scc1 L_100007
  s_waitcnt vmcnt(0)
  v_mov_b32 v10, 6
  ds_write_b32 v11, v10 offset:0
  s_waitcnt lgkmcnt(0)
  s_mov_b32 s57, 0
L_100008:
  ds_read_b128 v[12:15], v8 offset:16
  s_waitcnt lgkmcnt(0)
  v_min3_u32 v12, v12, v13, v14
  v_min_u32 v12, v12, v15
  s_nop 0
  v_readfirstlane_b32 s56, v12
  s_nop 3
  s_cmp_ge_u32 s56, 3
  s_cbranch_scc1 L_100009
  s_add_u32 s57, s57, 1
  s_sleep 1
  s_cmp_lt_u32 s57, 0x400000
  s_cbranch_scc1 L_100008
L_100009:
L_100007:
  s_add_u32 m0, s64, 65536
  s_mul_i32 s58, s67, 491520
  buffer_load_dwordx4 v16, s[12:15], s58 offen lds
  s_add_u32 m0, s64, 69632
  s_mul_i32 s58, s67, 491520
  buffer_load_dwordx4 v17, s[12:15], s58 offen lds
  s_add_u32 m0, s64, 73728
  s_mul_i32 s58, s67, 491520
  buffer_load_dwordx4 v18, s[12:15], s58 offen lds
  s_add_u32 m0, s64, 77824
  s_mul_i32 s58, s67, 491520
  buffer_load_dwordx4 v19, s[12:15], s58 offen lds
  s_add_u32 m0, s64, 81920
  s_mul_i32 s58, s67, 491520
  buffer_load_dwordx4 v20, s[12:15], s58 offen lds
  s_waitcnt vmcnt(5)
  v_mov_b32 v10, 6
  ds_write_b32 v11, v10
  s_waitcnt lgkmcnt(0)
  ds_read_b128 v[12:15], v8 offset:16
  s_waitcnt lgkmcnt(0)
  v_min3_u32 v12, v12, v13, v14
  v_min_u32 v12, v12, v15
  s_nop 0
  v_readfirstlane_b32 s56, v12
  s_nop 3
  s_cmp_ge_u32 s56, 4
  s_cbranch_scc1 L_100010
  s_waitcnt vmcnt(0)
  v_mov_b32 v10, 7
  ds_write_b32 v11, v10 offset:0
  s_waitcnt lgkmcnt(0)
  s_mov_b32 s57, 0
L_100011:
  ds_read_b128 v[12:15], v8 offset:16
  s_waitcnt lgkmcnt(0)
  v_min3_u32 v12, v12, v13, v14
  v_min_u32 v12, v12, v15
  s_nop 0
  v_readfirstlane_b32 s56, v12
  s_nop 3
  s_cmp_ge_u32 s56, 4
  s_cbranch_scc1 L_100012
  s_add_u32 s57, s57, 1
  s_sleep 1
  s_cmp_lt_u32 s57, 0x400000
  s_cbranch_scc1 L_100011
L_100012:
L_100010:
  s_add_u32 m0, s64, 0
  s_lshl_b32 s58, s69, 8
  s_add_u32 s58, s58, s63
  s_add_u32 s58, s58, 0
  buffer_load_dwordx4 v30, s[20:23], s58 offen lds
  s_add_u32 m0, s64, 4096
  s_lshl_b32 s58, s69, 8
  s_add_u32 s58, s58, s63
  s_add_u32 s58, s58, 20480
  buffer_load_dwordx4 v30, s[20:23], s58 offen lds
  s_add_u32 m0, s64, 8192
  s_lshl_b32 s58, s69, 8
  s_add_u32 s58, s58, s63
  s_add_u32 s58, s58, 40960
  buffer_load_dwordx4 v30, s[20:23], s58 offen lds
  s_add_u32 m0, s64, 12288
  s_lshl_b32 s58, s69, 8
  s_add_u32 s58, s58, s63
  s_add_u32 s58, s58, 61440
  buffer_load_dwordx4 v30, s[20:23], s58 offen lds
  s_add_u32 m0, s64, 16384
  s_lshl_b32 s58, s69, 8
  s_add_u32 s58, s58, s63
  s_add_u32 s58, s58, 81920
  buffer_load_dwordx4 v30, s[20:23], s58 offen lds
  s_add_u32 m0, s64, 20480
  s_lshl_b32 s58, s69, 8
  s_add_u32 s58, s58, s63
  s_add_u32 s58, s58, 102400
  buffer_load_dwordx4 v30, s[20:23], s58 offen lds
  s_add_u32 m0, s64, 24576
  s_lshl_b32 s58, s69, 8
  s_add_u32 s58, s58, s63
  s_add_u32 s58, s58, 122880
  buffer_load_dwordx4 v30, s[20:23], s58 offen lds
  s_add_u32 m0, s64, 28672
  s_lshl_b32 s58, s69, 8
  s_add_u32 s58, s58, s63
  s_add_u32 s58, s58, 143360
  buffer_load_dwordx4 v30, s[20:23], s58 offen lds
  s_waitcnt vmcnt(8)
  v_mov_b32 v10, 7
  ds_write_b32 v11, v10
  s_waitcnt lgkmcnt(0)
  ds_read_b128 v[12:15], v8 offset:16
  s_waitcnt lgkmcnt(0)
  v_min3_u32 v12, v12, v13, v14
  v_min_u32 v12, v12, v15
  s_nop 0
  v_readfirstlane_b32 s56, v12
  s_nop 3
  s_cmp_ge_u32 s56, 5
  s_cbranch_scc1 L_100013
  s_waitcnt vmcnt(0)
  v_mov_b32 v10, 8
  ds_write_b32 v11, v10 offset:0
  s_waitcnt lgkmcnt(0)
  s_mov_b32 s57, 0
L_100014:
  ds_read_b128 v[12:15], v8 offset:16
  s_waitcnt lgkmcnt(0)
  v_min3_u32 v12, v12, v13, v14
  v_min_u32 v12, v12, v15
  s_nop 0
  v_readfirstlane_b32 s56, v12
  s_nop 3
  s_cmp_ge_u32 s56, 5
  s_cbranch_scc1 L_100015
  s_add_u32 s57, s57, 1
  s_sleep 1
  s_cmp_lt_u32 s57, 0x400000
  s_cbranch_scc1 L_100014
L_100015:
L_100013:
  s_add_u32 m0, s64, 86016
  s_mul_i32 s58, s68, 491520
  buffer_load_dwordx4 v16, s[12:15], s58 offen lds
  s_add_u32 m0, s64, 90112
  s_mul_i32 s58, s68, 491520
  buffer_load_dwordx4 v17, s[12:15], s58 offen lds
  s_add_u32 m0, s64, 94208
  s_mul_i32 s58, s68, 491520
  buffer_load_dwordx4 v18, s[12:15], s58 offen lds
  s_add_u32 m0, s64, 98304
  s_mul_i32 s58, s68, 491520
  buffer_load_dwordx4 v19, s[12:15], s58 offen lds
  s_add_u32 m0, s64, 102400
  s_mul_i32 s58, s68, 491520
  buffer_load_dwordx4 v20, s[12:15], s58 offen lds
  s_waitcnt vmcnt(5)
  v_mov_b32 v10, 8
  ds_write_b32 v11, v10
  s_waitcnt lgkmcnt(0)
  ds_read_b128 v[12:15], v8 offset:16
  s_waitcnt lgkmcnt(0)
  v_min3_u32 v12, v12, v13, v14
  v_min_u32 v12, v12, v15
  s_nop 0
  v_readfirstlane_b32 s56, v12
  s_nop 3
  s_cmp_ge_u32 s56, 7
  s_cbranch_scc1 L_100016
  s_waitcnt vmcnt(0)
  v_mov_b32 v10, 9
  ds_write_b32 v11, v10 offset:0
  s_waitcnt lgkmcnt(0)
  s_mov_b32 s57, 0
L_100017:
  ds_read_b128 v[12:15], v8 offset:16
  s_waitcnt lgkmcnt(0)
  v_min3_u32 v12, v12, v13, v14
  v_min_u32 v12, v12, v15
  s_nop 0
  v_readfirstlane_b32 s56, v12
  s_nop 3
  s_cmp_ge_u32 s56, 7
  s_cbranch_scc1 L_100018
  s_add_u32 s57, s57, 1
  s_sleep 1
  s_cmp_lt_u32 s57, 0x400000
  s_cbranch_scc1 L_100017
L_100018:
L_100016:
  s_add_u32 m0, s64, 65536
  s_mul_i32 s58, s69, 491520
  buffer_load_dwordx4 v16, s[12:15], s58 offen lds
  s_add_u32 m0, s64, 69632
  s_mul_i32 s58, s69, 491520
  buffer_load_dwordx4 v17, s[12:15], s58 offen lds
  s_add_u32 m0, s64, 73728
  s_mul_i32 s58, s69, 491520
  buffer_load_dwordx4 v18, s[12:15], s58 offen lds
  s_add_u32 m0, s64, 77824
  s_mul_i32 s58, s69, 491520
  buffer_load_dwordx4 v19, s[12:15], s58 offen lds
  s_add_u32 m0, s64, 81920
  s_mul_i32 s58, s69, 491520
  buffer_load_dwordx4 v20, s[12:15], s58 offen lds
  s_waitcnt vmcnt(5)
  v_mov_b32 v10, 9
  ds_write_b32 v11, v10
  s_add_u32 m0, s64, 106496
  s_mul_i32 s58, s65, 491520
  buffer_load_dwordx4 v21, s[12:15], s58 offen lds
  s_add_u32 m0, s64, 110592
  s_mul_i32 s58, s65, 491520
  buffer_load_dwordx4 v22, s[12:15], s58 offen lds
  s_add_u32 m0, s64, 114688
  s_mul_i32 s58, s65, 491520
  buffer_load_dwordx4 v23, s[12:15], s58 offen lds
  s_waitcnt vmcnt(3)
  v_mov_b32 v10, 10
  ds_write_b32 v11, v10
  s_waitcnt lgkmcnt(0)
  ds_read_b128 v[12:15], v8 offset:16
  s_waitcnt lgkmcnt(0)
  v_min3_u32 v12, v12, v13, v14
  v_min_u32 v12, v12, v15
  s_nop 0
  v_readfirstlane_b32 s56, v12
  s_nop 3
  s_cmp_ge_u32 s56, 6
  s_cbranch_scc1 L_100019
  s_waitcnt vmcnt(0)
  v_mov_b32 v10, 11
  ds_write_b32 v11, v10 offset:0
  s_waitcnt lgkmcnt(0)
  s_mov_b32 s57, 0
L_100020:
  ds_read_b128 v[12:15], v8 offset:16
  s_waitcnt lgkmcnt(0)
  v_min3_u32 v12, v12, v13, v14
  v_min_u32 v12, v12, v15
  s_nop 0
  v_readfirstlane_b32 s56, v12
  s_nop 3
  s_cmp_ge_u32 s56, 6
  s_cbranch_scc1 L_100021
  s_add_u32 s57, s57, 1
  s_sleep 1
  s_cmp_lt_u32 s57, 0x400000
  s_cbranch_scc1 L_100020
L_100021:
L_100019:
  s_add_u32 m0, s64, 32768
  s_mul_i32 s58, s66, 491520
  buffer_load_dwordx4 v21, s[12:15], s58 offen lds
  s_add_u32 m0, s64, 36864
  s_mul_i32 s58, s66, 491520
  buffer_load_dwordx4 v22, s[12:15], s58 offen lds
  s_add_u32 m0, s64, 40960
  s_mul_i32 s58, s66, 491520
  buffer_load_dwordx4 v23, s[12:15], s58 offen lds
  s_waitcnt vmcnt(3)
  v_mov_b32 v10, 11
  ds_write_b32 v11, v10
  s_waitcnt lgkmcnt(0)
  ds_read_b128 v[12:15], v8 offset:16
  s_waitcnt lgkmcnt(0)
  v_min3_u32 v12, v12, v13, v14
  v_min_u32 v12, v12, v15
  s_nop 0
  v_readfirstlane_b32 s56, v12
  s_nop 3
  s_cmp_ge_u32 s56, 6
  s_cbranch_scc1 L_100022
  s_waitcnt vmcnt(0)
  v_mov_b32 v10, 12
  ds_write_b32 v11, v10 offset:0
  s_waitcnt lgkmcnt(0)
  s_mov_b32 s57, 0
L_100023:
  ds_read_b128 v[12:15], v8 offset:16
  s_waitcnt lgkmcnt(0)
  v_min3_u32 v12, v12, v13, v14
  v_min_u32 v12, v12, v15
  s_nop 0
  v_readfirstlane_b32 s56, v12
  s_nop 3
  s_cmp_ge_u32 s56, 6
  s_cbranch_scc1 L_100024
  s_add_u32 s57, s57, 1
  s_sleep 1
  s_cmp_lt_u32 s57, 0x400000
  s_cbranch_scc1 L_100023
L_100024:
L_100022:
  s_add_u32 m0, s64, 45056
  s_mul_i32 s58, s67, 491520
  buffer_load_dwordx4 v21, s[12:15], s58 offen lds
  s_add_u32 m0, s64, 49152
  s_mul_i32 s58, s67, 491520
  buffer_load_dwordx4 v22, s[12:15], s58 offen lds
  s_add_u32 m0, s64, 53248
  s_mul_i32 s58, s67, 491520
  buffer_load_dwordx4 v23, s[12:15], s58 offen lds
  s_waitcnt vmcnt(3)
  v_mov_b32 v10, 12
  ds_write_b32 v11, v10
  s_waitcnt lgkmcnt(0)
  ds_read_b128 v[12:15], v8 offset:16
  s_waitcnt lgkmcnt(0)
  v_min3_u32 v12, v12, v13, v14
  v_min_u32 v12, v12, v15
  s_nop 0
  v_readfirstlane_b32 s56, v12
  s_nop 3
  s_cmp_ge_u32 s56, 8
  s_cbranch_scc1 L_100025
  s_waitcnt vmcnt(0)
  v_mov_b32 v10, 13
  ds_write_b32 v11, v10 offset:0
  s_waitcnt lgkmcnt(0)
  s_mov_b32 s57, 0
L_100026:
  ds_read_b128 v[12:15], v8 offset:16
  s_waitcnt lgkmcnt(0)
  v_min3_u32 v12, v12, v13, v14
  v_min_u32 v12, v12, v15
  s_nop 0
  v_readfirstlane_b32 s56, v12
  s_nop 3
  s_cmp_ge_u32 s56, 8
  s_cbranch_scc1 L_100027
  s_add_u32 s57, s57, 1
  s_sleep 1
  s_cmp_lt_u32 s57, 0x400000
  s_cbranch_scc1 L_100026
L_100027:
L_100025:
  s_add_u32 m0, s64, 0
  s_mul_i32 s58, s68, 491520
  buffer_load_dwordx4 v21, s[12:15], s58 offen lds
  s_add_u32 m0, s64, 4096
  s_mul_i32 s58, s68, 491520
  buffer_load_dwordx4 v22, s[12:15], s58 offen lds
  s_add_u32 m0, s64, 8192
  s_mul_i32 s58, s68, 491520
  buffer_load_dwordx4 v23, s[12:15], s58 offen lds
  s_waitcnt vmcnt(3)
  v_mov_b32 v10, 13
  ds_write_b32 v11, v10
  s_waitcnt lgkmcnt(0)
  ds_read_b128 v[12:15], v8 offset:16
  s_waitcnt lgkmcnt(0)
  v_min3_u32 v12, v12, v13, v14
  v_min_u32 v12, v12, v15
  s_nop 0
  v_readfirstlane_b32 s56, v12
  s_nop 3
  s_cmp_ge_u32 s56, 8
  s_cbranch_scc1 L_100028
  s_waitcnt vmcnt(0)
  v_mov_b32 v10, 14
  ds_write_b32 v11, v10 offset:0
  s_waitcnt lgkmcnt(0)
  s_mov_b32 s57, 0
L_100029:
  ds_read_b128 v[12:15], v8 offset:16
  s_waitcnt lgkmcnt(0)
  v_min3_u32 v12, v12, v13, v14
  v_min_u32 v12, v12, v15
  s_nop 0
  v_readfirstlane_b32 s56, v12
  s_nop 3
  s_cmp_ge_u32 s56, 8
  s_cbranch_scc1 L_100030
  s_add_u32 s57, s57, 1
  s_sleep 1
  s_cmp_lt_u32 s57, 0x400000
  s_cbranch_scc1 L_100029
L_100030:
L_100028:
  s_add_u32 m0, s64, 12288
  s_mul_i32 s58, s69, 491520
  buffer_load_dwordx4 v21, s[12:15], s58 offen lds
  s_add_u32 m0, s64, 16384
  s_mul_i32 s58, s69, 491520
  buffer_load_dwordx4 v22, s[12:15], s58 offen lds
  s_add_u32 m0, s64, 20480
  s_mul_i32 s58, s69, 491520
  buffer_load_dwordx4 v23, s[12:15], s58 offen lds
  s_waitcnt vmcnt(3)
  v_mov_b32 v10, 14
  ds_write_b32 v11, v10
  s_waitcnt vmcnt(0)
  v_mov_b32 v10, 15
  ds_write_b32 v11, v10
  s_waitcnt vmcnt(0)
  v_mov_b32 v10, 0
  s_mov_b32 s58, 0
L_100031:
  buffer_load_dwordx2 v[12:13], v10, s[80:83], 0 offen sc1
  s_waitcnt vmcnt(0)
  v_readfirstlane_b32 s54, v12
  v_readfirstlane_b32 s55, v13
  s_add_u32 s58, s58, 1
  s_nop 4
  s_cmp_lg_u32 s54, 0
  s_cbranch_scc1 L_100032
  s_sleep 2
  s_cmp_lt_u32 s58, 0x40000
  s_cbranch_scc1 L_100031
L_100032:
  v_bfe_u32 v46, v0, 2, 2
  v_bfe_u32 v47, v0, 4, 1
  v_lshl_or_b32 v46, v47, 2, v46
  v_lshl_or_b32 v47, v3, 3, v46
  v_mul_u32_u24 v44, 96, v47
  v_xor_b32 v47, 4, v47
  v_mul_u32_u24 v45, 96, v47
  v_and_b32 v46, 3, v0
  v_lshl_add_u32 v44, v46, 3, v44
  v_lshl_add_u32 v45, v46, 3, v45
  s_min_u32 s56, s7, 2
  s_lshl_b32 s56, s56, 5
  v_add_u32 v44, s56, v44
  v_add_u32 v45, s56, v45
  v_mov_b32 v48, 0
  v_mov_b32 v49, 0
  s_waitcnt lgkmcnt(0)
  s_mov_b32 s57, 0
L_100033:
  ds_read_b128 v[12:15], v8 offset:0
  s_waitcnt lgkmcnt(0)
  v_min3_u32 v12, v12, v13, v14
  v_min_u32 v12, v12, v15
  s_nop 0
  v_readfirstlane_b32 s56, v12
  s_nop 3
  s_cmp_ge_u32 s56, 15
  s_cbranch_scc1 L_100034
  s_add_u32 s57, s57, 1
  s_cmp_lt_u32 s57, 0x400000
  s_cbranch_scc1 L_100033
L_100034:
  v_add_u32 v46, 106496, v44
  v_add_u32 v47, 106496, v45
  ds_read_b64_tr_b16 v[96:97], v46
  ds_read_b64_tr_b16 v[98:99], v47
  ds_read_b64_tr_b16 v[100:101], v46 offset:3072
  ds_read_b64_tr_b16 v[102:103], v47 offset:3072
  ds_read_b64_tr_b16 v[104:105], v46 offset:6144
  ds_read_b64_tr_b16 v[106:107], v47 offset:6144
  ds_read_b64_tr_b16 v[108:109], v46 offset:9216
  ds_read_b64_tr_b16 v[110:111], v47 offset:9216
  s_waitcnt lgkmcnt(7)
  v_dot2c_f32_bf16 v48, s61, v96
  v_dot2c_f32_bf16 v49, s61, v97
  s_waitcnt lgkmcnt(6)
  v_dot2c_f32_bf16 v48, s61, v98
  v_dot2c_f32_bf16 v49, s61, v99
  s_waitcnt lgkmcnt(5)
  v_dot2c_f32_bf16 v48, s61, v100
  v_dot2c_f32_bf16 v49, s61, v101
  s_waitcnt lgkmcnt(4)
  v_dot2c_f32_bf16 v48, s61, v102
  v_dot2c_f32_bf16 v49, s61, v103
  s_waitcnt lgkmcnt(3)
  v_dot2c_f32_bf16 v48, s61, v104
  v_dot2c_f32_bf16 v49, s61, v105
  s_waitcnt lgkmcnt(2)
  v_dot2c_f32_bf16 v48, s61, v106
  v_dot2c_f32_bf16 v49, s61, v107
  s_waitcnt lgkmcnt(1)
  v_dot2c_f32_bf16 v48, s61, v108
  v_dot2c_f32_bf16 v49, s61, v109
  s_waitcnt lgkmcnt(0)
  v_dot2c_f32_bf16 v48, s61, v110
  v_dot2c_f32_bf16 v49, s61, v111
  v_add_u32 v46, 32768, v44
  v_add_u32 v47, 32768, v45
  ds_read_b64_tr_b16 v[112:113], v46
  ds_read_b64_tr_b16 v[114:115], v47
  ds_read_b64_tr_b16 v[116:117], v46 offset:3072
  ds_read_b64_tr_b16 v[118:119], v47 offset:3072
  ds_read_b64_tr_b16 v[120:121], v46 offset:6144
  ds_read_b64_tr_b16 v[122:123], v47 offset:6144
  ds_read_b64_tr_b16 v[124:125], v46 offset:9216
  ds_read_b64_tr_b16 v[126:127], v47 offset:9216
  s_waitcnt lgkmcnt(7)
  v_dot2c_f32_bf16 v48, s61, v112
  v_dot2c_f32_bf16 v49, s61, v113
  s_waitcnt lgkmcnt(6)
  v_dot2c_f32_bf16 v48, s61, v114
  v_dot2c_f32_bf16 v49, s61, v115
  s_waitcnt lgkmcnt(5)
  v_dot2c_f32_bf16 v48, s61, v116
  v_dot2c_f32_bf16 v49, s61, v117
  s_waitcnt lgkmcnt(4)
  v_dot2c_f32_bf16 v48, s61, v118
  v_dot2c_f32_bf16 v49, s61, v119
  s_waitcnt lgkmcnt(3)
  v_dot2c_f32_bf16 v48, s61, v120
  v_dot2c_f32_bf16 v49, s61, v121
  s_waitcnt lgkmcnt(2)
  v_dot2c_f32_bf16 v48, s61, v122
  v_dot2c_f32_bf16 v49, s61, v123
  s_waitcnt lgkmcnt(1)
  v_dot2c_f32_bf16 v48, s61, v124
  v_dot2c_f32_bf16 v49, s61, v125
  s_waitcnt lgkmcnt(0)
  v_dot2c_f32_bf16 v48, s61, v126
  v_dot2c_f32_bf16 v49, s61, v127
  v_add_u32 v46, 45056, v44
  v_add_u32 v47, 45056, v45
  ds_read_b64_tr_b16 v[96:97], v46
  ds_read_b64_tr_b16 v[98:99], v47
  ds_read_b64_tr_b16 v[100:101], v46 offset:3072
  ds_read_b64_tr_b16 v[102:103], v47 offset:3072
  ds_read_b64_tr_b16 v[104:105], v46 offset:6144
  ds_read_b64_tr_b16 v[106:107], v47 offset:6144
  ds_read_b64_tr_b16 v[108:109], v46 offset:9216
  ds_read_b64_tr_b16 v[110:111], v47 offset:9216
  s_waitcnt lgkmcnt(7)
  v_dot2c_f32_bf16 v48, s61, v96
  v_dot2c_f32_bf16 v49, s61, v97
  s_waitcnt lgkmcnt(6)
  v_dot2c_f32_bf16 v48, s61, v98
  v_dot2c_f32_bf16 v49, s61, v99
  s_waitcnt lgkmcnt(5)
  v_dot2c_f32_bf16 v48, s61, v100
  v_dot2c_f32_bf16 v49, s61, v101
  s_waitcnt lgkmcnt(4)
  v_dot2c_f32_bf16 v48, s61, v102
  v_dot2c_f32_bf16 v49, s61, v103
  s_waitcnt lgkmcnt(3)
  v_dot2c_f32_bf16 v48, s61, v104
  v_dot2c_f32_bf16 v49, s61, v105
  s_waitcnt lgkmcnt(2)
  v_dot2c_f32_bf16 v48, s61, v106
  v_dot2c_f32_bf16 v49, s61, v107
  s_waitcnt lgkmcnt(1)
  v_dot2c_f32_bf16 v48, s61, v108
  v_dot2c_f32_bf16 v49, s61, v109
  s_waitcnt lgkmcnt(0)
  v_dot2c_f32_bf16 v48, s61, v110
  v_dot2c_f32_bf16 v49, s61, v111
  v_add_u32 v46, 0, v44
  v_add_u32 v47, 0, v45
  ds_read_b64_tr_b16 v[112:113], v46
  ds_read_b64_tr_b16 v[114:115], v47
  ds_read_b64_tr_b16 v[116:117], v46 offset:3072
  ds_read_b64_tr_b16 v[118:119], v47 offset:3072
  ds_read_b64_tr_b16 v[120:121], v46 offset:6144
  ds_read_b64_tr_b16 v[122:123], v47 offset:6144
  ds_read_b64_tr_b16 v[124:125], v46 offset:9216
  ds_read_b64_tr_b16 v[126:127], v47 offset:9216
  s_waitcnt lgkmcnt(7)
  v_dot2c_f32_bf16 v48, s61, v112
  v_dot2c_f32_bf16 v49, s61, v113
  s_waitcnt lgkmcnt(6)
  v_dot2c_f32_bf16 v48, s61, v114
  v_dot2c_f32_bf16 v49, s61, v115
  s_waitcnt lgkmcnt(5)
  v_dot2c_f32_bf16 v48, s61, v116
  v_dot2c_f32_bf16 v49, s61, v117
  s_waitcnt lgkmcnt(4)
  v_dot2c_f32_bf16 v48, s61, v118
  v_dot2c_f32_bf16 v49, s61, v119
  s_waitcnt lgkmcnt(3)
  v_dot2c_f32_bf16 v48, s61, v120
  v_dot2c_f32_bf16 v49, s61, v121
  s_waitcnt lgkmcnt(2)
  v_dot2c_f32_bf16 v48, s61, v122
  v_dot2c_f32_bf16 v49, s61, v123
  s_waitcnt lgkmcnt(1)
  v_dot2c_f32_bf16 v48, s61, v124
  v_dot2c_f32_bf16 v49, s61, v125
  s_waitcnt lgkmcnt(0)
  v_dot2c_f32_bf16 v48, s61, v126
  v_dot2c_f32_bf16 v49, s61, v127
  v_add_u32 v46, 12288, v44
  v_add_u32 v47, 12288, v45
  ds_read_b64_tr_b16 v[96:97], v46
  ds_read_b64_tr_b16 v[98:99], v47
  ds_read_b64_tr_b16 v[100:101], v46 offset:3072
  ds_read_b64_tr_b16 v[102:103], v47 offset:3072
  ds_read_b64_tr_b16 v[104:105], v46 offset:6144
  ds_read_b64_tr_b16 v[106:107], v47 offset:6144
  ds_read_b64_tr_b16 v[108:109], v46 offset:9216
  ds_read_b64_tr_b16 v[110:111], v47 offset:9216
  s_waitcnt lgkmcnt(7)
  v_dot2c_f32_bf16 v48, s61, v96
  v_dot2c_f32_bf16 v49, s61, v97
  s_waitcnt lgkmcnt(6)
  v_dot2c_f32_bf16 v48, s61, v98
  v_dot2c_f32_bf16 v49, s61, v99
  s_waitcnt lgkmcnt(5)
  v_dot2c_f32_bf16 v48, s61, v100
  v_dot2c_f32_bf16 v49, s61, v101
  s_waitcnt lgkmcnt(4)
  v_dot2c_f32_bf16 v48, s61, v102
  v_dot2c_f32_bf16 v49, s61, v103
  s_waitcnt lgkmcnt(3)
  v_dot2c_f32_bf16 v48, s61, v104
  v_dot2c_f32_bf16 v49, s61, v105
  s_waitcnt lgkmcnt(2)
  v_dot2c_f32_bf16 v48, s61, v106
  v_dot2c_f32_bf16 v49, s61, v107
  s_waitcnt lgkmcnt(1)
  v_dot2c_f32_bf16 v48, s61, v108
  v_dot2c_f32_bf16 v49, s61, v109
  s_waitcnt lgkmcnt(0)
  v_dot2c_f32_bf16 v48, s61, v110
  v_dot2c_f32_bf16 v49, s61, v111
  s_nop 2
  v_add_f32 v48, v48, v49
  v_mov_b32 v46, v48
  s_nop 1
  v_permlane32_swap_b32 v46, v48
  v_add_f32 v48, v48, v46
  v_mov_b32 v46, v48
  s_nop 1
  v_permlane16_swap_b32 v46, v48
  v_add_f32 v48, v48, v46
  s_lshl_b32 s56, s7, 6
  s_add_u32 s56, s56, 162048
  v_lshl_add_u32 v46, v2, 2, s56
  ds_write_b32 v46, v48
  s_waitcnt lgkmcnt(0)
  v_mov_b32 v10, 1
  ds_write_b32 v11, v10 offset:80
  v_subrev_u32 v40, 256, v0
  v_lshlrev_b32 v42, 4, v40
  v_cmp_gt_u32 vcc, 210, v40
  v_bfrev_b32 v41, 1
  s_nop 0
  v_cndmask_b32 v41, v41, v42, vcc
  v_min_u32 v42, 3392, v42
  v_add_u32 v42, 139264, v42
  s_add_u32 s16, s52, 17825792
  s_addc_u32 s17, s53, 0
  s_mov_b32 s18, 884736
  s_mov_b32 s19, 0x00020000
  s_lshl_b32 s56, s92, 4
  s_add_u32 s79, s56, s91
  s_mul_i32 s63, s79, 3456
  s_lshl_b32 s79, s79, 2
  s_add_u32 s79, s79, s7
  s_waitcnt lgkmcnt(0)
  s_mov_b32 s57, 0
L_100035:
  ds_read_b128 v[12:15], v8 offset:32
  s_waitcnt lgkmcnt(0)
  v_min3_u32 v12, v12, v13, v14
  v_min_u32 v12, v12, v15
  s_nop 0
  v_readfirstlane_b32 s56, v12
  s_nop 3
  s_cmp_ge_u32 s56, 1
  s_cbranch_scc1 L_100036
  s_add_u32 s57, s57, 1
  s_cmp_lt_u32 s57, 0x400000
  s_cbranch_scc1 L_100035
L_100036:
  ds_read_b128 v[64:67], v42
  ds_read_b128 v[68:71], v42 offset:3456
  ds_read_b128 v[72:75], v42 offset:6912
  ds_read_b128 v[76:79], v42 offset:10368
  s_waitcnt lgkmcnt(2)
  v_add_f32 v64, v64, v68
  s_waitcnt lgkmcnt(0)
  v_add_f32 v72, v72, v76
  v_add_f32 v65, v65, v69
  v_add_f32 v73, v73, v77
  v_add_f32 v66, v66, v70
  v_add_f32 v74, v74, v78
  v_add_f32 v67, v67, v71
  v_add_f32 v75, v75, v79
  v_add_f32 v64, v64, v72
  v_add_f32 v65, v65, v73
  v_add_f32 v66, v66, v74
  v_add_f32 v67, v67, v75
  buffer_store_dwordx4 v[64:67], v41, s[16:19], s63 offen sc1
  s_add_u32 s56, s54, 0
  v_mov_b32 v12, s56
  v_mov_b32 v13, s55
  v_mov_b32 v10, 0
  s_lshl_b32 s57, s79, 7
  s_add_u32 s57, s57, 0
  s_mov_b64 s[58:59], exec
  s_waitcnt vmcnt(0)
  s_mov_b64 exec, 1
  buffer_store_dwordx2 v[12:13], v10, s[24:27], s57 offen sc1
  s_mov_b64 exec, s[58:59]
  s_cmp_lg_u32 s7, 0
  s_cbranch_scc1 L_100037
  s_add_u32 s3, s2, 1024
  s_mov_b32 s84, s42
  s_mov_b32 s85, s43
  s_mov_b32 s57, 1080
  s_mov_b32 s31, 819200
  s_mov_b32 s39, 0x80000000
  s_mov_b32 s86, 819200
  s_mov_b32 s38, 102400
  s_cmp_lt_u32 s3, 1080
  s_cselect_b32 s84, s46, s84
  s_cselect_b32 s85, s47, s85
  s_cselect_b32 s57, 540, s57
  s_cselect_b32 s31, 1638400, s31
  s_cselect_b32 s39, 0x80000000, s39
  s_cselect_b32 s86, 2211840, s86
  s_cselect_b32 s38, 276480, s38
  s_mov_b32 s58, 6554
  s_mov_b32 s59, 10
  s_mov_b32 s60, 1280
  s_mov_b32 s62, 2560
  s_cmp_lt_u32 s3, 540
  s_cselect_b32 s84, s44, s84
  s_cselect_b32 s85, s45, s85
  s_cselect_b32 s57, 0, s57
  s_cselect_b32 s31, 3850240, s31
  s_cselect_b32 s39, 6195200, s39
  s_cselect_b32 s38, 0, s38
  s_cselect_b32 s58, 2428, s58
  s_cselect_b32 s59, 27, s59
  s_cselect_b32 s60, 3456, s60
  s_cselect_b32 s62, 6912, s62
  s_mov_b32 s87, 0x00020000
  s_sub_u32 s57, s3, s57
  s_mul_i32 s29, s57, s58
  s_lshr_b32 s29, s29, 16
  s_mul_i32 s59, s29, s59
  s_sub_u32 s57, s57, s59
  s_lshl_b32 s30, s57, 2
  s_mul_i32 s62, s62, s29
  s_add_u32 s39, s39, s62
  s_lshl_b32 s62, s57, 8
  s_add_u32 s39, s39, s62
  s_cmp_lt_u32 s3, 1280
  s_cselect_b32 s31, s31, 0x80000000
  s_lshl_b32 s58, s29, 5
  s_mul_i32 s58, s58, s60
  s_lshl_b32 s57, s57, 7
  s_add_u32 s58, s58, s57
  v_lshrrev_b32 v4, 3, v1
  v_mul_lo_u32 v4, v4, s60
  v_and_b32 v10, 7, v1
  v_lshl_add_u32 v4, v10, 4, v4
  s_lshl_b32 s60, s60, 3
  s_lshl_b32 s57, s7, 12
  s_add_u32 m0, s57, 155136
  s_nop 0
  buffer_load_dwordx4 v4, s[84:87], s58 offen lds
  s_add_u32 s58, s58, s60
  s_add_u32 m0, s57, 156160
  s_nop 0
  buffer_load_dwordx4 v4, s[84:87], s58 offen lds
  s_add_u32 s58, s58, s60
  s_add_u32 m0, s57, 157184
  s_nop 0
  buffer_load_dwordx4 v4, s[84:87], s58 offen lds
  s_add_u32 s58, s58, s60
  s_add_u32 m0, s57, 158208
  s_nop 0
  buffer_load_dwordx4 v4, s[84:87], s58 offen lds
L_100037:
  s_add_u32 m0, s64, 61440
  s_mov_b32 s58, 0
  buffer_load_dwordx4 v24, s[8:11], s58 offen lds
  s_add_u32 m0, s64, 65536
  s_mov_b32 s58, 0
  buffer_load_dwordx4 v25, s[8:11], s58 offen lds
  s_add_u32 m0, s64, 69632
  s_mov_b32 s58, 0
  buffer_load_dwordx4 v26, s[8:11], s58 offen lds
  s_add_u32 m0, s64, 73728
  s_mov_b32 s58, 0
  buffer_load_dwordx4 v27, s[8:11], s58 offen lds
  s_add_u32 m0, s64, 77824
  s_mov_b32 s58, 0
  buffer_load_dwordx4 v28, s[8:11], s58 offen lds
  s_add_u32 m0, s64, 81920
  s_mov_b32 s58, 163840
  buffer_load_dwordx4 v24, s[8:11], s58 offen lds
  s_waitcnt vmcnt(5)
  s_add_u32 m0, s64, 86016
  s_mov_b32 s58, 163840
  buffer_load_dwordx4 v25, s[8:11], s58 offen lds
  s_waitcnt vmcnt(5)
  s_add_u32 m0, s64, 90112
  s_mov_b32 s58, 163840
  buffer_load_dwordx4 v26, s[8:11], s58 offen lds
  s_waitcnt vmcnt(5)
  s_add_u32 m0, s64, 94208
  s_mov_b32 s58, 163840
  buffer_load_dwordx4 v27, s[8:11], s58 offen lds
  s_waitcnt vmcnt(5)
  s_add_u32 m0, s64, 98304
  s_mov_b32 s58, 163840
  buffer_load_dwordx4 v28, s[8:11], s58 offen lds
  s_waitcnt vmcnt(5)
  v_mov_b32 v10, 16
  ds_write_b32 v11, v10
  v_mul_u32_u24 v42, 13108, v40
  v_lshrrev_b32 v42, 16, v42
  v_mul_u32_u24 v43, 5, v42
  v_sub_u32 v43, v40, v43
  v_mul_u32_u24 v42, 48, v42
  v_lshl_add_u32 v42, v43, 3, v42
  v_add_u32 v42, 153088, v42
  v_mov_b32 v43, 155104
  v_cmp_gt_u32 vcc, 210, v40
  s_nop 1
  v_cndmask_b32 v42, v43, v42, vcc
  s_lshl_b32 s62, s76, 6
  s_mul_i32 s63, s76, 55296
  s_add_u32 s56, s54, 0
  v_add_u32 v10, s62, v1
  v_lshlrev_b32 v10, 7, v10
  v_add_u32 v10, 0, v10
  s_mov_b64 s[58:59], exec
  s_mov_b64 exec, -1
  s_mov_b32 s57, 0
  s_waitcnt vmcnt(0)
L_100038:
  buffer_load_dwordx2 v[12:13], v10, s[24:27], 0 offen sc1
  s_waitcnt vmcnt(0)
  v_cmp_ne_u32 vcc, s56, v12
  v_cmp_ne_u32 s[94:95], s55, v13
  s_add_u32 s57, s57, 1
  s_nop 4
  s_or_b64 vcc, vcc, s[94:95]
  s_cbranch_vccz L_100039
  s_cmp_lt_u32 s57, 0x80000
  s_cbranch_scc1 L_100038
L_100039:
  s_mov_b64 exec, s[58:59]
  s_waitcnt vmcnt(0)
  v_mov_b32 v10, 17
  ds_write_b32 v11, v10
  buffer_load_dwordx4 v[96:99], v41, s[16:19], s63 offen sc1
  s_add_u32 s63, s63, 3456
  buffer_load_dwordx4 v[100:103], v41, s[16:19], s63 offen sc1
  s_add_u32 s63, s63, 3456
  buffer_load_dwordx4 v[104:107], v41, s[16:19], s63 offen sc1
  s_add_u32 s63, s63, 3456
  buffer_load_dwordx4 v[108:111], v41, s[16:19], s63 offen sc1
  s_add_u32 s63, s63, 3456
  buffer_load_dwordx4 v[112:115], v41, s[16:19], s63 offen sc1
  s_add_u32 s63, s63, 3456
  buffer_load_dwordx4 v[116:119], v41, s[16:19], s63 offen sc1
  s_add_u32 s63, s63, 3456
  buffer_load_dwordx4 v[120:123], v41, s[16:19], s63 offen sc1
  s_add_u32 s63, s63, 3456
  buffer_load_dwordx4 v[124:127], v41, s[16:19], s63 offen sc1
  s_add_u32 s63, s63, 3456
  buffer_load_dwordx4 v[128:131], v41, s[16:19], s63 offen sc1
  s_add_u32 s63, s63, 3456
  buffer_load_dwordx4 v[132:135], v41, s[16:19], s63 offen sc1
  s_add_u32 s63, s63, 3456
  buffer_load_dwordx4 v[136:139], v41, s[16:19], s63 offen sc1
  s_add_u32 s63, s63, 3456
  buffer_load_dwordx4 v[140:143], v41, s[16:19], s63 offen sc1
  s_add_u32 s63, s63, 3456
  buffer_load_dwordx4 v[144:147], v41, s[16:19], s63 offen sc1
  s_add_u32 s63, s63, 3456
  buffer_load_dwordx4 v[148:151], v41, s[16:19], s63 offen sc1
  s_add_u32 s63, s63, 3456
  buffer_load_dwordx4 v[152:155], v41, s[16:19], s63 offen sc1
  s_add_u32 s63, s63, 3456
  buffer_load_dwordx4 v[156:159], v41, s[16:19], s63 offen sc1
  s_waitcnt vmcnt(14)
  v_add_f32 v96, v96, v100
  v_add_f32 v97, v97, v101
  v_add_f32 v98, v98, v102
  v_add_f32 v99, v99, v103
  s_waitcnt vmcnt(12)
  v_add_f32 v104, v104, v108
  v_add_f32 v105, v105, v109
  v_add_f32 v106, v106, v110
  v_add_f32 v107, v107, v111
  s_waitcnt vmcnt(10)
  v_add_f32 v112, v112, v116
  v_add_f32 v113, v113, v117
  v_add_f32 v114, v114, v118
  v_add_f32 v115, v115, v119
  s_waitcnt vmcnt(8)
  v_add_f32 v120, v120, v124
  v_add_f32 v121, v121, v125
  v_add_f32 v122, v122, v126
  v_add_f32 v123, v123, v127
  s_waitcnt vmcnt(6)
  v_add_f32 v128, v128, v132
  v_add_f32 v129, v129, v133
  v_add_f32 v130, v130, v134
  v_add_f32 v131, v131, v135
  s_waitcnt vmcnt(4)
  v_add_f32 v136, v136, v140
  v_add_f32 v137, v137, v141
  v_add_f32 v138, v138, v142
  v_add_f32 v139, v139, v143
  s_waitcnt vmcnt(2)
  v_add_f32 v144, v144, v148
  v_add_f32 v145, v145, v149
  v_add_f32 v146, v146, v150
  v_add_f32 v147, v147, v151
  s_waitcnt vmcnt(0)
  v_add_f32 v152, v152, v156
  v_add_f32 v153, v153, v157
  v_add_f32 v154, v154, v158
  v_add_f32 v155, v155, v159
  v_add_f32 v96, v96, v104
  v_add_f32 v97, v97, v105
  v_add_f32 v98, v98, v106
  v_add_f32 v99, v99, v107
  v_add_f32 v112, v112, v120
  v_add_f32 v113, v113, v121
  v_add_f32 v114, v114, v122
  v_add_f32 v115, v115, v123
  v_add_f32 v128, v128, v136
  v_add_f32 v129, v129, v137
  v_add_f32 v130, v130, v138
  v_add_f32 v131, v131, v139
  v_add_f32 v144, v144, v152
  v_add_f32 v145, v145, v153
  v_add_f32 v146, v146, v154
  v_add_f32 v147, v147, v155
  v_add_f32 v96, v96, v112
  v_add_f32 v97, v97, v113
  v_add_f32 v98, v98, v114
  v_add_f32 v99, v99, v115
  v_add_f32 v128, v128, v144
  v_add_f32 v129, v129, v145
  v_add_f32 v130, v130, v146
  v_add_f32 v131, v131, v147
  v_add_f32 v96, v96, v128
  v_add_f32 v97, v97, v129
  v_add_f32 v98, v98, v130
  v_add_f32 v99, v99, v131
  v_cvt_pk_bf16_f32 v96, v96, v97
  v_cvt_pk_bf16_f32 v97, v98, v99
  ds_write_b64 v42, v[96:97]
  s_waitcnt lgkmcnt(0)
  v_mov_b32 v10, 1
  ds_write_b32 v11, v10 offset:48
  s_waitcnt lgkmcnt(0)
  ds_read_b128 v[12:15], v8 offset:16
  s_waitcnt lgkmcnt(0)
  v_min3_u32 v12, v12, v13, v14
  v_min_u32 v12, v12, v15
  s_nop 0
  v_readfirstlane_b32 s56, v12
  s_nop 3
  s_cmp_ge_u32 s56, 11
  s_cbranch_scc1 L_100040
  s_waitcnt vmcnt(0)
  v_mov_b32 v10, 17
  ds_write_b32 v11, v10 offset:0
  s_waitcnt lgkmcnt(0)
  s_mov_b32 s57, 0
L_100041:
  ds_read_b128 v[12:15], v8 offset:16
  s_waitcnt lgkmcnt(0)
  v_min3_u32 v12, v12, v13, v14
  v_min_u32 v12, v12, v15
  s_nop 0
  v_readfirstlane_b32 s56, v12
  s_nop 3
  s_cmp_ge_u32 s56, 11
  s_cbranch_scc1 L_100042
  s_add_u32 s57, s57, 1
  s_sleep 1
  s_cmp_lt_u32 s57, 0x400000
  s_cbranch_scc1 L_100041
L_100042:
L_100040:
  s_add_u32 m0, s64, 102400
  s_mov_b32 s58, 327680
  buffer_load_dwordx4 v24, s[8:11], s58 offen lds
  s_add_u32 m0, s64, 106496
  s_mov_b32 s58, 327680
  buffer_load_dwordx4 v25, s[8:11], s58 offen lds
  s_add_u32 m0, s64, 110592
  s_mov_b32 s58, 327680
  buffer_load_dwordx4 v26, s[8:11], s58 offen lds
  s_add_u32 m0, s64, 114688
  s_mov_b32 s58, 327680
  buffer_load_dwordx4 v27, s[8:11], s58 offen lds
  s_add_u32 m0, s64, 118784
  s_mov_b32 s58, 327680
  buffer_load_dwordx4 v28, s[8:11], s58 offen lds
  s_waitcnt lgkmcnt(0)
  ds_read_b128 v[12:15], v8 offset:16
  s_waitcnt lgkmcnt(0)
  v_min3_u32 v12, v12, v13, v14
  v_min_u32 v12, v12, v15
  s_nop 0
  v_readfirstlane_b32 s56, v12
  s_nop 3
  s_cmp_ge_u32 s56, 15
  s_cbranch_scc1 L_100043
  s_waitcnt vmcnt(0)
  v_mov_b32 v10, 18
  ds_write_b32 v11, v10 offset:0
  s_waitcnt lgkmcnt(0)
  s_mov_b32 s57, 0
L_100044:
  ds_read_b128 v[12:15], v8 offset:16
  s_waitcnt lgkmcnt(0)
  v_min3_u32 v12, v12, v13, v14
  v_min_u32 v12, v12, v15
  s_nop 0
  v_readfirstlane_b32 s56, v12
  s_nop 3
  s_cmp_ge_u32 s56, 15
  s_cbranch_scc1 L_100045
  s_add_u32 s57, s57, 1
  s_sleep 1
  s_cmp_lt_u32 s57, 0x400000
  s_cbranch_scc1 L_100044
L_100045:
L_100043:
  s_add_u32 m0, s64, 0
  s_mov_b32 s58, 491520
  buffer_load_dwordx4 v24, s[8:11], s58 offen lds
  s_waitcnt vmcnt(5)
  s_add_u32 m0, s64, 4096
  s_mov_b32 s58, 491520
  buffer_load_dwordx4 v25, s[8:11], s58 offen lds
  s_waitcnt vmcnt(5)
  s_add_u32 m0, s64, 8192
  s_mov_b32 s58, 491520
  buffer_load_dwordx4 v26, s[8:11], s58 offen lds
  s_waitcnt vmcnt(5)
  s_add_u32 m0, s64, 12288
  s_mov_b32 s58, 491520
  buffer_load_dwordx4 v27, s[8:11], s58 offen lds
  s_waitcnt vmcnt(5)
  s_add_u32 m0, s64, 16384
  s_mov_b32 s58, 491520
  buffer_load_dwordx4 v28, s[8:11], s58 offen lds
  s_waitcnt vmcnt(5)
  v_mov_b32 v10, 18
  ds_write_b32 v11, v10
  s_waitcnt lgkmcnt(0)
  ds_read_b128 v[12:15], v8 offset:16
  s_waitcnt lgkmcnt(0)
  v_min3_u32 v12, v12, v13, v14
  v_min_u32 v12, v12, v15
  s_nop 0
  v_readfirstlane_b32 s56, v12
  s_nop 3
  s_cmp_ge_u32 s56, 13
  s_cbranch_scc1 L_100046
  s_waitcnt vmcnt(0)
  v_mov_b32 v10, 19
  ds_write_b32 v11, v10 offset:0
  s_waitcnt lgkmcnt(0)
  s_mov_b32 s57, 0
L_100047:
  ds_read_b128 v[12:15], v8 offset:16
  s_waitcnt lgkmcnt(0)
  v_min3_u32 v12, v12, v13, v14
  v_min_u32 v12, v12, v15
  s_nop 0
  v_readfirstlane_b32 s56, v12
  s_nop 3
  s_cmp_ge_u32 s56, 13
  s_cbranch_scc1 L_100048
  s_add_u32 s57, s57, 1
  s_sleep 1
  s_cmp_lt_u32 s57, 0x400000
  s_cbranch_scc1 L_100047
L_100048:
L_100046:
  s_add_u32 m0, s64, 40960
  s_mov_b32 s58, 655360
  buffer_load_dwordx4 v24, s[8:11], s58 offen lds
  s_waitcnt vmcnt(5)
  s_add_u32 m0, s64, 45056
  s_mov_b32 s58, 655360
  buffer_load_dwordx4 v25, s[8:11], s58 offen lds
  s_waitcnt vmcnt(5)
  s_add_u32 m0, s64, 49152
  s_mov_b32 s58, 655360
  buffer_load_dwordx4 v26, s[8:11], s58 offen lds
  s_waitcnt vmcnt(5)
  s_add_u32 m0, s64, 53248
  s_mov_b32 s58, 655360
  buffer_load_dwordx4 v27, s[8:11], s58 offen lds
  s_waitcnt vmcnt(5)
  s_add_u32 m0, s64, 57344
  s_mov_b32 s58, 655360
  buffer_load_dwordx4 v28, s[8:11], s58 offen lds
  s_waitcnt vmcnt(5)
  v_mov_b32 v10, 19
  ds_write_b32 v11, v10
  s_waitcnt vmcnt(0)
  v_mov_b32 v10, 20
  ds_write_b32 v11, v10
  s_cmp_lg_u32 s7, 0
  s_cbranch_scc1 L_100049
  v_bfe_u32 v60, v0, 2, 2
  v_lshl_add_u32 v60, v3, 3, v60
  v_lshlrev_b32 v60, 7, v60
  v_and_b32 v61, 3, v0
  v_lshl_add_u32 v60, v61, 3, v60
  s_lshl_b32 s57, s7, 12
  s_add_u32 s57, s57, 155136
  v_add_u32 v60, s57, v60
  s_add_u32 s84, s52, 20971520
  s_addc_u32 s85, s53, 0
  s_mov_b32 s86, 6333440
  s_mov_b32 s87, 0x00020000
  v_lshlrev_b32 v61, 4, v1
  ds_read_b64_tr_b16 v[64:65], v60
  ds_read_b64_tr_b16 v[66:67], v60 offset:512
  ds_read_b64_tr_b16 v[68:69], v60 offset:32
  ds_read_b64_tr_b16 v[70:71], v60 offset:544
  ds_read_b64_tr_b16 v[72:73], v60 offset:64
  ds_read_b64_tr_b16 v[74:75], v60 offset:576
  ds_read_b64_tr_b16 v[76:77], v60 offset:96
  ds_read_b64_tr_b16 v[78:79], v60 offset:608
  s_add_u32 s56, s30, 0
  s_mul_i32 s57, s56, 52
  s_lshr_b32 s57, s57, 8
  s_mul_i32 s58, s57, 5
  s_sub_u32 s58, s56, s58
  s_mul_i32 s57, s57, s38
  s_mul_i32 s59, s29, 5
  s_add_u32 s58, s58, s59
  s_lshl_b32 s58, s58, 10
  s_add_u32 s57, s57, s58
  s_lshl_b32 s58, s56, 2
  s_add_u32 s58, s58, 3
  s_mul_i32 s58, s58, 2428
  s_lshr_b32 s58, s58, 16
  s_mul_i32 s62, s29, 7
  s_add_u32 s62, s62, s56
  s_mul_i32 s59, s58, 27
  s_lshr_b32 s60, s59, 2
  s_sub_u32 s60, s62, s60
  s_lshl_b32 s60, s60, 10
  s_mul_i32 s63, s58, 143360
  s_add_u32 s60, s60, s63
  s_sub_u32 s59, s59, 27
  s_ashr_i32 s59, s59, 2
  s_sub_u32 s3, s56, s59
  s_sub_u32 s59, s62, s59
  s_lshl_b32 s59, s59, 10
  s_add_u32 s59, s59, s63
  s_sub_u32 s59, s59, 143360
  s_cmp_lt_u32 s3, 7
  s_cselect_b32 s59, s59, 0x40000000
  s_cmp_eq_u32 s58, 0
  s_cselect_b32 s59, 0x40000000, s59
  s_cmp_eq_u32 s38, 0
  s_cselect_b32 s60, s60, s57
  s_cselect_b32 s59, s59, 0x40000000
  s_add_u32 s60, s60, s31
  s_add_u32 s59, s59, s31
  s_waitcnt lgkmcnt(6)
  buffer_store_dwordx4 v[64:67], v61, s[84:87], s60 offen sc1
  buffer_store_dwordx4 v[64:67], v61, s[84:87], s59 offen sc1
  v_mov_b32 v84, 0
  v_dot2c_f32_bf16 v84, s61, v64
  v_dot2c_f32_bf16 v84, s61, v65
  v_dot2c_f32_bf16 v84, s61, v66
  v_dot2c_f32_bf16 v84, s61, v67
  s_add_u32 s56, s30, 1
  s_mul_i32 s57, s56, 52
  s_lshr_b32 s57, s57, 8
  s_mul_i32 s58, s57, 5
  s_sub_u32 s58, s56, s58
  s_mul_i32 s57, s57, s38
  s_mul_i32 s59, s29, 5
  s_add_u32 s58, s58, s59
  s_lshl_b32 s58, s58, 10
  s_add_u32 s57, s57, s58
  s_lshl_b32 s58, s56, 2
  s_add_u32 s58, s58, 3
  s_mul_i32 s58, s58, 2428
  s_lshr_b32 s58, s58, 16
  s_mul_i32 s62, s29, 7
  s_add_u32 s62, s62, s56
  s_mul_i32 s59, s58, 27
  s_lshr_b32 s60, s59, 2
  s_sub_u32 s60, s62, s60
  s_lshl_b32 s60, s60, 10
  s_mul_i32 s63, s58, 143360
  s_add_u32 s60, s60, s63
  s_sub_u32 s59, s59, 27
  s_ashr_i32 s59, s59, 2
  s_sub_u32 s3, s56, s59
  s_sub_u32 s59, s62, s59
  s_lshl_b32 s59, s59, 10
  s_add_u32 s59, s59, s63
  s_sub_u32 s59, s59, 143360
  s_cmp_lt_u32 s3, 7
  s_cselect_b32 s59, s59, 0x40000000
  s_cmp_eq_u32 s58, 0
  s_cselect_b32 s59, 0x40000000, s59
  s_cmp_eq_u32 s38, 0
  s_cselect_b32 s60, s60, s57
  s_cselect_b32 s59, s59, 0x40000000
  s_add_u32 s60, s60, s31
  s_add_u32 s59, s59, s31
  s_waitcnt lgkmcnt(4)
  buffer_store_dwordx4 v[68:71], v61, s[84:87], s60 offen sc1
  buffer_store_dwordx4 v[68:71], v61, s[84:87], s59 offen sc1
  v_mov_b32 v85, 0
  v_dot2c_f32_bf16 v85, s61, v68
  v_dot2c_f32_bf16 v85, s61, v69
  v_dot2c_f32_bf16 v85, s61, v70
  v_dot2c_f32_bf16 v85, s61, v71
  s_add_u32 s56, s30, 2
  s_mul_i32 s57, s56, 52
  s_lshr_b32 s57, s57, 8
  s_mul_i32 s58, s57, 5
  s_sub_u32 s58, s56, s58
  s_mul_i32 s57, s57, s38
  s_mul_i32 s59, s29, 5
  s_add_u32 s58, s58, s59
  s_lshl_b32 s58, s58, 10
  s_add_u32 s57, s57, s58
  s_lshl_b32 s58, s56, 2
  s_add_u32 s58, s58, 3
  s_mul_i32 s58, s58, 2428
  s_lshr_b32 s58, s58, 16
  s_mul_i32 s62, s29, 7
  s_add_u32 s62, s62, s56
  s_mul_i32 s59, s58, 27
  s_lshr_b32 s60, s59, 2
  s_sub_u32 s60, s62, s60
  s_lshl_b32 s60, s60, 10
  s_mul_i32 s63, s58, 143360
  s_add_u32 s60, s60, s63
  s_sub_u32 s59, s59, 27
  s_ashr_i32 s59, s59, 2
  s_sub_u32 s3, s56, s59
  s_sub_u32 s59, s62, s59
  s_lshl_b32 s59, s59, 10
  s_add_u32 s59, s59, s63
  s_sub_u32 s59, s59, 143360
  s_cmp_lt_u32 s3, 7
  s_cselect_b32 s59, s59, 0x40000000
  s_cmp_eq_u32 s58, 0
  s_cselect_b32 s59, 0x40000000, s59
  s_cmp_eq_u32 s38, 0
  s_cselect_b32 s60, s60, s57
  s_cselect_b32 s59, s59, 0x40000000
  s_add_u32 s60, s60, s31
  s_add_u32 s59, s59, s31
  s_waitcnt lgkmcnt(2)
  buffer_store_dwordx4 v[72:75], v61, s[84:87], s60 offen sc1
  buffer_store_dwordx4 v[72:75], v61, s[84:87], s59 offen sc1
  v_mov_b32 v86, 0
  v_dot2c_f32_bf16 v86, s61, v72
  v_dot2c_f32_bf16 v86, s61, v73
  v_dot2c_f32_bf16 v86, s61, v74
  v_dot2c_f32_bf16 v86, s61, v75
  s_add_u32 s56, s30, 3
  s_mul_i32 s57, s56, 52
  s_lshr_b32 s57, s57, 8
  s_mul_i32 s58, s57, 5
  s_sub_u32 s58, s56, s58
  s_mul_i32 s57, s57, s38
  s_mul_i32 s59, s29, 5
  s_add_u32 s58, s58, s59
  s_lshl_b32 s58, s58, 10
  s_add_u32 s57, s57, s58
  s_lshl_b32 s58, s56, 2
  s_add_u32 s58, s58, 3
  s_mul_i32 s58, s58, 2428
  s_lshr_b32 s58, s58, 16
  s_mul_i32 s62, s29, 7
  s_add_u32 s62, s62, s56
  s_mul_i32 s59, s58, 27
  s_lshr_b32 s60, s59, 2
  s_sub_u32 s60, s62, s60
  s_lshl_b32 s60, s60, 10
  s_mul_i32 s63, s58, 143360
  s_add_u32 s60, s60, s63
  s_sub_u32 s59, s59, 27
  s_ashr_i32 s59, s59, 2
  s_sub_u32 s3, s56, s59
  s_sub_u32 s59, s62, s59
  s_lshl_b32 s59, s59, 10
  s_add_u32 s59, s59, s63
  s_sub_u32 s59, s59, 143360
  s_cmp_lt_u32 s3, 7
  s_cselect_b32 s59, s59, 0x40000000
  s_cmp_eq_u32 s58, 0
  s_cselect_b32 s59, 0x40000000, s59
  s_cmp_eq_u32 s38, 0
  s_cselect_b32 s60, s60, s57
  s_cselect_b32 s59, s59, 0x40000000
  s_add_u32 s60, s60, s31
  s_add_u32 s59, s59, s31
  s_waitcnt lgkmcnt(0)
  buffer_store_dwordx4 v[76:79], v61, s[84:87], s60 offen sc1
  buffer_store_dwordx4 v[76:79], v61, s[84:87], s59 offen sc1
  v_mov_b32 v87, 0
  v_dot2c_f32_bf16 v87, s61, v76
  v_dot2c_f32_bf16 v87, s61, v77
  v_dot2c_f32_bf16 v87, s61, v78
  v_dot2c_f32_bf16 v87, s61, v79
  v_mov_b32 v62, v84
  s_nop 1
  v_permlane32_swap_b32 v62, v84
  v_add_f32 v84, v84, v62
  v_mov_b32 v62, v84
  s_nop 1
  v_permlane16_swap_b32 v62, v84
  v_add_f32 v84, v84, v62
  v_mov_b32 v62, v85
  s_nop 1
  v_permlane32_swap_b32 v62, v85
  v_add_f32 v85, v85, v62
  v_mov_b32 v62, v85
  s_nop 1
  v_permlane16_swap_b32 v62, v85
  v_add_f32 v85, v85, v62
  v_mov_b32 v62, v86
  s_nop 1
  v_permlane32_swap_b32 v62, v86
  v_add_f32 v86, v86, v62
  v_mov_b32 v62, v86
  s_nop 1
  v_permlane16_swap_b32 v62, v86
  v_add_f32 v86, v86, v62
  v_mov_b32 v62, v87
  s_nop 1
  v_permlane32_swap_b32 v62, v87
  v_add_f32 v87, v87, v62
  v_mov_b32 v62, v87
  s_nop 1
  v_permlane16_swap_b32 v62, v87
  v_add_f32 v87, v87, v62
  v_cmp_eq_u32 vcc, 1, v3
  s_nop 1
  v_cndmask_b32 v84, v84, v85, vcc
  v_cmp_eq_u32 vcc, 2, v3
  s_nop 1
  v_cndmask_b32 v84, v84, v86, vcc
  v_cmp_eq_u32 vcc, 3, v3
  s_nop 1
  v_cndmask_b32 v84, v84, v87, vcc
  v_lshlrev_b32 v62, 2, v1
  buffer_store_dword v84, v62, s[84:87], s39 offen sc1
  s_waitcnt lgkmcnt(0)
  s_waitcnt vmcnt(0)
  s_waitcnt lgkmcnt(0)
  s_mov_b32 s57, 0
L_100050:
  ds_read_b128 v[12:15], v8 offset:96
  s_waitcnt lgkmcnt(0)
  v_min3_u32 v12, v12, v13, v14
  v_min_u32 v12, v12, v15
  s_nop 0
  v_readfirstlane_b32 s56, v12
  s_nop 3
  s_cmp_ge_u32 s56, 1
  s_cbranch_scc1 L_100051
  s_add_u32 s57, s57, 1
  s_sleep 1
  s_cmp_lt_u32 s57, 0x400000
  s_cbranch_scc1 L_100050
L_100051:
  s_add_u32 s56, s54, 12
  v_mov_b32 v12, s56
  v_mov_b32 v13, s55
  v_mov_b32 v10, 0
  s_lshl_b32 s57, s2, 7
  s_add_u32 s57, s57, 786432
  s_mov_b64 s[58:59], exec
  s_mov_b64 exec, 1
  buffer_store_dwordx2 v[12:13], v10, s[24:27], s57 offen sc1
  s_mov_b64 exec, s[58:59]
L_100049:
  s_mov_b32 s12, s40
  s_mov_b32 s13, s41
  s_mov_b32 s14, 819200
  s_mov_b32 s15, 0x00020000
  v_bfe_u32 v46, v0, 2, 2
  v_bfe_u32 v47, v0, 4, 1
  v_lshl_or_b32 v46, v47, 2, v46
  v_lshl_or_b32 v47, v3, 3, v46
  v_mul_u32_u24 v44, 160, v47
  v_xor_b32 v47, 4, v47
  v_mul_u32_u24 v45, 160, v47
  v_and_b32 v46, 3, v0
  v_lshl_add_u32 v44, v46, 3, v44
  v_lshl_add_u32 v45, v46, 3, v45
  s_lshl_b32 s56, s7, 5
  v_add_u32 v44, s56, v44
  v_add_u32 v45, s56, v45
  v_mov_b32 v48, 0
  v_mov_b32 v49, 0
  s_waitcnt lgkmcnt(0)
  s_mov_b32 s57, 0
L_100052:
  ds_read_b128 v[12:15], v8 offset:96
  s_waitcnt lgkmcnt(0)
  v_min3_u32 v12, v12, v13, v14
  v_min_u32 v12, v12, v15
  s_nop 0
  v_readfirstlane_b32 s56, v12
  s_nop 3
  s_cmp_ge_u32 s56, 1
  s_cbranch_scc1 L_100053
  s_add_u32 s57, s57, 1
  s_sleep 1
  s_cmp_lt_u32 s57, 0x400000
  s_cbranch_scc1 L_100052
L_100053:
  s_waitcnt lgkmcnt(0)
  ds_read_b128 v[12:15], v8 offset:16
  s_waitcnt lgkmcnt(0)
  v_min3_u32 v12, v12, v13, v14
  v_min_u32 v12, v12, v15
  s_nop 0
  v_readfirstlane_b32 s56, v12
  s_nop 3
  s_cmp_ge_u32 s56, 15
  s_cbranch_scc1 L_100054
  s_waitcnt vmcnt(0)
  v_mov_b32 v10, 20
  ds_write_b32 v11, v10 offset:0
  s_waitcnt lgkmcnt(0)
  s_mov_b32 s57, 0
L_100055:
  ds_read_b128 v[12:15], v8 offset:16
  s_waitcnt lgkmcnt(0)
  v_min3_u32 v12, v12, v13, v14
  v_min_u32 v12, v12, v15
  s_nop 0
  v_readfirstlane_b32 s56, v12
  s_nop 3
  s_cmp_ge_u32 s56, 15
  s_cbranch_scc1 L_100056
  s_add_u32 s57, s57, 1
  s_sleep 1
  s_cmp_lt_u32 s57, 0x400000
  s_cbranch_scc1 L_100055
L_100056:
L_100054:
  s_add_u32 m0, s64, 20480
  s_mov_b32 s58, 0
  buffer_load_dwordx4 v24, s[12:15], s58 offen lds
  s_add_u32 m0, s64, 24576
  s_mov_b32 s58, 0
  buffer_load_dwordx4 v25, s[12:15], s58 offen lds
  s_add_u32 m0, s64, 28672
  s_mov_b32 s58, 0
  buffer_load_dwordx4 v26, s[12:15], s58 offen lds
  s_add_u32 m0, s64, 32768
  s_mov_b32 s58, 0
  buffer_load_dwordx4 v27, s[12:15], s58 offen lds
  s_add_u32 m0, s64, 36864
  s_mov_b32 s58, 0
  buffer_load_dwordx4 v28, s[12:15], s58 offen lds
  s_add_u32 m0, s64, 122880
  s_mov_b32 s58, 163840
  buffer_load_dwordx4 v24, s[12:15], s58 offen lds
  s_waitcnt vmcnt(5)
  s_add_u32 m0, s64, 126976
  s_mov_b32 s58, 163840
  buffer_load_dwordx4 v25, s[12:15], s58 offen lds
  s_waitcnt vmcnt(5)
  s_add_u32 m0, s64, 131072
  s_mov_b32 s58, 163840
  buffer_load_dwordx4 v26, s[12:15], s58 offen lds
  s_waitcnt vmcnt(5)
  s_add_u32 m0, s64, 135168
  s_mov_b32 s58, 163840
  buffer_load_dwordx4 v27, s[12:15], s58 offen lds
  s_waitcnt vmcnt(5)
  s_add_u32 m0, s64, 139264
  s_mov_b32 s58, 163840
  buffer_load_dwordx4 v28, s[12:15], s58 offen lds
  s_waitcnt vmcnt(5)
  v_mov_b32 v10, 21
  ds_write_b32 v11, v10
  s_waitcnt lgkmcnt(0)
  ds_read_b128 v[12:15], v8 offset:16
  s_waitcnt lgkmcnt(0)
  v_min3_u32 v12, v12, v13, v14
  v_min_u32 v12, v12, v15
  s_nop 0
  v_readfirstlane_b32 s56, v12
  s_nop 3
  s_cmp_ge_u32 s56, 16
  s_cbranch_scc1 L_100057
  s_waitcnt vmcnt(0)
  v_mov_b32 v10, 22
  ds_write_b32 v11, v10 offset:0
  s_waitcnt lgkmcnt(0)
  s_mov_b32 s57, 0
L_100058:
  ds_read_b128 v[12:15], v8 offset:16
  s_waitcnt lgkmcnt(0)
  v_min3_u32 v12, v12, v13, v14
  v_min_u32 v12, v12, v15
  s_nop 0
  v_readfirstlane_b32 s56, v12
  s_nop 3
  s_cmp_ge_u32 s56, 16
  s_cbranch_scc1 L_100059
  s_add_u32 s57, s57, 1
  s_sleep 1
  s_cmp_lt_u32 s57, 0x400000
  s_cbranch_scc1 L_100058
L_100059:
L_100057:
  s_add_u32 m0, s64, 61440
  s_mov_b32 s58, 327680
  buffer_load_dwordx4 v24, s[12:15], s58 offen lds
  s_waitcnt vmcnt(5)
  s_add_u32 m0, s64, 65536
  s_mov_b32 s58, 327680
  buffer_load_dwordx4 v25, s[12:15], s58 offen lds
  s_waitcnt vmcnt(5)
  s_add_u32 m0, s64, 69632
  s_mov_b32 s58, 327680
  buffer_load_dwordx4 v26, s[12:15], s58 offen lds
  s_waitcnt vmcnt(5)
  s_add_u32 m0, s64, 73728
  s_mov_b32 s58, 327680
  buffer_load_dwordx4 v27, s[12:15], s58 offen lds
  s_waitcnt vmcnt(5)
  s_add_u32 m0, s64, 77824
  s_mov_b32 s58, 327680
  buffer_load_dwordx4 v28, s[12:15], s58 offen lds
  s_waitcnt vmcnt(5)
  v_mov_b32 v10, 22
  ds_write_b32 v11, v10
  s_waitcnt lgkmcnt(0)
  ds_read_b128 v[12:15], v8 offset:16
  s_waitcnt lgkmcnt(0)
  v_min3_u32 v12, v12, v13, v14
  v_min_u32 v12, v12, v15
  s_nop 0
  v_readfirstlane_b32 s56, v12
  s_nop 3
  s_cmp_ge_u32 s56, 17
  s_cbranch_scc1 L_100060
  s_waitcnt vmcnt(0)
  v_mov_b32 v10, 23
  ds_write_b32 v11, v10 offset:0
  s_waitcnt lgkmcnt(0)
  s_mov_b32 s57, 0
L_100061:
  ds_read_b128 v[12:15], v8 offset:16
  s_waitcnt lgkmcnt(0)
  v_min3_u32 v12, v12, v13, v14
  v_min_u32 v12, v12, v15
  s_nop 0
  v_readfirstlane_b32 s56, v12
  s_nop 3
  s_cmp_ge_u32 s56, 17
  s_cbranch_scc1 L_100062
  s_add_u32 s57, s57, 1
  s_sleep 1
  s_cmp_lt_u32 s57, 0x400000
  s_cbranch_scc1 L_100061
L_100062:
L_100060:
  s_add_u32 m0, s64, 81920
  s_mov_b32 s58, 491520
  buffer_load_dwordx4 v24, s[12:15], s58 offen lds
  s_waitcnt vmcnt(5)
  s_add_u32 m0, s64, 86016
  s_mov_b32 s58, 491520
  buffer_load_dwordx4 v25, s[12:15], s58 offen lds
  s_waitcnt vmcnt(5)
  s_add_u32 m0, s64, 90112
  s_mov_b32 s58, 491520
  buffer_load_dwordx4 v26, s[12:15], s58 offen lds
  s_waitcnt vmcnt(5)
  s_add_u32 m0, s64, 94208
  s_mov_b32 s58, 491520
  buffer_load_dwordx4 v27, s[12:15], s58 offen lds
  s_waitcnt vmcnt(5)
  s_add_u32 m0, s64, 98304
  s_mov_b32 s58, 491520
  buffer_load_dwordx4 v28, s[12:15], s58 offen lds
  s_waitcnt vmcnt(5)
  v_mov_b32 v10, 23
  ds_write_b32 v11, v10
  s_waitcnt lgkmcnt(0)
  ds_read_b128 v[12:15], v8 offset:16
  s_waitcnt lgkmcnt(0)
  v_min3_u32 v12, v12, v13, v14
  v_min_u32 v12, v12, v15
  s_nop 0
  v_readfirstlane_b32 s56, v12
  s_nop 3
  s_cmp_ge_u32 s56, 18
  s_cbranch_scc1 L_100063
  s_waitcnt vmcnt(0)
  v_mov_b32 v10, 24
  ds_write_b32 v11, v10 offset:0
  s_waitcnt lgkmcnt(0)
  s_mov_b32 s57, 0
L_100064:
  ds_read_b128 v[12:15], v8 offset:16
  s_waitcnt lgkmcnt(0)
  v_min3_u32 v12, v12, v13, v14
  v_min_u32 v12, v12, v15
  s_nop 0
  v_readfirstlane_b32 s56, v12
  s_nop 3
  s_cmp_ge_u32 s56, 18
  s_cbranch_scc1 L_100065
  s_add_u32 s57, s57, 1
  s_sleep 1
  s_cmp_lt_u32 s57, 0x400000
  s_cbranch_scc1 L_100064
L_100065:
L_100063:
  s_add_u32 m0, s64, 102400
  s_mov_b32 s58, 655360
  buffer_load_dwordx4 v24, s[12:15], s58 offen lds
  s_waitcnt vmcnt(5)
  s_add_u32 m0, s64, 106496
  s_mov_b32 s58, 655360
  buffer_load_dwordx4 v25, s[12:15], s58 offen lds
  s_waitcnt vmcnt(5)
  s_add_u32 m0, s64, 110592
  s_mov_b32 s58, 655360
  buffer_load_dwordx4 v26, s[12:15], s58 offen lds
  s_waitcnt vmcnt(5)
  s_add_u32 m0, s64, 114688
  s_mov_b32 s58, 655360
  buffer_load_dwordx4 v27, s[12:15], s58 offen lds
  s_waitcnt vmcnt(5)
  s_add_u32 m0, s64, 118784
  s_mov_b32 s58, 655360
  buffer_load_dwordx4 v28, s[12:15], s58 offen lds
  s_waitcnt vmcnt(5)
  v_mov_b32 v10, 24
  ds_write_b32 v11, v10
  s_waitcnt vmcnt(0)
  v_mov_b32 v10, 25
  ds_write_b32 v11, v10
  s_waitcnt lgkmcnt(0)
  s_mov_b32 s57, 0
L_100066:
  ds_read_b128 v[12:15], v8 offset:0
  s_waitcnt lgkmcnt(0)
  v_min3_u32 v12, v12, v13, v14
  v_min_u32 v12, v12, v15
  s_nop 0
  v_readfirstlane_b32 s56, v12
  s_nop 3
  s_cmp_ge_u32 s56, 25
  s_cbranch_scc1 L_100067
  s_add_u32 s57, s57, 1
  s_cmp_lt_u32 s57, 0x400000
  s_cbranch_scc1 L_100066
L_100067:
  v_add_u32 v46, 20480, v44
  v_add_u32 v47, 20480, v45
  ds_read_b64_tr_b16 v[64:65], v46
  ds_read_b64_tr_b16 v[66:67], v47
  ds_read_b64_tr_b16 v[68:69], v46 offset:128
  ds_read_b64_tr_b16 v[70:71], v47 offset:128
  ds_read_b64_tr_b16 v[72:73], v46 offset:5120
  ds_read_b64_tr_b16 v[74:75], v47 offset:5120
  ds_read_b64_tr_b16 v[76:77], v46 offset:5248
  ds_read_b64_tr_b16 v[78:79], v47 offset:5248
  ds_read_b64_tr_b16 v[80:81], v46 offset:10240
  ds_read_b64_tr_b16 v[82:83], v47 offset:10240
  ds_read_b64_tr_b16 v[84:85], v46 offset:10368
  ds_read_b64_tr_b16 v[86:87], v47 offset:10368
  ds_read_b64_tr_b16 v[88:89], v46 offset:15360
  ds_read_b64_tr_b16 v[90:91], v47 offset:15360
  ds_read_b64_tr_b16 v[92:93], v46 offset:15488
  ds_read_b64_tr_b16 v[94:95], v47 offset:15488
  s_waitcnt lgkmcnt(15)
  v_dot2c_f32_bf16 v48, s61, v64
  s_waitcnt lgkmcnt(13)
  v_dot2c_f32_bf16 v49, s61, v68
  v_dot2c_f32_bf16 v48, s61, v65
  v_dot2c_f32_bf16 v49, s61, v69
  v_dot2c_f32_bf16 v48, s61, v66
  s_waitcnt lgkmcnt(12)
  v_dot2c_f32_bf16 v49, s61, v70
  v_dot2c_f32_bf16 v48, s61, v67
  v_dot2c_f32_bf16 v49, s61, v71
  s_waitcnt lgkmcnt(11)
  v_dot2c_f32_bf16 v48, s61, v72
  s_waitcnt lgkmcnt(9)
  v_dot2c_f32_bf16 v49, s61, v76
  v_dot2c_f32_bf16 v48, s61, v73
  v_dot2c_f32_bf16 v49, s61, v77
  v_dot2c_f32_bf16 v48, s61, v74
  s_waitcnt lgkmcnt(8)
  v_dot2c_f32_bf16 v49, s61, v78
  v_dot2c_f32_bf16 v48, s61, v75
  v_dot2c_f32_bf16 v49, s61, v79
  s_waitcnt lgkmcnt(7)
  v_dot2c_f32_bf16 v48, s61, v80
  s_waitcnt lgkmcnt(5)
  v_dot2c_f32_bf16 v49, s61, v84
  v_dot2c_f32_bf16 v48, s61, v81
  v_dot2c_f32_bf16 v49, s61, v85
  v_dot2c_f32_bf16 v48, s61, v82
  s_waitcnt lgkmcnt(4)
  v_dot2c_f32_bf16 v49, s61, v86
  v_dot2c_f32_bf16 v48, s61, v83
  v_dot2c_f32_bf16 v49, s61, v87
  s_waitcnt lgkmcnt(3)
  v_dot2c_f32_bf16 v48, s61, v88
  s_waitcnt lgkmcnt(1)
  v_dot2c_f32_bf16 v49, s61, v92
  v_dot2c_f32_bf16 v48, s61, v89
  v_dot2c_f32_bf16 v49, s61, v93
  v_dot2c_f32_bf16 v48, s61, v90
  s_waitcnt lgkmcnt(0)
  v_dot2c_f32_bf16 v49, s61, v94
  v_dot2c_f32_bf16 v48, s61, v91
  v_dot2c_f32_bf16 v49, s61, v95
  v_add_u32 v46, 122880, v44
  v_add_u32 v47, 122880, v45
  ds_read_b64_tr_b16 v[64:65], v46
  ds_read_b64_tr_b16 v[66:67], v47
  ds_read_b64_tr_b16 v[68:69], v46 offset:128
  ds_read_b64_tr_b16 v[70:71], v47 offset:128
  ds_read_b64_tr_b16 v[72:73], v46 offset:5120
  ds_read_b64_tr_b16 v[74:75], v47 offset:5120
  ds_read_b64_tr_b16 v[76:77], v46 offset:5248
  ds_read_b64_tr_b16 v[78:79], v47 offset:5248
  ds_read_b64_tr_b16 v[80:81], v46 offset:10240
  ds_read_b64_tr_b16 v[82:83], v47 offset:10240
  ds_read_b64_tr_b16 v[84:85], v46 offset:10368
  ds_read_b64_tr_b16 v[86:87], v47 offset:10368
  ds_read_b64_tr_b16 v[88:89], v46 offset:15360
  ds_read_b64_tr_b16 v[90:91], v47 offset:15360
  ds_read_b64_tr_b16 v[92:93], v46 offset:15488
  ds_read_b64_tr_b16 v[94:95], v47 offset:15488
  s_waitcnt lgkmcnt(15)
  v_dot2c_f32_bf16 v48, s61, v64
  s_waitcnt lgkmcnt(13)
  v_dot2c_f32_bf16 v49, s61, v68
  v_dot2c_f32_bf16 v48, s61, v65
  v_dot2c_f32_bf16 v49, s61, v69
  v_dot2c_f32_bf16 v48, s61, v66
  s_waitcnt lgkmcnt(12)
  v_dot2c_f32_bf16 v49, s61, v70
  v_dot2c_f32_bf16 v48, s61, v67
  v_dot2c_f32_bf16 v49, s61, v71
  s_waitcnt lgkmcnt(11)
  v_dot2c_f32_bf16 v48, s61, v72
  s_waitcnt lgkmcnt(9)
  v_dot2c_f32_bf16 v49, s61, v76
  v_dot2c_f32_bf16 v48, s61, v73
  v_dot2c_f32_bf16 v49, s61, v77
  v_dot2c_f32_bf16 v48, s61, v74
  s_waitcnt lgkmcnt(8)
  v_dot2c_f32_bf16 v49, s61, v78
  v_dot2c_f32_bf16 v48, s61, v75
  v_dot2c_f32_bf16 v49, s61, v79
  s_waitcnt lgkmcnt(7)
  v_dot2c_f32_bf16 v48, s61, v80
  s_waitcnt lgkmcnt(5)
  v_dot2c_f32_bf16 v49, s61, v84
  v_dot2c_f32_bf16 v48, s61, v81
  v_dot2c_f32_bf16 v49, s61, v85
  v_dot2c_f32_bf16 v48, s61, v82
  s_waitcnt lgkmcnt(4)
  v_dot2c_f32_bf16 v49, s61, v86
  v_dot2c_f32_bf16 v48, s61, v83
  v_dot2c_f32_bf16 v49, s61, v87
  s_waitcnt lgkmcnt(3)
  v_dot2c_f32_bf16 v48, s61, v88
  s_waitcnt lgkmcnt(1)
  v_dot2c_f32_bf16 v49, s61, v92
  v_dot2c_f32_bf16 v48, s61, v89
  v_dot2c_f32_bf16 v49, s61, v93
  v_dot2c_f32_bf16 v48, s61, v90
  s_waitcnt lgkmcnt(0)
  v_dot2c_f32_bf16 v49, s61, v94
  v_dot2c_f32_bf16 v48, s61, v91
  v_dot2c_f32_bf16 v49, s61, v95
  v_add_u32 v46, 61440, v44
  v_add_u32 v47, 61440, v45
  ds_read_b64_tr_b16 v[64:65], v46
  ds_read_b64_tr_b16 v[66:67], v47
  ds_read_b64_tr_b16 v[68:69], v46 offset:128
  ds_read_b64_tr_b16 v[70:71], v47 offset:128
  ds_read_b64_tr_b16 v[72:73], v46 offset:5120
  ds_read_b64_tr_b16 v[74:75], v47 offset:5120
  ds_read_b64_tr_b16 v[76:77], v46 offset:5248
  ds_read_b64_tr_b16 v[78:79], v47 offset:5248
  ds_read_b64_tr_b16 v[80:81], v46 offset:10240
  ds_read_b64_tr_b16 v[82:83], v47 offset:10240
  ds_read_b64_tr_b16 v[84:85], v46 offset:10368
  ds_read_b64_tr_b16 v[86:87], v47 offset:10368
  ds_read_b64_tr_b16 v[88:89], v46 offset:15360
  ds_read_b64_tr_b16 v[90:91], v47 offset:15360
  ds_read_b64_tr_b16 v[92:93], v46 offset:15488
  ds_read_b64_tr_b16 v[94:95], v47 offset:15488
  s_waitcnt lgkmcnt(15)
  v_dot2c_f32_bf16 v48, s61, v64
  s_waitcnt lgkmcnt(13)
  v_dot2c_f32_bf16 v49, s61, v68
  v_dot2c_f32_bf16 v48, s61, v65
  v_dot2c_f32_bf16 v49, s61, v69
  v_dot2c_f32_bf16 v48, s61, v66
  s_waitcnt lgkmcnt(12)
  v_dot2c_f32_bf16 v49, s61, v70
  v_dot2c_f32_bf16 v48, s61, v67
  v_dot2c_f32_bf16 v49, s61, v71
  s_waitcnt lgkmcnt(11)
  v_dot2c_f32_bf16 v48, s61, v72
  s_waitcnt lgkmcnt(9)
  v_dot2c_f32_bf16 v49, s61, v76
  v_dot2c_f32_bf16 v48, s61, v73
  v_dot2c_f32_bf16 v49, s61, v77
  v_dot2c_f32_bf16 v48, s61, v74
  s_waitcnt lgkmcnt(8)
  v_dot2c_f32_bf16 v49, s61, v78
  v_dot2c_f32_bf16 v48, s61, v75
  v_dot2c_f32_bf16 v49, s61, v79
  s_waitcnt lgkmcnt(7)
  v_dot2c_f32_bf16 v48, s61, v80
  s_waitcnt lgkmcnt(5)
  v_dot2c_f32_bf16 v49, s61, v84
  v_dot2c_f32_bf16 v48, s61, v81
  v_dot2c_f32_bf16 v49, s61, v85
  v_dot2c_f32_bf16 v48, s61, v82
  s_waitcnt lgkmcnt(4)
  v_dot2c_f32_bf16 v49, s61, v86
  v_dot2c_f32_bf16 v48, s61, v83
  v_dot2c_f32_bf16 v49, s61, v87
  s_waitcnt lgkmcnt(3)
  v_dot2c_f32_bf16 v48, s61, v88
  s_waitcnt lgkmcnt(1)
  v_dot2c_f32_bf16 v49, s61, v92
  v_dot2c_f32_bf16 v48, s61, v89
  v_dot2c_f32_bf16 v49, s61, v93
  v_dot2c_f32_bf16 v48, s61, v90
  s_waitcnt lgkmcnt(0)
  v_dot2c_f32_bf16 v49, s61, v94
  v_dot2c_f32_bf16 v48, s61, v91
  v_dot2c_f32_bf16 v49, s61, v95
  v_add_u32 v46, 81920, v44
  v_add_u32 v47, 81920, v45
  ds_read_b64_tr_b16 v[64:65], v46
  ds_read_b64_tr_b16 v[66:67], v47
  ds_read_b64_tr_b16 v[68:69], v46 offset:128
  ds_read_b64_tr_b16 v[70:71], v47 offset:128
  ds_read_b64_tr_b16 v[72:73], v46 offset:5120
  ds_read_b64_tr_b16 v[74:75], v47 offset:5120
  ds_read_b64_tr_b16 v[76:77], v46 offset:5248
  ds_read_b64_tr_b16 v[78:79], v47 offset:5248
  ds_read_b64_tr_b16 v[80:81], v46 offset:10240
  ds_read_b64_tr_b16 v[82:83], v47 offset:10240
  ds_read_b64_tr_b16 v[84:85], v46 offset:10368
  ds_read_b64_tr_b16 v[86:87], v47 offset:10368
  ds_read_b64_tr_b16 v[88:89], v46 offset:15360
  ds_read_b64_tr_b16 v[90:91], v47 offset:15360
  ds_read_b64_tr_b16 v[92:93], v46 offset:15488
  ds_read_b64_tr_b16 v[94:95], v47 offset:15488
  s_waitcnt lgkmcnt(15)
  v_dot2c_f32_bf16 v48, s61, v64
  s_waitcnt lgkmcnt(13)
  v_dot2c_f32_bf16 v49, s61, v68
  v_dot2c_f32_bf16 v48, s61, v65
  v_dot2c_f32_bf16 v49, s61, v69
  v_dot2c_f32_bf16 v48, s61, v66
  s_waitcnt lgkmcnt(12)
  v_dot2c_f32_bf16 v49, s61, v70
  v_dot2c_f32_bf16 v48, s61, v67
  v_dot2c_f32_bf16 v49, s61, v71
  s_waitcnt lgkmcnt(11)
  v_dot2c_f32_bf16 v48, s61, v72
  s_waitcnt lgkmcnt(9)
  v_dot2c_f32_bf16 v49, s61, v76
  v_dot2c_f32_bf16 v48, s61, v73
  v_dot2c_f32_bf16 v49, s61, v77
  v_dot2c_f32_bf16 v48, s61, v74
  s_waitcnt lgkmcnt(8)
  v_dot2c_f32_bf16 v49, s61, v78
  v_dot2c_f32_bf16 v48, s61, v75
  v_dot2c_f32_bf16 v49, s61, v79
  s_waitcnt lgkmcnt(7)
  v_dot2c_f32_bf16 v48, s61, v80
  s_waitcnt lgkmcnt(5)
  v_dot2c_f32_bf16 v49, s61, v84
  v_dot2c_f32_bf16 v48, s61, v81
  v_dot2c_f32_bf16 v49, s61, v85
  v_dot2c_f32_bf16 v48, s61, v82
  s_waitcnt lgkmcnt(4)
  v_dot2c_f32_bf16 v49, s61, v86
  v_dot2c_f32_bf16 v48, s61, v83
  v_dot2c_f32_bf16 v49, s61, v87
  s_waitcnt lgkmcnt(3)
  v_dot2c_f32_bf16 v48, s61, v88
  s_waitcnt lgkmcnt(1)
  v_dot2c_f32_bf16 v49, s61, v92
  v_dot2c_f32_bf16 v48, s61, v89
  v_dot2c_f32_bf16 v49, s61, v93
  v_dot2c_f32_bf16 v48, s61, v90
  s_waitcnt lgkmcnt(0)
  v_dot2c_f32_bf16 v49, s61, v94
  v_dot2c_f32_bf16 v48, s61, v91
  v_dot2c_f32_bf16 v49, s61, v95
  v_add_u32 v46, 102400, v44
  v_add_u32 v47, 102400, v45
  ds_read_b64_tr_b16 v[64:65], v46
  ds_read_b64_tr_b16 v[66:67], v47
  ds_read_b64_tr_b16 v[68:69], v46 offset:128
  ds_read_b64_tr_b16 v[70:71], v47 offset:128
  ds_read_b64_tr_b16 v[72:73], v46 offset:5120
  ds_read_b64_tr_b16 v[74:75], v47 offset:5120
  ds_read_b64_tr_b16 v[76:77], v46 offset:5248
  ds_read_b64_tr_b16 v[78:79], v47 offset:5248
  ds_read_b64_tr_b16 v[80:81], v46 offset:10240
  ds_read_b64_tr_b16 v[82:83], v47 offset:10240
  ds_read_b64_tr_b16 v[84:85], v46 offset:10368
  ds_read_b64_tr_b16 v[86:87], v47 offset:10368
  ds_read_b64_tr_b16 v[88:89], v46 offset:15360
  ds_read_b64_tr_b16 v[90:91], v47 offset:15360
  ds_read_b64_tr_b16 v[92:93], v46 offset:15488
  ds_read_b64_tr_b16 v[94:95], v47 offset:15488
  s_waitcnt lgkmcnt(15)
  v_dot2c_f32_bf16 v48, s61, v64
  s_waitcnt lgkmcnt(13)
  v_dot2c_f32_bf16 v49, s61, v68
  v_dot2c_f32_bf16 v48, s61, v65
  v_dot2c_f32_bf16 v49, s61, v69
  v_dot2c_f32_bf16 v48, s61, v66
  s_waitcnt lgkmcnt(12)
  v_dot2c_f32_bf16 v49, s61, v70
  v_dot2c_f32_bf16 v48, s61, v67
  v_dot2c_f32_bf16 v49, s61, v71
  s_waitcnt lgkmcnt(11)
  v_dot2c_f32_bf16 v48, s61, v72
  s_waitcnt lgkmcnt(9)
  v_dot2c_f32_bf16 v49, s61, v76
  v_dot2c_f32_bf16 v48, s61, v73
  v_dot2c_f32_bf16 v49, s61, v77
  v_dot2c_f32_bf16 v48, s61, v74
  s_waitcnt lgkmcnt(8)
  v_dot2c_f32_bf16 v49, s61, v78
  v_dot2c_f32_bf16 v48, s61, v75
  v_dot2c_f32_bf16 v49, s61, v79
  s_waitcnt lgkmcnt(7)
  v_dot2c_f32_bf16 v48, s61, v80
  s_waitcnt lgkmcnt(5)
  v_dot2c_f32_bf16 v49, s61, v84
  v_dot2c_f32_bf16 v48, s61, v81
  v_dot2c_f32_bf16 v49, s61, v85
  v_dot2c_f32_bf16 v48, s61, v82
  s_waitcnt lgkmcnt(4)
  v_dot2c_f32_bf16 v49, s61, v86
  v_dot2c_f32_bf16 v48, s61, v83
  v_dot2c_f32_bf16 v49, s61, v87
  s_waitcnt lgkmcnt(3)
  v_dot2c_f32_bf16 v48, s61, v88
  s_waitcnt lgkmcnt(1)
  v_dot2c_f32_bf16 v49, s61, v92
  v_dot2c_f32_bf16 v48, s61, v89
  v_dot2c_f32_bf16 v49, s61, v93
  v_dot2c_f32_bf16 v48, s61, v90
  s_waitcnt lgkmcnt(0)
  v_dot2c_f32_bf16 v49, s61, v94
  v_dot2c_f32_bf16 v48, s61, v91
  v_dot2c_f32_bf16 v49, s61, v95
  s_nop 1
  v_mov_b32 v46, v48
  s_nop 1
  v_permlane32_swap_b32 v46, v48
  v_add_f32 v48, v48, v46
  v_mov_b32 v46, v48
  s_nop 1
  v_permlane16_swap_b32 v46, v48
  v_add_f32 v48, v48, v46
  v_mov_b32 v46, v49
  s_nop 1
  v_permlane32_swap_b32 v46, v49
  v_add_f32 v49, v49, v46
  v_mov_b32 v46, v49
  s_nop 1
  v_permlane16_swap_b32 v46, v49
  v_add_f32 v49, v49, v46
  s_lshl_b32 s56, s7, 6
  s_add_u32 s56, s56, 162560
  v_lshl_add_u32 v46, v2, 2, s56
  ds_write_b32 v46, v48
  ds_write_b32 v46, v49 offset:256
  s_waitcnt lgkmcnt(0)
  v_mov_b32 v10, 2
  ds_write_b32 v11, v10 offset:64
  s_cmp_lg_u32 s7, 0
  s_cbranch_scc1 L_100068
  s_add_u32 s56, s54, 12
  v_lshlrev_b32 v10, 9, v1
  v_add_u32 v10, 786432, v10
  s_mov_b32 s57, 0
L_100069:
  buffer_load_dwordx2 v[96:97], v10, s[24:27], 0 offen offset:0 sc1
  buffer_load_dwordx2 v[98:99], v10, s[24:27], 0 offen offset:128 sc1
  buffer_load_dwordx2 v[100:101], v10, s[24:27], 0 offen offset:256 sc1
  buffer_load_dwordx2 v[102:103], v10, s[24:27], 0 offen offset:384 sc1
  s_waitcnt vmcnt(0)
  v_xor_b32 v96, s56, v96
  v_xor_b32 v97, s55, v97
  v_xor_b32 v98, s56, v98
  v_xor_b32 v99, s55, v99
  v_xor_b32 v100, s56, v100
  v_xor_b32 v101, s55, v101
  v_xor_b32 v102, s56, v102
  v_xor_b32 v103, s55, v103
  v_or3_b32 v96, v96, v97, v98
  v_or3_b32 v99, v99, v100, v101
  v_or3_b32 v96, v96, v102, v103
  v_or_b32 v96, v96, v99
  v_cmp_ne_u32 vcc, 0, v96
  s_add_u32 s57, s57, 1
  s_nop 4
  s_cbranch_vccz L_100070
  s_sleep 1
  s_cmp_lt_u32 s57, 0x80000
  s_cbranch_scc1 L_100069
L_100070:
  v_mov_b32 v10, 1
  ds_write_b32 v8, v10 offset:112
L_100068:
  s_waitcnt lgkmcnt(0)
  s_mov_b32 s57, 0
L_100071:
  ds_read_b32 v12, v8 offset:112
  s_waitcnt lgkmcnt(0)
  s_nop 0
  v_readfirstlane_b32 s56, v12
  s_nop 3
  s_cmp_ge_u32 s56, 1
  s_cbranch_scc1 L_100072
  s_add_u32 s57, s57, 1
  s_sleep 1
  s_cmp_lt_u32 s57, 0x400000
  s_cbranch_scc1 L_100071
L_100072:
  s_add_u32 s20, s52, 20971520
  s_addc_u32 s21, s53, 0
  s_mov_b32 s22, 6333440
  s_mov_b32 s23, 0x00020000
  s_mul_i32 s66, s89, 102400
  s_add_u32 s66, s66, 819200
  s_mul_i32 s67, s92, 143360
  s_add_u32 s67, s67, 3850240
  s_mul_i32 s68, s89, 276480
  s_add_u32 s68, s68, 1638400
  s_waitcnt lgkmcnt(0)
  ds_read_b128 v[12:15], v8 offset:16
  s_waitcnt lgkmcnt(0)
  v_min3_u32 v12, v12, v13, v14
  v_min_u32 v12, v12, v15
  s_nop 0
  v_readfirstlane_b32 s56, v12
  s_nop 3
  s_cmp_ge_u32 s56, 19
  s_cbranch_scc1 L_100073
  s_waitcnt vmcnt(0)
  v_mov_b32 v10, 25
  ds_write_b32 v11, v10 offset:0
  s_waitcnt lgkmcnt(0)
  s_mov_b32 s57, 0
L_100074:
  ds_read_b128 v[12:15], v8 offset:16
  s_waitcnt lgkmcnt(0)
  v_min3_u32 v12, v12, v13, v14
  v_min_u32 v12, v12, v15
  s_nop 0
  v_readfirstlane_b32 s56, v12
  s_nop 3
  s_cmp_ge_u32 s56, 19
  s_cbranch_scc1 L_100075
  s_add_u32 s57, s57, 1
  s_sleep 1
  s_cmp_lt_u32 s57, 0x400000
  s_cbranch_scc1 L_100074
L_100075:
L_100073:
  s_add_u32 m0, s64, 0
  s_add_u32 s58, s66, 0
  buffer_load_dwordx4 v29, s[20:23], s58 offen sc1 lds
  s_add_u32 m0, s64, 4096
  s_add_u32 s58, s66, 4096
  buffer_load_dwordx4 v29, s[20:23], s58 offen sc1 lds
  s_add_u32 m0, s64, 8192
  s_add_u32 s58, s66, 8192
  buffer_load_dwordx4 v29, s[20:23], s58 offen sc1 lds
  s_add_u32 m0, s64, 12288
  s_add_u32 s58, s66, 12288
  buffer_load_dwordx4 v29, s[20:23], s58 offen sc1 lds
  s_add_u32 m0, s64, 16384
  s_add_u32 s58, s66, 16384
  buffer_load_dwordx4 v29, s[20:23], s58 offen sc1 lds
  s_waitcnt lgkmcnt(0)
  ds_read_b128 v[12:15], v8 offset:16
  s_waitcnt lgkmcnt(0)
  v_min3_u32 v12, v12, v13, v14
  v_min_u32 v12, v12, v15
  s_nop 0
  v_readfirstlane_b32 s56, v12
  s_nop 3
  s_cmp_ge_u32 s56, 20
  s_cbranch_scc1 L_100076
  s_waitcnt vmcnt(0)
  v_mov_b32 v10, 26
  ds_write_b32 v11, v10 offset:0
  s_waitcnt lgkmcnt(0)
  s_mov_b32 s57, 0
L_100077:
  ds_read_b128 v[12:15], v8 offset:16
  s_waitcnt lgkmcnt(0)
  v_min3_u32 v12, v12, v13, v14
  v_min_u32 v12, v12, v15
  s_nop 0
  v_readfirstlane_b32 s56, v12
  s_nop 3
  s_cmp_ge_u32 s56, 20
  s_cbranch_scc1 L_100078
  s_add_u32 s57, s57, 1
  s_sleep 1
  s_cmp_lt_u32 s57, 0x400000
  s_cbranch_scc1 L_100077
L_100078:
L_100076:
  s_add_u32 m0, s64, 40960
  s_add_u32 s58, s66, 20480
  buffer_load_dwordx4 v29, s[20:23], s58 offen sc1 lds
  s_waitcnt vmcnt(5)
  s_add_u32 m0, s64, 45056
  s_add_u32 s58, s66, 24576
  buffer_load_dwordx4 v29, s[20:23], s58 offen sc1 lds
  s_waitcnt vmcnt(5)
  s_add_u32 m0, s64, 49152
  s_add_u32 s58, s66, 28672
  buffer_load_dwordx4 v29, s[20:23], s58 offen sc1 lds
  s_waitcnt vmcnt(5)
  s_add_u32 m0, s64, 53248
  s_add_u32 s58, s66, 32768
  buffer_load_dwordx4 v29, s[20:23], s58 offen sc1 lds
  s_waitcnt vmcnt(5)
  s_add_u32 m0, s64, 57344
  s_add_u32 s58, s66, 36864
  buffer_load_dwordx4 v29, s[20:23], s58 offen sc1 lds
  s_waitcnt vmcnt(5)
  v_mov_b32 v10, 26
  ds_write_b32 v11, v10
  s_mul_i32 s62, s92, 27
  s_lshr_b32 s62, s62, 2
  s_lshl_b32 s62, s62, 6
  s_add_u32 s62, s62, 6195200
  s_and_b32 s56, s7, 1
  s_lshl_b32 s56, s56, 8
  v_lshl_add_u32 v42, v1, 2, s56
  buffer_load_dword v96, v42, s[20:23], s62 offen sc1
  s_add_u32 s62, s62, 6912
  buffer_load_dword v97, v42, s[20:23], s62 offen sc1
  s_add_u32 s62, s62, 6912
  buffer_load_dword v98, v42, s[20:23], s62 offen sc1
  s_add_u32 s62, s62, 6912
  buffer_load_dword v99, v42, s[20:23], s62 offen sc1
  s_add_u32 s62, s62, 6912
  buffer_load_dword v100, v42, s[20:23], s62 offen sc1
  s_add_u32 s62, s62, 6912
  buffer_load_dword v101, v42, s[20:23], s62 offen sc1
  s_add_u32 s62, s62, 6912
  buffer_load_dword v102, v42, s[20:23], s62 offen sc1
  s_add_u32 s62, s62, 6912
  buffer_load_dword v103, v42, s[20:23], s62 offen sc1
  s_add_u32 s62, s62, 6912
  buffer_load_dword v104, v42, s[20:23], s62 offen sc1
  s_add_u32 s62, s62, 6912
  buffer_load_dword v105, v42, s[20:23], s62 offen sc1
  s_add_u32 s62, s62, 6912
  buffer_load_dword v106, v42, s[20:23], s62 offen sc1
  s_add_u32 s62, s62, 6912
  buffer_load_dword v107, v42, s[20:23], s62 offen sc1
  s_add_u32 s62, s62, 6912
  buffer_load_dword v108, v42, s[20:23], s62 offen sc1
  s_add_u32 s62, s62, 6912
  buffer_load_dword v109, v42, s[20:23], s62 offen sc1
  s_add_u32 s62, s62, 6912
  buffer_load_dword v110, v42, s[20:23], s62 offen sc1
  s_add_u32 s62, s62, 6912
  buffer_load_dword v111, v42, s[20:23], s62 offen sc1
  s_add_u32 s62, s62, 6912
  buffer_load_dword v112, v42, s[20:23], s62 offen sc1
  s_add_u32 s62, s62, 6912
  buffer_load_dword v113, v42, s[20:23], s62 offen sc1
  s_add_u32 s62, s62, 6912
  buffer_load_dword v114, v42, s[20:23], s62 offen sc1
  s_add_u32 s62, s62, 6912
  buffer_load_dword v115, v42, s[20:23], s62 offen sc1
  s_waitcnt vmcnt(18)
  v_add_f32 v96, v96, v97
  s_waitcnt vmcnt(17)
  v_add_f32 v96, v96, v98
  s_waitcnt vmcnt(16)
  v_add_f32 v96, v96, v99
  s_waitcnt vmcnt(15)
  v_add_f32 v96, v96, v100
  s_waitcnt vmcnt(14)
  v_add_f32 v96, v96, v101
  s_waitcnt vmcnt(13)
  v_add_f32 v96, v96, v102
  s_waitcnt vmcnt(12)
  v_add_f32 v96, v96, v103
  s_waitcnt vmcnt(11)
  v_add_f32 v96, v96, v104
  s_waitcnt vmcnt(10)
  v_add_f32 v96, v96, v105
  s_waitcnt vmcnt(9)
  v_add_f32 v96, v96, v106
  s_waitcnt vmcnt(8)
  v_add_f32 v96, v96, v107
  s_waitcnt vmcnt(7)
  v_add_f32 v96, v96, v108
  s_waitcnt vmcnt(6)
  v_add_f32 v96, v96, v109
  s_waitcnt vmcnt(5)
  v_add_f32 v96, v96, v110
  s_waitcnt vmcnt(4)
  v_add_f32 v96, v96, v111
  s_waitcnt vmcnt(3)
  v_add_f32 v96, v96, v112
  s_waitcnt vmcnt(2)
  v_add_f32 v96, v96, v113
  s_waitcnt vmcnt(1)
  v_add_f32 v96, v96, v114
  s_waitcnt vmcnt(0)
  v_add_f32 v96, v96, v115
  v_add_u32 v42, 163072, v42
  ds_write_b32 v42, v96
  s_waitcnt lgkmcnt(0)
  v_mov_b32 v10, 2
  ds_write_b32 v11, v10 offset:80
  s_waitcnt vmcnt(0)
  v_mov_b32 v10, 27
  ds_write_b32 v11, v10
  s_waitcnt lgkmcnt(0)
  ds_read_b128 v[12:15], v8 offset:16
  s_waitcnt lgkmcnt(0)
  v_min3_u32 v12, v12, v13, v14
  v_min_u32 v12, v12, v15
  s_nop 0
  v_readfirstlane_b32 s56, v12
  s_nop 3
  s_cmp_ge_u32 s56, 21
  s_cbranch_scc1 L_100079
  s_waitcnt vmcnt(0)
  v_mov_b32 v10, 27
  ds_write_b32 v11, v10 offset:0
  s_waitcnt lgkmcnt(0)
  s_mov_b32 s57, 0
L_100080:
  ds_read_b128 v[12:15], v8 offset:16
  s_waitcnt lgkmcnt(0)
  v_min3_u32 v12, v12, v13, v14
  v_min_u32 v12, v12, v15
  s_nop 0
  v_readfirstlane_b32 s56, v12
  s_nop 3
  s_cmp_ge_u32 s56, 21
  s_cbranch_scc1 L_100081
  s_add_u32 s57, s57, 1
  s_sleep 1
  s_cmp_lt_u32 s57, 0x400000
  s_cbranch_scc1 L_100080
L_100081:
L_100079:
  s_add_u32 m0, s64, 20480
  s_add_u32 s58, s66, 40960
  buffer_load_dwordx4 v29, s[20:23], s58 offen sc1 lds
  s_add_u32 m0, s64, 24576
  s_add_u32 s58, s66, 45056
  buffer_load_dwordx4 v29, s[20:23], s58 offen sc1 lds
  s_add_u32 m0, s64, 28672
  s_add_u32 s58, s66, 49152
  buffer_load_dwordx4 v29, s[20:23], s58 offen sc1 lds
  s_add_u32 m0, s64, 32768
  s_add_u32 s58, s66, 53248
  buffer_load_dwordx4 v29, s[20:23], s58 offen sc1 lds
  s_add_u32 m0, s64, 36864
  s_add_u32 s58, s66, 57344
  buffer_load_dwordx4 v29, s[20:23], s58 offen sc1 lds
  s_waitcnt lgkmcnt(0)
  ds_read_b128 v[12:15], v8 offset:16
  s_waitcnt lgkmcnt(0)
  v_min3_u32 v12, v12, v13, v14
  v_min_u32 v12, v12, v15
  s_nop 0
  v_readfirstlane_b32 s56, v12
  s_nop 3
  s_cmp_ge_u32 s56, 23
  s_cbranch_scc1 L_100082
  s_waitcnt vmcnt(0)
  v_mov_b32 v10, 28
  ds_write_b32 v11, v10 offset:0
  s_waitcnt lgkmcnt(0)
  s_mov_b32 s57, 0
L_100083:
  ds_read_b128 v[12:15], v8 offset:16
  s_waitcnt lgkmcnt(0)
  v_min3_u32 v12, v12, v13, v14
  v_min_u32 v12, v12, v15
  s_nop 0
  v_readfirstlane_b32 s56, v12
  s_nop 3
  s_cmp_ge_u32 s56, 23
  s_cbranch_scc1 L_100084
  s_add_u32 s57, s57, 1
  s_sleep 1
  s_cmp_lt_u32 s57, 0x400000
  s_cbranch_scc1 L_100083
L_100084:
L_100082:
  s_add_u32 m0, s64, 61440
  s_add_u32 s58, s66, 61440
  buffer_load_dwordx4 v29, s[20:23], s58 offen sc1 lds
  s_waitcnt vmcnt(5)
  s_add_u32 m0, s64, 65536
  s_add_u32 s58, s66, 65536
  buffer_load_dwordx4 v29, s[20:23], s58 offen sc1 lds
  s_waitcnt vmcnt(5)
  s_add_u32 m0, s64, 69632
  s_add_u32 s58, s66, 69632
  buffer_load_dwordx4 v29, s[20:23], s58 offen sc1 lds
  s_waitcnt vmcnt(5)
  s_add_u32 m0, s64, 73728
  s_add_u32 s58, s66, 73728
  buffer_load_dwordx4 v29, s[20:23], s58 offen sc1 lds
  s_waitcnt vmcnt(5)
  s_add_u32 m0, s64, 77824
  s_add_u32 s58, s66, 77824
  buffer_load_dwordx4 v29, s[20:23], s58 offen sc1 lds
  s_waitcnt vmcnt(5)
  v_mov_b32 v10, 28
  ds_write_b32 v11, v10
  s_waitcnt lgkmcnt(0)
  ds_read_b128 v[12:15], v8 offset:16
  s_waitcnt lgkmcnt(0)
  v_min3_u32 v12, v12, v13, v14
  v_min_u32 v12, v12, v15
  s_nop 0
  v_readfirstlane_b32 s56, v12
  s_nop 3
  s_cmp_ge_u32 s56, 24
  s_cbranch_scc1 L_100085
  s_waitcnt vmcnt(0)
  v_mov_b32 v10, 29
  ds_write_b32 v11, v10 offset:0
  s_waitcnt lgkmcnt(0)
  s_mov_b32 s57, 0
L_100086:
  ds_read_b128 v[12:15], v8 offset:16
  s_waitcnt lgkmcnt(0)
  v_min3_u32 v12, v12, v13, v14
  v_min_u32 v12, v12, v15
  s_nop 0
  v_readfirstlane_b32 s56, v12
  s_nop 3
  s_cmp_ge_u32 s56, 24
  s_cbranch_scc1 L_100087
  s_add_u32 s57, s57, 1
  s_sleep 1
  s_cmp_lt_u32 s57, 0x400000
  s_cbranch_scc1 L_100086
L_100087:
L_100085:
  s_add_u32 m0, s64, 81920
  s_add_u32 s58, s66, 81920
  buffer_load_dwordx4 v29, s[20:23], s58 offen sc1 lds
  s_waitcnt vmcnt(5)
  s_add_u32 m0, s64, 86016
  s_add_u32 s58, s66, 86016
  buffer_load_dwordx4 v29, s[20:23], s58 offen sc1 lds
  s_waitcnt vmcnt(5)
  s_add_u32 m0, s64, 90112
  s_add_u32 s58, s66, 90112
  buffer_load_dwordx4 v29, s[20:23], s58 offen sc1 lds
  s_waitcnt vmcnt(5)
  s_add_u32 m0, s64, 94208
  s_add_u32 s58, s66, 94208
  buffer_load_dwordx4 v29, s[20:23], s58 offen sc1 lds
  s_waitcnt vmcnt(5)
  s_add_u32 m0, s64, 98304
  s_add_u32 s58, s66, 98304
  buffer_load_dwordx4 v29, s[20:23], s58 offen sc1 lds
  s_waitcnt vmcnt(5)
  v_mov_b32 v10, 29
  ds_write_b32 v11, v10
  s_waitcnt lgkmcnt(0)
  ds_read_b128 v[12:15], v8 offset:16
  s_waitcnt lgkmcnt(0)
  v_min3_u32 v12, v12, v13, v14
  v_min_u32 v12, v12, v15
  s_nop 0
  v_readfirstlane_b32 s56, v12
  s_nop 3
  s_cmp_ge_u32 s56, 25
  s_cbranch_scc1 L_100088
  s_waitcnt vmcnt(0)
  v_mov_b32 v10, 30
  ds_write_b32 v11, v10 offset:0
  s_waitcnt lgkmcnt(0)
  s_mov_b32 s57, 0
L_100089:
  ds_read_b128 v[12:15], v8 offset:16
  s_waitcnt lgkmcnt(0)
  v_min3_u32 v12, v12, v13, v14
  v_min_u32 v12, v12, v15
  s_nop 0
  v_readfirstlane_b32 s56, v12
  s_nop 3
  s_cmp_ge_u32 s56, 25
  s_cbranch_scc1 L_100090
  s_add_u32 s57, s57, 1
  s_sleep 1
  s_cmp_lt_u32 s57, 0x400000
  s_cbranch_scc1 L_100089
L_100090:
L_100088:
  s_add_u32 m0, s64, 102400
  s_add_u32 s58, s67, 0
  buffer_load_dwordx4 v29, s[20:23], s58 offen sc1 lds
  s_waitcnt vmcnt(5)
  s_add_u32 m0, s64, 106496
  s_add_u32 s58, s67, 4096
  buffer_load_dwordx4 v29, s[20:23], s58 offen sc1 lds
  s_waitcnt vmcnt(5)
  s_add_u32 m0, s64, 110592
  s_add_u32 s58, s67, 8192
  buffer_load_dwordx4 v29, s[20:23], s58 offen sc1 lds
  s_waitcnt vmcnt(5)
  s_add_u32 m0, s64, 114688
  s_add_u32 s58, s67, 12288
  buffer_load_dwordx4 v29, s[20:23], s58 offen sc1 lds
  s_waitcnt vmcnt(5)
  s_add_u32 m0, s64, 118784
  s_add_u32 s58, s67, 16384
  buffer_load_dwordx4 v29, s[20:23], s58 offen sc1 lds
  s_waitcnt vmcnt(5)
  s_add_u32 m0, s64, 122880
  s_add_u32 s58, s67, 20480
  buffer_load_dwordx4 v29, s[20:23], s58 offen sc1 lds
  s_waitcnt vmcnt(5)
  s_add_u32 m0, s64, 126976
  s_add_u32 s58, s67, 24576
  buffer_load_dwordx4 v29, s[20:23], s58 offen sc1 lds
  v_mov_b32 v10, 30
  ds_write_b32 v11, v10
  s_waitcnt lgkmcnt(0)
  ds_read_b128 v[12:15], v8 offset:16
  s_waitcnt lgkmcnt(0)
  v_min3_u32 v12, v12, v13, v14
  v_min_u32 v12, v12, v15
  s_nop 0
  v_readfirstlane_b32 s56, v12
  s_nop 3
  s_cmp_ge_u32 s56, 22
  s_cbranch_scc1 L_100091
  s_waitcnt vmcnt(0)
  v_mov_b32 v10, 31
  ds_write_b32 v11, v10 offset:0
  s_waitcnt lgkmcnt(0)
  s_mov_b32 s57, 0
L_100092:
  ds_read_b128 v[12:15], v8 offset:16
  s_waitcnt lgkmcnt(0)
  v_min3_u32 v12, v12, v13, v14
  v_min_u32 v12, v12, v15
  s_nop 0
  v_readfirstlane_b32 s56, v12
  s_nop 3
  s_cmp_ge_u32 s56, 22
  s_cbranch_scc1 L_100093
  s_add_u32 s57, s57, 1
  s_sleep 1
  s_cmp_lt_u32 s57, 0x400000
  s_cbranch_scc1 L_100092
L_100093:
L_100091:
  s_waitcnt vmcnt(5)
  s_add_u32 m0, s64, 131072
  s_add_u32 s58, s67, 28672
  buffer_load_dwordx4 v29, s[20:23], s58 offen sc1 lds
  s_waitcnt vmcnt(5)
  s_add_u32 m0, s64, 135168
  s_add_u32 s58, s67, 32768
  buffer_load_dwordx4 v29, s[20:23], s58 offen sc1 lds
  s_waitcnt vmcnt(5)
  s_add_u32 m0, s64, 139264
  s_add_u32 s58, s67, 36864
  buffer_load_dwordx4 v29, s[20:23], s58 offen sc1 lds
  s_waitcnt vmcnt(5)
  s_add_u32 m0, s64, 143360
  s_add_u32 s58, s67, 40960
  buffer_load_dwordx4 v29, s[20:23], s58 offen sc1 lds
  s_waitcnt vmcnt(5)
  s_add_u32 m0, s64, 147456
  s_add_u32 s58, s67, 45056
  buffer_load_dwordx4 v29, s[20:23], s58 offen sc1 lds
  s_waitcnt vmcnt(5)
  s_add_u32 m0, s64, 151552
  s_add_u32 s58, s67, 49152
  buffer_load_dwordx4 v29, s[20:23], s58 offen sc1 lds
  s_waitcnt vmcnt(5)
  s_add_u32 m0, s64, 155648
  s_add_u32 s58, s67, 53248
  buffer_load_dwordx4 v29, s[20:23], s58 offen sc1 lds
  v_mov_b32 v10, 31
  ds_write_b32 v11, v10
  s_waitcnt lgkmcnt(0)
  ds_read_b128 v[12:15], v8 offset:16
  s_waitcnt lgkmcnt(0)
  v_min3_u32 v12, v12, v13, v14
  v_min_u32 v12, v12, v15
  s_nop 0
  v_readfirstlane_b32 s56, v12
  s_nop 3
  s_cmp_ge_u32 s56, 28
  s_cbranch_scc1 L_100094
  s_waitcnt vmcnt(0)
  v_mov_b32 v10, 32
  ds_write_b32 v11, v10 offset:0
  s_waitcnt lgkmcnt(0)
  s_mov_b32 s57, 0
L_100095:
  ds_read_b128 v[12:15], v8 offset:16
  s_waitcnt lgkmcnt(0)
  v_min3_u32 v12, v12, v13, v14
  v_min_u32 v12, v12, v15
  s_nop 0
  v_readfirstlane_b32 s56, v12
  s_nop 3
  s_cmp_ge_u32 s56, 28
  s_cbranch_scc1 L_100096
  s_add_u32 s57, s57, 1
  s_sleep 1
  s_cmp_lt_u32 s57, 0x400000
  s_cbranch_scc1 L_100095
L_100096:
L_100094:
  s_waitcnt vmcnt(5)
  s_add_u32 m0, s64, 0
  s_add_u32 s58, s67, 57344
  buffer_load_dwordx4 v29, s[20:23], s58 offen sc1 lds
  s_waitcnt vmcnt(5)
  s_add_u32 m0, s64, 4096
  s_add_u32 s58, s67, 61440
  buffer_load_dwordx4 v29, s[20:23], s58 offen sc1 lds
  s_waitcnt vmcnt(5)
  s_add_u32 m0, s64, 8192
  s_add_u32 s58, s67, 65536
  buffer_load_dwordx4 v29, s[20:23], s58 offen sc1 lds
  s_waitcnt vmcnt(5)
  s_add_u32 m0, s64, 12288
  s_add_u32 s58, s67, 69632
  buffer_load_dwordx4 v29, s[20:23], s58 offen sc1 lds
  s_waitcnt vmcnt(5)
  s_add_u32 m0, s64, 16384
  s_add_u32 s58, s67, 73728
  buffer_load_dwordx4 v29, s[20:23], s58 offen sc1 lds
  s_waitcnt vmcnt(5)
  s_add_u32 m0, s64, 20480
  s_add_u32 s58, s67, 77824
  buffer_load_dwordx4 v29, s[20:23], s58 offen sc1 lds
  s_waitcnt vmcnt(5)
  s_add_u32 m0, s64, 24576
  s_add_u32 s58, s67, 81920
  buffer_load_dwordx4 v29, s[20:23], s58 offen sc1 lds
  v_mov_b32 v10, 32
  ds_write_b32 v11, v10
  s_waitcnt lgkmcnt(0)
  ds_read_b128 v[12:15], v8 offset:16
  s_waitcnt lgkmcnt(0)
  v_min3_u32 v12, v12, v13, v14
  v_min_u32 v12, v12, v15
  s_nop 0
  v_readfirstlane_b32 s56, v12
  s_nop 3
  s_cmp_ge_u32 s56, 28
  s_cbranch_scc1 L_100097
  s_waitcnt vmcnt(0)
  v_mov_b32 v10, 33
  ds_write_b32 v11, v10 offset:0
  s_waitcnt lgkmcnt(0)
  s_mov_b32 s57, 0
L_100098:
  ds_read_b128 v[12:15], v8 offset:16
  s_waitcnt lgkmcnt(0)
  v_min3_u32 v12, v12, v13, v14
  v_min_u32 v12, v12, v15
  s_nop 0
  v_readfirstlane_b32 s56, v12
  s_nop 3
  s_cmp_ge_u32 s56, 28
  s_cbranch_scc1 L_100099
  s_add_u32 s57, s57, 1
  s_sleep 1
  s_cmp_lt_u32 s57, 0x400000
  s_cbranch_scc1 L_100098
L_100099:
L_100097:
  s_waitcnt vmcnt(5)
  s_add_u32 m0, s64, 28672
  s_add_u32 s58, s67, 86016
  buffer_load_dwordx4 v29, s[20:23], s58 offen sc1 lds
  s_waitcnt vmcnt(5)
  s_add_u32 m0, s64, 32768
  s_add_u32 s58, s67, 90112
  buffer_load_dwordx4 v29, s[20:23], s58 offen sc1 lds
  s_waitcnt vmcnt(5)
  s_add_u32 m0, s64, 36864
  s_add_u32 s58, s67, 94208
  buffer_load_dwordx4 v29, s[20:23], s58 offen sc1 lds
  s_waitcnt vmcnt(5)
  s_add_u32 m0, s64, 40960
  s_add_u32 s58, s67, 98304
  buffer_load_dwordx4 v29, s[20:23], s58 offen sc1 lds
  s_waitcnt vmcnt(5)
  s_add_u32 m0, s64, 45056
  s_add_u32 s58, s67, 102400
  buffer_load_dwordx4 v29, s[20:23], s58 offen sc1 lds
  s_waitcnt vmcnt(5)
  s_add_u32 m0, s64, 49152
  s_add_u32 s58, s67, 106496
  buffer_load_dwordx4 v29, s[20:23], s58 offen sc1 lds
  s_waitcnt vmcnt(5)
  s_add_u32 m0, s64, 53248
  s_add_u32 s58, s67, 110592
  buffer_load_dwordx4 v29, s[20:23], s58 offen sc1 lds
  v_mov_b32 v10, 33
  ds_write_b32 v11, v10
  s_waitcnt lgkmcnt(0)
  ds_read_b128 v[12:15], v8 offset:16
  s_waitcnt lgkmcnt(0)
  v_min3_u32 v12, v12, v13, v14
  v_min_u32 v12, v12, v15
  s_nop 0
  v_readfirstlane_b32 s56, v12
  s_nop 3
  s_cmp_ge_u32 s56, 30
  s_cbranch_scc1 L_100100
  s_waitcnt vmcnt(0)
  v_mov_b32 v10, 34
  ds_write_b32 v11, v10 offset:0
  s_waitcnt lgkmcnt(0)
  s_mov_b32 s57, 0
L_100101:
  ds_read_b128 v[12:15], v8 offset:16
  s_waitcnt lgkmcnt(0)
  v_min3_u32 v12, v12, v13, v14
  v_min_u32 v12, v12, v15
  s_nop 0
  v_readfirstlane_b32 s56, v12
  s_nop 3
  s_cmp_ge_u32 s56, 30
  s_cbranch_scc1 L_100102
  s_add_u32 s57, s57, 1
  s_sleep 1
  s_cmp_lt_u32 s57, 0x400000
  s_cbranch_scc1 L_100101
L_100102:
L_100100:
  s_waitcnt vmcnt(5)
  s_add_u32 m0, s64, 57344
  s_add_u32 s58, s67, 114688
  buffer_load_dwordx4 v29, s[20:23], s58 offen sc1 lds
  s_waitcnt vmcnt(5)
  s_add_u32 m0, s64, 61440
  s_add_u32 s58, s67, 118784
  buffer_load_dwordx4 v29, s[20:23], s58 offen sc1 lds
  s_waitcnt vmcnt(5)
  s_add_u32 m0, s64, 65536
  s_add_u32 s58, s67, 122880
  buffer_load_dwordx4 v29, s[20:23], s58 offen sc1 lds
  s_waitcnt vmcnt(5)
  s_add_u32 m0, s64, 69632
  s_add_u32 s58, s67, 126976
  buffer_load_dwordx4 v29, s[20:23], s58 offen sc1 lds
  s_waitcnt vmcnt(5)
  s_add_u32 m0, s64, 73728
  s_add_u32 s58, s67, 131072
  buffer_load_dwordx4 v29, s[20:23], s58 offen sc1 lds
  s_waitcnt vmcnt(5)
  s_add_u32 m0, s64, 77824
  s_add_u32 s58, s67, 135168
  buffer_load_dwordx4 v29, s[20:23], s58 offen sc1 lds
  s_waitcnt vmcnt(5)
  s_add_u32 m0, s64, 81920
  s_add_u32 s58, s67, 139264
  buffer_load_dwordx4 v29, s[20:23], s58 offen sc1 lds
  v_mov_b32 v10, 34
  ds_write_b32 v11, v10
  s_waitcnt lgkmcnt(0)
  ds_read_b128 v[12:15], v8 offset:16
  s_waitcnt lgkmcnt(0)
  v_min3_u32 v12, v12, v13, v14
  v_min_u32 v12, v12, v15
  s_nop 0
  v_readfirstlane_b32 s56, v12
  s_nop 3
  s_cmp_ge_u32 s56, 31
  s_cbranch_scc1 L_100103
  s_waitcnt vmcnt(0)
  v_mov_b32 v10, 35
  ds_write_b32 v11, v10 offset:0
  s_waitcnt lgkmcnt(0)
  s_mov_b32 s57, 0
L_100104:
  ds_read_b128 v[12:15], v8 offset:16
  s_waitcnt lgkmcnt(0)
  v_min3_u32 v12, v12, v13, v14
  v_min_u32 v12, v12, v15
  s_nop 0
  v_readfirstlane_b32 s56, v12
  s_nop 3
  s_cmp_ge_u32 s56, 31
  s_cbranch_scc1 L_100105
  s_add_u32 s57, s57, 1
  s_sleep 1
  s_cmp_lt_u32 s57, 0x400000
  s_cbranch_scc1 L_100104
L_100105:
L_100103:
  s_add_u32 m0, s64, 102400
  s_add_u32 s58, s68, 0
  buffer_load_dwordx4 v29, s[20:23], s58 offen sc1 lds
  s_add_u32 m0, s64, 106496
  s_add_u32 s58, s68, 4096
  buffer_load_dwordx4 v29, s[20:23], s58 offen sc1 lds
  s_waitcnt vmcnt(7)
  s_add_u32 m0, s64, 110592
  s_add_u32 s58, s68, 8192
  buffer_load_dwordx4 v29, s[20:23], s58 offen sc1 lds
  s_waitcnt vmcnt(7)
  s_add_u32 m0, s64, 114688
  s_add_u32 s58, s68, 12288
  buffer_load_dwordx4 v29, s[20:23], s58 offen sc1 lds
  s_waitcnt vmcnt(7)
  s_add_u32 m0, s64, 118784
  s_add_u32 s58, s68, 16384
  buffer_load_dwordx4 v29, s[20:23], s58 offen sc1 lds
  s_waitcnt vmcnt(5)
  v_mov_b32 v10, 35
  ds_write_b32 v11, v10
  s_waitcnt lgkmcnt(0)
  ds_read_b128 v[12:15], v8 offset:16
  s_waitcnt lgkmcnt(0)
  v_min3_u32 v12, v12, v13, v14
  v_min_u32 v12, v12, v15
  s_nop 0
  v_readfirstlane_b32 s56, v12
  s_nop 3
  s_cmp_ge_u32 s56, 32
  s_cbranch_scc1 L_100106
  s_waitcnt vmcnt(0)
  v_mov_b32 v10, 36
  ds_write_b32 v11, v10 offset:0
  s_waitcnt lgkmcnt(0)
  s_mov_b32 s57, 0
L_100107:
  ds_read_b128 v[12:15], v8 offset:16
  s_waitcnt lgkmcnt(0)
  v_min3_u32 v12, v12, v13, v14
  v_min_u32 v12, v12, v15
  s_nop 0
  v_readfirstlane_b32 s56, v12
  s_nop 3
  s_cmp_ge_u32 s56, 32
  s_cbranch_scc1 L_100108
  s_add_u32 s57, s57, 1
  s_sleep 1
  s_cmp_lt_u32 s57, 0x400000
  s_cbranch_scc1 L_100107
L_100108:
L_100106:
  s_add_u32 m0, s64, 122880
  s_add_u32 s58, s68, 20480
  buffer_load_dwordx4 v29, s[20:23], s58 offen sc1 lds
  s_add_u32 m0, s64, 126976
  s_add_u32 s58, s68, 24576
  buffer_load_dwordx4 v29, s[20:23], s58 offen sc1 lds
  s_add_u32 m0, s64, 131072
  s_add_u32 s58, s68, 28672
  buffer_load_dwordx4 v29, s[20:23], s58 offen sc1 lds
  s_waitcnt vmcnt(7)
  s_add_u32 m0, s64, 135168
  s_add_u32 s58, s68, 32768
  buffer_load_dwordx4 v29, s[20:23], s58 offen sc1 lds
  s_waitcnt vmcnt(7)
  s_add_u32 m0, s64, 139264
  s_add_u32 s58, s68, 36864
  buffer_load_dwordx4 v29, s[20:23], s58 offen sc1 lds
  s_waitcnt vmcnt(5)
  v_mov_b32 v10, 36
  ds_write_b32 v11, v10
  s_waitcnt lgkmcnt(0)
  ds_read_b128 v[12:15], v8 offset:16
  s_waitcnt lgkmcnt(0)
  v_min3_u32 v12, v12, v13, v14
  v_min_u32 v12, v12, v15
  s_nop 0
  v_readfirstlane_b32 s56, v12
  s_nop 3
  s_cmp_ge_u32 s56, 33
  s_cbranch_scc1 L_100109
  s_waitcnt vmcnt(0)
  v_mov_b32 v10, 37
  ds_write_b32 v11, v10 offset:0
  s_waitcnt lgkmcnt(0)
  s_mov_b32 s57, 0
L_100110:
  ds_read_b128 v[12:15], v8 offset:16
  s_waitcnt lgkmcnt(0)
  v_min3_u32 v12, v12, v13, v14
  v_min_u32 v12, v12, v15
  s_nop 0
  v_readfirstlane_b32 s56, v12
  s_nop 3
  s_cmp_ge_u32 s56, 33
  s_cbranch_scc1 L_100111
  s_add_u32 s57, s57, 1
  s_sleep 1
  s_cmp_lt_u32 s57, 0x400000
  s_cbranch_scc1 L_100110
L_100111:
L_100109:
  s_add_u32 m0, s64, 0
  s_add_u32 s58, s68, 40960
  buffer_load_dwordx4 v29, s[20:23], s58 offen sc1 lds
  s_add_u32 m0, s64, 4096
  s_add_u32 s58, s68, 45056
  buffer_load_dwordx4 v29, s[20:23], s58 offen sc1 lds
  s_add_u32 m0, s64, 8192
  s_add_u32 s58, s68, 49152
  buffer_load_dwordx4 v29, s[20:23], s58 offen sc1 lds
  s_waitcnt vmcnt(7)
  s_add_u32 m0, s64, 12288
  s_add_u32 s58, s68, 53248
  buffer_load_dwordx4 v29, s[20:23], s58 offen sc1 lds
  s_waitcnt vmcnt(7)
  s_add_u32 m0, s64, 16384
  s_add_u32 s58, s68, 57344
  buffer_load_dwordx4 v29, s[20:23], s58 offen sc1 lds
  s_waitcnt vmcnt(5)
  v_mov_b32 v10, 37
  ds_write_b32 v11, v10
  s_waitcnt lgkmcnt(0)
  ds_read_b128 v[12:15], v8 offset:16
  s_waitcnt lgkmcnt(0)
  v_min3_u32 v12, v12, v13, v14
  v_min_u32 v12, v12, v15
  s_nop 0
  v_readfirstlane_b32 s56, v12
  s_nop 3
  s_cmp_ge_u32 s56, 34
  s_cbranch_scc1 L_100112
  s_waitcnt vmcnt(0)
  v_mov_b32 v10, 38
  ds_write_b32 v11, v10 offset:0
  s_waitcnt lgkmcnt(0)
  s_mov_b32 s57, 0
L_100113:
  ds_read_b128 v[12:15], v8 offset:16
  s_waitcnt lgkmcnt(0)
  v_min3_u32 v12, v12, v13, v14
  v_min_u32 v12, v12, v15
  s_nop 0
  v_readfirstlane_b32 s56, v12
  s_nop 3
  s_cmp_ge_u32 s56, 34
  s_cbranch_scc1 L_100114
  s_add_u32 s57, s57, 1
  s_sleep 1
  s_cmp_lt_u32 s57, 0x400000
  s_cbranch_scc1 L_100113
L_100114:
L_100112:
  s_add_u32 m0, s64, 20480
  s_add_u32 s58, s68, 61440
  buffer_load_dwordx4 v29, s[20:23], s58 offen sc1 lds
  s_add_u32 m0, s64, 24576
  s_add_u32 s58, s68, 65536
  buffer_load_dwordx4 v29, s[20:23], s58 offen sc1 lds
  s_add_u32 m0, s64, 28672
  s_add_u32 s58, s68, 69632
  buffer_load_dwordx4 v29, s[20:23], s58 offen sc1 lds
  s_waitcnt vmcnt(7)
  s_add_u32 m0, s64, 32768
  s_add_u32 s58, s68, 73728
  buffer_load_dwordx4 v29, s[20:23], s58 offen sc1 lds
  s_waitcnt vmcnt(7)
  s_add_u32 m0, s64, 36864
  s_add_u32 s58, s68, 77824
  buffer_load_dwordx4 v29, s[20:23], s58 offen sc1 lds
  s_waitcnt vmcnt(5)
  v_mov_b32 v10, 38
  ds_write_b32 v11, v10
  s_waitcnt lgkmcnt(0)
  ds_read_b128 v[12:15], v8 offset:16
  s_waitcnt lgkmcnt(0)
  v_min3_u32 v12, v12, v13, v14
  v_min_u32 v12, v12, v15
  s_nop 0
  v_readfirstlane_b32 s56, v12
  s_nop 3
  s_cmp_ge_u32 s56, 35
  s_cbranch_scc1 L_100115
  s_waitcnt vmcnt(0)
  v_mov_b32 v10, 39
  ds_write_b32 v11, v10 offset:0
  s_waitcnt lgkmcnt(0)
  s_mov_b32 s57, 0
L_100116:
  ds_read_b128 v[12:15], v8 offset:16
  s_waitcnt lgkmcnt(0)
  v_min3_u32 v12, v12, v13, v14
  v_min_u32 v12, v12, v15
  s_nop 0
  v_readfirstlane_b32 s56, v12
  s_nop 3
  s_cmp_ge_u32 s56, 35
  s_cbranch_scc1 L_100117
  s_add_u32 s57, s57, 1
  s_sleep 1
  s_cmp_lt_u32 s57, 0x400000
  s_cbranch_scc1 L_100116
L_100117:
L_100115:
  s_add_u32 m0, s64, 40960
  s_add_u32 s58, s68, 81920
  buffer_load_dwordx4 v29, s[20:23], s58 offen sc1 lds
  s_add_u32 m0, s64, 45056
  s_add_u32 s58, s68, 86016
  buffer_load_dwordx4 v29, s[20:23], s58 offen sc1 lds
  s_add_u32 m0, s64, 49152
  s_add_u32 s58, s68, 90112
  buffer_load_dwordx4 v29, s[20:23], s58 offen sc1 lds
  s_waitcnt vmcnt(7)
  s_add_u32 m0, s64, 53248
  s_add_u32 s58, s68, 94208
  buffer_load_dwordx4 v29, s[20:23], s58 offen sc1 lds
  s_waitcnt vmcnt(7)
  s_add_u32 m0, s64, 57344
  s_add_u32 s58, s68, 98304
  buffer_load_dwordx4 v29, s[20:23], s58 offen sc1 lds
  s_waitcnt vmcnt(5)
  v_mov_b32 v10, 39
  ds_write_b32 v11, v10
  s_waitcnt lgkmcnt(0)
  ds_read_b128 v[12:15], v8 offset:16
  s_waitcnt lgkmcnt(0)
  v_min3_u32 v12, v12, v13, v14
  v_min_u32 v12, v12, v15
  s_nop 0
  v_readfirstlane_b32 s56, v12
  s_nop 3
  s_cmp_ge_u32 s56, 35
  s_cbranch_scc1 L_100118
  s_waitcnt vmcnt(0)
  v_mov_b32 v10, 40
  ds_write_b32 v11, v10 offset:0
  s_waitcnt lgkmcnt(0)
  s_mov_b32 s57, 0
L_100119:
  ds_read_b128 v[12:15], v8 offset:16
  s_waitcnt lgkmcnt(0)
  v_min3_u32 v12, v12, v13, v14
  v_min_u32 v12, v12, v15
  s_nop 0
  v_readfirstlane_b32 s56, v12
  s_nop 3
  s_cmp_ge_u32 s56, 35
  s_cbranch_scc1 L_100120
  s_add_u32 s57, s57, 1
  s_sleep 1
  s_cmp_lt_u32 s57, 0x400000
  s_cbranch_scc1 L_100119
L_100120:
L_100118:
  s_add_u32 m0, s64, 61440
  s_add_u32 s58, s68, 102400
  buffer_load_dwordx4 v29, s[20:23], s58 offen sc1 lds
  s_add_u32 m0, s64, 65536
  s_add_u32 s58, s68, 106496
  buffer_load_dwordx4 v29, s[20:23], s58 offen sc1 lds
  s_add_u32 m0, s64, 69632
  s_add_u32 s58, s68, 110592
  buffer_load_dwordx4 v29, s[20:23], s58 offen sc1 lds
  s_waitcnt vmcnt(7)
  s_add_u32 m0, s64, 73728
  s_add_u32 s58, s68, 114688
  buffer_load_dwordx4 v29, s[20:23], s58 offen sc1 lds
  s_waitcnt vmcnt(7)
  s_add_u32 m0, s64, 77824
  s_add_u32 s58, s68, 118784
  buffer_load_dwordx4 v29, s[20:23], s58 offen sc1 lds
  s_waitcnt vmcnt(5)
  v_mov_b32 v10, 40
  ds_write_b32 v11, v10
  s_waitcnt lgkmcnt(0)
  ds_read_b128 v[12:15], v8 offset:16
  s_waitcnt lgkmcnt(0)
  v_min3_u32 v12, v12, v13, v14
  v_min_u32 v12, v12, v15
  s_nop 0
  v_readfirstlane_b32 s56, v12
  s_nop 3
  s_cmp_ge_u32 s56, 35
  s_cbranch_scc1 L_100121
  s_waitcnt vmcnt(0)
  v_mov_b32 v10, 41
  ds_write_b32 v11, v10 offset:0
  s_waitcnt lgkmcnt(0)
  s_mov_b32 s57, 0
L_100122:
  ds_read_b128 v[12:15], v8 offset:16
  s_waitcnt lgkmcnt(0)
  v_min3_u32 v12, v12, v13, v14
  v_min_u32 v12, v12, v15
  s_nop 0
  v_readfirstlane_b32 s56, v12
  s_nop 3
  s_cmp_ge_u32 s56, 35
  s_cbranch_scc1 L_100123
  s_add_u32 s57, s57, 1
  s_sleep 1
  s_cmp_lt_u32 s57, 0x400000
  s_cbranch_scc1 L_100122
L_100123:
L_100121:
  s_add_u32 m0, s64, 81920
  s_add_u32 s58, s68, 122880
  buffer_load_dwordx4 v29, s[20:23], s58 offen sc1 lds
  s_add_u32 m0, s64, 86016
  s_add_u32 s58, s68, 126976
  buffer_load_dwordx4 v29, s[20:23], s58 offen sc1 lds
  s_add_u32 m0, s64, 90112
  s_add_u32 s58, s68, 131072
  buffer_load_dwordx4 v29, s[20:23], s58 offen sc1 lds
  s_waitcnt vmcnt(7)
  s_add_u32 m0, s64, 94208
  s_add_u32 s58, s68, 135168
  buffer_load_dwordx4 v29, s[20:23], s58 offen sc1 lds
  s_waitcnt vmcnt(7)
  s_add_u32 m0, s64, 98304
  s_add_u32 s58, s68, 139264
  buffer_load_dwordx4 v29, s[20:23], s58 offen sc1 lds
  s_waitcnt vmcnt(5)
  v_mov_b32 v10, 41
  ds_write_b32 v11, v10
  s_waitcnt lgkmcnt(0)
  ds_read_b128 v[12:15], v8 offset:16
  s_waitcnt lgkmcnt(0)
  v_min3_u32 v12, v12, v13, v14
  v_min_u32 v12, v12, v15
  s_nop 0
  v_readfirstlane_b32 s56, v12
  s_nop 3
  s_cmp_ge_u32 s56, 36
  s_cbranch_scc1 L_100124
  s_waitcnt vmcnt(0)
  v_mov_b32 v10, 42
  ds_write_b32 v11, v10 offset:0
  s_waitcnt lgkmcnt(0)
  s_mov_b32 s57, 0
L_100125:
  ds_read_b128 v[12:15], v8 offset:16
  s_waitcnt lgkmcnt(0)
  v_min3_u32 v12, v12, v13, v14
  v_min_u32 v12, v12, v15
  s_nop 0
  v_readfirstlane_b32 s56, v12
  s_nop 3
  s_cmp_ge_u32 s56, 36
  s_cbranch_scc1 L_100126
  s_add_u32 s57, s57, 1
  s_sleep 1
  s_cmp_lt_u32 s57, 0x400000
  s_cbranch_scc1 L_100125
L_100126:
L_100124:
  s_add_u32 m0, s64, 102400
  s_add_u32 s58, s68, 143360
  buffer_load_dwordx4 v29, s[20:23], s58 offen sc1 lds
  s_add_u32 m0, s64, 106496
  s_add_u32 s58, s68, 147456
  buffer_load_dwordx4 v29, s[20:23], s58 offen sc1 lds
  s_add_u32 m0, s64, 110592
  s_add_u32 s58, s68, 151552
  buffer_load_dwordx4 v29, s[20:23], s58 offen sc1 lds
  s_waitcnt vmcnt(7)
  s_add_u32 m0, s64, 114688
  s_add_u32 s58, s68, 155648
  buffer_load_dwordx4 v29, s[20:23], s58 offen sc1 lds
  s_waitcnt vmcnt(7)
  s_add_u32 m0, s64, 118784
  s_add_u32 s58, s68, 159744
  buffer_load_dwordx4 v29, s[20:23], s58 offen sc1 lds
  s_waitcnt vmcnt(5)
  v_mov_b32 v10, 42
  ds_write_b32 v11, v10
  s_waitcnt lgkmcnt(0)
  ds_read_b128 v[12:15], v8 offset:16
  s_waitcnt lgkmcnt(0)
  v_min3_u32 v12, v12, v13, v14
  v_min_u32 v12, v12, v15
  s_nop 0
  v_readfirstlane_b32 s56, v12
  s_nop 3
  s_cmp_ge_u32 s56, 37
  s_cbranch_scc1 L_100127
  s_waitcnt vmcnt(0)
  v_mov_b32 v10, 43
  ds_write_b32 v11, v10 offset:0
  s_waitcnt lgkmcnt(0)
  s_mov_b32 s57, 0
L_100128:
  ds_read_b128 v[12:15], v8 offset:16
  s_waitcnt lgkmcnt(0)
  v_min3_u32 v12, v12, v13, v14
  v_min_u32 v12, v12, v15
  s_nop 0
  v_readfirstlane_b32 s56, v12
  s_nop 3
  s_cmp_ge_u32 s56, 37
  s_cbranch_scc1 L_100129
  s_add_u32 s57, s57, 1
  s_sleep 1
  s_cmp_lt_u32 s57, 0x400000
  s_cbranch_scc1 L_100128
L_100129:
L_100127:
  s_add_u32 m0, s64, 122880
  s_add_u32 s58, s68, 163840
  buffer_load_dwordx4 v29, s[20:23], s58 offen sc1 lds
  s_add_u32 m0, s64, 126976
  s_add_u32 s58, s68, 167936
  buffer_load_dwordx4 v29, s[20:23], s58 offen sc1 lds
  s_add_u32 m0, s64, 131072
  s_add_u32 s58, s68, 172032
  buffer_load_dwordx4 v29, s[20:23], s58 offen sc1 lds
  s_waitcnt vmcnt(7)
  s_add_u32 m0, s64, 135168
  s_add_u32 s58, s68, 176128
  buffer_load_dwordx4 v29, s[20:23], s58 offen sc1 lds
  s_waitcnt vmcnt(7)
  s_add_u32 m0, s64, 139264
  s_add_u32 s58, s68, 180224
  buffer_load_dwordx4 v29, s[20:23], s58 offen sc1 lds
  s_waitcnt vmcnt(5)
  v_mov_b32 v10, 43
  ds_write_b32 v11, v10
  s_waitcnt lgkmcnt(0)
  ds_read_b128 v[12:15], v8 offset:16
  s_waitcnt lgkmcnt(0)
  v_min3_u32 v12, v12, v13, v14
  v_min_u32 v12, v12, v15
  s_nop 0
  v_readfirstlane_b32 s56, v12
  s_nop 3
  s_cmp_ge_u32 s56, 38
  s_cbranch_scc1 L_100130
  s_waitcnt vmcnt(0)
  v_mov_b32 v10, 44
  ds_write_b32 v11, v10 offset:0
  s_waitcnt lgkmcnt(0)
  s_mov_b32 s57, 0
L_100131:
  ds_read_b128 v[12:15], v8 offset:16
  s_waitcnt lgkmcnt(0)
  v_min3_u32 v12, v12, v13, v14
  v_min_u32 v12, v12, v15
  s_nop 0
  v_readfirstlane_b32 s56, v12
  s_nop 3
  s_cmp_ge_u32 s56, 38
  s_cbranch_scc1 L_100132
  s_add_u32 s57, s57, 1
  s_sleep 1
  s_cmp_lt_u32 s57, 0x400000
  s_cbranch_scc1 L_100131
L_100132:
L_100130:
  s_add_u32 m0, s64, 0
  s_add_u32 s58, s68, 184320
  buffer_load_dwordx4 v29, s[20:23], s58 offen sc1 lds
  s_add_u32 m0, s64, 4096
  s_add_u32 s58, s68, 188416
  buffer_load_dwordx4 v29, s[20:23], s58 offen sc1 lds
  s_add_u32 m0, s64, 8192
  s_add_u32 s58, s68, 192512
  buffer_load_dwordx4 v29, s[20:23], s58 offen sc1 lds
  s_waitcnt vmcnt(7)
  s_add_u32 m0, s64, 12288
  s_add_u32 s58, s68, 196608
  buffer_load_dwordx4 v29, s[20:23], s58 offen sc1 lds
  s_waitcnt vmcnt(7)
  s_add_u32 m0, s64, 16384
  s_add_u32 s58, s68, 200704
  buffer_load_dwordx4 v29, s[20:23], s58 offen sc1 lds
  s_waitcnt vmcnt(5)
  v_mov_b32 v10, 44
  ds_write_b32 v11, v10
  s_waitcnt lgkmcnt(0)
  ds_read_b128 v[12:15], v8 offset:16
  s_waitcnt lgkmcnt(0)
  v_min3_u32 v12, v12, v13, v14
  v_min_u32 v12, v12, v15
  s_nop 0
  v_readfirstlane_b32 s56, v12
  s_nop 3
  s_cmp_ge_u32 s56, 39
  s_cbranch_scc1 L_100133
  s_waitcnt vmcnt(0)
  v_mov_b32 v10, 45
  ds_write_b32 v11, v10 offset:0
  s_waitcnt lgkmcnt(0)
  s_mov_b32 s57, 0
L_100134:
  ds_read_b128 v[12:15], v8 offset:16
  s_waitcnt lgkmcnt(0)
  v_min3_u32 v12, v12, v13, v14
  v_min_u32 v12, v12, v15
  s_nop 0
  v_readfirstlane_b32 s56, v12
  s_nop 3
  s_cmp_ge_u32 s56, 39
  s_cbranch_scc1 L_100135
  s_add_u32 s57, s57, 1
  s_sleep 1
  s_cmp_lt_u32 s57, 0x400000
  s_cbranch_scc1 L_100134
L_100135:
L_100133:
  s_add_u32 m0, s64, 20480
  s_add_u32 s58, s68, 204800
  buffer_load_dwordx4 v29, s[20:23], s58 offen sc1 lds
  s_add_u32 m0, s64, 24576
  s_add_u32 s58, s68, 208896
  buffer_load_dwordx4 v29, s[20:23], s58 offen sc1 lds
  s_add_u32 m0, s64, 28672
  s_add_u32 s58, s68, 212992
  buffer_load_dwordx4 v29, s[20:23], s58 offen sc1 lds
  s_waitcnt vmcnt(7)
  s_add_u32 m0, s64, 32768
  s_add_u32 s58, s68, 217088
  buffer_load_dwordx4 v29, s[20:23], s58 offen sc1 lds
  s_waitcnt vmcnt(7)
  s_add_u32 m0, s64, 36864
  s_add_u32 s58, s68, 221184
  buffer_load_dwordx4 v29, s[20:23], s58 offen sc1 lds
  s_waitcnt vmcnt(5)
  v_mov_b32 v10, 45
  ds_write_b32 v11, v10
  s_waitcnt lgkmcnt(0)
  ds_read_b128 v[12:15], v8 offset:16
  s_waitcnt lgkmcnt(0)
  v_min3_u32 v12, v12, v13, v14
  v_min_u32 v12, v12, v15
  s_nop 0
  v_readfirstlane_b32 s56, v12
  s_nop 3
  s_cmp_ge_u32 s56, 40
  s_cbranch_scc1 L_100136
  s_waitcnt vmcnt(0)
  v_mov_b32 v10, 46
  ds_write_b32 v11, v10 offset:0
  s_waitcnt lgkmcnt(0)
  s_mov_b32 s57, 0
L_100137:
  ds_read_b128 v[12:15], v8 offset:16
  s_waitcnt lgkmcnt(0)
  v_min3_u32 v12, v12, v13, v14
  v_min_u32 v12, v12, v15
  s_nop 0
  v_readfirstlane_b32 s56, v12
  s_nop 3
  s_cmp_ge_u32 s56, 40
  s_cbranch_scc1 L_100138
  s_add_u32 s57, s57, 1
  s_sleep 1
  s_cmp_lt_u32 s57, 0x400000
  s_cbranch_scc1 L_100137
L_100138:
L_100136:
  s_add_u32 m0, s64, 40960
  s_add_u32 s58, s68, 225280
  buffer_load_dwordx4 v29, s[20:23], s58 offen sc1 lds
  s_add_u32 m0, s64, 45056
  s_add_u32 s58, s68, 229376
  buffer_load_dwordx4 v29, s[20:23], s58 offen sc1 lds
  s_add_u32 m0, s64, 49152
  s_add_u32 s58, s68, 233472
  buffer_load_dwordx4 v29, s[20:23], s58 offen sc1 lds
  s_waitcnt vmcnt(7)
  s_add_u32 m0, s64, 53248
  s_add_u32 s58, s68, 237568
  buffer_load_dwordx4 v29, s[20:23], s58 offen sc1 lds
  s_waitcnt vmcnt(7)
  s_add_u32 m0, s64, 57344
  s_add_u32 s58, s68, 241664
  buffer_load_dwordx4 v29, s[20:23], s58 offen sc1 lds
  s_waitcnt vmcnt(5)
  v_mov_b32 v10, 46
  ds_write_b32 v11, v10
  s_waitcnt lgkmcnt(0)
  ds_read_b128 v[12:15], v8 offset:16
  s_waitcnt lgkmcnt(0)
  v_min3_u32 v12, v12, v13, v14
  v_min_u32 v12, v12, v15
  s_nop 0
  v_readfirstlane_b32 s56, v12
  s_nop 3
  s_cmp_ge_u32 s56, 41
  s_cbranch_scc1 L_100139
  s_waitcnt vmcnt(0)
  v_mov_b32 v10, 47
  ds_write_b32 v11, v10 offset:0
  s_waitcnt lgkmcnt(0)
  s_mov_b32 s57, 0
L_100140:
  ds_read_b128 v[12:15], v8 offset:16
  s_waitcnt lgkmcnt(0)
  v_min3_u32 v12, v12, v13, v14
  v_min_u32 v12, v12, v15
  s_nop 0
  v_readfirstlane_b32 s56, v12
  s_nop 3
  s_cmp_ge_u32 s56, 41
  s_cbranch_scc1 L_100141
  s_add_u32 s57, s57, 1
  s_sleep 1
  s_cmp_lt_u32 s57, 0x400000
  s_cbranch_scc1 L_100140
L_100141:
L_100139:
  s_add_u32 m0, s64, 61440
  s_add_u32 s58, s68, 245760
  buffer_load_dwordx4 v29, s[20:23], s58 offen sc1 lds
  s_add_u32 m0, s64, 65536
  s_add_u32 s58, s68, 249856
  buffer_load_dwordx4 v29, s[20:23], s58 offen sc1 lds
  s_add_u32 m0, s64, 69632
  s_add_u32 s58, s68, 253952
  buffer_load_dwordx4 v29, s[20:23], s58 offen sc1 lds
  s_waitcnt vmcnt(7)
  s_add_u32 m0, s64, 73728
  s_add_u32 s58, s68, 258048
  buffer_load_dwordx4 v29, s[20:23], s58 offen sc1 lds
  s_waitcnt vmcnt(7)
  s_add_u32 m0, s64, 77824
  s_add_u32 s58, s68, 262144
  buffer_load_dwordx4 v29, s[20:23], s58 offen sc1 lds
  s_waitcnt vmcnt(5)
  v_mov_b32 v10, 47
  ds_write_b32 v11, v10
  s_waitcnt lgkmcnt(0)
  ds_read_b128 v[12:15], v8 offset:16
  s_waitcnt lgkmcnt(0)
  v_min3_u32 v12, v12, v13, v14
  v_min_u32 v12, v12, v15
  s_nop 0
  v_readfirstlane_b32 s56, v12
  s_nop 3
  s_cmp_ge_u32 s56, 42
  s_cbranch_scc1 L_100142
  s_waitcnt vmcnt(0)
  v_mov_b32 v10, 48
  ds_write_b32 v11, v10 offset:0
  s_waitcnt lgkmcnt(0)
  s_mov_b32 s57, 0
L_100143:
  ds_read_b128 v[12:15], v8 offset:16
  s_waitcnt lgkmcnt(0)
  v_min3_u32 v12, v12, v13, v14
  v_min_u32 v12, v12, v15
  s_nop 0
  v_readfirstlane_b32 s56, v12
  s_nop 3
  s_cmp_ge_u32 s56, 42
  s_cbranch_scc1 L_100144
  s_add_u32 s57, s57, 1
  s_sleep 1
  s_cmp_lt_u32 s57, 0x400000
  s_cbranch_scc1 L_100143
L_100144:
L_100142:
  s_add_u32 m0, s64, 81920
  s_add_u32 s58, s68, 266240
  buffer_load_dwordx4 v29, s[20:23], s58 offen sc1 lds
  s_add_u32 m0, s64, 86016
  s_add_u32 s58, s68, 270336
  buffer_load_dwordx4 v29, s[20:23], s58 offen sc1 lds
  s_add_u32 m0, s64, 90112
  s_add_u32 s58, s68, 274432
  buffer_load_dwordx4 v29, s[20:23], s58 offen sc1 lds
  s_waitcnt vmcnt(3)
  v_mov_b32 v10, 48
  ds_write_b32 v11, v10
  s_waitcnt vmcnt(0)
  v_mov_b32 v10, 49
  ds_write_b32 v11, v10
L_end:
  s_endpgm
.section .rodata,"a"
.p2align 6
.amdhsa_kernel sequential_preLN__linear_attn_block__mixer_s_mlp__prompt_kernel
  .amdhsa_next_free_vgpr 256
  .amdhsa_next_free_sgpr 96
  .amdhsa_accum_offset 256
  .amdhsa_group_segment_fixed_size 0
  .amdhsa_kernarg_size 88
  .amdhsa_user_sgpr_count 2
  .amdhsa_user_sgpr_kernarg_segment_ptr 1
  .amdhsa_system_sgpr_workgroup_id_x 1
.end_amdhsa_kernel
```
